```python
import torch

def _softmax(x, axis=-1):
    return torch.softmax(x, dim=axis)
def _gelu(x):
    return torch.nn.functional.gelu(x, approximate="tanh")
def _silu(x):
    return torch.nn.functional.silu(x)
def _sigmoid(x):
    return torch.sigmoid(x)
def _layernorm(x, axis=-1, eps=1e-5):
    m = x.mean(dim=axis, keepdim=True)
    v = x.var(dim=axis, keepdim=True, unbiased=False)
    return (x - m) / torch.sqrt(v + eps)
def _scatter_add(tgt, idx, src, axis=0):
    return tgt.clone().index_add_(axis, idx, src)
def _segment_sum(src, seg, n):
    out = torch.zeros((n,) + src.shape[1:], dtype=src.dtype)
    return out.index_add_(0, seg, src)
def _pad(x, pw):
    flat = tuple(v for pair in reversed(pw) for v in pair)
    return torch.nn.functional.pad(x, flat)

kernel_name = 'standalone__mha_block_cached__near_ridge'

def setup_inputs():

    _w = (lambda a: (lambda t: t.to(torch.bfloat16) if t.is_floating_point() else t)(torch.as_tensor(a)))
    B, Sq, D = 16, 192, 448
    H, Sk, Dh = 16, 512, 256
    return {
        "x": _w((lambda *s: torch.randn(*s, dtype=torch.bfloat16) * 0.8)(B, Sq, D)),
        "k_cache": _w((lambda *s: torch.randn(*s, dtype=torch.bfloat16) * 0.8)(B, H, Sk, Dh)),
        "v_cache": _w((lambda *s: torch.randn(*s, dtype=torch.bfloat16) * 0.05)(B, H, Sk, Dh)),
        "wq": _w((lambda *s: torch.randn(*s, dtype=torch.bfloat16) * 0.8)(D, H * Dh) * (D ** -0.5)),
        "wo": _w((lambda *s: torch.randn(*s, dtype=torch.bfloat16) * 0.05)(H * Dh, D) * ((H * Dh) ** -0.5)),
    }

def reference(x, k_cache, v_cache, wq, wo):
    B, Sq, D = x.shape
    H, Dh = 16, 256
    q = (lambda x, *d: x.permute(*d))((x @ wq).reshape(B, Sq, H, Dh), 0, 2, 1, 3)
    scores = torch.einsum("bhqd,bhkd->bhqk", q, k_cache) * (Dh ** -0.5)
    p = _softmax(scores, axis=-1)
    o = torch.einsum("bhqk,bhkd->bhqd", p, v_cache)
    return (lambda x, *d: x.permute(*d))(o, 0, 2, 1, 3).reshape(B, Sq, H * Dh) @ wo
```

```asm
; @launch grid=(256,1,1) block=(256,1,1) lds=163840
.amdgcn_target "amdgcn-amd-amdhsa--gfx950"
.text
.globl standalone__mha_block_cached__near_ridge_kernel
.p2align 8
.type standalone__mha_block_cached__near_ridge_kernel,@function
standalone__mha_block_cached__near_ridge_kernel:
    s_cmp_ge_u32 s2, 256
    s_cbranch_scc1 L_end
    s_load_dwordx16 s[16:31], s[0:1], 0
    v_lshrrev_b32 v211, 6, v0
    v_and_b32 v210, 63, v0
    v_readfirstlane_b32 s3, v211
    v_lshrrev_b32 v212, 4, v210
    v_and_b32 v213, 15, v210
    v_mov_b32 v221, v0
    s_and_b32 s6, s2, 7
    s_lshr_b32 s7, s2, 3
    s_lshr_b32 s4, s6, 2
    s_lshl_b32 s4, s4, 3
    s_lshr_b32 s12, s7, 2
    s_add_u32 s4, s4, s12
    s_and_b32 s75, s6, 3
    s_and_b32 s76, s7, 3
    s_lshl_b32 s5, s75, 2
    s_add_u32 s5, s5, s76
    s_lshl_b32 s10, s3, 12
    s_mul_i32 s11, s3, 6144
    v_lshrrev_b32 v214, 5, v210
    v_and_b32 v215, 1, v211
    v_lshlrev_b32 v215, 3, v215
    v_and_b32 v216, 31, v210
    v_lshl_add_u32 v220, v211, 3, v214
    v_lshlrev_b32 v220, 13, v220
    v_lshl_add_u32 v217, v214, 1, v215
    v_xor_b32 v217, v217, v216
    v_lshl_add_u32 v202, v217, 4, v220
    v_add_u32 v204, 30720, v202
    v_lshl_add_u32 v217, v214, 1, v215
    v_add_u32 v217, 4, v217
    v_xor_b32 v217, v217, v216
    v_lshl_add_u32 v203, v217, 4, v220
    v_add_u32 v203, 15360, v203
    v_add_u32 v205, 30720, v203
    v_mul_u32_u24 v220, 48, v211
    v_lshrrev_b32 v217, 3, v210
    v_add_u32 v220, v220, v217
    v_mul_u32_u24 v220, 896, v220
    v_and_b32 v217, 7, v210
    v_xor_b32 v217, v217, v212
    v_lshl_add_u32 v206, v217, 4, v220
    v_xor_b32 v217, 4, v217
    v_lshl_add_u32 v207, v217, 4, v220
    v_add_u32 v207, 6144, v207
    v_add_u32 v208, 12288, v206
    v_add_u32 v209, 12288, v207
    s_lshl_b32 s7, s5, 9
    s_mul_i32 s12, s4, 172032
    s_waitcnt lgkmcnt(0)
    s_add_u32 s36, s22, s7
    s_addc_u32 s37, s23, 0
    s_mov_b32 s38, 3662336
    s_mov_b32 s39, 0x20000
    s_add_u32 s32, s16, s12
    s_addc_u32 s33, s17, 0
    s_mov_b32 s34, 172032
    s_mov_b32 s35, 0x20000
    s_mov_b32 s9, 0
    s_add_u32 m0, s10, 0
    s_nop 0
    buffer_load_dwordx4 v202, s[36:39], s9 offen lds
    buffer_load_dwordx4 v203, s[36:39], s9 offen offset:1024 lds
    buffer_load_dwordx4 v204, s[36:39], s9 offen offset:2048 lds
    buffer_load_dwordx4 v205, s[36:39], s9 offen offset:3072 lds
    s_mov_b32 s72, 0
    s_add_u32 m0, s11, 65536
    s_nop 0
    buffer_load_dwordx4 v206, s[32:35], s72 offen lds
    buffer_load_dwordx4 v207, s[32:35], s72 offen offset:1024 lds
    buffer_load_dwordx4 v208, s[32:35], s72 offen offset:2048 lds
    buffer_load_dwordx4 v209, s[32:35], s72 offen offset:3072 lds
    s_mov_b32 s72, 28672
    s_add_u32 m0, s11, 69632
    s_nop 0
    buffer_load_dwordx4 v206, s[32:35], s72 offen lds
    buffer_load_dwordx4 v207, s[32:35], s72 offen offset:1024 lds
    s_getpc_b64 s[84:85]
    s_lshr_b32 s6, s2, 3
    s_lshl_b32 s6, s6, 2
    s_add_u32 s6, s6, s3
    s_lshl_b32 s6, s6, 9
    v_and_b32 v217, 3, v210
    v_lshlrev_b32 v217, 7, v217
    v_add_u32 v217, s6, v217
    global_load_dword a255, v217, s[84:85]
    s_lshl_b32 s6, s4, 4
    s_add_u32 s6, s6, s5
    s_lshl_b32 s7, s6, 18
    s_add_u32 s40, s18, s7
    s_addc_u32 s41, s19, 0
    s_mov_b32 s42, 262144
    s_mov_b32 s43, 0x20000
    s_add_u32 s44, s20, s7
    s_addc_u32 s45, s21, 0
    s_mov_b32 s46, 262144
    s_mov_b32 s47, 0x20000
    v_lshlrev_b32 v220, 9, v214
    v_lshl_add_u32 v220, v211, 12, v220
    v_add_u32 v214, v214, v215
    v_add_u32 v217, 0, v214
    v_xor_b32 v217, v217, v216
    v_lshl_add_u32 v244, v217, 4, v220
    v_add_u32 v217, 2, v214
    v_xor_b32 v217, v217, v216
    v_lshl_add_u32 v245, v217, 4, v220
    v_add_u32 v217, 4, v214
    v_xor_b32 v217, v217, v216
    v_lshl_add_u32 v246, v217, 4, v220
    v_add_u32 v217, 6, v214
    v_xor_b32 v217, v217, v216
    v_lshl_add_u32 v247, v217, 4, v220
    v_lshrrev_b32 v218, 2, v213
    v_and_b32 v219, 3, v213
    v_and_b32 v214, 1, v212
    v_lshl_add_u32 v214, v214, 2, v218
    v_lshlrev_b32 v214, 1, v214
    v_lshrrev_b32 v215, 1, v219
    v_lshl_add_u32 v216, v212, 3, v218
    v_lshlrev_b32 v216, 9, v216
    v_and_b32 v217, 1, v219
    v_lshl_add_u32 v216, v217, 3, v216
    v_xor_b32 v217, v215, v214
    v_lshl_add_u32 v192, v217, 4, v216
    v_xor_b32 v193, 32, v192
    v_xor_b32 v194, 64, v192
    v_xor_b32 v195, 96, v192
    v_xor_b32 v196, 128, v192
    v_xor_b32 v197, 160, v192
    v_xor_b32 v198, 192, v192
    v_xor_b32 v199, 224, v192
    v_lshrrev_b32 v217, 1, v213
    v_xor_b32 v217, v217, v212
    v_lshlrev_b32 v217, 4, v217
    v_lshl_add_u32 v200, v213, 7, v217
    v_add_u32 v200, s11, v200
    v_add_u32 v200, 65536, v200
    v_xor_b32 v201, 64, v200
    s_mov_b32 s9, 262144
    s_add_u32 m0, s10, 16384
    s_nop 0
    buffer_load_dwordx4 v202, s[36:39], s9 offen lds
    buffer_load_dwordx4 v203, s[36:39], s9 offen offset:1024 lds
    buffer_load_dwordx4 v204, s[36:39], s9 offen offset:2048 lds
    buffer_load_dwordx4 v205, s[36:39], s9 offen offset:3072 lds
    s_waitcnt vmcnt(5)
    s_barrier
    ds_read_b128 a[144:147], v200
    ds_read_b128 a[148:151], v200 offset:2048
    ds_read_b128 a[152:155], v200 offset:4096
    ds_read_b64_tr_b16 a[96:97], v192
    ds_read_b64_tr_b16 a[98:99], v192 offset:2048
    ds_read_b64_tr_b16 a[100:101], v193
    ds_read_b64_tr_b16 a[102:103], v193 offset:2048
    ds_read_b64_tr_b16 a[104:105], v194
    ds_read_b64_tr_b16 a[106:107], v194 offset:2048
    ds_read_b64_tr_b16 a[108:109], v195
    ds_read_b64_tr_b16 a[110:111], v195 offset:2048
    ds_read_b64_tr_b16 a[112:113], v196
    ds_read_b64_tr_b16 a[114:115], v196 offset:2048
    ds_read_b64_tr_b16 a[116:117], v197
    ds_read_b64_tr_b16 a[118:119], v197 offset:2048
    ds_read_b64_tr_b16 a[120:121], v198
    ds_read_b64_tr_b16 a[122:123], v198 offset:2048
    ds_read_b64_tr_b16 a[124:125], v199
    ds_read_b64_tr_b16 a[126:127], v199 offset:2048
    ds_read_b64_tr_b16 a[128:129], v192 offset:256
    ds_read_b64_tr_b16 a[130:131], v192 offset:2304
    s_waitcnt lgkmcnt(14)
    v_mfma_f32_16x16x32_bf16 v[0:3], a[96:99], a[144:147], 0
    s_mov_b32 s9, 524288
    s_add_u32 m0, s10, 32768
    v_mfma_f32_16x16x32_bf16 v[4:7], a[96:99], a[148:151], 0
    s_mov_b32 s14, 0x3db8aa3b
    s_mov_b32 s15, 0x3db8aa3b
    buffer_load_dwordx4 v202, s[36:39], s9 offen lds
    v_mfma_f32_16x16x32_bf16 v[8:11], a[96:99], a[152:155], 0
    s_add_u32 m0, s10, 32768
    ds_read_b128 a[156:159], v201
    ds_read_b64_tr_b16 a[132:133], v193 offset:256
    v_mfma_f32_16x16x32_bf16 v[12:15], a[100:103], a[144:147], 0
    s_lshl_b32 s6, s4, 12
    ds_read_b64_tr_b16 a[134:135], v193 offset:2304
    buffer_load_dwordx4 v203, s[36:39], s9 offen offset:1024 lds
    v_mfma_f32_16x16x32_bf16 v[16:19], a[100:103], a[148:151], 0
    s_add_u32 s6, s6, 62914560
    s_add_u32 s68, s30, s6
    s_addc_u32 s69, s31, 0
    s_mov_b32 s70, 4096
    v_mfma_f32_16x16x32_bf16 v[20:23], a[100:103], a[152:155], 0
    s_waitcnt lgkmcnt(13)
    ds_read_b128 a[160:163], v201 offset:2048
    ds_read_b64_tr_b16 a[136:137], v194 offset:256
    v_mfma_f32_16x16x32_bf16 v[24:27], a[104:107], a[144:147], 0
    s_add_u32 m0, s10, 32768
    s_mov_b32 s71, 0x20000
    ds_read_b64_tr_b16 a[138:139], v194 offset:2304
    v_mfma_f32_16x16x32_bf16 v[28:31], a[104:107], a[148:151], 0
    s_mov_b32 s88, s28
    s_mov_b32 s89, s29
    buffer_load_dwordx4 v204, s[36:39], s9 offen offset:2048 lds
    v_mfma_f32_16x16x32_bf16 v[32:35], a[104:107], a[152:155], 0
    s_add_u32 m0, s10, 32768
    ds_read_b128 a[164:167], v201 offset:4096
    ds_read_b64_tr_b16 a[140:141], v195 offset:256
    v_mfma_f32_16x16x32_bf16 v[36:39], a[108:111], a[144:147], 0
    s_mov_b32 s90, 256
    ds_read_b64_tr_b16 a[142:143], v195 offset:2304
    buffer_load_dwordx4 v205, s[36:39], s9 offen offset:3072 lds
    v_mfma_f32_16x16x32_bf16 v[40:43], a[108:111], a[148:151], 0
    s_mov_b32 s91, 0x20000
    s_lshl_b32 s6, s5, 8
    s_lshl_b32 s7, s4, 4
    v_mfma_f32_16x16x32_bf16 v[44:47], a[108:111], a[152:155], 0
    s_waitcnt lgkmcnt(14)
    ds_read_b64_tr_b16 a[96:97], v196 offset:256
    ds_read_b64_tr_b16 a[98:99], v196 offset:2304
    v_mfma_f32_16x16x32_bf16 v[48:51], a[112:115], a[144:147], 0
    s_mov_b32 s8, 0
    s_add_u32 m0, s10, 114688
    v_mov_b32 v217, 0x7ff00000
    v_mfma_f32_16x16x32_bf16 v[52:55], a[112:115], a[148:151], 0
    buffer_load_dwordx4 v244, s[40:43], s8 offen nt lds
    v_mov_b32 v216, s6
    v_mfma_f32_16x16x32_bf16 v[56:59], a[112:115], a[152:155], 0
    s_mov_b32 s72, 128
    s_add_u32 m0, s11, 90112
    ds_read_b64_tr_b16 a[100:101], v197 offset:256
    ds_read_b64_tr_b16 a[102:103], v197 offset:2304
    v_mfma_f32_16x16x32_bf16 v[60:63], a[116:119], a[144:147], 0
    buffer_load_dwordx4 v206, s[32:35], s72 offen lds
    v_mov_b32 v214, s7
    v_mfma_f32_16x16x32_bf16 v[64:67], a[116:119], a[148:151], 0
    v_cmp_eq_u32 vcc, 0, v221
    s_nop 1
    v_cndmask_b32 v216, v217, v216, vcc
    v_mfma_f32_16x16x32_bf16 v[68:71], a[116:119], a[152:155], 0
    s_waitcnt lgkmcnt(14)
    ds_read_b64_tr_b16 a[104:105], v198 offset:256
    ds_read_b64_tr_b16 a[106:107], v198 offset:2304
    v_mfma_f32_16x16x32_bf16 v[72:75], a[120:123], a[144:147], 0
    s_add_u32 m0, s11, 90112
    v_cndmask_b32 v214, v217, v214, vcc
    v_accvgpr_write_b32 a193, v216
    v_mfma_f32_16x16x32_bf16 v[76:79], a[120:123], a[148:151], 0
    buffer_load_dwordx4 v207, s[32:35], s72 offen offset:1024 lds
    v_accvgpr_write_b32 a197, v214
    v_mfma_f32_16x16x32_bf16 v[80:83], a[120:123], a[152:155], 0
    s_add_u32 m0, s11, 90112
    ds_read_b64_tr_b16 a[108:109], v199 offset:256
    ds_read_b64_tr_b16 a[110:111], v199 offset:2304
    v_mfma_f32_16x16x32_bf16 v[84:87], a[124:127], a[144:147], 0
    s_waitcnt vmcnt(7) lgkmcnt(0)
    s_barrier
    buffer_load_dwordx4 v208, s[32:35], s72 offen offset:2048 lds
    v_mfma_f32_16x16x32_bf16 v[88:91], a[124:127], a[148:151], 0
    s_add_u32 m0, s11, 90112
    ds_read_b64_tr_b16 a[112:113], v192 offset:16384
    ds_read_b64_tr_b16 a[114:115], v192 offset:18432
    v_mfma_f32_16x16x32_bf16 v[92:95], a[124:127], a[152:155], 0
    buffer_load_dwordx4 v209, s[32:35], s72 offen offset:3072 lds
    v_mov_b32 v220, 0
    v_mfma_f32_16x16x32_bf16 v[96:99], a[128:131], a[144:147], 0
    buffer_store_dword v220, v216, s[68:71], 0 offen sc1
    v_mfma_f32_16x16x32_bf16 v[100:103], a[128:131], a[148:151], 0
    s_mov_b32 s72, 28800
    s_add_u32 m0, s11, 94208
    ds_read_b64_tr_b16 a[116:117], v193 offset:16384
    ds_read_b64_tr_b16 a[118:119], v193 offset:18432
    v_mfma_f32_16x16x32_bf16 v[104:107], a[128:131], a[152:155], 0
    s_lshl_b32 s6, s75, 10
    buffer_load_dwordx4 v206, s[32:35], s72 offen lds
    v_and_b32 v214, 3, v210
    v_mfma_f32_16x16x32_bf16 v[108:111], a[132:135], a[144:147], 0
    s_add_u32 m0, s11, 94208
    ds_read_b64_tr_b16 a[120:121], v194 offset:16384
    ds_read_b64_tr_b16 a[122:123], v194 offset:18432
    v_mfma_f32_16x16x32_bf16 v[112:115], a[132:135], a[148:151], 0
    buffer_load_dwordx4 v207, s[32:35], s72 offen offset:1024 lds
    v_lshlrev_b32 v214, 8, v214
    v_mfma_f32_16x16x32_bf16 v[116:119], a[132:135], a[152:155], 0
    v_add_u32 v214, s6, v214
    v_accvgpr_write_b32 a196, v214
    v_mfma_f32_16x16x32_bf16 v[120:123], a[136:139], a[144:147], 0
    s_mov_b32 s9, 786432
    s_add_u32 m0, s10, 49152
    ds_read_b64_tr_b16 a[124:125], v195 offset:16384
    ds_read_b64_tr_b16 a[126:127], v195 offset:18432
    v_mfma_f32_16x16x32_bf16 v[124:127], a[136:139], a[148:151], 0
    buffer_load_dwordx4 v202, s[36:39], s9 offen lds
    v_lshlrev_b32 v214, 4, v210
    v_mfma_f32_16x16x32_bf16 v[128:131], a[136:139], a[152:155], 0
    s_add_u32 m0, s10, 114688
    ds_read_b64_tr_b16 a[128:129], v196 offset:16384
    ds_read_b64_tr_b16 a[130:131], v196 offset:18432
    v_mfma_f32_16x16x32_bf16 v[132:135], a[140:143], a[144:147], 0
    s_mul_i32 s6, s3, 393216
    buffer_load_dwordx4 v245, s[40:43], s8 offen offset:1024 nt lds
    v_add_u32 v217, s6, v214
    v_mfma_f32_16x16x32_bf16 v[136:139], a[140:143], a[148:151], 0
    v_accvgpr_write_b32 a194, v217
    v_add_u32 v214, s10, v214
    v_mfma_f32_16x16x32_bf16 v[140:143], a[140:143], a[152:155], 0
    ds_read_b64_tr_b16 a[132:133], v197 offset:16384
    ds_read_b64_tr_b16 a[134:135], v197 offset:18432
    v_mfma_f32_16x16x32_bf16 v[144:147], a[96:99], a[144:147], 0
    s_add_u32 m0, s10, 49152
    v_accvgpr_write_b32 a198, v214
    v_lshlrev_b32 v217, 1, v212
    v_mfma_f32_16x16x32_bf16 v[148:151], a[96:99], a[148:151], 0
    buffer_load_dwordx4 v203, s[36:39], s9 offen offset:1024 lds
    v_and_b32 v214, 7, v210
    v_mfma_f32_16x16x32_bf16 v[152:155], a[96:99], a[152:155], 0
    s_add_u32 m0, s10, 49152
    ds_read_b64_tr_b16 a[136:137], v198 offset:16384
    ds_read_b64_tr_b16 a[138:139], v198 offset:18432
    v_mfma_f32_16x16x32_bf16 v[156:159], a[100:103], a[144:147], 0
    buffer_load_dwordx4 v204, s[36:39], s9 offen offset:2048 lds
    v_xor_b32 v217, v217, v214
    v_mfma_f32_16x16x32_bf16 v[160:163], a[100:103], a[148:151], 0
    s_add_u32 m0, s10, 49152
    ds_read_b64_tr_b16 a[140:141], v199 offset:16384
    ds_read_b64_tr_b16 a[142:143], v199 offset:18432
    v_mfma_f32_16x16x32_bf16 v[164:167], a[100:103], a[152:155], 0
    buffer_load_dwordx4 v205, s[36:39], s9 offen offset:3072 lds
    v_lshlrev_b32 v217, 4, v217
    v_mfma_f32_16x16x32_bf16 v[168:171], a[104:107], a[144:147], 0
    v_lshrrev_b32 v214, 3, v210
    v_lshl_add_u32 v214, v211, 5, v214
    v_mfma_f32_16x16x32_bf16 v[172:175], a[104:107], a[148:151], 0
    s_mov_b32 s9, 1048576
    s_add_u32 m0, s10, 0
    ds_read_b64_tr_b16 a[96:97], v192 offset:16640
    ds_read_b64_tr_b16 a[98:99], v192 offset:18688
    v_mfma_f32_16x16x32_bf16 v[176:179], a[104:107], a[152:155], 0
    buffer_load_dwordx4 v202, s[36:39], s9 offen lds
    v_lshl_add_u32 v248, v214, 9, v217
    v_mfma_f32_16x16x32_bf16 v[180:183], a[108:111], a[144:147], 0
    s_add_u32 m0, s10, 0
    ds_read_b64_tr_b16 a[100:101], v193 offset:16640
    ds_read_b64_tr_b16 a[102:103], v193 offset:18688
    v_mfma_f32_16x16x32_bf16 v[184:187], a[108:111], a[148:151], 0
    buffer_load_dwordx4 v203, s[36:39], s9 offen offset:1024 lds
    v_add_u32 v249, 3072, v248
    v_mfma_f32_16x16x32_bf16 v[188:191], a[108:111], a[152:155], 0
    s_waitcnt lgkmcnt(14)
    v_add_u32 v250, 6144, v248
    v_add_u32 v251, 9216, v248
    v_mfma_f32_16x16x32_bf16 v[0:3], a[112:115], a[156:159], v[0:3]
    s_add_u32 m0, s10, 0
    ds_read_b64_tr_b16 a[104:105], v194 offset:16640
    ds_read_b64_tr_b16 a[106:107], v194 offset:18688
    v_mfma_f32_16x16x32_bf16 v[4:7], a[112:115], a[160:163], v[4:7]
    buffer_load_dwordx4 v204, s[36:39], s9 offen offset:2048 lds
    v_and_b32 v214, 1, v212
    v_mfma_f32_16x16x32_bf16 v[8:11], a[112:115], a[164:167], v[8:11]
    v_lshlrev_b32 v214, 1, v214
    v_lshrrev_b32 v217, 1, v212
    v_mfma_f32_16x16x32_bf16 v[12:15], a[116:119], a[156:159], v[12:15]
    s_add_u32 m0, s10, 0
    ds_read_b64_tr_b16 a[108:109], v195 offset:16640
    ds_read_b64_tr_b16 a[110:111], v195 offset:18688
    v_mfma_f32_16x16x32_bf16 v[16:19], a[116:119], a[160:163], v[16:19]
    buffer_load_dwordx4 v205, s[36:39], s9 offen offset:3072 lds
    v_or_b32 v214, v214, v217
    v_mfma_f32_16x16x32_bf16 v[20:23], a[116:119], a[164:167], v[20:23]
    s_waitcnt lgkmcnt(14)
    ds_read_b64_tr_b16 a[112:113], v196 offset:16640
    ds_read_b64_tr_b16 a[114:115], v196 offset:18688
    v_mfma_f32_16x16x32_bf16 v[24:27], a[120:123], a[156:159], v[24:27]
    s_mov_b32 s72, 256
    s_add_u32 m0, s11, 65536
    v_xor_b32 v217, v214, v213
    v_mfma_f32_16x16x32_bf16 v[28:31], a[120:123], a[160:163], v[28:31]
    buffer_load_dwordx4 v206, s[32:35], s72 offen lds
    v_lshlrev_b32 v217, 4, v217
    v_mfma_f32_16x16x32_bf16 v[32:35], a[120:123], a[164:167], v[32:35]
    s_add_u32 m0, s10, 114688
    ds_read_b64_tr_b16 a[116:117], v197 offset:16640
    ds_read_b64_tr_b16 a[118:119], v197 offset:18688
    v_mfma_f32_16x16x32_bf16 v[36:39], a[124:127], a[156:159], v[36:39]
    buffer_load_dwordx4 v246, s[40:43], s8 offen offset:2048 nt lds
    v_lshl_add_u32 v240, v213, 9, v217
    v_mfma_f32_16x16x32_bf16 v[40:43], a[124:127], a[160:163], v[40:43]
    s_add_u32 m0, s11, 65536
    ds_read_b64_tr_b16 a[120:121], v198 offset:16640
    ds_read_b64_tr_b16 a[122:123], v198 offset:18688
    v_mfma_f32_16x16x32_bf16 v[44:47], a[124:127], a[164:167], v[44:47]
    s_waitcnt lgkmcnt(14)
    buffer_load_dwordx4 v207, s[32:35], s72 offen offset:1024 lds
    v_xor_b32 v241, 64, v240
    v_mfma_f32_16x16x32_bf16 v[48:51], a[128:131], a[156:159], v[48:51]
    v_xor_b32 v242, 128, v240
    v_xor_b32 v243, 192, v240
    v_mfma_f32_16x16x32_bf16 v[52:55], a[128:131], a[160:163], v[52:55]
    s_add_u32 m0, s11, 65536
    ds_read_b64_tr_b16 a[124:125], v199 offset:16640
    ds_read_b64_tr_b16 a[126:127], v199 offset:18688
    v_mfma_f32_16x16x32_bf16 v[56:59], a[128:131], a[164:167], v[56:59]
    buffer_load_dwordx4 v208, s[32:35], s72 offen offset:2048 lds
    v_lshlrev_b32 v217, 4, v214
    v_mfma_f32_16x16x32_bf16 v[60:63], a[132:135], a[156:159], v[60:63]
    s_add_u32 m0, s11, 65536
    v_lshl_add_u32 v217, v213, 9, v217
    v_accvgpr_write_b32 a195, v217
    v_mfma_f32_16x16x32_bf16 v[64:67], a[132:135], a[160:163], v[64:67]
    buffer_load_dwordx4 v209, s[32:35], s72 offen offset:3072 lds
    v_lshrrev_b32 v214, 1, v218
    v_mfma_f32_16x16x32_bf16 v[68:71], a[132:135], a[164:167], v[68:71]
    s_add_u32 m0, s10, 114688
    v_lshl_add_u32 v214, v212, 1, v214
    v_mfma_f32_16x16x32_bf16 v[72:75], a[136:139], a[156:159], v[72:75]
    buffer_load_dwordx4 v247, s[40:43], s8 offen offset:3072 nt lds
    v_and_b32 v214, 3, v214
    v_mfma_f32_16x16x32_bf16 v[76:79], a[136:139], a[160:163], v[76:79]
    s_mov_b32 s72, 28928
    s_add_u32 m0, s11, 69632
    v_lshlrev_b32 v214, 1, v214
    v_mfma_f32_16x16x32_bf16 v[80:83], a[136:139], a[164:167], v[80:83]
    buffer_load_dwordx4 v206, s[32:35], s72 offen lds
    v_lshl_add_u32 v220, v212, 2, v218
    v_mfma_f32_16x16x32_bf16 v[84:87], a[140:143], a[156:159], v[84:87]
    s_waitcnt vmcnt(16) lgkmcnt(0)
    s_barrier
    v_lshlrev_b32 v216, 7, v220
    v_mfma_f32_16x16x32_bf16 v[88:91], a[140:143], a[160:163], v[88:91]
    s_add_u32 m0, s11, 69632
    ds_read_b64_tr_b16 a[128:129], v192 offset:32768
    ds_read_b64_tr_b16 a[130:131], v192 offset:34816
    v_mfma_f32_16x16x32_bf16 v[92:95], a[140:143], a[164:167], v[92:95]
    buffer_load_dwordx4 v207, s[32:35], s72 offen offset:1024 lds
    v_and_b32 v217, 1, v219
    v_mfma_f32_16x16x32_bf16 v[96:99], a[96:99], a[156:159], v[96:99]
    ds_read_b128 a[168:171], v200 offset:24576
    v_lshl_add_u32 v216, v217, 3, v216
    v_mfma_f32_16x16x32_bf16 v[100:103], a[96:99], a[160:163], v[100:103]
    s_mov_b32 s9, 1310720
    s_add_u32 m0, s10, 16384
    ds_read_b64_tr_b16 a[132:133], v193 offset:32768
    ds_read_b64_tr_b16 a[134:135], v193 offset:34816
    v_mfma_f32_16x16x32_bf16 v[104:107], a[96:99], a[164:167], v[104:107]
    buffer_load_dwordx4 v202, s[36:39], s9 offen lds
    v_xor_b32 v217, v215, v214
    v_mfma_f32_16x16x32_bf16 v[108:111], a[100:103], a[156:159], v[108:111]
    s_mov_b32 s8, 16384
    s_add_u32 m0, s10, 131072
    ds_read_b128 a[172:175], v200 offset:26624
    ds_read_b64_tr_b16 a[136:137], v194 offset:32768
    v_mfma_f32_16x16x32_bf16 v[112:115], a[100:103], a[160:163], v[112:115]
    ds_read_b64_tr_b16 a[138:139], v194 offset:34816
    buffer_load_dwordx4 v244, s[40:43], s8 offen nt lds
    v_mfma_f32_16x16x32_bf16 v[116:119], a[100:103], a[164:167], v[116:119]
    v_lshl_add_u32 v216, v217, 4, v216
    v_xor_b32 v217, 0, v216
    v_mfma_f32_16x16x32_bf16 v[120:123], a[104:107], a[156:159], v[120:123]
    ds_read_b128 a[176:179], v200 offset:28672
    ds_read_b64_tr_b16 a[140:141], v195 offset:32768
    v_mfma_f32_16x16x32_bf16 v[124:127], a[104:107], a[160:163], v[124:127]
    ds_read_b64_tr_b16 a[142:143], v195 offset:34816
    v_accvgpr_write_b32 a184, v217
    v_mfma_f32_16x16x32_bf16 v[128:131], a[104:107], a[164:167], v[128:131]
    s_add_u32 m0, s10, 16384
    ds_read_b64_tr_b16 a[96:97], v196 offset:32768
    ds_read_b64_tr_b16 a[98:99], v196 offset:34816
    v_mfma_f32_16x16x32_bf16 v[132:135], a[108:111], a[156:159], v[132:135]
    ds_read_b128 a[144:147], v201 offset:24576
    buffer_load_dwordx4 v203, s[36:39], s9 offen offset:1024 lds
    v_mfma_f32_16x16x32_bf16 v[136:139], a[108:111], a[160:163], v[136:139]
    v_xor_b32 v217, 32, v216
    v_accvgpr_write_b32 a185, v217
    v_mfma_f32_16x16x32_bf16 v[140:143], a[108:111], a[164:167], v[140:143]
    ds_read_b64_tr_b16 a[100:101], v197 offset:32768
    ds_read_b64_tr_b16 a[102:103], v197 offset:34816
    v_mfma_f32_16x16x32_bf16 v[144:147], a[112:115], a[156:159], v[144:147]
    s_add_u32 m0, s10, 16384
    ds_read_b128 a[148:151], v201 offset:26624
    v_xor_b32 v217, 64, v216
    v_mfma_f32_16x16x32_bf16 v[148:151], a[112:115], a[160:163], v[148:151]
    buffer_load_dwordx4 v204, s[36:39], s9 offen offset:2048 lds
    v_accvgpr_write_b32 a186, v217
    v_mfma_f32_16x16x32_bf16 v[152:155], a[112:115], a[164:167], v[152:155]
    ds_read_b64_tr_b16 a[104:105], v198 offset:32768
    ds_read_b64_tr_b16 a[106:107], v198 offset:34816
    v_mfma_f32_16x16x32_bf16 v[156:159], a[116:119], a[156:159], v[156:159]
    ds_read_b128 a[152:155], v201 offset:28672
    v_xor_b32 v217, 96, v216
    v_mfma_f32_16x16x32_bf16 v[160:163], a[116:119], a[160:163], v[160:163]
    s_add_u32 m0, s10, 16384
    ds_read_b64_tr_b16 a[108:109], v199 offset:32768
    ds_read_b64_tr_b16 a[110:111], v199 offset:34816
    v_mfma_f32_16x16x32_bf16 v[164:167], a[116:119], a[164:167], v[164:167]
    buffer_load_dwordx4 v205, s[36:39], s9 offen offset:3072 lds
    v_accvgpr_write_b32 a187, v217
    v_mfma_f32_16x16x32_bf16 v[168:171], a[120:123], a[156:159], v[168:171]
    v_mul_u32_u24 v217, 224, v220
    v_lshl_add_u32 v217, v219, 3, v217
    v_mfma_f32_16x16x32_bf16 v[172:175], a[120:123], a[160:163], v[172:175]
    s_add_u32 m0, s10, 131072
    ds_read_b64_tr_b16 a[112:113], v192 offset:33024
    ds_read_b64_tr_b16 a[114:115], v192 offset:35072
    v_mfma_f32_16x16x32_bf16 v[176:179], a[120:123], a[164:167], v[176:179]
    buffer_load_dwordx4 v245, s[40:43], s8 offen offset:1024 nt lds
    v_accvgpr_write_b32 a192, v217
    v_mfma_f32_16x16x32_bf16 v[180:183], a[124:127], a[156:159], v[180:183]
    s_mov_b32 s6, 4682
    ds_read_b64_tr_b16 a[116:117], v193 offset:33024
    ds_read_b64_tr_b16 a[118:119], v193 offset:35072
    v_mfma_f32_16x16x32_bf16 v[184:187], a[124:127], a[160:163], v[184:187]
    v_mov_b32 v220, 0x7ff00000
    v_lshl_add_u32 v214, v211, 8, v210
    v_mfma_f32_16x16x32_bf16 v[188:191], a[124:127], a[164:167], v[188:191]
    s_waitcnt lgkmcnt(14)
    v_mul_u32_u24 v216, s6, v214
    v_lshrrev_b32 v216, 16, v216
    v_mfma_f32_16x16x32_bf16 v[0:3], a[128:131], a[168:171], v[0:3]
    ds_read_b64_tr_b16 a[120:121], v194 offset:33024
    ds_read_b64_tr_b16 a[122:123], v194 offset:35072
    v_mfma_f32_16x16x32_bf16 v[4:7], a[128:131], a[172:175], v[4:7]
    v_mul_u32_u24 v216, 672, v216
    v_lshl_add_u32 v216, v214, 4, v216
    v_mfma_f32_16x16x32_bf16 v[8:11], a[128:131], a[176:179], v[8:11]
    v_cmp_gt_u32 vcc, 896, v214
    s_nop 1
    v_cndmask_b32 v216, v220, v216, vcc
    v_mfma_f32_16x16x32_bf16 v[12:15], a[132:135], a[168:171], v[12:15]
    ds_read_b64_tr_b16 a[124:125], v195 offset:33024
    ds_read_b64_tr_b16 a[126:127], v195 offset:35072
    v_mfma_f32_16x16x32_bf16 v[16:19], a[132:135], a[172:175], v[16:19]
    v_accvgpr_write_b32 a188, v216
    v_lshl_add_u32 v214, v211, 8, v210
    v_mfma_f32_16x16x32_bf16 v[20:23], a[132:135], a[176:179], v[20:23]
    ds_read_b64_tr_b16 a[128:129], v196 offset:33024
    ds_read_b64_tr_b16 a[130:131], v196 offset:35072
    v_mfma_f32_16x16x32_bf16 v[24:27], a[136:139], a[168:171], v[24:27]
    v_add_u32 v214, 64, v214
    v_mul_u32_u24 v216, s6, v214
    v_mfma_f32_16x16x32_bf16 v[28:31], a[136:139], a[172:175], v[28:31]
    v_lshrrev_b32 v216, 16, v216
    v_mul_u32_u24 v216, 672, v216
    v_mfma_f32_16x16x32_bf16 v[32:35], a[136:139], a[176:179], v[32:35]
    ds_read_b64_tr_b16 a[132:133], v197 offset:33024
    ds_read_b64_tr_b16 a[134:135], v197 offset:35072
    v_mfma_f32_16x16x32_bf16 v[36:39], a[140:143], a[168:171], v[36:39]
    v_lshl_add_u32 v216, v214, 4, v216
    v_subrev_u32 v216, 1024, v216
    v_mfma_f32_16x16x32_bf16 v[40:43], a[140:143], a[172:175], v[40:43]
    ds_read_b64_tr_b16 a[136:137], v198 offset:33024
    ds_read_b64_tr_b16 a[138:139], v198 offset:35072
    v_mfma_f32_16x16x32_bf16 v[44:47], a[140:143], a[176:179], v[44:47]
    s_waitcnt lgkmcnt(14)
    v_cmp_gt_u32 vcc, 896, v214
    s_nop 1
    v_cndmask_b32 v216, v220, v216, vcc
    v_mfma_f32_16x16x32_bf16 v[48:51], a[96:99], a[168:171], v[48:51]
    v_accvgpr_write_b32 a189, v216
    v_lshl_add_u32 v214, v211, 8, v210
    v_mfma_f32_16x16x32_bf16 v[52:55], a[96:99], a[172:175], v[52:55]
    s_add_u32 m0, s10, 131072
    ds_read_b64_tr_b16 a[140:141], v199 offset:33024
    ds_read_b64_tr_b16 a[142:143], v199 offset:35072
    v_mfma_f32_16x16x32_bf16 v[56:59], a[96:99], a[176:179], v[56:59]
    buffer_load_dwordx4 v246, s[40:43], s8 offen offset:2048 nt lds
    v_add_u32 v214, 128, v214
    v_mfma_f32_16x16x32_bf16 v[60:63], a[100:103], a[168:171], v[60:63]
    v_mul_u32_u24 v216, s6, v214
    v_lshrrev_b32 v216, 16, v216
    v_mfma_f32_16x16x32_bf16 v[64:67], a[100:103], a[172:175], v[64:67]
    v_mul_u32_u24 v216, 672, v216
    v_lshl_add_u32 v216, v214, 4, v216
    v_mfma_f32_16x16x32_bf16 v[68:71], a[100:103], a[176:179], v[68:71]
    v_subrev_u32 v216, 2048, v216
    v_cmp_gt_u32 vcc, 896, v214
    v_mfma_f32_16x16x32_bf16 v[72:75], a[104:107], a[168:171], v[72:75]
    s_nop 0
    v_cndmask_b32 v216, v220, v216, vcc
    v_accvgpr_write_b32 a190, v216
    v_mfma_f32_16x16x32_bf16 v[76:79], a[104:107], a[172:175], v[76:79]
    v_lshl_add_u32 v214, v211, 8, v210
    v_add_u32 v214, 192, v214
    v_mfma_f32_16x16x32_bf16 v[80:83], a[104:107], a[176:179], v[80:83]
    v_mul_u32_u24 v216, s6, v214
    v_lshrrev_b32 v216, 16, v216
    v_mfma_f32_16x16x32_bf16 v[84:87], a[108:111], a[168:171], v[84:87]
    s_waitcnt vmcnt(19) lgkmcnt(0)
    s_barrier
    v_mul_u32_u24 v216, 672, v216
    v_mfma_f32_16x16x32_bf16 v[88:91], a[108:111], a[172:175], v[88:91]
    s_mov_b32 s9, 1572864
    s_add_u32 m0, s10, 32768
    ds_read_b64_tr_b16 a[96:97], v192 offset:49152
    ds_read_b64_tr_b16 a[98:99], v192 offset:51200
    v_mfma_f32_16x16x32_bf16 v[92:95], a[108:111], a[176:179], v[92:95]
    buffer_load_dwordx4 v202, s[36:39], s9 offen lds
    v_lshl_add_u32 v216, v214, 4, v216
    v_mfma_f32_16x16x32_bf16 v[96:99], a[112:115], a[168:171], v[96:99]
    v_subrev_u32 v216, 3072, v216
    v_cmp_gt_u32 vcc, 896, v214
    v_mfma_f32_16x16x32_bf16 v[100:103], a[112:115], a[172:175], v[100:103]
    ds_read_b64_tr_b16 a[100:101], v193 offset:49152
    ds_read_b64_tr_b16 a[102:103], v193 offset:51200
    v_mfma_f32_16x16x32_bf16 v[104:107], a[112:115], a[176:179], v[104:107]
    v_cndmask_b32 v216, v220, v216, vcc
    v_accvgpr_write_b32 a191, v216
    v_mfma_f32_16x16x32_bf16 v[108:111], a[116:119], a[168:171], v[108:111]
    s_add_u32 m0, s10, 32768
    ds_read_b64_tr_b16 a[104:105], v194 offset:49152
    ds_read_b64_tr_b16 a[106:107], v194 offset:51200
    v_mfma_f32_16x16x32_bf16 v[112:115], a[116:119], a[172:175], v[112:115]
    s_lshr_b32 s6, s2, 6
    s_lshl_b32 s6, s6, 8
    buffer_load_dwordx4 v203, s[36:39], s9 offen offset:1024 lds
    v_mfma_f32_16x16x32_bf16 v[116:119], a[116:119], a[176:179], v[116:119]
    s_lshr_b32 s7, s2, 3
    s_and_b32 s7, s7, 7
    v_mfma_f32_16x16x32_bf16 v[120:123], a[120:123], a[168:171], v[120:123]
    s_add_u32 m0, s10, 131072
    ds_read_b64_tr_b16 a[108:109], v195 offset:49152
    ds_read_b64_tr_b16 a[110:111], v195 offset:51200
    v_mfma_f32_16x16x32_bf16 v[124:127], a[120:123], a[172:175], v[124:127]
    s_lshl_b32 s7, s7, 3
    s_add_u32 s6, s6, s7
    buffer_load_dwordx4 v247, s[40:43], s8 offen offset:3072 nt lds
    v_mfma_f32_16x16x32_bf16 v[128:131], a[120:123], a[176:179], v[128:131]
    s_lshl_b32 s7, s3, 1
    ds_read_b64_tr_b16 a[112:113], v196 offset:49152
    ds_read_b64_tr_b16 a[114:115], v196 offset:51200
    v_mfma_f32_16x16x32_bf16 v[132:135], a[124:127], a[168:171], v[132:135]
    s_add_u32 s6, s6, s7
    s_mul_i32 s6, s6, 896
    v_lshlrev_b32 v214, 7, v210
    v_mfma_f32_16x16x32_bf16 v[136:139], a[124:127], a[172:175], v[136:139]
    v_add_u32 v214, s6, v214
    v_cmp_gt_u32 vcc, 14, v210
    v_mfma_f32_16x16x32_bf16 v[140:143], a[124:127], a[176:179], v[140:143]
    ds_read_b64_tr_b16 a[116:117], v197 offset:49152
    ds_read_b64_tr_b16 a[118:119], v197 offset:51200
    v_mfma_f32_16x16x32_bf16 v[144:147], a[128:131], a[168:171], v[144:147]
    s_add_u32 m0, s10, 32768
    v_cndmask_b32 v214, v220, v214, vcc
    v_accvgpr_write_b32 a199, v214
    v_mfma_f32_16x16x32_bf16 v[148:151], a[128:131], a[172:175], v[148:151]
    buffer_load_dwordx4 v204, s[36:39], s9 offen offset:2048 lds
    v_mov_b32 v252, 0
    v_mfma_f32_16x16x32_bf16 v[152:155], a[128:131], a[176:179], v[152:155]
    s_add_u32 m0, s10, 32768
    ds_read_b64_tr_b16 a[120:121], v198 offset:49152
    ds_read_b64_tr_b16 a[122:123], v198 offset:51200
    v_mfma_f32_16x16x32_bf16 v[156:159], a[132:135], a[168:171], v[156:159]
    buffer_load_dwordx4 v205, s[36:39], s9 offen offset:3072 lds
    v_mov_b32 v253, 0
    v_mfma_f32_16x16x32_bf16 v[160:163], a[132:135], a[172:175], v[160:163]
    ds_read_b64_tr_b16 a[124:125], v199 offset:49152
    ds_read_b64_tr_b16 a[126:127], v199 offset:51200
    v_mfma_f32_16x16x32_bf16 v[164:167], a[132:135], a[176:179], v[164:167]
    v_mov_b32 v254, 0
    v_mfma_f32_16x16x32_bf16 v[168:171], a[136:139], a[168:171], v[168:171]
    s_mul_i32 s6, s4, 1572864
    s_mul_i32 s7, s75, 98304
    s_add_u32 s6, s6, s7
    v_mfma_f32_16x16x32_bf16 v[172:175], a[136:139], a[172:175], v[172:175]
    s_mov_b32 s72, 384
    s_add_u32 m0, s11, 90112
    ds_read_b64_tr_b16 a[128:129], v192 offset:49408
    ds_read_b64_tr_b16 a[130:131], v192 offset:51456
    v_mfma_f32_16x16x32_bf16 v[176:179], a[136:139], a[176:179], v[176:179]
    s_add_u32 s52, s30, s6
    s_addc_u32 s53, s31, 0
    s_mov_b32 s54, 1277952
    buffer_load_dwordx4 v206, s[32:35], s72 offen lds
    v_mfma_f32_16x16x32_bf16 v[180:183], a[140:143], a[168:171], v[180:183]
    s_mov_b32 s55, 0x20000
    ds_read_b64_tr_b16 a[132:133], v193 offset:49408
    ds_read_b64_tr_b16 a[134:135], v193 offset:51456
    v_mfma_f32_16x16x32_bf16 v[184:187], a[140:143], a[172:175], v[184:187]
    s_mov_b32 s8, 32768
    s_add_u32 m0, s10, 147456
    s_mul_i32 s77, s76, 24576
    v_mfma_f32_16x16x32_bf16 v[188:191], a[140:143], a[176:179], v[188:191]
    s_waitcnt lgkmcnt(14)
    s_mul_i32 s6, s75, 917504
    buffer_load_dwordx4 v244, s[40:43], s8 offen nt lds
    v_mfma_f32_16x16x32_bf16 v[0:3], a[96:99], a[144:147], v[0:3]
    s_add_u32 s92, s24, s6
    s_addc_u32 s93, s25, 0
    ds_read_b64_tr_b16 a[136:137], v194 offset:49408
    ds_read_b64_tr_b16 a[138:139], v194 offset:51456
    v_mfma_f32_16x16x32_bf16 v[4:7], a[96:99], a[148:151], v[4:7]
    s_mov_b32 s94, 917504
    s_mov_b32 s95, 0x20000
    s_mul_i32 s7, s76, 224
    v_mfma_f32_16x16x32_bf16 v[8:11], a[96:99], a[152:155], v[8:11]
    s_add_u32 s6, s6, s7
    s_add_u32 s48, s24, s6
    s_addc_u32 s49, s25, 0
    s_mov_b32 s50, 916832
    v_mfma_f32_16x16x32_bf16 v[12:15], a[100:103], a[144:147], v[12:15]
    s_add_u32 m0, s11, 90112
    ds_read_b64_tr_b16 a[140:141], v195 offset:49408
    ds_read_b64_tr_b16 a[142:143], v195 offset:51456
    v_mfma_f32_16x16x32_bf16 v[16:19], a[100:103], a[148:151], v[16:19]
    s_mov_b32 s51, 0x20000
    s_lshl_b32 s6, s4, 2
    buffer_load_dwordx4 v207, s[32:35], s72 offen offset:1024 lds
    v_mfma_f32_16x16x32_bf16 v[20:23], a[100:103], a[152:155], v[20:23]
    s_waitcnt lgkmcnt(14)
    ds_read_b64_tr_b16 a[96:97], v196 offset:49408
    ds_read_b64_tr_b16 a[98:99], v196 offset:51456
    v_mfma_f32_16x16x32_bf16 v[24:27], a[104:107], a[144:147], v[24:27]
    s_add_u32 m0, s11, 90112
    s_add_u32 s6, s6, s76
    s_mul_i32 s6, s6, 196608
    v_mfma_f32_16x16x32_bf16 v[28:31], a[104:107], a[148:151], v[28:31]
    s_add_u32 s6, s6, 33554432
    s_add_u32 s56, s30, s6
    s_addc_u32 s57, s31, 0
    buffer_load_dwordx4 v208, s[32:35], s72 offen offset:2048 lds
    v_mfma_f32_16x16x32_bf16 v[32:35], a[104:107], a[152:155], v[32:35]
    s_mov_b32 s58, 196608
    ds_read_b64_tr_b16 a[100:101], v197 offset:49408
    ds_read_b64_tr_b16 a[102:103], v197 offset:51456
    v_mfma_f32_16x16x32_bf16 v[36:39], a[108:111], a[144:147], v[36:39]
    s_mov_b32 s59, 0x20000
    s_mul_i32 s6, s4, 172032
    s_mul_i32 s12, s75, 43008
    v_mfma_f32_16x16x32_bf16 v[40:43], a[108:111], a[148:151], v[40:43]
    s_add_u32 m0, s11, 90112
    ds_read_b64_tr_b16 a[104:105], v198 offset:49408
    ds_read_b64_tr_b16 a[106:107], v198 offset:51456
    v_mfma_f32_16x16x32_bf16 v[44:47], a[108:111], a[152:155], v[44:47]
    s_waitcnt lgkmcnt(14)
    s_add_u32 s6, s6, s12
    buffer_load_dwordx4 v209, s[32:35], s72 offen offset:3072 lds
    v_mfma_f32_16x16x32_bf16 v[48:51], a[112:115], a[144:147], v[48:51]
    s_add_u32 s6, s6, s7
    s_add_u32 s60, s26, s6
    s_addc_u32 s61, s27, 0
    s_mov_b32 s62, 42336
    v_mfma_f32_16x16x32_bf16 v[52:55], a[112:115], a[148:151], v[52:55]
    s_mov_b32 s63, 0x20000
    ds_read_b64_tr_b16 a[108:109], v199 offset:49408
    ds_read_b64_tr_b16 a[110:111], v199 offset:51456
    v_mfma_f32_16x16x32_bf16 v[56:59], a[112:115], a[152:155], v[56:59]
    s_mov_b32 s72, 29056
    s_add_u32 m0, s11, 94208
    s_mov_b32 s86, 0
    v_mfma_f32_16x16x32_bf16 v[60:63], a[116:119], a[144:147], v[60:63]
    s_add_u32 s6, s76, 1
    s_and_b32 s6, s6, 3
    buffer_load_dwordx4 v206, s[32:35], s72 offen lds
    v_mfma_f32_16x16x32_bf16 v[64:67], a[116:119], a[148:151], v[64:67]
    s_mul_i32 s96, s6, 24576
    s_mul_i32 s99, s6, 229376
    s_add_u32 s6, s76, 2
    v_mfma_f32_16x16x32_bf16 v[68:71], a[116:119], a[152:155], v[68:71]
    s_and_b32 s6, s6, 3
    s_mul_i32 s97, s6, 24576
    v_mfma_f32_16x16x32_bf16 v[72:75], a[120:123], a[144:147], v[72:75]
    s_add_u32 m0, s10, 147456
    s_mul_i32 s100, s6, 229376
    s_add_u32 s6, s76, 3
    v_mfma_f32_16x16x32_bf16 v[76:79], a[120:123], a[148:151], v[76:79]
    s_and_b32 s6, s6, 3
    s_mul_i32 s98, s6, 24576
    buffer_load_dwordx4 v245, s[40:43], s8 offen offset:1024 nt lds
    v_mfma_f32_16x16x32_bf16 v[80:83], a[120:123], a[152:155], v[80:83]
    s_mul_i32 s101, s6, 229376
    s_add_u32 s6, s76, 4
    s_and_b32 s6, s6, 3
    v_mfma_f32_16x16x32_bf16 v[84:87], a[124:127], a[144:147], v[84:87]
    s_waitcnt vmcnt(19) lgkmcnt(0)
    s_barrier
    s_mul_i32 s82, s6, 229376
    v_mfma_f32_16x16x32_bf16 v[88:91], a[124:127], a[148:151], v[88:91]
    s_add_u32 m0, s11, 94208
    ds_read_b64_tr_b16 a[112:113], v192
    ds_read_b64_tr_b16 a[114:115], v192 offset:2048
    v_mfma_f32_16x16x32_bf16 v[92:95], a[124:127], a[152:155], v[92:95]
    s_lshl_b32 s6, s3, 2
    buffer_load_dwordx4 v207, s[32:35], s72 offen offset:1024 lds
    v_mfma_f32_16x16x32_bf16 v[96:99], a[128:131], a[144:147], v[96:99]
    s_add_u32 s6, s6, s75
    s_mul_i32 s79, s6, 12288
    ds_read_b128 a[156:159], v200
    v_mfma_f32_16x16x32_bf16 v[100:103], a[128:131], a[148:151], v[100:103]
    s_cmp_eq_u32 s3, s75
    s_cselect_b32 s79, 0x7ff00000, s79
    ds_read_b64_tr_b16 a[116:117], v193
    ds_read_b64_tr_b16 a[118:119], v193 offset:2048
    v_mfma_f32_16x16x32_bf16 v[104:107], a[128:131], a[152:155], v[104:107]
    s_add_u32 s12, s75, 1
    s_and_b32 s12, s12, 3
    s_mul_i32 s17, s12, 12288
    v_mfma_f32_16x16x32_bf16 v[108:111], a[132:135], a[144:147], v[108:111]
    s_mov_b32 s9, 1835008
    s_add_u32 m0, s10, 49152
    ds_read_b128 a[160:163], v200 offset:2048
    ds_read_b64_tr_b16 a[120:121], v194
    v_mfma_f32_16x16x32_bf16 v[112:115], a[132:135], a[148:151], v[112:115]
    s_add_u32 s12, s75, 2
    ds_read_b64_tr_b16 a[122:123], v194 offset:2048
    buffer_load_dwordx4 v202, s[36:39], s9 offen lds
    v_mfma_f32_16x16x32_bf16 v[116:119], a[132:135], a[152:155], v[116:119]
    s_and_b32 s12, s12, 3
    s_mul_i32 s18, s12, 12288
    v_mfma_f32_16x16x32_bf16 v[120:123], a[136:139], a[144:147], v[120:123]
    s_add_u32 m0, s10, 49152
    ds_read_b128 a[164:167], v200 offset:4096
    ds_read_b64_tr_b16 a[124:125], v195
    v_mfma_f32_16x16x32_bf16 v[124:127], a[136:139], a[148:151], v[124:127]
    s_add_u32 s12, s75, 3
    ds_read_b64_tr_b16 a[126:127], v195 offset:2048
    buffer_load_dwordx4 v203, s[36:39], s9 offen offset:1024 lds
    v_mfma_f32_16x16x32_bf16 v[128:131], a[136:139], a[152:155], v[128:131]
    s_and_b32 s12, s12, 3
    ds_read_b64_tr_b16 a[128:129], v196
    ds_read_b64_tr_b16 a[130:131], v196 offset:2048
    v_mfma_f32_16x16x32_bf16 v[132:135], a[140:143], a[144:147], v[132:135]
    s_mul_i32 s19, s12, 12288
    s_mul_i32 s6, s75, 49152
    ds_read_b128 a[168:171], v201
    v_mfma_f32_16x16x32_bf16 v[136:139], a[140:143], a[148:151], v[136:139]
    s_mul_i32 s7, s3, 3072
    s_add_u32 s6, s6, s7
    s_add_u32 s17, s17, s6
    v_mfma_f32_16x16x32_bf16 v[140:143], a[140:143], a[152:155], v[140:143]
    ds_read_b64_tr_b16 a[132:133], v197
    ds_read_b64_tr_b16 a[134:135], v197 offset:2048
    v_mfma_f32_16x16x32_bf16 v[144:147], a[96:99], a[144:147], v[144:147]
    s_add_u32 m0, s10, 147456
    s_add_u32 s18, s18, s6
    ds_read_b128 a[172:175], v201 offset:2048
    v_mfma_f32_16x16x32_bf16 v[148:151], a[96:99], a[148:151], v[148:151]
    s_add_u32 s19, s19, s6
    s_lshl_b32 s83, s3, 6
    buffer_load_dwordx4 v246, s[40:43], s8 offen offset:2048 nt lds
    v_mfma_f32_16x16x32_bf16 v[152:155], a[96:99], a[152:155], v[152:155]
    s_add_u32 m0, s10, 49152
    ds_read_b64_tr_b16 a[136:137], v198
    ds_read_b64_tr_b16 a[138:139], v198 offset:2048
    v_mfma_f32_16x16x32_bf16 v[156:159], a[100:103], a[144:147], v[156:159]
    s_add_u32 s6, s3, 1
    ds_read_b128 a[176:179], v201 offset:4096
    buffer_load_dwordx4 v204, s[36:39], s9 offen offset:2048 lds
    v_mfma_f32_16x16x32_bf16 v[160:163], a[100:103], a[148:151], v[160:163]
    s_lshr_b32 s6, s6, 2
    ds_read_b64_tr_b16 a[140:141], v199
    ds_read_b64_tr_b16 a[142:143], v199 offset:2048
    v_mfma_f32_16x16x32_bf16 v[164:167], a[100:103], a[152:155], v[164:167]
    s_lshl_b32 s6, s6, 30
    s_add_u32 s16, s83, 32
    v_mfma_f32_16x16x32_bf16 v[168:171], a[104:107], a[144:147], v[168:171]
    s_add_u32 s16, s16, s6
    v_mfma_f32_16x16x32_bf16 v[172:175], a[104:107], a[148:151], v[172:175]
    s_add_u32 m0, s10, 49152
    ds_read_b64_tr_b16 a[96:97], v192 offset:256
    ds_read_b64_tr_b16 a[98:99], v192 offset:2304
    v_mfma_f32_16x16x32_bf16 v[176:179], a[104:107], a[152:155], v[176:179]
    buffer_load_dwordx4 v205, s[36:39], s9 offen offset:3072 lds
    v_mfma_f32_16x16x32_bf16 v[180:183], a[108:111], a[144:147], v[180:183]
    ds_read_b64_tr_b16 a[100:101], v193 offset:256
    ds_read_b64_tr_b16 a[102:103], v193 offset:2304
    v_mfma_f32_16x16x32_bf16 v[184:187], a[108:111], a[148:151], v[184:187]
    v_mfma_f32_16x16x32_bf16 v[188:191], a[108:111], a[152:155], v[188:191]
    s_waitcnt lgkmcnt(14)
    v_mfma_f32_16x16x32_bf16 v[0:3], a[112:115], a[156:159], v[0:3]
    ds_read_b64_tr_b16 a[104:105], v194 offset:256
    ds_read_b64_tr_b16 a[106:107], v194 offset:2304
    v_mfma_f32_16x16x32_bf16 v[4:7], a[112:115], a[160:163], v[4:7]
    s_add_u32 m0, s10, 147456
    v_mfma_f32_16x16x32_bf16 v[8:11], a[112:115], a[164:167], v[8:11]
    buffer_load_dwordx4 v247, s[40:43], s8 offen offset:3072 nt lds
    v_mfma_f32_16x16x32_bf16 v[12:15], a[116:119], a[156:159], v[12:15]
    ds_read_b64_tr_b16 a[108:109], v195 offset:256
    ds_read_b64_tr_b16 a[110:111], v195 offset:2304
    v_mfma_f32_16x16x32_bf16 v[16:19], a[116:119], a[160:163], v[16:19]
    v_mfma_f32_16x16x32_bf16 v[20:23], a[116:119], a[164:167], v[20:23]
    ds_read_b64_tr_b16 a[112:113], v196 offset:256
    ds_read_b64_tr_b16 a[114:115], v196 offset:2304
    v_mfma_f32_16x16x32_bf16 v[24:27], a[120:123], a[156:159], v[24:27]
    v_mfma_f32_16x16x32_bf16 v[28:31], a[120:123], a[160:163], v[28:31]
    v_mfma_f32_16x16x32_bf16 v[32:35], a[120:123], a[164:167], v[32:35]
    ds_read_b64_tr_b16 a[116:117], v197 offset:256
    ds_read_b64_tr_b16 a[118:119], v197 offset:2304
    v_mfma_f32_16x16x32_bf16 v[36:39], a[124:127], a[156:159], v[36:39]
    v_mfma_f32_16x16x32_bf16 v[40:43], a[124:127], a[160:163], v[40:43]
    ds_read_b64_tr_b16 a[120:121], v198 offset:256
    ds_read_b64_tr_b16 a[122:123], v198 offset:2304
    v_mfma_f32_16x16x32_bf16 v[44:47], a[124:127], a[164:167], v[44:47]
    s_waitcnt lgkmcnt(14)
    v_mfma_f32_16x16x32_bf16 v[48:51], a[128:131], a[156:159], v[48:51]
    v_mfma_f32_16x16x32_bf16 v[52:55], a[128:131], a[160:163], v[52:55]
    ds_read_b64_tr_b16 a[124:125], v199 offset:256
    ds_read_b64_tr_b16 a[126:127], v199 offset:2304
    v_mfma_f32_16x16x32_bf16 v[56:59], a[128:131], a[164:167], v[56:59]
    v_mfma_f32_16x16x32_bf16 v[60:63], a[132:135], a[156:159], v[60:63]
    v_mfma_f32_16x16x32_bf16 v[64:67], a[132:135], a[160:163], v[64:67]
    v_mfma_f32_16x16x32_bf16 v[68:71], a[132:135], a[164:167], v[68:71]
    v_mfma_f32_16x16x32_bf16 v[72:75], a[136:139], a[156:159], v[72:75]
    v_mfma_f32_16x16x32_bf16 v[76:79], a[136:139], a[160:163], v[76:79]
    s_mov_b32 s8, 49152
    buffer_load_dwordx4 a[0:3], v244, s[40:43], s8 offen nt
    v_mfma_f32_16x16x32_bf16 v[80:83], a[136:139], a[164:167], v[80:83]
    v_mfma_f32_16x16x32_bf16 v[84:87], a[140:143], a[156:159], v[84:87]
    s_waitcnt vmcnt(22) lgkmcnt(0)
    s_barrier
    v_mfma_f32_16x16x32_bf16 v[88:91], a[140:143], a[160:163], v[88:91]
    s_mov_b32 s9, 2097152
    s_add_u32 m0, s10, 0
    ds_read_b64_tr_b16 a[128:129], v192 offset:16384
    ds_read_b64_tr_b16 a[130:131], v192 offset:18432
    v_mfma_f32_16x16x32_bf16 v[92:95], a[140:143], a[164:167], v[92:95]
    buffer_load_dwordx4 v202, s[36:39], s9 offen lds
    v_mfma_f32_16x16x32_bf16 v[96:99], a[96:99], a[156:159], v[96:99]
    v_mfma_f32_16x16x32_bf16 v[100:103], a[96:99], a[160:163], v[100:103]
    ds_read_b64_tr_b16 a[132:133], v193 offset:16384
    ds_read_b64_tr_b16 a[134:135], v193 offset:18432
    v_mfma_f32_16x16x32_bf16 v[104:107], a[96:99], a[164:167], v[104:107]
    v_mfma_f32_16x16x32_bf16 v[108:111], a[100:103], a[156:159], v[108:111]
    s_add_u32 m0, s10, 0
    ds_read_b64_tr_b16 a[136:137], v194 offset:16384
    ds_read_b64_tr_b16 a[138:139], v194 offset:18432
    v_mfma_f32_16x16x32_bf16 v[112:115], a[100:103], a[160:163], v[112:115]
    buffer_load_dwordx4 v203, s[36:39], s9 offen offset:1024 lds
    v_mfma_f32_16x16x32_bf16 v[116:119], a[100:103], a[164:167], v[116:119]
    v_mfma_f32_16x16x32_bf16 v[120:123], a[104:107], a[156:159], v[120:123]
    s_add_u32 m0, s10, 0
    ds_read_b64_tr_b16 a[140:141], v195 offset:16384
    ds_read_b64_tr_b16 a[142:143], v195 offset:18432
    v_mfma_f32_16x16x32_bf16 v[124:127], a[104:107], a[160:163], v[124:127]
    buffer_load_dwordx4 v204, s[36:39], s9 offen offset:2048 lds
    v_mfma_f32_16x16x32_bf16 v[128:131], a[104:107], a[164:167], v[128:131]
    ds_read_b64_tr_b16 a[96:97], v196 offset:16384
    ds_read_b64_tr_b16 a[98:99], v196 offset:18432
    v_mfma_f32_16x16x32_bf16 v[132:135], a[108:111], a[156:159], v[132:135]
    v_mfma_f32_16x16x32_bf16 v[136:139], a[108:111], a[160:163], v[136:139]
    v_mfma_f32_16x16x32_bf16 v[140:143], a[108:111], a[164:167], v[140:143]
    ds_read_b64_tr_b16 a[100:101], v197 offset:16384
    ds_read_b64_tr_b16 a[102:103], v197 offset:18432
    v_mfma_f32_16x16x32_bf16 v[144:147], a[112:115], a[156:159], v[144:147]
    s_add_u32 m0, s10, 0
    v_mfma_f32_16x16x32_bf16 v[148:151], a[112:115], a[160:163], v[148:151]
    buffer_load_dwordx4 v205, s[36:39], s9 offen offset:3072 lds
    v_mfma_f32_16x16x32_bf16 v[152:155], a[112:115], a[164:167], v[152:155]
    ds_read_b64_tr_b16 a[104:105], v198 offset:16384
    ds_read_b64_tr_b16 a[106:107], v198 offset:18432
    v_mfma_f32_16x16x32_bf16 v[156:159], a[116:119], a[156:159], v[156:159]
    buffer_load_dwordx4 a[4:7], v245, s[40:43], s8 offen offset:1024 nt
    v_mfma_f32_16x16x32_bf16 v[160:163], a[116:119], a[160:163], v[160:163]
    ds_read_b64_tr_b16 a[108:109], v199 offset:16384
    ds_read_b64_tr_b16 a[110:111], v199 offset:18432
    v_mfma_f32_16x16x32_bf16 v[164:167], a[116:119], a[164:167], v[164:167]
    v_mfma_f32_16x16x32_bf16 v[168:171], a[120:123], a[156:159], v[168:171]
    v_mfma_f32_16x16x32_bf16 v[172:175], a[120:123], a[160:163], v[172:175]
    s_mov_b32 s72, 512
    s_add_u32 m0, s11, 65536
    ds_read_b64_tr_b16 a[112:113], v192 offset:16640
    ds_read_b64_tr_b16 a[114:115], v192 offset:18688
    v_mfma_f32_16x16x32_bf16 v[176:179], a[120:123], a[164:167], v[176:179]
    buffer_load_dwordx4 v206, s[32:35], s72 offen lds
    v_mfma_f32_16x16x32_bf16 v[180:183], a[124:127], a[156:159], v[180:183]
    ds_read_b64_tr_b16 a[116:117], v193 offset:16640
    ds_read_b64_tr_b16 a[118:119], v193 offset:18688
    v_mfma_f32_16x16x32_bf16 v[184:187], a[124:127], a[160:163], v[184:187]
    s_add_u32 m0, s11, 65536
    v_mfma_f32_16x16x32_bf16 v[188:191], a[124:127], a[164:167], v[188:191]
    s_waitcnt lgkmcnt(14)
    buffer_load_dwordx4 v207, s[32:35], s72 offen offset:1024 lds
    v_mfma_f32_16x16x32_bf16 v[0:3], a[128:131], a[168:171], v[0:3]
    ds_read_b64_tr_b16 a[120:121], v194 offset:16640
    ds_read_b64_tr_b16 a[122:123], v194 offset:18688
    v_mfma_f32_16x16x32_bf16 v[4:7], a[128:131], a[172:175], v[4:7]
    v_mfma_f32_16x16x32_bf16 v[8:11], a[128:131], a[176:179], v[8:11]
    v_mfma_f32_16x16x32_bf16 v[12:15], a[132:135], a[168:171], v[12:15]
    s_add_u32 m0, s11, 65536
    ds_read_b64_tr_b16 a[124:125], v195 offset:16640
    ds_read_b64_tr_b16 a[126:127], v195 offset:18688
    v_mfma_f32_16x16x32_bf16 v[16:19], a[132:135], a[172:175], v[16:19]
    buffer_load_dwordx4 v208, s[32:35], s72 offen offset:2048 lds
    v_mfma_f32_16x16x32_bf16 v[20:23], a[132:135], a[176:179], v[20:23]
    s_waitcnt lgkmcnt(14)
    ds_read_b64_tr_b16 a[128:129], v196 offset:16640
    ds_read_b64_tr_b16 a[130:131], v196 offset:18688
    v_mfma_f32_16x16x32_bf16 v[24:27], a[136:139], a[168:171], v[24:27]
    v_mfma_f32_16x16x32_bf16 v[28:31], a[136:139], a[172:175], v[28:31]
    buffer_load_dwordx4 a[8:11], v246, s[40:43], s8 offen offset:2048 nt
    v_mfma_f32_16x16x32_bf16 v[32:35], a[136:139], a[176:179], v[32:35]
    ds_read_b64_tr_b16 a[132:133], v197 offset:16640
    ds_read_b64_tr_b16 a[134:135], v197 offset:18688
    v_mfma_f32_16x16x32_bf16 v[36:39], a[140:143], a[168:171], v[36:39]
    v_mfma_f32_16x16x32_bf16 v[40:43], a[140:143], a[172:175], v[40:43]
    s_add_u32 m0, s11, 65536
    ds_read_b64_tr_b16 a[136:137], v198 offset:16640
    ds_read_b64_tr_b16 a[138:139], v198 offset:18688
    v_mfma_f32_16x16x32_bf16 v[44:47], a[140:143], a[176:179], v[44:47]
    s_waitcnt lgkmcnt(14)
    buffer_load_dwordx4 v209, s[32:35], s72 offen offset:3072 lds
    v_mfma_f32_16x16x32_bf16 v[48:51], a[96:99], a[168:171], v[48:51]
    v_mfma_f32_16x16x32_bf16 v[52:55], a[96:99], a[172:175], v[52:55]
    ds_read_b64_tr_b16 a[140:141], v199 offset:16640
    ds_read_b64_tr_b16 a[142:143], v199 offset:18688
    v_mfma_f32_16x16x32_bf16 v[56:59], a[96:99], a[176:179], v[56:59]
    s_mov_b32 s72, 29184
    s_add_u32 m0, s11, 69632
    v_mfma_f32_16x16x32_bf16 v[60:63], a[100:103], a[168:171], v[60:63]
    buffer_load_dwordx4 v206, s[32:35], s72 offen lds
    v_mfma_f32_16x16x32_bf16 v[64:67], a[100:103], a[172:175], v[64:67]
    v_mfma_f32_16x16x32_bf16 v[68:71], a[100:103], a[176:179], v[68:71]
    v_mfma_f32_16x16x32_bf16 v[72:75], a[104:107], a[168:171], v[72:75]
    s_add_u32 m0, s11, 69632
    v_mfma_f32_16x16x32_bf16 v[76:79], a[104:107], a[172:175], v[76:79]
    buffer_load_dwordx4 v207, s[32:35], s72 offen offset:1024 lds
    v_mfma_f32_16x16x32_bf16 v[80:83], a[104:107], a[176:179], v[80:83]
    v_mfma_f32_16x16x32_bf16 v[84:87], a[108:111], a[168:171], v[84:87]
    s_waitcnt vmcnt(19) lgkmcnt(0)
    s_barrier
    v_mfma_f32_16x16x32_bf16 v[88:91], a[108:111], a[172:175], v[88:91]
    ds_read_b64_tr_b16 a[96:97], v192 offset:32768
    ds_read_b64_tr_b16 a[98:99], v192 offset:34816
    v_mfma_f32_16x16x32_bf16 v[92:95], a[108:111], a[176:179], v[92:95]
    buffer_load_dwordx4 a[12:15], v247, s[40:43], s8 offen offset:3072 nt
    v_mfma_f32_16x16x32_bf16 v[96:99], a[112:115], a[168:171], v[96:99]
    ds_read_b128 a[144:147], v200 offset:24576
    v_mfma_f32_16x16x32_bf16 v[100:103], a[112:115], a[172:175], v[100:103]
    ds_read_b64_tr_b16 a[100:101], v193 offset:32768
    ds_read_b64_tr_b16 a[102:103], v193 offset:34816
    v_mfma_f32_16x16x32_bf16 v[104:107], a[112:115], a[176:179], v[104:107]
    v_mfma_f32_16x16x32_bf16 v[108:111], a[116:119], a[168:171], v[108:111]
    s_mov_b32 s9, 2359296
    s_add_u32 m0, s10, 16384
    ds_read_b128 a[148:151], v200 offset:26624
    ds_read_b64_tr_b16 a[104:105], v194 offset:32768
    v_mfma_f32_16x16x32_bf16 v[112:115], a[116:119], a[172:175], v[112:115]
    ds_read_b64_tr_b16 a[106:107], v194 offset:34816
    buffer_load_dwordx4 v202, s[36:39], s9 offen lds
    v_mfma_f32_16x16x32_bf16 v[116:119], a[116:119], a[176:179], v[116:119]
    v_mfma_f32_16x16x32_bf16 v[120:123], a[120:123], a[168:171], v[120:123]
    s_add_u32 m0, s10, 16384
    ds_read_b128 a[152:155], v200 offset:28672
    ds_read_b64_tr_b16 a[108:109], v195 offset:32768
    v_mfma_f32_16x16x32_bf16 v[124:127], a[120:123], a[172:175], v[124:127]
    ds_read_b64_tr_b16 a[110:111], v195 offset:34816
    buffer_load_dwordx4 v203, s[36:39], s9 offen offset:1024 lds
    v_mfma_f32_16x16x32_bf16 v[128:131], a[120:123], a[176:179], v[128:131]
    ds_read_b64_tr_b16 a[112:113], v196 offset:32768
    ds_read_b64_tr_b16 a[114:115], v196 offset:34816
    v_mfma_f32_16x16x32_bf16 v[132:135], a[124:127], a[168:171], v[132:135]
    ds_read_b128 a[156:159], v201 offset:24576
    v_mfma_f32_16x16x32_bf16 v[136:139], a[124:127], a[172:175], v[136:139]
    v_mfma_f32_16x16x32_bf16 v[140:143], a[124:127], a[176:179], v[140:143]
    ds_read_b64_tr_b16 a[116:117], v197 offset:32768
    ds_read_b64_tr_b16 a[118:119], v197 offset:34816
    v_mfma_f32_16x16x32_bf16 v[144:147], a[128:131], a[168:171], v[144:147]
    s_add_u32 m0, s10, 16384
    ds_read_b128 a[160:163], v201 offset:26624
    v_mfma_f32_16x16x32_bf16 v[148:151], a[128:131], a[172:175], v[148:151]
    buffer_load_dwordx4 v204, s[36:39], s9 offen offset:2048 lds
    v_mfma_f32_16x16x32_bf16 v[152:155], a[128:131], a[176:179], v[152:155]
    ds_read_b64_tr_b16 a[120:121], v198 offset:32768
    ds_read_b64_tr_b16 a[122:123], v198 offset:34816
    v_mfma_f32_16x16x32_bf16 v[156:159], a[132:135], a[168:171], v[156:159]
    s_mov_b32 s8, 65536
    ds_read_b128 a[164:167], v201 offset:28672
    buffer_load_dwordx4 a[16:19], v244, s[40:43], s8 offen nt
    v_mfma_f32_16x16x32_bf16 v[160:163], a[132:135], a[172:175], v[160:163]
    ds_read_b64_tr_b16 a[124:125], v199 offset:32768
    ds_read_b64_tr_b16 a[126:127], v199 offset:34816
    v_mfma_f32_16x16x32_bf16 v[164:167], a[132:135], a[176:179], v[164:167]
    v_mfma_f32_16x16x32_bf16 v[168:171], a[136:139], a[168:171], v[168:171]
    v_mfma_f32_16x16x32_bf16 v[172:175], a[136:139], a[172:175], v[172:175]
    s_add_u32 m0, s10, 16384
    ds_read_b64_tr_b16 a[128:129], v192 offset:33024
    ds_read_b64_tr_b16 a[130:131], v192 offset:35072
    v_mfma_f32_16x16x32_bf16 v[176:179], a[136:139], a[176:179], v[176:179]
    buffer_load_dwordx4 v205, s[36:39], s9 offen offset:3072 lds
    v_mfma_f32_16x16x32_bf16 v[180:183], a[140:143], a[168:171], v[180:183]
    ds_read_b64_tr_b16 a[132:133], v193 offset:33024
    ds_read_b64_tr_b16 a[134:135], v193 offset:35072
    v_mfma_f32_16x16x32_bf16 v[184:187], a[140:143], a[172:175], v[184:187]
    v_mfma_f32_16x16x32_bf16 v[188:191], a[140:143], a[176:179], v[188:191]
    s_waitcnt lgkmcnt(14)
    v_mfma_f32_16x16x32_bf16 v[0:3], a[96:99], a[144:147], v[0:3]
    ds_read_b64_tr_b16 a[136:137], v194 offset:33024
    ds_read_b64_tr_b16 a[138:139], v194 offset:35072
    v_mfma_f32_16x16x32_bf16 v[4:7], a[96:99], a[148:151], v[4:7]
    v_mfma_f32_16x16x32_bf16 v[8:11], a[96:99], a[152:155], v[8:11]
    v_mfma_f32_16x16x32_bf16 v[12:15], a[100:103], a[144:147], v[12:15]
    ds_read_b64_tr_b16 a[140:141], v195 offset:33024
    ds_read_b64_tr_b16 a[142:143], v195 offset:35072
    v_mfma_f32_16x16x32_bf16 v[16:19], a[100:103], a[148:151], v[16:19]
    v_mfma_f32_16x16x32_bf16 v[20:23], a[100:103], a[152:155], v[20:23]
    ds_read_b64_tr_b16 a[96:97], v196 offset:33024
    ds_read_b64_tr_b16 a[98:99], v196 offset:35072
    v_mfma_f32_16x16x32_bf16 v[24:27], a[104:107], a[144:147], v[24:27]
    v_mfma_f32_16x16x32_bf16 v[28:31], a[104:107], a[148:151], v[28:31]
    v_mfma_f32_16x16x32_bf16 v[32:35], a[104:107], a[152:155], v[32:35]
    ds_read_b64_tr_b16 a[100:101], v197 offset:33024
    ds_read_b64_tr_b16 a[102:103], v197 offset:35072
    v_mfma_f32_16x16x32_bf16 v[36:39], a[108:111], a[144:147], v[36:39]
    buffer_load_dwordx4 a[20:23], v245, s[40:43], s8 offen offset:1024 nt
    v_mfma_f32_16x16x32_bf16 v[40:43], a[108:111], a[148:151], v[40:43]
    ds_read_b64_tr_b16 a[104:105], v198 offset:33024
    ds_read_b64_tr_b16 a[106:107], v198 offset:35072
    v_mfma_f32_16x16x32_bf16 v[44:47], a[108:111], a[152:155], v[44:47]
    s_waitcnt lgkmcnt(14)
    v_mfma_f32_16x16x32_bf16 v[48:51], a[112:115], a[144:147], v[48:51]
    v_mfma_f32_16x16x32_bf16 v[52:55], a[112:115], a[148:151], v[52:55]
    ds_read_b64_tr_b16 a[108:109], v199 offset:33024
    ds_read_b64_tr_b16 a[110:111], v199 offset:35072
    v_mfma_f32_16x16x32_bf16 v[56:59], a[112:115], a[152:155], v[56:59]
    v_mfma_f32_16x16x32_bf16 v[60:63], a[116:119], a[144:147], v[60:63]
    v_mfma_f32_16x16x32_bf16 v[64:67], a[116:119], a[148:151], v[64:67]
    v_mfma_f32_16x16x32_bf16 v[68:71], a[116:119], a[152:155], v[68:71]
    v_mfma_f32_16x16x32_bf16 v[72:75], a[120:123], a[144:147], v[72:75]
    v_mfma_f32_16x16x32_bf16 v[76:79], a[120:123], a[148:151], v[76:79]
    v_mfma_f32_16x16x32_bf16 v[80:83], a[120:123], a[152:155], v[80:83]
    v_mfma_f32_16x16x32_bf16 v[84:87], a[124:127], a[144:147], v[84:87]
    s_waitcnt vmcnt(21) lgkmcnt(0)
    s_barrier
    v_mfma_f32_16x16x32_bf16 v[88:91], a[124:127], a[148:151], v[88:91]
    s_mov_b32 s9, 2621440
    s_add_u32 m0, s10, 32768
    ds_read_b64_tr_b16 a[112:113], v192 offset:49152
    ds_read_b64_tr_b16 a[114:115], v192 offset:51200
    v_mfma_f32_16x16x32_bf16 v[92:95], a[124:127], a[152:155], v[92:95]
    buffer_load_dwordx4 v202, s[36:39], s9 offen lds
    v_mfma_f32_16x16x32_bf16 v[96:99], a[128:131], a[144:147], v[96:99]
    v_mfma_f32_16x16x32_bf16 v[100:103], a[128:131], a[148:151], v[100:103]
    ds_read_b64_tr_b16 a[116:117], v193 offset:49152
    ds_read_b64_tr_b16 a[118:119], v193 offset:51200
    v_mfma_f32_16x16x32_bf16 v[104:107], a[128:131], a[152:155], v[104:107]
    v_mfma_f32_16x16x32_bf16 v[108:111], a[132:135], a[144:147], v[108:111]
    ds_read_b64_tr_b16 a[120:121], v194 offset:49152
    ds_read_b64_tr_b16 a[122:123], v194 offset:51200
    v_mfma_f32_16x16x32_bf16 v[112:115], a[132:135], a[148:151], v[112:115]
    buffer_load_dwordx4 a[24:27], v246, s[40:43], s8 offen offset:2048 nt
    v_mfma_f32_16x16x32_bf16 v[116:119], a[132:135], a[152:155], v[116:119]
    v_mfma_f32_16x16x32_bf16 v[120:123], a[136:139], a[144:147], v[120:123]
    s_add_u32 m0, s10, 32768
    ds_read_b64_tr_b16 a[124:125], v195 offset:49152
    ds_read_b64_tr_b16 a[126:127], v195 offset:51200
    v_mfma_f32_16x16x32_bf16 v[124:127], a[136:139], a[148:151], v[124:127]
    buffer_load_dwordx4 v203, s[36:39], s9 offen offset:1024 lds
    v_mfma_f32_16x16x32_bf16 v[128:131], a[136:139], a[152:155], v[128:131]
    ds_read_b64_tr_b16 a[128:129], v196 offset:49152
    ds_read_b64_tr_b16 a[130:131], v196 offset:51200
    v_mfma_f32_16x16x32_bf16 v[132:135], a[140:143], a[144:147], v[132:135]
    v_mfma_f32_16x16x32_bf16 v[136:139], a[140:143], a[148:151], v[136:139]
    v_mfma_f32_16x16x32_bf16 v[140:143], a[140:143], a[152:155], v[140:143]
    ds_read_b64_tr_b16 a[132:133], v197 offset:49152
    ds_read_b64_tr_b16 a[134:135], v197 offset:51200
    v_mfma_f32_16x16x32_bf16 v[144:147], a[96:99], a[144:147], v[144:147]
    s_add_u32 m0, s10, 32768
    v_mfma_f32_16x16x32_bf16 v[148:151], a[96:99], a[148:151], v[148:151]
    buffer_load_dwordx4 v204, s[36:39], s9 offen offset:2048 lds
    v_mfma_f32_16x16x32_bf16 v[152:155], a[96:99], a[152:155], v[152:155]
    s_add_u32 m0, s10, 32768
    ds_read_b64_tr_b16 a[136:137], v198 offset:49152
    ds_read_b64_tr_b16 a[138:139], v198 offset:51200
    v_mfma_f32_16x16x32_bf16 v[156:159], a[100:103], a[144:147], v[156:159]
    buffer_load_dwordx4 v205, s[36:39], s9 offen offset:3072 lds
    v_mfma_f32_16x16x32_bf16 v[160:163], a[100:103], a[148:151], v[160:163]
    ds_read_b64_tr_b16 a[140:141], v199 offset:49152
    ds_read_b64_tr_b16 a[142:143], v199 offset:51200
    v_mfma_f32_16x16x32_bf16 v[164:167], a[100:103], a[152:155], v[164:167]
    v_mfma_f32_16x16x32_bf16 v[168:171], a[104:107], a[144:147], v[168:171]
    v_mfma_f32_16x16x32_bf16 v[172:175], a[104:107], a[148:151], v[172:175]
    ds_read_b64_tr_b16 a[96:97], v192 offset:49408
    ds_read_b64_tr_b16 a[98:99], v192 offset:51456
    v_mfma_f32_16x16x32_bf16 v[176:179], a[104:107], a[152:155], v[176:179]
    buffer_load_dwordx4 a[28:31], v247, s[40:43], s8 offen offset:3072 nt
    v_mfma_f32_16x16x32_bf16 v[180:183], a[108:111], a[144:147], v[180:183]
    ds_read_b64_tr_b16 a[100:101], v193 offset:49408
    ds_read_b64_tr_b16 a[102:103], v193 offset:51456
    v_mfma_f32_16x16x32_bf16 v[184:187], a[108:111], a[148:151], v[184:187]
    s_mov_b32 s72, 640
    s_add_u32 m0, s11, 90112
    v_mfma_f32_16x16x32_bf16 v[188:191], a[108:111], a[152:155], v[188:191]
    s_waitcnt lgkmcnt(14)
    buffer_load_dwordx4 v206, s[32:35], s72 offen lds
    v_mfma_f32_16x16x32_bf16 v[0:3], a[112:115], a[156:159], v[0:3]
    ds_read_b64_tr_b16 a[104:105], v194 offset:49408
    ds_read_b64_tr_b16 a[106:107], v194 offset:51456
    v_mfma_f32_16x16x32_bf16 v[4:7], a[112:115], a[160:163], v[4:7]
    v_mfma_f32_16x16x32_bf16 v[8:11], a[112:115], a[164:167], v[8:11]
    v_mfma_f32_16x16x32_bf16 v[12:15], a[116:119], a[156:159], v[12:15]
    s_add_u32 m0, s11, 90112
    ds_read_b64_tr_b16 a[108:109], v195 offset:49408
    ds_read_b64_tr_b16 a[110:111], v195 offset:51456
    v_mfma_f32_16x16x32_bf16 v[16:19], a[116:119], a[160:163], v[16:19]
    buffer_load_dwordx4 v207, s[32:35], s72 offen offset:1024 lds
    v_mfma_f32_16x16x32_bf16 v[20:23], a[116:119], a[164:167], v[20:23]
    s_waitcnt lgkmcnt(14)
    ds_read_b64_tr_b16 a[112:113], v196 offset:49408
    ds_read_b64_tr_b16 a[114:115], v196 offset:51456
    v_mfma_f32_16x16x32_bf16 v[24:27], a[120:123], a[156:159], v[24:27]
    s_add_u32 m0, s11, 90112
    v_mfma_f32_16x16x32_bf16 v[28:31], a[120:123], a[160:163], v[28:31]
    buffer_load_dwordx4 v208, s[32:35], s72 offen offset:2048 lds
    v_mfma_f32_16x16x32_bf16 v[32:35], a[120:123], a[164:167], v[32:35]
    ds_read_b64_tr_b16 a[116:117], v197 offset:49408
    ds_read_b64_tr_b16 a[118:119], v197 offset:51456
    v_mfma_f32_16x16x32_bf16 v[36:39], a[124:127], a[156:159], v[36:39]
    v_mfma_f32_16x16x32_bf16 v[40:43], a[124:127], a[160:163], v[40:43]
    ds_read_b64_tr_b16 a[120:121], v198 offset:49408
    ds_read_b64_tr_b16 a[122:123], v198 offset:51456
    v_mfma_f32_16x16x32_bf16 v[44:47], a[124:127], a[164:167], v[44:47]
    s_waitcnt lgkmcnt(14)
    s_mov_b32 s8, 81920
    buffer_load_dwordx4 a[32:35], v244, s[40:43], s8 offen nt
    v_mfma_f32_16x16x32_bf16 v[48:51], a[128:131], a[156:159], v[48:51]
    v_mfma_f32_16x16x32_bf16 v[52:55], a[128:131], a[160:163], v[52:55]
    ds_read_b64_tr_b16 a[124:125], v199 offset:49408
    ds_read_b64_tr_b16 a[126:127], v199 offset:51456
    v_mfma_f32_16x16x32_bf16 v[56:59], a[128:131], a[164:167], v[56:59]
    s_add_u32 m0, s11, 90112
    v_mfma_f32_16x16x32_bf16 v[60:63], a[132:135], a[156:159], v[60:63]
    buffer_load_dwordx4 v209, s[32:35], s72 offen offset:3072 lds
    v_mfma_f32_16x16x32_bf16 v[64:67], a[132:135], a[160:163], v[64:67]
    v_mfma_f32_16x16x32_bf16 v[68:71], a[132:135], a[164:167], v[68:71]
    v_mfma_f32_16x16x32_bf16 v[72:75], a[136:139], a[156:159], v[72:75]
    s_mov_b32 s72, 29312
    s_add_u32 m0, s11, 94208
    v_mfma_f32_16x16x32_bf16 v[76:79], a[136:139], a[160:163], v[76:79]
    buffer_load_dwordx4 v206, s[32:35], s72 offen lds
    v_mfma_f32_16x16x32_bf16 v[80:83], a[136:139], a[164:167], v[80:83]
    v_mfma_f32_16x16x32_bf16 v[84:87], a[140:143], a[156:159], v[84:87]
    s_waitcnt vmcnt(19) lgkmcnt(0)
    s_barrier
    v_mfma_f32_16x16x32_bf16 v[88:91], a[140:143], a[160:163], v[88:91]
    s_add_u32 m0, s11, 94208
    ds_read_b64_tr_b16 a[128:129], v192
    ds_read_b64_tr_b16 a[130:131], v192 offset:2048
    v_mfma_f32_16x16x32_bf16 v[92:95], a[140:143], a[164:167], v[92:95]
    buffer_load_dwordx4 v207, s[32:35], s72 offen offset:1024 lds
    v_mfma_f32_16x16x32_bf16 v[96:99], a[96:99], a[156:159], v[96:99]
    ds_read_b128 a[168:171], v200
    v_mfma_f32_16x16x32_bf16 v[100:103], a[96:99], a[160:163], v[100:103]
    ds_read_b64_tr_b16 a[132:133], v193
    ds_read_b64_tr_b16 a[134:135], v193 offset:2048
    v_mfma_f32_16x16x32_bf16 v[104:107], a[96:99], a[164:167], v[104:107]
    v_mfma_f32_16x16x32_bf16 v[108:111], a[100:103], a[156:159], v[108:111]
    s_mov_b32 s9, 2883584
    s_add_u32 m0, s10, 49152
    ds_read_b128 a[172:175], v200 offset:2048
    ds_read_b64_tr_b16 a[136:137], v194
    v_mfma_f32_16x16x32_bf16 v[112:115], a[100:103], a[160:163], v[112:115]
    ds_read_b64_tr_b16 a[138:139], v194 offset:2048
    buffer_load_dwordx4 v202, s[36:39], s9 offen lds
    v_mfma_f32_16x16x32_bf16 v[116:119], a[100:103], a[164:167], v[116:119]
    v_mfma_f32_16x16x32_bf16 v[120:123], a[104:107], a[156:159], v[120:123]
    ds_read_b128 a[176:179], v200 offset:4096
    ds_read_b64_tr_b16 a[140:141], v195
    v_mfma_f32_16x16x32_bf16 v[124:127], a[104:107], a[160:163], v[124:127]
    ds_read_b64_tr_b16 a[142:143], v195 offset:2048
    buffer_load_dwordx4 a[36:39], v245, s[40:43], s8 offen offset:1024 nt
    v_mfma_f32_16x16x32_bf16 v[128:131], a[104:107], a[164:167], v[128:131]
    ds_read_b64_tr_b16 a[96:97], v196
    ds_read_b64_tr_b16 a[98:99], v196 offset:2048
    v_mfma_f32_16x16x32_bf16 v[132:135], a[108:111], a[156:159], v[132:135]
    ds_read_b128 a[144:147], v201
    v_mfma_f32_16x16x32_bf16 v[136:139], a[108:111], a[160:163], v[136:139]
    v_mfma_f32_16x16x32_bf16 v[140:143], a[108:111], a[164:167], v[140:143]
    ds_read_b64_tr_b16 a[100:101], v197
    ds_read_b64_tr_b16 a[102:103], v197 offset:2048
    v_mfma_f32_16x16x32_bf16 v[144:147], a[112:115], a[156:159], v[144:147]
    s_add_u32 m0, s10, 49152
    ds_read_b128 a[148:151], v201 offset:2048
    v_mfma_f32_16x16x32_bf16 v[148:151], a[112:115], a[160:163], v[148:151]
    buffer_load_dwordx4 v203, s[36:39], s9 offen offset:1024 lds
    v_mfma_f32_16x16x32_bf16 v[152:155], a[112:115], a[164:167], v[152:155]
    s_add_u32 m0, s10, 49152
    ds_read_b64_tr_b16 a[104:105], v198
    ds_read_b64_tr_b16 a[106:107], v198 offset:2048
    v_mfma_f32_16x16x32_bf16 v[156:159], a[116:119], a[156:159], v[156:159]
    ds_read_b128 a[152:155], v201 offset:4096
    buffer_load_dwordx4 v204, s[36:39], s9 offen offset:2048 lds
    v_mfma_f32_16x16x32_bf16 v[160:163], a[116:119], a[160:163], v[160:163]
    ds_read_b64_tr_b16 a[108:109], v199
    ds_read_b64_tr_b16 a[110:111], v199 offset:2048
    v_mfma_f32_16x16x32_bf16 v[164:167], a[116:119], a[164:167], v[164:167]
    v_mfma_f32_16x16x32_bf16 v[168:171], a[120:123], a[156:159], v[168:171]
    v_mfma_f32_16x16x32_bf16 v[172:175], a[120:123], a[160:163], v[172:175]
    s_add_u32 m0, s10, 49152
    ds_read_b64_tr_b16 a[112:113], v192 offset:256
    ds_read_b64_tr_b16 a[114:115], v192 offset:2304
    v_mfma_f32_16x16x32_bf16 v[176:179], a[120:123], a[164:167], v[176:179]
    buffer_load_dwordx4 v205, s[36:39], s9 offen offset:3072 lds
    v_mfma_f32_16x16x32_bf16 v[180:183], a[124:127], a[156:159], v[180:183]
    ds_read_b64_tr_b16 a[116:117], v193 offset:256
    ds_read_b64_tr_b16 a[118:119], v193 offset:2304
    v_mfma_f32_16x16x32_bf16 v[184:187], a[124:127], a[160:163], v[184:187]
    v_mfma_f32_16x16x32_bf16 v[188:191], a[124:127], a[164:167], v[188:191]
    s_waitcnt lgkmcnt(14)
    buffer_load_dwordx4 a[40:43], v246, s[40:43], s8 offen offset:2048 nt
    v_mfma_f32_16x16x32_bf16 v[0:3], a[128:131], a[168:171], v[0:3]
    ds_read_b64_tr_b16 a[120:121], v194 offset:256
    ds_read_b64_tr_b16 a[122:123], v194 offset:2304
    v_mfma_f32_16x16x32_bf16 v[4:7], a[128:131], a[172:175], v[4:7]
    v_mfma_f32_16x16x32_bf16 v[8:11], a[128:131], a[176:179], v[8:11]
    v_mfma_f32_16x16x32_bf16 v[12:15], a[132:135], a[168:171], v[12:15]
    ds_read_b64_tr_b16 a[124:125], v195 offset:256
    ds_read_b64_tr_b16 a[126:127], v195 offset:2304
    v_mfma_f32_16x16x32_bf16 v[16:19], a[132:135], a[172:175], v[16:19]
    v_mfma_f32_16x16x32_bf16 v[20:23], a[132:135], a[176:179], v[20:23]
    ds_read_b64_tr_b16 a[128:129], v196 offset:256
    ds_read_b64_tr_b16 a[130:131], v196 offset:2304
    v_mfma_f32_16x16x32_bf16 v[24:27], a[136:139], a[168:171], v[24:27]
    v_mfma_f32_16x16x32_bf16 v[28:31], a[136:139], a[172:175], v[28:31]
    v_mfma_f32_16x16x32_bf16 v[32:35], a[136:139], a[176:179], v[32:35]
    ds_read_b64_tr_b16 a[132:133], v197 offset:256
    ds_read_b64_tr_b16 a[134:135], v197 offset:2304
    v_mfma_f32_16x16x32_bf16 v[36:39], a[140:143], a[168:171], v[36:39]
    v_mfma_f32_16x16x32_bf16 v[40:43], a[140:143], a[172:175], v[40:43]
    ds_read_b64_tr_b16 a[136:137], v198 offset:256
    ds_read_b64_tr_b16 a[138:139], v198 offset:2304
    v_mfma_f32_16x16x32_bf16 v[44:47], a[140:143], a[176:179], v[44:47]
    s_waitcnt lgkmcnt(14)
    v_mfma_f32_16x16x32_bf16 v[48:51], a[96:99], a[168:171], v[48:51]
    v_mfma_f32_16x16x32_bf16 v[52:55], a[96:99], a[172:175], v[52:55]
    ds_read_b64_tr_b16 a[140:141], v199 offset:256
    ds_read_b64_tr_b16 a[142:143], v199 offset:2304
    v_mfma_f32_16x16x32_bf16 v[56:59], a[96:99], a[176:179], v[56:59]
    buffer_load_dwordx4 a[44:47], v247, s[40:43], s8 offen offset:3072 nt
    v_mfma_f32_16x16x32_bf16 v[60:63], a[100:103], a[168:171], v[60:63]
    v_mfma_f32_16x16x32_bf16 v[64:67], a[100:103], a[172:175], v[64:67]
    v_mfma_f32_16x16x32_bf16 v[68:71], a[100:103], a[176:179], v[68:71]
    v_mfma_f32_16x16x32_bf16 v[72:75], a[104:107], a[168:171], v[72:75]
    v_mfma_f32_16x16x32_bf16 v[76:79], a[104:107], a[172:175], v[76:79]
    v_mfma_f32_16x16x32_bf16 v[80:83], a[104:107], a[176:179], v[80:83]
    v_mfma_f32_16x16x32_bf16 v[84:87], a[108:111], a[168:171], v[84:87]
    s_waitcnt vmcnt(21) lgkmcnt(0)
    s_barrier
    v_mfma_f32_16x16x32_bf16 v[88:91], a[108:111], a[172:175], v[88:91]
    s_mov_b32 s9, 3145728
    s_add_u32 m0, s10, 0
    ds_read_b64_tr_b16 a[96:97], v192 offset:16384
    ds_read_b64_tr_b16 a[98:99], v192 offset:18432
    v_mfma_f32_16x16x32_bf16 v[92:95], a[108:111], a[176:179], v[92:95]
    buffer_load_dwordx4 v202, s[36:39], s9 offen lds
    v_mfma_f32_16x16x32_bf16 v[96:99], a[112:115], a[168:171], v[96:99]
    v_mfma_f32_16x16x32_bf16 v[100:103], a[112:115], a[172:175], v[100:103]
    ds_read_b64_tr_b16 a[100:101], v193 offset:16384
    ds_read_b64_tr_b16 a[102:103], v193 offset:18432
    v_mfma_f32_16x16x32_bf16 v[104:107], a[112:115], a[176:179], v[104:107]
    v_mfma_f32_16x16x32_bf16 v[108:111], a[116:119], a[168:171], v[108:111]
    s_add_u32 m0, s10, 0
    ds_read_b64_tr_b16 a[104:105], v194 offset:16384
    ds_read_b64_tr_b16 a[106:107], v194 offset:18432
    v_mfma_f32_16x16x32_bf16 v[112:115], a[116:119], a[172:175], v[112:115]
    buffer_load_dwordx4 v203, s[36:39], s9 offen offset:1024 lds
    v_mfma_f32_16x16x32_bf16 v[116:119], a[116:119], a[176:179], v[116:119]
    v_mfma_f32_16x16x32_bf16 v[120:123], a[120:123], a[168:171], v[120:123]
    ds_read_b64_tr_b16 a[108:109], v195 offset:16384
    ds_read_b64_tr_b16 a[110:111], v195 offset:18432
    v_mfma_f32_16x16x32_bf16 v[124:127], a[120:123], a[172:175], v[124:127]
    s_mov_b32 s8, 98304
    buffer_load_dwordx4 a[48:51], v244, s[40:43], s8 offen nt
    v_mfma_f32_16x16x32_bf16 v[128:131], a[120:123], a[176:179], v[128:131]
    ds_read_b64_tr_b16 a[112:113], v196 offset:16384
    ds_read_b64_tr_b16 a[114:115], v196 offset:18432
    v_mfma_f32_16x16x32_bf16 v[132:135], a[124:127], a[168:171], v[132:135]
    v_mfma_f32_16x16x32_bf16 v[136:139], a[124:127], a[172:175], v[136:139]
    v_mfma_f32_16x16x32_bf16 v[140:143], a[124:127], a[176:179], v[140:143]
    ds_read_b64_tr_b16 a[116:117], v197 offset:16384
    ds_read_b64_tr_b16 a[118:119], v197 offset:18432
    v_mfma_f32_16x16x32_bf16 v[144:147], a[128:131], a[168:171], v[144:147]
    s_add_u32 m0, s10, 0
    v_mfma_f32_16x16x32_bf16 v[148:151], a[128:131], a[172:175], v[148:151]
    buffer_load_dwordx4 v204, s[36:39], s9 offen offset:2048 lds
    v_mfma_f32_16x16x32_bf16 v[152:155], a[128:131], a[176:179], v[152:155]
    s_add_u32 m0, s10, 0
    ds_read_b64_tr_b16 a[120:121], v198 offset:16384
    ds_read_b64_tr_b16 a[122:123], v198 offset:18432
    v_mfma_f32_16x16x32_bf16 v[156:159], a[132:135], a[168:171], v[156:159]
    buffer_load_dwordx4 v205, s[36:39], s9 offen offset:3072 lds
    v_mfma_f32_16x16x32_bf16 v[160:163], a[132:135], a[172:175], v[160:163]
    ds_read_b64_tr_b16 a[124:125], v199 offset:16384
    ds_read_b64_tr_b16 a[126:127], v199 offset:18432
    v_mfma_f32_16x16x32_bf16 v[164:167], a[132:135], a[176:179], v[164:167]
    v_mfma_f32_16x16x32_bf16 v[168:171], a[136:139], a[168:171], v[168:171]
    v_mfma_f32_16x16x32_bf16 v[172:175], a[136:139], a[172:175], v[172:175]
    s_mov_b32 s72, 768
    s_add_u32 m0, s11, 65536
    ds_read_b64_tr_b16 a[128:129], v192 offset:16640
    ds_read_b64_tr_b16 a[130:131], v192 offset:18688
    v_mfma_f32_16x16x32_bf16 v[176:179], a[136:139], a[176:179], v[176:179]
    buffer_load_dwordx4 v206, s[32:35], s72 offen lds
    v_mfma_f32_16x16x32_bf16 v[180:183], a[140:143], a[168:171], v[180:183]
    ds_read_b64_tr_b16 a[132:133], v193 offset:16640
    ds_read_b64_tr_b16 a[134:135], v193 offset:18688
    v_mfma_f32_16x16x32_bf16 v[184:187], a[140:143], a[172:175], v[184:187]
    s_add_u32 m0, s11, 65536
    v_mfma_f32_16x16x32_bf16 v[188:191], a[140:143], a[176:179], v[188:191]
    s_waitcnt lgkmcnt(14)
    buffer_load_dwordx4 v207, s[32:35], s72 offen offset:1024 lds
    v_mfma_f32_16x16x32_bf16 v[0:3], a[96:99], a[144:147], v[0:3]
    ds_read_b64_tr_b16 a[136:137], v194 offset:16640
    ds_read_b64_tr_b16 a[138:139], v194 offset:18688
    v_mfma_f32_16x16x32_bf16 v[4:7], a[96:99], a[148:151], v[4:7]
    v_mfma_f32_16x16x32_bf16 v[8:11], a[96:99], a[152:155], v[8:11]
    v_mfma_f32_16x16x32_bf16 v[12:15], a[100:103], a[144:147], v[12:15]
    ds_read_b64_tr_b16 a[140:141], v195 offset:16640
    ds_read_b64_tr_b16 a[142:143], v195 offset:18688
    v_mfma_f32_16x16x32_bf16 v[16:19], a[100:103], a[148:151], v[16:19]
    buffer_load_dwordx4 a[52:55], v245, s[40:43], s8 offen offset:1024 nt
    v_mfma_f32_16x16x32_bf16 v[20:23], a[100:103], a[152:155], v[20:23]
    s_waitcnt lgkmcnt(14)
    ds_read_b64_tr_b16 a[96:97], v196 offset:16640
    ds_read_b64_tr_b16 a[98:99], v196 offset:18688
    v_mfma_f32_16x16x32_bf16 v[24:27], a[104:107], a[144:147], v[24:27]
    s_add_u32 m0, s11, 65536
    v_mfma_f32_16x16x32_bf16 v[28:31], a[104:107], a[148:151], v[28:31]
    buffer_load_dwordx4 v208, s[32:35], s72 offen offset:2048 lds
    v_mfma_f32_16x16x32_bf16 v[32:35], a[104:107], a[152:155], v[32:35]
    ds_read_b64_tr_b16 a[100:101], v197 offset:16640
    ds_read_b64_tr_b16 a[102:103], v197 offset:18688
    v_mfma_f32_16x16x32_bf16 v[36:39], a[108:111], a[144:147], v[36:39]
    v_mfma_f32_16x16x32_bf16 v[40:43], a[108:111], a[148:151], v[40:43]
    s_add_u32 m0, s11, 65536
    ds_read_b64_tr_b16 a[104:105], v198 offset:16640
    ds_read_b64_tr_b16 a[106:107], v198 offset:18688
    v_mfma_f32_16x16x32_bf16 v[44:47], a[108:111], a[152:155], v[44:47]
    s_waitcnt lgkmcnt(14)
    buffer_load_dwordx4 v209, s[32:35], s72 offen offset:3072 lds
    v_mfma_f32_16x16x32_bf16 v[48:51], a[112:115], a[144:147], v[48:51]
    v_mfma_f32_16x16x32_bf16 v[52:55], a[112:115], a[148:151], v[52:55]
    ds_read_b64_tr_b16 a[108:109], v199 offset:16640
    ds_read_b64_tr_b16 a[110:111], v199 offset:18688
    v_mfma_f32_16x16x32_bf16 v[56:59], a[112:115], a[152:155], v[56:59]
    s_mov_b32 s72, 29440
    s_add_u32 m0, s11, 69632
    v_mfma_f32_16x16x32_bf16 v[60:63], a[116:119], a[144:147], v[60:63]
    buffer_load_dwordx4 v206, s[32:35], s72 offen lds
    v_mfma_f32_16x16x32_bf16 v[64:67], a[116:119], a[148:151], v[64:67]
    v_mfma_f32_16x16x32_bf16 v[68:71], a[116:119], a[152:155], v[68:71]
    v_mfma_f32_16x16x32_bf16 v[72:75], a[120:123], a[144:147], v[72:75]
    v_mfma_f32_16x16x32_bf16 v[76:79], a[120:123], a[148:151], v[76:79]
    buffer_load_dwordx4 a[56:59], v246, s[40:43], s8 offen offset:2048 nt
    v_mfma_f32_16x16x32_bf16 v[80:83], a[120:123], a[152:155], v[80:83]
    v_mfma_f32_16x16x32_bf16 v[84:87], a[124:127], a[144:147], v[84:87]
    s_waitcnt vmcnt(19) lgkmcnt(0)
    s_barrier
    v_mfma_f32_16x16x32_bf16 v[88:91], a[124:127], a[148:151], v[88:91]
    s_add_u32 m0, s11, 69632
    ds_read_b64_tr_b16 a[112:113], v192 offset:32768
    ds_read_b64_tr_b16 a[114:115], v192 offset:34816
    v_mfma_f32_16x16x32_bf16 v[92:95], a[124:127], a[152:155], v[92:95]
    buffer_load_dwordx4 v207, s[32:35], s72 offen offset:1024 lds
    v_mfma_f32_16x16x32_bf16 v[96:99], a[128:131], a[144:147], v[96:99]
    ds_read_b128 a[156:159], v200 offset:24576
    v_mfma_f32_16x16x32_bf16 v[100:103], a[128:131], a[148:151], v[100:103]
    ds_read_b64_tr_b16 a[116:117], v193 offset:32768
    ds_read_b64_tr_b16 a[118:119], v193 offset:34816
    v_mfma_f32_16x16x32_bf16 v[104:107], a[128:131], a[152:155], v[104:107]
    v_mfma_f32_16x16x32_bf16 v[108:111], a[132:135], a[144:147], v[108:111]
    s_mov_b32 s9, 3407872
    s_add_u32 m0, s10, 16384
    ds_read_b128 a[160:163], v200 offset:26624
    ds_read_b64_tr_b16 a[120:121], v194 offset:32768
    v_mfma_f32_16x16x32_bf16 v[112:115], a[132:135], a[148:151], v[112:115]
    ds_read_b64_tr_b16 a[122:123], v194 offset:34816
    buffer_load_dwordx4 v202, s[36:39], s9 offen lds
    v_mfma_f32_16x16x32_bf16 v[116:119], a[132:135], a[152:155], v[116:119]
    v_mfma_f32_16x16x32_bf16 v[120:123], a[136:139], a[144:147], v[120:123]
    s_add_u32 m0, s10, 16384
    ds_read_b128 a[164:167], v200 offset:28672
    ds_read_b64_tr_b16 a[124:125], v195 offset:32768
    v_mfma_f32_16x16x32_bf16 v[124:127], a[136:139], a[148:151], v[124:127]
    ds_read_b64_tr_b16 a[126:127], v195 offset:34816
    buffer_load_dwordx4 v203, s[36:39], s9 offen offset:1024 lds
    v_mfma_f32_16x16x32_bf16 v[128:131], a[136:139], a[152:155], v[128:131]
    ds_read_b64_tr_b16 a[128:129], v196 offset:32768
    ds_read_b64_tr_b16 a[130:131], v196 offset:34816
    v_mfma_f32_16x16x32_bf16 v[132:135], a[140:143], a[144:147], v[132:135]
    ds_read_b128 a[168:171], v201 offset:24576
    v_mfma_f32_16x16x32_bf16 v[136:139], a[140:143], a[148:151], v[136:139]
    v_mfma_f32_16x16x32_bf16 v[140:143], a[140:143], a[152:155], v[140:143]
    ds_read_b64_tr_b16 a[132:133], v197 offset:32768
    ds_read_b64_tr_b16 a[134:135], v197 offset:34816
    v_mfma_f32_16x16x32_bf16 v[144:147], a[96:99], a[144:147], v[144:147]
    ds_read_b128 a[172:175], v201 offset:26624
    buffer_load_dwordx4 a[60:63], v247, s[40:43], s8 offen offset:3072 nt
    v_mfma_f32_16x16x32_bf16 v[148:151], a[96:99], a[148:151], v[148:151]
    v_mfma_f32_16x16x32_bf16 v[152:155], a[96:99], a[152:155], v[152:155]
    s_add_u32 m0, s10, 16384
    ds_read_b64_tr_b16 a[136:137], v198 offset:32768
    ds_read_b64_tr_b16 a[138:139], v198 offset:34816
    v_mfma_f32_16x16x32_bf16 v[156:159], a[100:103], a[144:147], v[156:159]
    ds_read_b128 a[176:179], v201 offset:28672
    buffer_load_dwordx4 v204, s[36:39], s9 offen offset:2048 lds
    v_mfma_f32_16x16x32_bf16 v[160:163], a[100:103], a[148:151], v[160:163]
    ds_read_b64_tr_b16 a[140:141], v199 offset:32768
    ds_read_b64_tr_b16 a[142:143], v199 offset:34816
    v_mfma_f32_16x16x32_bf16 v[164:167], a[100:103], a[152:155], v[164:167]
    v_mfma_f32_16x16x32_bf16 v[168:171], a[104:107], a[144:147], v[168:171]
    v_mfma_f32_16x16x32_bf16 v[172:175], a[104:107], a[148:151], v[172:175]
    s_add_u32 m0, s10, 16384
    ds_read_b64_tr_b16 a[96:97], v192 offset:33024
    ds_read_b64_tr_b16 a[98:99], v192 offset:35072
    v_mfma_f32_16x16x32_bf16 v[176:179], a[104:107], a[152:155], v[176:179]
    buffer_load_dwordx4 v205, s[36:39], s9 offen offset:3072 lds
    v_mfma_f32_16x16x32_bf16 v[180:183], a[108:111], a[144:147], v[180:183]
    ds_read_b64_tr_b16 a[100:101], v193 offset:33024
    ds_read_b64_tr_b16 a[102:103], v193 offset:35072
    v_mfma_f32_16x16x32_bf16 v[184:187], a[108:111], a[148:151], v[184:187]
    v_mfma_f32_16x16x32_bf16 v[188:191], a[108:111], a[152:155], v[188:191]
    s_waitcnt lgkmcnt(14)
    v_mfma_f32_16x16x32_bf16 v[0:3], a[112:115], a[156:159], v[0:3]
    ds_read_b64_tr_b16 a[104:105], v194 offset:33024
    ds_read_b64_tr_b16 a[106:107], v194 offset:35072
    v_mfma_f32_16x16x32_bf16 v[4:7], a[112:115], a[160:163], v[4:7]
    v_mfma_f32_16x16x32_bf16 v[8:11], a[112:115], a[164:167], v[8:11]
    v_mfma_f32_16x16x32_bf16 v[12:15], a[116:119], a[156:159], v[12:15]
    ds_read_b64_tr_b16 a[108:109], v195 offset:33024
    ds_read_b64_tr_b16 a[110:111], v195 offset:35072
    v_mfma_f32_16x16x32_bf16 v[16:19], a[116:119], a[160:163], v[16:19]
    s_mov_b32 s8, 114688
    buffer_load_dwordx4 a[64:67], v244, s[40:43], s8 offen nt
    v_mfma_f32_16x16x32_bf16 v[20:23], a[116:119], a[164:167], v[20:23]
    ds_read_b64_tr_b16 a[112:113], v196 offset:33024
    ds_read_b64_tr_b16 a[114:115], v196 offset:35072
    v_mfma_f32_16x16x32_bf16 v[24:27], a[120:123], a[156:159], v[24:27]
    v_mfma_f32_16x16x32_bf16 v[28:31], a[120:123], a[160:163], v[28:31]
    v_mfma_f32_16x16x32_bf16 v[32:35], a[120:123], a[164:167], v[32:35]
    ds_read_b64_tr_b16 a[116:117], v197 offset:33024
    ds_read_b64_tr_b16 a[118:119], v197 offset:35072
    v_mfma_f32_16x16x32_bf16 v[36:39], a[124:127], a[156:159], v[36:39]
    v_mfma_f32_16x16x32_bf16 v[40:43], a[124:127], a[160:163], v[40:43]
    ds_read_b64_tr_b16 a[120:121], v198 offset:33024
    ds_read_b64_tr_b16 a[122:123], v198 offset:35072
    v_mfma_f32_16x16x32_bf16 v[44:47], a[124:127], a[164:167], v[44:47]
    s_waitcnt lgkmcnt(14)
    v_mfma_f32_16x16x32_bf16 v[48:51], a[128:131], a[156:159], v[48:51]
    v_mfma_f32_16x16x32_bf16 v[52:55], a[128:131], a[160:163], v[52:55]
    ds_read_b64_tr_b16 a[124:125], v199 offset:33024
    ds_read_b64_tr_b16 a[126:127], v199 offset:35072
    v_mfma_f32_16x16x32_bf16 v[56:59], a[128:131], a[164:167], v[56:59]
    v_mfma_f32_16x16x32_bf16 v[60:63], a[132:135], a[156:159], v[60:63]
    v_mfma_f32_16x16x32_bf16 v[64:67], a[132:135], a[160:163], v[64:67]
    v_mfma_f32_16x16x32_bf16 v[68:71], a[132:135], a[164:167], v[68:71]
    v_mfma_f32_16x16x32_bf16 v[72:75], a[136:139], a[156:159], v[72:75]
    v_mfma_f32_16x16x32_bf16 v[76:79], a[136:139], a[160:163], v[76:79]
    v_mfma_f32_16x16x32_bf16 v[80:83], a[136:139], a[164:167], v[80:83]
    buffer_load_dwordx4 a[68:71], v245, s[40:43], s8 offen offset:1024 nt
    v_mfma_f32_16x16x32_bf16 v[84:87], a[140:143], a[156:159], v[84:87]
    s_waitcnt vmcnt(22) lgkmcnt(0)
    s_barrier
    v_mfma_f32_16x16x32_bf16 v[88:91], a[140:143], a[160:163], v[88:91]
    ds_read_b64_tr_b16 a[128:129], v192 offset:49152
    ds_read_b64_tr_b16 a[130:131], v192 offset:51200
    v_mfma_f32_16x16x32_bf16 v[92:95], a[140:143], a[164:167], v[92:95]
    v_accvgpr_read_b32 v226, a198
    v_mfma_f32_16x16x32_bf16 v[96:99], a[96:99], a[156:159], v[96:99]
    ds_write_b128 v226, a[0:3] offset:32768
    v_mfma_f32_16x16x32_bf16 v[100:103], a[96:99], a[160:163], v[100:103]
    ds_read_b64_tr_b16 a[132:133], v193 offset:49152
    ds_read_b64_tr_b16 a[134:135], v193 offset:51200
    v_mfma_f32_16x16x32_bf16 v[104:107], a[96:99], a[164:167], v[104:107]
    ds_write_b128 v226, a[4:7] offset:33792
    v_mfma_f32_16x16x32_bf16 v[108:111], a[100:103], a[156:159], v[108:111]
    ds_read_b64_tr_b16 a[136:137], v194 offset:49152
    ds_read_b64_tr_b16 a[138:139], v194 offset:51200
    v_mfma_f32_16x16x32_bf16 v[112:115], a[100:103], a[160:163], v[112:115]
    ds_write_b128 v226, a[8:11] offset:34816
    v_mfma_f32_16x16x32_bf16 v[116:119], a[100:103], a[164:167], v[116:119]
    v_mfma_f32_16x16x32_bf16 v[120:123], a[104:107], a[156:159], v[120:123]
    ds_read_b64_tr_b16 a[140:141], v195 offset:49152
    ds_read_b64_tr_b16 a[142:143], v195 offset:51200
    v_mfma_f32_16x16x32_bf16 v[124:127], a[104:107], a[160:163], v[124:127]
    ds_write_b128 v226, a[12:15] offset:35840
    v_mfma_f32_16x16x32_bf16 v[128:131], a[104:107], a[164:167], v[128:131]
    ds_read_b64_tr_b16 a[96:97], v196 offset:49152
    ds_read_b64_tr_b16 a[98:99], v196 offset:51200
    v_mfma_f32_16x16x32_bf16 v[132:135], a[108:111], a[156:159], v[132:135]
    v_mfma_f32_16x16x32_bf16 v[136:139], a[108:111], a[160:163], v[136:139]
    v_mfma_f32_16x16x32_bf16 v[140:143], a[108:111], a[164:167], v[140:143]
    ds_read_b64_tr_b16 a[100:101], v197 offset:49152
    ds_read_b64_tr_b16 a[102:103], v197 offset:51200
    v_mfma_f32_16x16x32_bf16 v[144:147], a[112:115], a[156:159], v[144:147]
    v_accvgpr_read_b32 v226, a198
    v_add_u32 v226, 65536, v226
    v_mfma_f32_16x16x32_bf16 v[148:151], a[112:115], a[160:163], v[148:151]
    buffer_load_dwordx4 a[72:75], v246, s[40:43], s8 offen offset:2048 nt
    v_mfma_f32_16x16x32_bf16 v[152:155], a[112:115], a[164:167], v[152:155]
    ds_read_b64_tr_b16 a[104:105], v198 offset:49152
    ds_read_b64_tr_b16 a[106:107], v198 offset:51200
    v_mfma_f32_16x16x32_bf16 v[156:159], a[116:119], a[156:159], v[156:159]
    ds_write_b128 v226, a[16:19] offset:32768
    v_mfma_f32_16x16x32_bf16 v[160:163], a[116:119], a[160:163], v[160:163]
    ds_read_b64_tr_b16 a[108:109], v199 offset:49152
    ds_read_b64_tr_b16 a[110:111], v199 offset:51200
    v_mfma_f32_16x16x32_bf16 v[164:167], a[116:119], a[164:167], v[164:167]
    ds_write_b128 v226, a[20:23] offset:33792
    v_mfma_f32_16x16x32_bf16 v[168:171], a[120:123], a[156:159], v[168:171]
    v_mfma_f32_16x16x32_bf16 v[172:175], a[120:123], a[160:163], v[172:175]
    ds_read_b64_tr_b16 a[112:113], v192 offset:49408
    ds_read_b64_tr_b16 a[114:115], v192 offset:51456
    v_mfma_f32_16x16x32_bf16 v[176:179], a[120:123], a[164:167], v[176:179]
    ds_write_b128 v226, a[24:27] offset:34816
    v_mfma_f32_16x16x32_bf16 v[180:183], a[124:127], a[156:159], v[180:183]
    ds_read_b64_tr_b16 a[116:117], v193 offset:49408
    ds_read_b64_tr_b16 a[118:119], v193 offset:51456
    v_mfma_f32_16x16x32_bf16 v[184:187], a[124:127], a[160:163], v[184:187]
    ds_write_b128 v226, a[28:31] offset:35840
    v_mfma_f32_16x16x32_bf16 v[188:191], a[124:127], a[164:167], v[188:191]
    s_waitcnt lgkmcnt(14)
    v_mfma_f32_16x16x32_bf16 v[0:3], a[128:131], a[168:171], v[0:3]
    ds_read_b64_tr_b16 a[120:121], v194 offset:49408
    ds_read_b64_tr_b16 a[122:123], v194 offset:51456
    v_mfma_f32_16x16x32_bf16 v[4:7], a[128:131], a[172:175], v[4:7]
    buffer_load_dwordx4 a[76:79], v247, s[40:43], s8 offen offset:3072 nt
    v_mfma_f32_16x16x32_bf16 v[8:11], a[128:131], a[176:179], v[8:11]
    v_mfma_f32_16x16x32_bf16 v[12:15], a[132:135], a[168:171], v[12:15]
    ds_read_b64_tr_b16 a[124:125], v195 offset:49408
    ds_read_b64_tr_b16 a[126:127], v195 offset:51456
    v_mfma_f32_16x16x32_bf16 v[16:19], a[132:135], a[172:175], v[16:19]
    v_mfma_f32_16x16x32_bf16 v[20:23], a[132:135], a[176:179], v[20:23]
    ds_read_b64_tr_b16 a[128:129], v196 offset:49408
    ds_read_b64_tr_b16 a[130:131], v196 offset:51456
    v_mfma_f32_16x16x32_bf16 v[24:27], a[136:139], a[168:171], v[24:27]
    v_mfma_f32_16x16x32_bf16 v[28:31], a[136:139], a[172:175], v[28:31]
    v_mfma_f32_16x16x32_bf16 v[32:35], a[136:139], a[176:179], v[32:35]
    ds_read_b64_tr_b16 a[132:133], v197 offset:49408
    ds_read_b64_tr_b16 a[134:135], v197 offset:51456
    v_mfma_f32_16x16x32_bf16 v[36:39], a[140:143], a[168:171], v[36:39]
    v_mfma_f32_16x16x32_bf16 v[40:43], a[140:143], a[172:175], v[40:43]
    ds_read_b64_tr_b16 a[136:137], v198 offset:49408
    ds_read_b64_tr_b16 a[138:139], v198 offset:51456
    v_mfma_f32_16x16x32_bf16 v[44:47], a[140:143], a[176:179], v[44:47]
    s_waitcnt lgkmcnt(14)
    v_mfma_f32_16x16x32_bf16 v[48:51], a[96:99], a[168:171], v[48:51]
    v_mfma_f32_16x16x32_bf16 v[52:55], a[96:99], a[172:175], v[52:55]
    ds_read_b64_tr_b16 a[140:141], v199 offset:49408
    ds_read_b64_tr_b16 a[142:143], v199 offset:51456
    v_mfma_f32_16x16x32_bf16 v[56:59], a[96:99], a[176:179], v[56:59]
    s_mov_b32 s8, 131072
    buffer_load_dwordx4 a[80:83], v244, s[40:43], s8 offen nt
    v_mfma_f32_16x16x32_bf16 v[60:63], a[100:103], a[168:171], v[60:63]
    v_mfma_f32_16x16x32_bf16 v[64:67], a[100:103], a[172:175], v[64:67]
    v_mfma_f32_16x16x32_bf16 v[68:71], a[100:103], a[176:179], v[68:71]
    v_mfma_f32_16x16x32_bf16 v[72:75], a[104:107], a[168:171], v[72:75]
    v_mfma_f32_16x16x32_bf16 v[76:79], a[104:107], a[172:175], v[76:79]
    v_mfma_f32_16x16x32_bf16 v[80:83], a[104:107], a[176:179], v[80:83]
    v_mfma_f32_16x16x32_bf16 v[84:87], a[108:111], a[168:171], v[84:87]
    s_waitcnt vmcnt(10) lgkmcnt(0)
    s_barrier
    v_mfma_f32_16x16x32_bf16 v[88:91], a[108:111], a[172:175], v[88:91]
    ds_read_b64_tr_b16 a[96:97], v192
    ds_read_b64_tr_b16 a[98:99], v192 offset:2048
    v_mfma_f32_16x16x32_bf16 v[92:95], a[108:111], a[176:179], v[92:95]
    v_accvgpr_read_b32 v226, a198
    v_mfma_f32_16x16x32_bf16 v[96:99], a[112:115], a[168:171], v[96:99]
    ds_read_b128 a[144:147], v200
    v_mfma_f32_16x16x32_bf16 v[100:103], a[112:115], a[172:175], v[100:103]
    ds_read_b64_tr_b16 a[100:101], v193
    ds_read_b64_tr_b16 a[102:103], v193 offset:2048
    v_mfma_f32_16x16x32_bf16 v[104:107], a[112:115], a[176:179], v[104:107]
    buffer_load_dwordx4 a[84:87], v245, s[40:43], s8 offen offset:1024 nt
    v_mfma_f32_16x16x32_bf16 v[108:111], a[116:119], a[168:171], v[108:111]
    ds_read_b128 a[148:151], v200 offset:2048
    ds_read_b64_tr_b16 a[104:105], v194
    v_mfma_f32_16x16x32_bf16 v[112:115], a[116:119], a[172:175], v[112:115]
    ds_read_b64_tr_b16 a[106:107], v194 offset:2048
    v_mfma_f32_16x16x32_bf16 v[116:119], a[116:119], a[176:179], v[116:119]
    ds_write_b128 v226, a[32:35] offset:49152
    v_mfma_f32_16x16x32_bf16 v[120:123], a[120:123], a[168:171], v[120:123]
    ds_read_b128 a[152:155], v200 offset:4096
    ds_read_b64_tr_b16 a[108:109], v195
    v_mfma_f32_16x16x32_bf16 v[124:127], a[120:123], a[172:175], v[124:127]
    ds_read_b64_tr_b16 a[110:111], v195 offset:2048
    v_mfma_f32_16x16x32_bf16 v[128:131], a[120:123], a[176:179], v[128:131]
    ds_read_b64_tr_b16 a[112:113], v196
    ds_read_b64_tr_b16 a[114:115], v196 offset:2048
    v_mfma_f32_16x16x32_bf16 v[132:135], a[124:127], a[168:171], v[132:135]
    ds_read_b128 a[156:159], v201
    v_mfma_f32_16x16x32_bf16 v[136:139], a[124:127], a[172:175], v[136:139]
    ds_write_b128 v226, a[36:39] offset:50176
    v_mfma_f32_16x16x32_bf16 v[140:143], a[124:127], a[176:179], v[140:143]
    ds_read_b64_tr_b16 a[116:117], v197
    ds_read_b64_tr_b16 a[118:119], v197 offset:2048
    v_mfma_f32_16x16x32_bf16 v[144:147], a[128:131], a[168:171], v[144:147]
    ds_read_b128 a[160:163], v201 offset:2048
    v_mfma_f32_16x16x32_bf16 v[148:151], a[128:131], a[172:175], v[148:151]
    buffer_load_dwordx4 a[88:91], v246, s[40:43], s8 offen offset:2048 nt
    v_mfma_f32_16x16x32_bf16 v[152:155], a[128:131], a[176:179], v[152:155]
    ds_read_b64_tr_b16 a[120:121], v198
    ds_read_b64_tr_b16 a[122:123], v198 offset:2048
    v_mfma_f32_16x16x32_bf16 v[156:159], a[132:135], a[168:171], v[156:159]
    ds_read_b128 a[164:167], v201 offset:4096
    v_mfma_f32_16x16x32_bf16 v[160:163], a[132:135], a[172:175], v[160:163]
    ds_read_b64_tr_b16 a[124:125], v199
    ds_read_b64_tr_b16 a[126:127], v199 offset:2048
    v_mfma_f32_16x16x32_bf16 v[164:167], a[132:135], a[176:179], v[164:167]
    ds_write_b128 v226, a[40:43] offset:51200
    v_mfma_f32_16x16x32_bf16 v[168:171], a[136:139], a[168:171], v[168:171]
    v_mfma_f32_16x16x32_bf16 v[172:175], a[136:139], a[172:175], v[172:175]
    ds_read_b64_tr_b16 a[128:129], v192 offset:256
    ds_read_b64_tr_b16 a[130:131], v192 offset:2304
    v_mfma_f32_16x16x32_bf16 v[176:179], a[136:139], a[176:179], v[176:179]
    ds_write_b128 v226, a[44:47] offset:52224
    v_mfma_f32_16x16x32_bf16 v[180:183], a[140:143], a[168:171], v[180:183]
    ds_read_b64_tr_b16 a[132:133], v193 offset:256
    ds_read_b64_tr_b16 a[134:135], v193 offset:2304
    v_mfma_f32_16x16x32_bf16 v[184:187], a[140:143], a[172:175], v[184:187]
    v_mfma_f32_16x16x32_bf16 v[188:191], a[140:143], a[176:179], v[188:191]
    s_waitcnt lgkmcnt(14)
    v_mfma_f32_16x16x32_bf16 v[0:3], a[96:99], a[144:147], v[0:3]
    ds_read_b64_tr_b16 a[136:137], v194 offset:256
    ds_read_b64_tr_b16 a[138:139], v194 offset:2304
    v_mfma_f32_16x16x32_bf16 v[4:7], a[96:99], a[148:151], v[4:7]
    buffer_load_dwordx4 a[92:95], v247, s[40:43], s8 offen offset:3072 nt
    v_mfma_f32_16x16x32_bf16 v[8:11], a[96:99], a[152:155], v[8:11]
    v_mfma_f32_16x16x32_bf16 v[12:15], a[100:103], a[144:147], v[12:15]
    ds_read_b64_tr_b16 a[140:141], v195 offset:256
    ds_read_b64_tr_b16 a[142:143], v195 offset:2304
    v_mfma_f32_16x16x32_bf16 v[16:19], a[100:103], a[148:151], v[16:19]
    v_mfma_f32_16x16x32_bf16 v[20:23], a[100:103], a[152:155], v[20:23]
    ds_read_b64_tr_b16 a[96:97], v196 offset:256
    ds_read_b64_tr_b16 a[98:99], v196 offset:2304
    v_mfma_f32_16x16x32_bf16 v[24:27], a[104:107], a[144:147], v[24:27]
    v_mfma_f32_16x16x32_bf16 v[28:31], a[104:107], a[148:151], v[28:31]
    v_mfma_f32_16x16x32_bf16 v[32:35], a[104:107], a[152:155], v[32:35]
    ds_read_b64_tr_b16 a[100:101], v197 offset:256
    ds_read_b64_tr_b16 a[102:103], v197 offset:2304
    v_mfma_f32_16x16x32_bf16 v[36:39], a[108:111], a[144:147], v[36:39]
    v_mfma_f32_16x16x32_bf16 v[40:43], a[108:111], a[148:151], v[40:43]
    ds_read_b64_tr_b16 a[104:105], v198 offset:256
    ds_read_b64_tr_b16 a[106:107], v198 offset:2304
    v_mfma_f32_16x16x32_bf16 v[44:47], a[108:111], a[152:155], v[44:47]
    s_waitcnt lgkmcnt(14)
    v_mfma_f32_16x16x32_bf16 v[48:51], a[112:115], a[144:147], v[48:51]
    v_mfma_f32_16x16x32_bf16 v[52:55], a[112:115], a[148:151], v[52:55]
    ds_read_b64_tr_b16 a[108:109], v199 offset:256
    ds_read_b64_tr_b16 a[110:111], v199 offset:2304
    v_mfma_f32_16x16x32_bf16 v[56:59], a[112:115], a[152:155], v[56:59]
    v_mfma_f32_16x16x32_bf16 v[60:63], a[116:119], a[144:147], v[60:63]
    v_mfma_f32_16x16x32_bf16 v[64:67], a[116:119], a[148:151], v[64:67]
    v_mfma_f32_16x16x32_bf16 v[68:71], a[116:119], a[152:155], v[68:71]
    v_mfma_f32_16x16x32_bf16 v[72:75], a[120:123], a[144:147], v[72:75]
    v_mfma_f32_16x16x32_bf16 v[76:79], a[120:123], a[148:151], v[76:79]
    v_mfma_f32_16x16x32_bf16 v[80:83], a[120:123], a[152:155], v[80:83]
    v_mfma_f32_16x16x32_bf16 v[84:87], a[124:127], a[144:147], v[84:87]
    s_waitcnt vmcnt(8) lgkmcnt(0)
    s_barrier
    v_mfma_f32_16x16x32_bf16 v[88:91], a[124:127], a[148:151], v[88:91]
    ds_read_b64_tr_b16 a[112:113], v192 offset:16384
    ds_read_b64_tr_b16 a[114:115], v192 offset:18432
    v_mfma_f32_16x16x32_bf16 v[92:95], a[124:127], a[152:155], v[92:95]
    v_accvgpr_read_b32 v226, a198
    v_mfma_f32_16x16x32_bf16 v[96:99], a[128:131], a[144:147], v[96:99]
    ds_write_b128 v226, a[48:51]
    v_mfma_f32_16x16x32_bf16 v[100:103], a[128:131], a[148:151], v[100:103]
    ds_read_b64_tr_b16 a[116:117], v193 offset:16384
    ds_read_b64_tr_b16 a[118:119], v193 offset:18432
    v_mfma_f32_16x16x32_bf16 v[104:107], a[128:131], a[152:155], v[104:107]
    ds_write_b128 v226, a[52:55] offset:1024
    v_mfma_f32_16x16x32_bf16 v[108:111], a[132:135], a[144:147], v[108:111]
    ds_read_b64_tr_b16 a[120:121], v194 offset:16384
    ds_read_b64_tr_b16 a[122:123], v194 offset:18432
    v_mfma_f32_16x16x32_bf16 v[112:115], a[132:135], a[148:151], v[112:115]
    ds_write_b128 v226, a[56:59] offset:2048
    v_mfma_f32_16x16x32_bf16 v[116:119], a[132:135], a[152:155], v[116:119]
    v_mfma_f32_16x16x32_bf16 v[120:123], a[136:139], a[144:147], v[120:123]
    ds_read_b64_tr_b16 a[124:125], v195 offset:16384
    ds_read_b64_tr_b16 a[126:127], v195 offset:18432
    v_mfma_f32_16x16x32_bf16 v[124:127], a[136:139], a[148:151], v[124:127]
    ds_write_b128 v226, a[60:63] offset:3072
    v_mfma_f32_16x16x32_bf16 v[128:131], a[136:139], a[152:155], v[128:131]
    ds_read_b64_tr_b16 a[128:129], v196 offset:16384
    ds_read_b64_tr_b16 a[130:131], v196 offset:18432
    v_mfma_f32_16x16x32_bf16 v[132:135], a[140:143], a[144:147], v[132:135]
    v_mfma_f32_16x16x32_bf16 v[136:139], a[140:143], a[148:151], v[136:139]
    v_mfma_f32_16x16x32_bf16 v[140:143], a[140:143], a[152:155], v[140:143]
    ds_read_b64_tr_b16 a[132:133], v197 offset:16384
    ds_read_b64_tr_b16 a[134:135], v197 offset:18432
    v_mfma_f32_16x16x32_bf16 v[144:147], a[96:99], a[144:147], v[144:147]
    v_mfma_f32_16x16x32_bf16 v[148:151], a[96:99], a[148:151], v[148:151]
    v_mfma_f32_16x16x32_bf16 v[152:155], a[96:99], a[152:155], v[152:155]
    ds_read_b64_tr_b16 a[136:137], v198 offset:16384
    ds_read_b64_tr_b16 a[138:139], v198 offset:18432
    v_mfma_f32_16x16x32_bf16 v[156:159], a[100:103], a[144:147], v[156:159]
    v_mfma_f32_16x16x32_bf16 v[160:163], a[100:103], a[148:151], v[160:163]
    ds_read_b64_tr_b16 a[140:141], v199 offset:16384
    ds_read_b64_tr_b16 a[142:143], v199 offset:18432
    v_mfma_f32_16x16x32_bf16 v[164:167], a[100:103], a[152:155], v[164:167]
    v_mfma_f32_16x16x32_bf16 v[168:171], a[104:107], a[144:147], v[168:171]
    v_mfma_f32_16x16x32_bf16 v[172:175], a[104:107], a[148:151], v[172:175]
    ds_read_b64_tr_b16 a[96:97], v192 offset:16640
    ds_read_b64_tr_b16 a[98:99], v192 offset:18688
    v_mfma_f32_16x16x32_bf16 v[176:179], a[104:107], a[152:155], v[176:179]
    v_mfma_f32_16x16x32_bf16 v[180:183], a[108:111], a[144:147], v[180:183]
    ds_read_b64_tr_b16 a[100:101], v193 offset:16640
    ds_read_b64_tr_b16 a[102:103], v193 offset:18688
    v_mfma_f32_16x16x32_bf16 v[184:187], a[108:111], a[148:151], v[184:187]
    v_mfma_f32_16x16x32_bf16 v[188:191], a[108:111], a[152:155], v[188:191]
    s_waitcnt lgkmcnt(14)
    v_mfma_f32_16x16x32_bf16 v[0:3], a[112:115], a[156:159], v[0:3]
    ds_read_b64_tr_b16 a[104:105], v194 offset:16640
    ds_read_b64_tr_b16 a[106:107], v194 offset:18688
    v_mfma_f32_16x16x32_bf16 v[4:7], a[112:115], a[160:163], v[4:7]
    v_mfma_f32_16x16x32_bf16 v[8:11], a[112:115], a[164:167], v[8:11]
    v_mfma_f32_16x16x32_bf16 v[12:15], a[116:119], a[156:159], v[12:15]
    ds_read_b64_tr_b16 a[108:109], v195 offset:16640
    ds_read_b64_tr_b16 a[110:111], v195 offset:18688
    v_mfma_f32_16x16x32_bf16 v[16:19], a[116:119], a[160:163], v[16:19]
    v_mfma_f32_16x16x32_bf16 v[20:23], a[116:119], a[164:167], v[20:23]
    s_waitcnt lgkmcnt(14)
    ds_read_b64_tr_b16 a[112:113], v196 offset:16640
    ds_read_b64_tr_b16 a[114:115], v196 offset:18688
    v_mfma_f32_16x16x32_bf16 v[24:27], a[120:123], a[156:159], v[24:27]
    v_mfma_f32_16x16x32_bf16 v[28:31], a[120:123], a[160:163], v[28:31]
    v_mfma_f32_16x16x32_bf16 v[32:35], a[120:123], a[164:167], v[32:35]
    ds_read_b64_tr_b16 a[116:117], v197 offset:16640
    ds_read_b64_tr_b16 a[118:119], v197 offset:18688
    v_mfma_f32_16x16x32_bf16 v[36:39], a[124:127], a[156:159], v[36:39]
    v_mfma_f32_16x16x32_bf16 v[40:43], a[124:127], a[160:163], v[40:43]
    ds_read_b64_tr_b16 a[120:121], v198 offset:16640
    ds_read_b64_tr_b16 a[122:123], v198 offset:18688
    v_mfma_f32_16x16x32_bf16 v[44:47], a[124:127], a[164:167], v[44:47]
    s_waitcnt lgkmcnt(14)
    v_mfma_f32_16x16x32_bf16 v[48:51], a[128:131], a[156:159], v[48:51]
    v_mfma_f32_16x16x32_bf16 v[52:55], a[128:131], a[160:163], v[52:55]
    ds_read_b64_tr_b16 a[124:125], v199 offset:16640
    ds_read_b64_tr_b16 a[126:127], v199 offset:18688
    v_mfma_f32_16x16x32_bf16 v[56:59], a[128:131], a[164:167], v[56:59]
    v_add_u32 v240, 0x10000, v240
    v_add_u32 v241, 0x10000, v241
    v_mfma_f32_16x16x32_bf16 v[60:63], a[132:135], a[156:159], v[60:63]
    v_add_u32 v242, 0x10000, v242
    v_add_u32 v243, 0x10000, v243
    v_mfma_f32_16x16x32_bf16 v[64:67], a[132:135], a[160:163], v[64:67]
    v_mfma_f32_16x16x32_bf16 v[68:71], a[132:135], a[164:167], v[68:71]
    v_mfma_f32_16x16x32_bf16 v[72:75], a[136:139], a[156:159], v[72:75]
    v_mfma_f32_16x16x32_bf16 v[76:79], a[136:139], a[160:163], v[76:79]
    v_mfma_f32_16x16x32_bf16 v[80:83], a[136:139], a[164:167], v[80:83]
    v_mfma_f32_16x16x32_bf16 v[84:87], a[140:143], a[156:159], v[84:87]
    s_waitcnt lgkmcnt(0)
    s_barrier
    v_mfma_f32_16x16x32_bf16 v[88:91], a[140:143], a[160:163], v[88:91]
    ds_read_b128 a[128:131], v240 offset:49152
    v_mfma_f32_16x16x32_bf16 v[92:95], a[140:143], a[164:167], v[92:95]
    v_mfma_f32_16x16x32_bf16 v[96:99], a[96:99], a[156:159], v[96:99]
    v_mfma_f32_16x16x32_bf16 v[100:103], a[96:99], a[160:163], v[100:103]
    v_mfma_f32_16x16x32_bf16 v[104:107], a[96:99], a[164:167], v[104:107]
    v_mfma_f32_16x16x32_bf16 v[108:111], a[100:103], a[156:159], v[108:111]
    v_mfma_f32_16x16x32_bf16 v[112:115], a[100:103], a[160:163], v[112:115]
    v_mfma_f32_16x16x32_bf16 v[116:119], a[100:103], a[164:167], v[116:119]
    v_mfma_f32_16x16x32_bf16 v[120:123], a[104:107], a[156:159], v[120:123]
    v_mfma_f32_16x16x32_bf16 v[124:127], a[104:107], a[160:163], v[124:127]
    ds_read_b128 a[132:135], v241 offset:49152
    v_mfma_f32_16x16x32_bf16 v[128:131], a[104:107], a[164:167], v[128:131]
    v_mfma_f32_16x16x32_bf16 v[132:135], a[108:111], a[156:159], v[132:135]
    v_mfma_f32_16x16x32_bf16 v[136:139], a[108:111], a[160:163], v[136:139]
    v_mfma_f32_16x16x32_bf16 v[140:143], a[108:111], a[164:167], v[140:143]
    v_accvgpr_read_b32 v226, a198
    v_mfma_f32_16x16x32_bf16 v[144:147], a[112:115], a[156:159], v[144:147]
    s_waitcnt vmcnt(7)
    ds_write_b128 v226, a[64:67] offset:16384
    v_mfma_f32_16x16x32_bf16 v[148:151], a[112:115], a[160:163], v[148:151]
    v_mfma_f32_16x16x32_bf16 v[152:155], a[112:115], a[164:167], v[152:155]
    s_waitcnt vmcnt(6)
    ds_write_b128 v226, a[68:71] offset:17408
    v_mfma_f32_16x16x32_bf16 v[156:159], a[116:119], a[156:159], v[156:159]
    v_mfma_f32_16x16x32_bf16 v[160:163], a[116:119], a[160:163], v[160:163]
    ds_read_b128 a[136:139], v242 offset:49152
    v_mfma_f32_16x16x32_bf16 v[164:167], a[116:119], a[164:167], v[164:167]
    s_waitcnt vmcnt(5)
    ds_write_b128 v226, a[72:75] offset:18432
    v_mfma_f32_16x16x32_bf16 v[168:171], a[120:123], a[156:159], v[168:171]
    v_mfma_f32_16x16x32_bf16 v[172:175], a[120:123], a[160:163], v[172:175]
    s_waitcnt vmcnt(4)
    ds_write_b128 v226, a[76:79] offset:19456
    v_mfma_f32_16x16x32_bf16 v[176:179], a[120:123], a[164:167], v[176:179]
    v_mfma_f32_16x16x32_bf16 v[180:183], a[124:127], a[156:159], v[180:183]
    v_accvgpr_read_b32 v227, a199
    v_mfma_f32_16x16x32_bf16 v[184:187], a[124:127], a[160:163], v[184:187]
    v_mfma_f32_16x16x32_bf16 v[188:191], a[124:127], a[164:167], v[188:191]
    v_pk_mul_f32 v[0:1], v[0:1], s[14:15]
    v_pk_mul_f32 v[2:3], v[2:3], s[14:15]
    v_pk_mul_f32 v[12:13], v[12:13], s[14:15]
    v_pk_mul_f32 v[14:15], v[14:15], s[14:15]
    v_cvt_pk_bf16_f32 v210, v0, v1
    v_cvt_pk_bf16_f32 v212, v12, v13
    v_cvt_pk_bf16_f32 v211, v2, v3
    v_cvt_pk_bf16_f32 v213, v14, v15
    ds_read_b128 a[140:143], v243 offset:49152
    v_pk_mul_f32 v[4:5], v[4:5], s[14:15]
    v_pk_mul_f32 v[6:7], v[6:7], s[14:15]
    v_pk_mul_f32 v[16:17], v[16:17], s[14:15]
    v_pk_mul_f32 v[18:19], v[18:19], s[14:15]
    v_cvt_pk_bf16_f32 v214, v4, v5
    v_cvt_pk_bf16_f32 v216, v16, v17
    v_cvt_pk_bf16_f32 v215, v6, v7
    v_cvt_pk_bf16_f32 v217, v18, v19
    v_permlane16_swap_b32 v210, v212
    v_permlane16_swap_b32 v211, v213
    v_accvgpr_write_b32 a0, v210
    v_accvgpr_write_b32 a1, v211
    v_accvgpr_write_b32 a2, v212
    v_accvgpr_write_b32 a3, v213
    s_mov_b32 s87, 0
    buffer_load_dword a248, v227, s[92:95], s87 offen
    v_pk_mul_f32 v[8:9], v[8:9], s[14:15]
    v_pk_mul_f32 v[10:11], v[10:11], s[14:15]
    v_pk_mul_f32 v[20:21], v[20:21], s[14:15]
    v_pk_mul_f32 v[22:23], v[22:23], s[14:15]
    v_cvt_pk_bf16_f32 v218, v8, v9
    v_cvt_pk_bf16_f32 v220, v20, v21
    v_cvt_pk_bf16_f32 v219, v10, v11
    v_cvt_pk_bf16_f32 v221, v22, v23
    v_permlane16_swap_b32 v214, v216
    v_permlane16_swap_b32 v215, v217
    v_accvgpr_write_b32 a4, v214
    v_accvgpr_write_b32 a5, v215
    v_accvgpr_write_b32 a6, v216
    v_accvgpr_write_b32 a7, v217
    s_mov_b32 s87, 57344
    buffer_load_dword a249, v227, s[92:95], s87 offen
    v_pk_mul_f32 v[24:25], v[24:25], s[14:15]
    v_pk_mul_f32 v[26:27], v[26:27], s[14:15]
    v_pk_mul_f32 v[36:37], v[36:37], s[14:15]
    v_pk_mul_f32 v[38:39], v[38:39], s[14:15]
    ds_read_b128 a[96:99], v240 offset:57344
    v_cvt_pk_bf16_f32 v222, v24, v25
    v_cvt_pk_bf16_f32 v224, v36, v37
    v_cvt_pk_bf16_f32 v223, v26, v27
    v_cvt_pk_bf16_f32 v225, v38, v39
    v_permlane16_swap_b32 v218, v220
    v_permlane16_swap_b32 v219, v221
    v_accvgpr_write_b32 a8, v218
    v_accvgpr_write_b32 a9, v219
    v_accvgpr_write_b32 a10, v220
    v_accvgpr_write_b32 a11, v221
    s_mov_b32 s87, 114688
    buffer_load_dword a250, v227, s[92:95], s87 offen
    v_pk_mul_f32 v[28:29], v[28:29], s[14:15]
    v_pk_mul_f32 v[30:31], v[30:31], s[14:15]
    v_pk_mul_f32 v[40:41], v[40:41], s[14:15]
    v_pk_mul_f32 v[42:43], v[42:43], s[14:15]
    v_cvt_pk_bf16_f32 v210, v28, v29
    v_cvt_pk_bf16_f32 v212, v40, v41
    v_cvt_pk_bf16_f32 v211, v30, v31
    v_cvt_pk_bf16_f32 v213, v42, v43
    v_permlane16_swap_b32 v222, v224
    v_permlane16_swap_b32 v223, v225
    v_accvgpr_write_b32 a12, v222
    v_accvgpr_write_b32 a13, v223
    v_accvgpr_write_b32 a14, v224
    v_accvgpr_write_b32 a15, v225
    s_mov_b32 s87, 172032
    buffer_load_dword a251, v227, s[92:95], s87 offen
    v_pk_mul_f32 v[32:33], v[32:33], s[14:15]
    v_pk_mul_f32 v[34:35], v[34:35], s[14:15]
    v_pk_mul_f32 v[44:45], v[44:45], s[14:15]
    v_pk_mul_f32 v[46:47], v[46:47], s[14:15]
    v_cvt_pk_bf16_f32 v214, v32, v33
    v_cvt_pk_bf16_f32 v216, v44, v45
    v_cvt_pk_bf16_f32 v215, v34, v35
    v_cvt_pk_bf16_f32 v217, v46, v47
    ds_read_b128 a[100:103], v241 offset:57344
    v_permlane16_swap_b32 v210, v212
    v_permlane16_swap_b32 v211, v213
    v_accvgpr_write_b32 a16, v210
    v_accvgpr_write_b32 a17, v211
    v_accvgpr_write_b32 a18, v212
    v_accvgpr_write_b32 a19, v213
    v_pk_mul_f32 v[48:49], v[48:49], s[14:15]
    v_pk_mul_f32 v[50:51], v[50:51], s[14:15]
    v_pk_mul_f32 v[60:61], v[60:61], s[14:15]
    v_pk_mul_f32 v[62:63], v[62:63], s[14:15]
    v_cvt_pk_bf16_f32 v218, v48, v49
    v_cvt_pk_bf16_f32 v220, v60, v61
    v_cvt_pk_bf16_f32 v219, v50, v51
    v_cvt_pk_bf16_f32 v221, v62, v63
    v_accvgpr_read_b32 v0, a197
    v_mov_b32 v1, 1
    v_permlane16_swap_b32 v214, v216
    v_permlane16_swap_b32 v215, v217
    buffer_atomic_add v1, v0, s[88:91], 0 offen sc1
    v_accvgpr_write_b32 a20, v214
    v_accvgpr_write_b32 a21, v215
    v_accvgpr_write_b32 a22, v216
    v_accvgpr_write_b32 a23, v217
    v_pk_mul_f32 v[52:53], v[52:53], s[14:15]
    v_pk_mul_f32 v[54:55], v[54:55], s[14:15]
    v_pk_mul_f32 v[64:65], v[64:65], s[14:15]
    v_pk_mul_f32 v[66:67], v[66:67], s[14:15]
    v_cvt_pk_bf16_f32 v222, v52, v53
    v_cvt_pk_bf16_f32 v224, v64, v65
    v_cvt_pk_bf16_f32 v223, v54, v55
    v_cvt_pk_bf16_f32 v225, v66, v67
    v_permlane16_swap_b32 v218, v220
    v_permlane16_swap_b32 v219, v221
    ds_read_b128 a[104:107], v242 offset:57344
    v_accvgpr_write_b32 a24, v218
    v_accvgpr_write_b32 a25, v219
    v_accvgpr_write_b32 a26, v220
    v_accvgpr_write_b32 a27, v221
    v_pk_mul_f32 v[56:57], v[56:57], s[14:15]
    v_pk_mul_f32 v[58:59], v[58:59], s[14:15]
    v_pk_mul_f32 v[68:69], v[68:69], s[14:15]
    v_pk_mul_f32 v[70:71], v[70:71], s[14:15]
    v_cvt_pk_bf16_f32 v210, v56, v57
    v_cvt_pk_bf16_f32 v212, v68, v69
    v_cvt_pk_bf16_f32 v211, v58, v59
    v_cvt_pk_bf16_f32 v213, v70, v71
    v_permlane16_swap_b32 v222, v224
    v_permlane16_swap_b32 v223, v225
    v_accvgpr_write_b32 a28, v222
    v_accvgpr_write_b32 a29, v223
    v_accvgpr_write_b32 a30, v224
    v_accvgpr_write_b32 a31, v225
    v_pk_mul_f32 v[72:73], v[72:73], s[14:15]
    v_pk_mul_f32 v[74:75], v[74:75], s[14:15]
    v_pk_mul_f32 v[84:85], v[84:85], s[14:15]
    v_pk_mul_f32 v[86:87], v[86:87], s[14:15]
    v_cvt_pk_bf16_f32 v214, v72, v73
    v_cvt_pk_bf16_f32 v216, v84, v85
    v_cvt_pk_bf16_f32 v215, v74, v75
    v_cvt_pk_bf16_f32 v217, v86, v87
    v_accvgpr_read_b32 v226, a198
    v_add_u32 v226, 65536, v226
    v_permlane16_swap_b32 v210, v212
    v_permlane16_swap_b32 v211, v213
    s_waitcnt vmcnt(8)
    ds_write_b128 v226, a[80:83]
    v_accvgpr_write_b32 a32, v210
    v_accvgpr_write_b32 a33, v211
    v_accvgpr_write_b32 a34, v212
    v_accvgpr_write_b32 a35, v213
    ds_read_b128 a[108:111], v243 offset:57344
    v_pk_mul_f32 v[76:77], v[76:77], s[14:15]
    v_pk_mul_f32 v[78:79], v[78:79], s[14:15]
    v_pk_mul_f32 v[88:89], v[88:89], s[14:15]
    v_pk_mul_f32 v[90:91], v[90:91], s[14:15]
    s_waitcnt vmcnt(7)
    ds_write_b128 v226, a[84:87] offset:1024
    v_cvt_pk_bf16_f32 v218, v76, v77
    v_cvt_pk_bf16_f32 v220, v88, v89
    v_cvt_pk_bf16_f32 v219, v78, v79
    v_cvt_pk_bf16_f32 v221, v90, v91
    v_permlane16_swap_b32 v214, v216
    v_permlane16_swap_b32 v215, v217
    s_waitcnt vmcnt(6)
    ds_write_b128 v226, a[88:91] offset:2048
    v_accvgpr_write_b32 a36, v214
    v_accvgpr_write_b32 a37, v215
    v_accvgpr_write_b32 a38, v216
    v_accvgpr_write_b32 a39, v217
    v_pk_mul_f32 v[80:81], v[80:81], s[14:15]
    v_pk_mul_f32 v[82:83], v[82:83], s[14:15]
    v_pk_mul_f32 v[92:93], v[92:93], s[14:15]
    v_pk_mul_f32 v[94:95], v[94:95], s[14:15]
    s_waitcnt vmcnt(5)
    ds_write_b128 v226, a[92:95] offset:3072
    v_cvt_pk_bf16_f32 v222, v80, v81
    v_cvt_pk_bf16_f32 v224, v92, v93
    v_cvt_pk_bf16_f32 v223, v82, v83
    v_cvt_pk_bf16_f32 v225, v94, v95
    v_permlane16_swap_b32 v218, v220
    v_permlane16_swap_b32 v219, v221
    v_accvgpr_write_b32 a40, v218
    v_accvgpr_write_b32 a41, v219
    v_accvgpr_write_b32 a42, v220
    v_accvgpr_write_b32 a43, v221
    v_pk_mul_f32 v[96:97], v[96:97], s[14:15]
    v_pk_mul_f32 v[98:99], v[98:99], s[14:15]
    v_pk_mul_f32 v[108:109], v[108:109], s[14:15]
    v_pk_mul_f32 v[110:111], v[110:111], s[14:15]
    ds_read_b128 a[112:115], v240 offset:49408
    v_cvt_pk_bf16_f32 v210, v96, v97
    v_cvt_pk_bf16_f32 v212, v108, v109
    v_cvt_pk_bf16_f32 v211, v98, v99
    v_cvt_pk_bf16_f32 v213, v110, v111
    v_permlane16_swap_b32 v222, v224
    v_permlane16_swap_b32 v223, v225
    v_accvgpr_write_b32 a44, v222
    v_accvgpr_write_b32 a45, v223
    v_accvgpr_write_b32 a46, v224
    v_accvgpr_write_b32 a47, v225
    v_pk_mul_f32 v[100:101], v[100:101], s[14:15]
    v_pk_mul_f32 v[102:103], v[102:103], s[14:15]
    v_pk_mul_f32 v[112:113], v[112:113], s[14:15]
    v_pk_mul_f32 v[114:115], v[114:115], s[14:15]
    v_cvt_pk_bf16_f32 v214, v100, v101
    v_cvt_pk_bf16_f32 v216, v112, v113
    v_cvt_pk_bf16_f32 v215, v102, v103
    v_cvt_pk_bf16_f32 v217, v114, v115
    v_permlane16_swap_b32 v210, v212
    v_permlane16_swap_b32 v211, v213
    v_accvgpr_write_b32 a48, v210
    v_accvgpr_write_b32 a49, v211
    v_accvgpr_write_b32 a50, v212
    v_accvgpr_write_b32 a51, v213
    v_pk_mul_f32 v[104:105], v[104:105], s[14:15]
    v_pk_mul_f32 v[106:107], v[106:107], s[14:15]
    v_pk_mul_f32 v[116:117], v[116:117], s[14:15]
    v_pk_mul_f32 v[118:119], v[118:119], s[14:15]
    v_cvt_pk_bf16_f32 v218, v104, v105
    v_cvt_pk_bf16_f32 v220, v116, v117
    v_cvt_pk_bf16_f32 v219, v106, v107
    v_cvt_pk_bf16_f32 v221, v118, v119
    ds_read_b128 a[116:119], v241 offset:49408
    v_permlane16_swap_b32 v214, v216
    v_permlane16_swap_b32 v215, v217
    v_accvgpr_write_b32 a52, v214
    v_accvgpr_write_b32 a53, v215
    v_accvgpr_write_b32 a54, v216
    v_accvgpr_write_b32 a55, v217
    v_pk_mul_f32 v[120:121], v[120:121], s[14:15]
    v_pk_mul_f32 v[122:123], v[122:123], s[14:15]
    v_pk_mul_f32 v[132:133], v[132:133], s[14:15]
    v_pk_mul_f32 v[134:135], v[134:135], s[14:15]
    v_cvt_pk_bf16_f32 v222, v120, v121
    v_cvt_pk_bf16_f32 v224, v132, v133
    v_cvt_pk_bf16_f32 v223, v122, v123
    v_cvt_pk_bf16_f32 v225, v134, v135
    v_permlane16_swap_b32 v218, v220
    v_permlane16_swap_b32 v219, v221
    v_accvgpr_write_b32 a56, v218
    v_accvgpr_write_b32 a57, v219
    v_accvgpr_write_b32 a58, v220
    v_accvgpr_write_b32 a59, v221
    v_pk_mul_f32 v[124:125], v[124:125], s[14:15]
    v_pk_mul_f32 v[126:127], v[126:127], s[14:15]
    v_pk_mul_f32 v[136:137], v[136:137], s[14:15]
    v_pk_mul_f32 v[138:139], v[138:139], s[14:15]
    v_cvt_pk_bf16_f32 v210, v124, v125
    v_cvt_pk_bf16_f32 v212, v136, v137
    v_cvt_pk_bf16_f32 v211, v126, v127
    v_cvt_pk_bf16_f32 v213, v138, v139
    v_permlane16_swap_b32 v222, v224
    v_permlane16_swap_b32 v223, v225
    ds_read_b128 a[120:123], v242 offset:49408
    v_accvgpr_write_b32 a60, v222
    v_accvgpr_write_b32 a61, v223
    v_accvgpr_write_b32 a62, v224
    v_accvgpr_write_b32 a63, v225
    v_pk_mul_f32 v[128:129], v[128:129], s[14:15]
    v_pk_mul_f32 v[130:131], v[130:131], s[14:15]
    v_pk_mul_f32 v[140:141], v[140:141], s[14:15]
    v_pk_mul_f32 v[142:143], v[142:143], s[14:15]
    v_cvt_pk_bf16_f32 v214, v128, v129
    v_cvt_pk_bf16_f32 v216, v140, v141
    v_cvt_pk_bf16_f32 v215, v130, v131
    v_cvt_pk_bf16_f32 v217, v142, v143
    v_permlane16_swap_b32 v210, v212
    v_permlane16_swap_b32 v211, v213
    v_accvgpr_write_b32 a64, v210
    v_accvgpr_write_b32 a65, v211
    v_accvgpr_write_b32 a66, v212
    v_accvgpr_write_b32 a67, v213
    v_pk_mul_f32 v[144:145], v[144:145], s[14:15]
    v_pk_mul_f32 v[146:147], v[146:147], s[14:15]
    v_pk_mul_f32 v[156:157], v[156:157], s[14:15]
    v_pk_mul_f32 v[158:159], v[158:159], s[14:15]
    v_cvt_pk_bf16_f32 v218, v144, v145
    v_cvt_pk_bf16_f32 v220, v156, v157
    v_cvt_pk_bf16_f32 v219, v146, v147
    v_cvt_pk_bf16_f32 v221, v158, v159
    v_permlane16_swap_b32 v214, v216
    v_permlane16_swap_b32 v215, v217
    v_accvgpr_write_b32 a68, v214
    v_accvgpr_write_b32 a69, v215
    v_accvgpr_write_b32 a70, v216
    v_accvgpr_write_b32 a71, v217
    ds_read_b128 a[124:127], v243 offset:49408
    v_pk_mul_f32 v[148:149], v[148:149], s[14:15]
    v_pk_mul_f32 v[150:151], v[150:151], s[14:15]
    v_pk_mul_f32 v[160:161], v[160:161], s[14:15]
    v_pk_mul_f32 v[162:163], v[162:163], s[14:15]
    v_cvt_pk_bf16_f32 v222, v148, v149
    v_cvt_pk_bf16_f32 v224, v160, v161
    v_cvt_pk_bf16_f32 v223, v150, v151
    v_cvt_pk_bf16_f32 v225, v162, v163
    v_permlane16_swap_b32 v218, v220
    v_permlane16_swap_b32 v219, v221
    v_accvgpr_write_b32 a72, v218
    v_accvgpr_write_b32 a73, v219
    v_accvgpr_write_b32 a74, v220
    v_accvgpr_write_b32 a75, v221
    v_pk_mul_f32 v[152:153], v[152:153], s[14:15]
    v_pk_mul_f32 v[154:155], v[154:155], s[14:15]
    v_pk_mul_f32 v[164:165], v[164:165], s[14:15]
    v_pk_mul_f32 v[166:167], v[166:167], s[14:15]
    v_cvt_pk_bf16_f32 v210, v152, v153
    v_cvt_pk_bf16_f32 v212, v164, v165
    v_cvt_pk_bf16_f32 v211, v154, v155
    v_cvt_pk_bf16_f32 v213, v166, v167
    v_permlane16_swap_b32 v222, v224
    v_permlane16_swap_b32 v223, v225
    v_accvgpr_write_b32 a76, v222
    v_accvgpr_write_b32 a77, v223
    v_accvgpr_write_b32 a78, v224
    v_accvgpr_write_b32 a79, v225
    v_pk_mul_f32 v[168:169], v[168:169], s[14:15]
    v_pk_mul_f32 v[170:171], v[170:171], s[14:15]
    v_pk_mul_f32 v[180:181], v[180:181], s[14:15]
    v_pk_mul_f32 v[182:183], v[182:183], s[14:15]
    v_cvt_pk_bf16_f32 v214, v168, v169
    v_cvt_pk_bf16_f32 v216, v180, v181
    v_cvt_pk_bf16_f32 v215, v170, v171
    v_cvt_pk_bf16_f32 v217, v182, v183
    v_permlane16_swap_b32 v210, v212
    v_permlane16_swap_b32 v211, v213
    v_accvgpr_write_b32 a80, v210
    v_accvgpr_write_b32 a81, v211
    v_accvgpr_write_b32 a82, v212
    v_accvgpr_write_b32 a83, v213
    v_pk_mul_f32 v[172:173], v[172:173], s[14:15]
    v_pk_mul_f32 v[174:175], v[174:175], s[14:15]
    v_pk_mul_f32 v[184:185], v[184:185], s[14:15]
    v_pk_mul_f32 v[186:187], v[186:187], s[14:15]
    v_cvt_pk_bf16_f32 v218, v172, v173
    v_cvt_pk_bf16_f32 v220, v184, v185
    v_cvt_pk_bf16_f32 v219, v174, v175
    v_cvt_pk_bf16_f32 v221, v186, v187
    v_permlane16_swap_b32 v214, v216
    v_permlane16_swap_b32 v215, v217
    v_accvgpr_write_b32 a84, v214
    v_accvgpr_write_b32 a85, v215
    v_accvgpr_write_b32 a86, v216
    v_accvgpr_write_b32 a87, v217
    v_pk_mul_f32 v[176:177], v[176:177], s[14:15]
    v_pk_mul_f32 v[178:179], v[178:179], s[14:15]
    v_pk_mul_f32 v[188:189], v[188:189], s[14:15]
    v_pk_mul_f32 v[190:191], v[190:191], s[14:15]
    v_cvt_pk_bf16_f32 v222, v176, v177
    v_cvt_pk_bf16_f32 v224, v188, v189
    v_cvt_pk_bf16_f32 v223, v178, v179
    v_cvt_pk_bf16_f32 v225, v190, v191
    v_permlane16_swap_b32 v218, v220
    v_permlane16_swap_b32 v219, v221
    v_accvgpr_write_b32 a88, v218
    v_accvgpr_write_b32 a89, v219
    v_accvgpr_write_b32 a90, v220
    v_accvgpr_write_b32 a91, v221
    v_permlane16_swap_b32 v222, v224
    v_permlane16_swap_b32 v223, v225
    v_accvgpr_write_b32 a92, v222
    v_accvgpr_write_b32 a93, v223
    v_accvgpr_write_b32 a94, v224
    v_accvgpr_write_b32 a95, v225
    s_waitcnt lgkmcnt(12)
    v_mfma_f32_16x16x32_bf16 v[180:183], a[128:131], a[0:3], 0
    v_mfma_f32_16x16x32_bf16 v[180:183], a[132:135], a[12:15], v[180:183]
    v_mfma_f32_16x16x32_bf16 v[180:183], a[136:139], a[24:27], v[180:183]
    v_mfma_f32_16x16x32_bf16 v[180:183], a[140:143], a[36:39], v[180:183]
    v_mfma_f32_16x16x32_bf16 v[184:187], a[128:131], a[4:7], 0
    v_mfma_f32_16x16x32_bf16 v[184:187], a[132:135], a[16:19], v[184:187]
    v_mfma_f32_16x16x32_bf16 v[184:187], a[136:139], a[28:31], v[184:187]
    v_mfma_f32_16x16x32_bf16 v[184:187], a[140:143], a[40:43], v[184:187]
    v_mfma_f32_16x16x32_bf16 v[188:191], a[128:131], a[8:11], 0
    ds_read_b128 a[128:131], v240 offset:57600
    v_mfma_f32_16x16x32_bf16 v[188:191], a[132:135], a[20:23], v[188:191]
    ds_read_b128 a[132:135], v241 offset:57600
    v_mfma_f32_16x16x32_bf16 v[188:191], a[136:139], a[32:35], v[188:191]
    ds_read_b128 a[136:139], v242 offset:57600
    v_mfma_f32_16x16x32_bf16 v[188:191], a[140:143], a[44:47], v[188:191]
    s_waitcnt lgkmcnt(10)
    v_mfma_f32_16x16x32_bf16 v[192:195], a[96:99], a[0:3], 0
    v_mfma_f32_16x16x32_bf16 v[192:195], a[100:103], a[12:15], v[192:195]
    ds_read_b128 a[140:143], v243 offset:57600
    v_mfma_f32_16x16x32_bf16 v[192:195], a[104:107], a[24:27], v[192:195]
    v_add_u32 v240, 0x10000, v240
    v_add_u32 v241, 0x10000, v241
    v_mfma_f32_16x16x32_bf16 v[192:195], a[108:111], a[36:39], v[192:195]
    v_add_u32 v242, 0x10000, v242
    v_add_u32 v243, 0x10000, v243
    v_mfma_f32_16x16x32_bf16 v[196:199], a[96:99], a[4:7], 0
    v_mfma_f32_16x16x32_bf16 v[196:199], a[100:103], a[16:19], v[196:199]
    v_mfma_f32_16x16x32_bf16 v[196:199], a[104:107], a[28:31], v[196:199]
    v_mfma_f32_16x16x32_bf16 v[196:199], a[108:111], a[40:43], v[196:199]
    v_mfma_f32_16x16x32_bf16 v[200:203], a[96:99], a[8:11], 0
    v_mfma_f32_16x16x32_bf16 v[200:203], a[100:103], a[20:23], v[200:203]
    s_waitcnt lgkmcnt(0)
    s_barrier
    v_mfma_f32_16x16x32_bf16 v[200:203], a[104:107], a[32:35], v[200:203]
    s_mov_b32 s8, 147456
    s_add_u32 m0, s10, 81920
    ds_read_b128 a[96:99], v240
    v_mfma_f32_16x16x32_bf16 v[200:203], a[108:111], a[44:47], v[200:203]
    buffer_load_dwordx4 v244, s[40:43], s8 offen nt lds
    v_mfma_f32_16x16x32_bf16 v[180:183], a[112:115], a[48:51], v[180:183]
    v_mfma_f32_16x16x32_bf16 v[180:183], a[116:119], a[60:63], v[180:183]
    ds_read_b128 a[100:103], v241
    v_mfma_f32_16x16x32_bf16 v[180:183], a[120:123], a[72:75], v[180:183]
    s_add_u32 m0, s10, 81920
    v_mfma_f32_16x16x32_bf16 v[180:183], a[124:127], a[84:87], v[180:183]
    ds_read_b128 a[104:107], v242
    buffer_load_dwordx4 v245, s[40:43], s8 offen offset:1024 nt lds
    v_mfma_f32_16x16x32_bf16 v[184:187], a[112:115], a[52:55], v[184:187]
    v_mfma_f32_16x16x32_bf16 v[184:187], a[116:119], a[64:67], v[184:187]
    v_mfma_f32_16x16x32_bf16 v[184:187], a[120:123], a[76:79], v[184:187]
    ds_read_b128 a[108:111], v243
    v_mfma_f32_16x16x32_bf16 v[184:187], a[124:127], a[88:91], v[184:187]
    v_mfma_f32_16x16x32_bf16 v[188:191], a[112:115], a[56:59], v[188:191]
    ds_read_b128 a[112:115], v240 offset:8192
    v_mfma_f32_16x16x32_bf16 v[188:191], a[116:119], a[68:71], v[188:191]
    v_mfma_f32_16x16x32_bf16 v[188:191], a[120:123], a[80:83], v[188:191]
    v_mfma_f32_16x16x32_bf16 v[188:191], a[124:127], a[92:95], v[188:191]
    ds_read_b128 a[116:119], v241 offset:8192
    v_mfma_f32_16x16x32_bf16 v[192:195], a[128:131], a[48:51], v[192:195]
    v_mfma_f32_16x16x32_bf16 v[192:195], a[132:135], a[60:63], v[192:195]
    v_mfma_f32_16x16x32_bf16 v[192:195], a[136:139], a[72:75], v[192:195]
    s_add_u32 m0, s10, 81920
    ds_read_b128 a[120:123], v242 offset:8192
    v_mfma_f32_16x16x32_bf16 v[192:195], a[140:143], a[84:87], v[192:195]
    buffer_load_dwordx4 v246, s[40:43], s8 offen offset:2048 nt lds
    v_mfma_f32_16x16x32_bf16 v[196:199], a[128:131], a[52:55], v[196:199]
    ds_read_b128 a[124:127], v243 offset:8192
    v_mfma_f32_16x16x32_bf16 v[196:199], a[132:135], a[64:67], v[196:199]
    v_mfma_f32_16x16x32_bf16 v[196:199], a[136:139], a[76:79], v[196:199]
    v_mfma_f32_16x16x32_bf16 v[196:199], a[140:143], a[88:91], v[196:199]
    v_mfma_f32_16x16x32_bf16 v[200:203], a[128:131], a[56:59], v[200:203]
    ds_read_b128 a[128:131], v240 offset:256
    v_mfma_f32_16x16x32_bf16 v[200:203], a[132:135], a[68:71], v[200:203]
    ds_read_b128 a[132:135], v241 offset:256
    v_mfma_f32_16x16x32_bf16 v[200:203], a[136:139], a[80:83], v[200:203]
    v_mfma_f32_16x16x32_bf16 v[200:203], a[140:143], a[92:95], v[200:203]
    s_waitcnt lgkmcnt(6)
    v_mfma_f32_16x16x32_bf16 v[204:207], a[96:99], a[0:3], 0
    ds_read_b128 a[136:139], v242 offset:256
    v_mfma_f32_16x16x32_bf16 v[204:207], a[100:103], a[12:15], v[204:207]
    v_mfma_f32_16x16x32_bf16 v[204:207], a[104:107], a[24:27], v[204:207]
    s_add_u32 m0, s10, 81920
    v_max3_f32 v100, v180, v181, v182
    v_max3_f32 v100, v100, v183, v192
    v_mfma_f32_16x16x32_bf16 v[204:207], a[108:111], a[36:39], v[204:207]
    ds_read_b128 a[140:143], v243 offset:256
    buffer_load_dwordx4 v247, s[40:43], s8 offen offset:3072 nt lds
    v_mfma_f32_16x16x32_bf16 v[208:211], a[96:99], a[4:7], 0
    v_max3_f32 v100, v100, v193, v194
    v_max_f32 v100, v100, v195
    v_mfma_f32_16x16x32_bf16 v[208:211], a[100:103], a[16:19], v[208:211]
    v_mov_b32 v101, v100
    v_mfma_f32_16x16x32_bf16 v[208:211], a[104:107], a[28:31], v[208:211]
    s_nop 0
    v_permlane16_swap_b32 v100, v101
    v_mfma_f32_16x16x32_bf16 v[208:211], a[108:111], a[40:43], v[208:211]
    v_max_f32 v100, v100, v101
    v_mov_b32 v101, v100
    v_mfma_f32_16x16x32_bf16 v[212:215], a[96:99], a[8:11], 0
    ds_read_b128 a[96:99], v240 offset:8448
    v_mfma_f32_16x16x32_bf16 v[212:215], a[100:103], a[20:23], v[212:215]
    ds_read_b128 a[100:103], v241 offset:8448
    v_mfma_f32_16x16x32_bf16 v[212:215], a[104:107], a[32:35], v[212:215]
    ds_read_b128 a[104:107], v242 offset:8448
    v_mfma_f32_16x16x32_bf16 v[212:215], a[108:111], a[44:47], v[212:215]
    s_waitcnt lgkmcnt(7)
    v_permlane32_swap_b32 v100, v101
    v_mfma_f32_16x16x32_bf16 v[216:219], a[112:115], a[0:3], 0
    v_max_f32 v100, v100, v101
    v_sub_f32 v228, 0, v100
    v_mfma_f32_16x16x32_bf16 v[216:219], a[116:119], a[12:15], v[216:219]
    ds_read_b128 a[108:111], v243 offset:8448
    v_sub_f32 v229, 0, v100
    v_mfma_f32_16x16x32_bf16 v[216:219], a[120:123], a[24:27], v[216:219]
    v_sub_f32 v230, 0, v100
    v_sub_f32 v231, 0, v100
    v_mfma_f32_16x16x32_bf16 v[216:219], a[124:127], a[36:39], v[216:219]
    v_max3_f32 v100, v184, v185, v186
    v_max3_f32 v100, v100, v187, v196
    v_mfma_f32_16x16x32_bf16 v[220:223], a[112:115], a[4:7], 0
    v_max3_f32 v100, v100, v197, v198
    v_max_f32 v100, v100, v199
    v_mfma_f32_16x16x32_bf16 v[220:223], a[116:119], a[16:19], v[220:223]
    v_mov_b32 v101, v100
    v_mfma_f32_16x16x32_bf16 v[220:223], a[120:123], a[28:31], v[220:223]
    s_nop 0
    v_permlane16_swap_b32 v100, v101
    v_mfma_f32_16x16x32_bf16 v[220:223], a[124:127], a[40:43], v[220:223]
    v_max_f32 v100, v100, v101
    v_mov_b32 v101, v100
    v_mfma_f32_16x16x32_bf16 v[224:227], a[112:115], a[8:11], 0
    s_nop 0
    v_permlane32_swap_b32 v100, v101
    v_mfma_f32_16x16x32_bf16 v[224:227], a[116:119], a[20:23], v[224:227]
    s_waitcnt lgkmcnt(0)
    s_barrier
    v_max_f32 v100, v100, v101
    v_mfma_f32_16x16x32_bf16 v[224:227], a[120:123], a[32:35], v[224:227]
    s_mov_b32 s8, 163840
    s_add_u32 m0, s10, 114688
    ds_read_b128 a[112:115], v240 offset:16384
    v_mfma_f32_16x16x32_bf16 v[224:227], a[124:127], a[44:47], v[224:227]
    s_waitcnt vmcnt(3)
    buffer_load_dwordx4 v244, s[40:43], s8 offen nt lds
    v_sub_f32 v232, 0, v100
    v_mfma_f32_16x16x32_bf16 v[204:207], a[128:131], a[48:51], v[204:207]
    v_sub_f32 v233, 0, v100
    v_sub_f32 v234, 0, v100
    v_mfma_f32_16x16x32_bf16 v[204:207], a[132:135], a[60:63], v[204:207]
    ds_read_b128 a[116:119], v241 offset:16384
    v_sub_f32 v235, 0, v100
    v_mfma_f32_16x16x32_bf16 v[204:207], a[136:139], a[72:75], v[204:207]
    s_add_u32 m0, s10, 114688
    v_max3_f32 v100, v188, v189, v190
    v_max3_f32 v100, v100, v191, v200
    v_mfma_f32_16x16x32_bf16 v[204:207], a[140:143], a[84:87], v[204:207]
    ds_read_b128 a[120:123], v242 offset:16384
    s_waitcnt vmcnt(3)
    buffer_load_dwordx4 v245, s[40:43], s8 offen offset:1024 nt lds
    v_mfma_f32_16x16x32_bf16 v[208:211], a[128:131], a[52:55], v[208:211]
    v_max3_f32 v100, v100, v201, v202
    v_max_f32 v100, v100, v203
    v_mfma_f32_16x16x32_bf16 v[208:211], a[132:135], a[64:67], v[208:211]
    v_mov_b32 v101, v100
    v_mfma_f32_16x16x32_bf16 v[208:211], a[136:139], a[76:79], v[208:211]
    ds_read_b128 a[124:127], v243 offset:16384
    v_mfma_f32_16x16x32_bf16 v[208:211], a[140:143], a[88:91], v[208:211]
    v_permlane16_swap_b32 v100, v101
    v_mfma_f32_16x16x32_bf16 v[212:215], a[128:131], a[56:59], v[212:215]
    ds_read_b128 a[128:131], v240 offset:24576
    v_max_f32 v100, v100, v101
    v_mfma_f32_16x16x32_bf16 v[212:215], a[132:135], a[68:71], v[212:215]
    v_mov_b32 v101, v100
    v_mfma_f32_16x16x32_bf16 v[212:215], a[136:139], a[80:83], v[212:215]
    s_nop 0
    v_permlane32_swap_b32 v100, v101
    v_mfma_f32_16x16x32_bf16 v[212:215], a[140:143], a[92:95], v[212:215]
    ds_read_b128 a[132:135], v241 offset:24576
    v_max_f32 v100, v100, v101
    v_mfma_f32_16x16x32_bf16 v[216:219], a[96:99], a[48:51], v[216:219]
    v_sub_f32 v236, 0, v100
    v_sub_f32 v237, 0, v100
    v_mfma_f32_16x16x32_bf16 v[216:219], a[100:103], a[60:63], v[216:219]
    v_sub_f32 v238, 0, v100
    v_sub_f32 v239, 0, v100
    v_mfma_f32_16x16x32_bf16 v[216:219], a[104:107], a[72:75], v[216:219]
    s_add_u32 m0, s10, 114688
    ds_read_b128 a[136:139], v242 offset:24576
    v_add_f32 v180, v180, v228
    v_mfma_f32_16x16x32_bf16 v[216:219], a[108:111], a[84:87], v[216:219]
    s_waitcnt vmcnt(3)
    buffer_load_dwordx4 v246, s[40:43], s8 offen offset:2048 nt lds
    v_add_f32 v181, v181, v228
    v_mfma_f32_16x16x32_bf16 v[220:223], a[96:99], a[52:55], v[220:223]
    ds_read_b128 a[140:143], v243 offset:24576
    v_add_f32 v182, v182, v228
    v_mfma_f32_16x16x32_bf16 v[220:223], a[100:103], a[64:67], v[220:223]
    v_add_f32 v183, v183, v228
    v_mfma_f32_16x16x32_bf16 v[220:223], a[104:107], a[76:79], v[220:223]
    v_exp_f32 v180, v180
    v_mfma_f32_16x16x32_bf16 v[220:223], a[108:111], a[88:91], v[220:223]
    v_exp_f32 v181, v181
    v_mfma_f32_16x16x32_bf16 v[224:227], a[96:99], a[56:59], v[224:227]
    ds_read_b128 a[96:99], v240 offset:16640
    v_mfma_f32_16x16x32_bf16 v[224:227], a[100:103], a[68:71], v[224:227]
    ds_read_b128 a[100:103], v241 offset:16640
    v_mfma_f32_16x16x32_bf16 v[224:227], a[104:107], a[80:83], v[224:227]
    v_exp_f32 v182, v182
    v_exp_f32 v183, v183
    v_add_f32 v192, v192, v228
    v_add_f32 v193, v193, v228
    v_add_f32 v194, v194, v228
    v_add_f32 v195, v195, v228
    v_exp_f32 v192, v192
    v_cvt_pk_bf16_f32 v0, v180, v181
    v_cvt_pk_bf16_f32 v1, v182, v183
    v_exp_f32 v193, v193
    v_add_f32 v252, v252, v180
    v_add_f32 v252, v252, v181
    v_exp_f32 v194, v194
    v_add_f32 v252, v252, v182
    v_add_f32 v252, v252, v183
    v_exp_f32 v195, v195
    v_add_f32 v184, v184, v232
    v_add_f32 v185, v185, v232
    v_add_f32 v186, v186, v232
    v_add_f32 v187, v187, v232
    v_exp_f32 v184, v184
    v_cvt_pk_bf16_f32 v2, v192, v193
    v_cvt_pk_bf16_f32 v3, v194, v195
    v_exp_f32 v185, v185
    v_add_f32 v252, v252, v192
    v_add_f32 v252, v252, v193
    v_exp_f32 v186, v186
    v_add_f32 v252, v252, v194
    v_add_f32 v252, v252, v195
    v_exp_f32 v187, v187
    v_add_f32 v196, v196, v232
    v_add_f32 v197, v197, v232
    v_add_f32 v198, v198, v232
    v_add_f32 v199, v199, v232
    v_exp_f32 v196, v196
    v_cvt_pk_bf16_f32 v4, v184, v185
    v_cvt_pk_bf16_f32 v5, v186, v187
    v_exp_f32 v197, v197
    v_add_f32 v253, v253, v184
    v_add_f32 v253, v253, v185
    v_exp_f32 v198, v198
    v_add_f32 v253, v253, v186
    v_add_f32 v253, v253, v187
    v_exp_f32 v199, v199
    v_add_f32 v188, v188, v236
    v_add_f32 v189, v189, v236
    v_add_f32 v190, v190, v236
    v_add_f32 v191, v191, v236
    v_exp_f32 v188, v188
    v_cvt_pk_bf16_f32 v6, v196, v197
    v_cvt_pk_bf16_f32 v7, v198, v199
    v_exp_f32 v189, v189
    v_add_f32 v253, v253, v196
    v_add_f32 v253, v253, v197
    v_exp_f32 v190, v190
    v_add_f32 v253, v253, v198
    v_add_f32 v253, v253, v199
    v_exp_f32 v191, v191
    v_add_f32 v200, v200, v236
    v_add_f32 v201, v201, v236
    v_add_f32 v202, v202, v236
    v_add_f32 v203, v203, v236
    v_exp_f32 v200, v200
    v_cvt_pk_bf16_f32 v8, v188, v189
    v_cvt_pk_bf16_f32 v9, v190, v191
    v_exp_f32 v201, v201
    v_add_f32 v254, v254, v188
    v_add_f32 v254, v254, v189
    v_exp_f32 v202, v202
    v_add_f32 v254, v254, v190
    v_add_f32 v254, v254, v191
    v_exp_f32 v203, v203
    v_cvt_pk_bf16_f32 v10, v200, v201
    v_cvt_pk_bf16_f32 v11, v202, v203
    v_add_f32 v254, v254, v200
    v_add_f32 v254, v254, v201
    v_add_f32 v254, v254, v202
    v_add_f32 v254, v254, v203
    v_mfma_f32_16x16x32_bf16 v[224:227], a[108:111], a[92:95], v[224:227]
    s_waitcnt lgkmcnt(6)
    v_mfma_f32_16x16x32_bf16 v[180:183], a[112:115], a[0:3], v[228:231]
    ds_read_b128 a[104:107], v242 offset:16640
    v_mfma_f32_16x16x32_bf16 v[180:183], a[116:119], a[12:15], v[180:183]
    v_mfma_f32_16x16x32_bf16 v[180:183], a[120:123], a[24:27], v[180:183]
    s_add_u32 m0, s10, 114688
    v_add_f32 v204, v204, v228
    v_add_f32 v205, v205, v228
    v_mfma_f32_16x16x32_bf16 v[180:183], a[124:127], a[36:39], v[180:183]
    ds_read_b128 a[108:111], v243 offset:16640
    s_waitcnt vmcnt(3)
    buffer_load_dwordx4 v247, s[40:43], s8 offen offset:3072 nt lds
    v_mfma_f32_16x16x32_bf16 v[184:187], a[112:115], a[4:7], v[232:235]
    v_add_f32 v206, v206, v228
    v_add_f32 v207, v207, v228
    v_mfma_f32_16x16x32_bf16 v[184:187], a[116:119], a[16:19], v[184:187]
    v_exp_f32 v204, v204
    v_mfma_f32_16x16x32_bf16 v[184:187], a[120:123], a[28:31], v[184:187]
    v_exp_f32 v205, v205
    v_mfma_f32_16x16x32_bf16 v[184:187], a[124:127], a[40:43], v[184:187]
    v_exp_f32 v206, v206
    v_mfma_f32_16x16x32_bf16 v[188:191], a[112:115], a[8:11], v[236:239]
    ds_read_b128 a[112:115], v240 offset:24832
    v_mfma_f32_16x16x32_bf16 v[188:191], a[116:119], a[20:23], v[188:191]
    ds_read_b128 a[116:119], v241 offset:24832
    v_mfma_f32_16x16x32_bf16 v[188:191], a[120:123], a[32:35], v[188:191]
    ds_read_b128 a[120:123], v242 offset:24832
    v_mfma_f32_16x16x32_bf16 v[188:191], a[124:127], a[44:47], v[188:191]
    s_waitcnt lgkmcnt(7)
    v_exp_f32 v207, v207
    v_mfma_f32_16x16x32_bf16 v[192:195], a[128:131], a[0:3], v[228:231]
    v_add_f32 v216, v216, v228
    v_add_f32 v217, v217, v228
    v_mfma_f32_16x16x32_bf16 v[192:195], a[132:135], a[12:15], v[192:195]
    ds_read_b128 a[124:127], v243 offset:24832
    v_add_f32 v218, v218, v228
    v_mfma_f32_16x16x32_bf16 v[192:195], a[136:139], a[24:27], v[192:195]
    v_add_u32 v240, 0xfffe0000, v240
    v_add_u32 v241, 0xfffe0000, v241
    v_mfma_f32_16x16x32_bf16 v[192:195], a[140:143], a[36:39], v[192:195]
    v_add_u32 v242, 0xfffe0000, v242
    v_add_u32 v243, 0xfffe0000, v243
    v_mfma_f32_16x16x32_bf16 v[196:199], a[128:131], a[4:7], v[232:235]
    v_add_f32 v219, v219, v228
    v_mfma_f32_16x16x32_bf16 v[196:199], a[132:135], a[16:19], v[196:199]
    v_exp_f32 v216, v216
    v_mfma_f32_16x16x32_bf16 v[196:199], a[136:139], a[28:31], v[196:199]
    v_cvt_pk_bf16_f32 v12, v204, v205
    v_cvt_pk_bf16_f32 v13, v206, v207
    v_mfma_f32_16x16x32_bf16 v[196:199], a[140:143], a[40:43], v[196:199]
    v_exp_f32 v217, v217
    v_mfma_f32_16x16x32_bf16 v[200:203], a[128:131], a[8:11], v[236:239]
    v_add_f32 v252, v252, v204
    v_add_f32 v252, v252, v205
    v_mfma_f32_16x16x32_bf16 v[200:203], a[132:135], a[20:23], v[200:203]
    s_waitcnt lgkmcnt(0)
    s_barrier
    v_mfma_f32_16x16x32_bf16 v[200:203], a[136:139], a[32:35], v[200:203]
    s_mov_b32 s8, 180224
    s_add_u32 m0, s10, 131072
    ds_read_b128 a[128:131], v240 offset:32768
    v_mfma_f32_16x16x32_bf16 v[200:203], a[140:143], a[44:47], v[200:203]
    s_waitcnt vmcnt(3)
    buffer_load_dwordx4 v244, s[40:43], s8 offen nt lds
    v_mfma_f32_16x16x32_bf16 v[180:183], a[96:99], a[48:51], v[180:183]
    v_exp_f32 v218, v218
    v_mfma_f32_16x16x32_bf16 v[180:183], a[100:103], a[60:63], v[180:183]
    ds_read_b128 a[132:135], v241 offset:32768
    v_add_f32 v252, v252, v206
    v_mfma_f32_16x16x32_bf16 v[180:183], a[104:107], a[72:75], v[180:183]
    s_add_u32 m0, s10, 131072
    v_add_f32 v252, v252, v207
    v_mfma_f32_16x16x32_bf16 v[180:183], a[108:111], a[84:87], v[180:183]
    ds_read_b128 a[136:139], v242 offset:32768
    s_waitcnt vmcnt(3)
    buffer_load_dwordx4 v245, s[40:43], s8 offen offset:1024 nt lds
    v_mfma_f32_16x16x32_bf16 v[184:187], a[96:99], a[52:55], v[184:187]
    v_exp_f32 v219, v219
    v_mfma_f32_16x16x32_bf16 v[184:187], a[100:103], a[64:67], v[184:187]
    v_add_f32 v208, v208, v232
    v_add_f32 v209, v209, v232
    v_mfma_f32_16x16x32_bf16 v[184:187], a[104:107], a[76:79], v[184:187]
    ds_read_b128 a[140:143], v243 offset:32768
    v_add_f32 v210, v210, v232
    v_mfma_f32_16x16x32_bf16 v[184:187], a[108:111], a[88:91], v[184:187]
    v_add_f32 v211, v211, v232
    v_mfma_f32_16x16x32_bf16 v[188:191], a[96:99], a[56:59], v[188:191]
    ds_read_b128 a[96:99], v240 offset:40960
    v_mfma_f32_16x16x32_bf16 v[188:191], a[100:103], a[68:71], v[188:191]
    v_exp_f32 v208, v208
    v_mfma_f32_16x16x32_bf16 v[188:191], a[104:107], a[80:83], v[188:191]
    v_cvt_pk_bf16_f32 v14, v216, v217
    v_cvt_pk_bf16_f32 v15, v218, v219
    v_mfma_f32_16x16x32_bf16 v[188:191], a[108:111], a[92:95], v[188:191]
    ds_read_b128 a[100:103], v241 offset:40960
    v_mfma_f32_16x16x32_bf16 v[192:195], a[112:115], a[48:51], v[192:195]
    v_exp_f32 v209, v209
    v_mfma_f32_16x16x32_bf16 v[192:195], a[116:119], a[60:63], v[192:195]
    v_add_f32 v252, v252, v216
    v_add_f32 v252, v252, v217
    v_mfma_f32_16x16x32_bf16 v[192:195], a[120:123], a[72:75], v[192:195]
    s_add_u32 m0, s10, 131072
    ds_read_b128 a[104:107], v242 offset:40960
    v_mfma_f32_16x16x32_bf16 v[192:195], a[124:127], a[84:87], v[192:195]
    s_waitcnt vmcnt(3)
    buffer_load_dwordx4 v246, s[40:43], s8 offen offset:2048 nt lds
    v_mfma_f32_16x16x32_bf16 v[196:199], a[112:115], a[52:55], v[196:199]
    ds_read_b128 a[108:111], v243 offset:40960
    v_mfma_f32_16x16x32_bf16 v[196:199], a[116:119], a[64:67], v[196:199]
    v_exp_f32 v210, v210
    v_mfma_f32_16x16x32_bf16 v[196:199], a[120:123], a[76:79], v[196:199]
    v_add_f32 v252, v252, v218
    v_add_f32 v252, v252, v219
    v_mfma_f32_16x16x32_bf16 v[196:199], a[124:127], a[88:91], v[196:199]
    v_exp_f32 v211, v211
    v_mfma_f32_16x16x32_bf16 v[200:203], a[112:115], a[56:59], v[200:203]
    ds_read_b128 a[112:115], v240 offset:33024
    v_add_f32 v220, v220, v232
    v_mfma_f32_16x16x32_bf16 v[200:203], a[116:119], a[68:71], v[200:203]
    ds_read_b128 a[116:119], v241 offset:33024
    v_add_f32 v221, v221, v232
    v_mfma_f32_16x16x32_bf16 v[200:203], a[120:123], a[80:83], v[200:203]
    v_add_f32 v222, v222, v232
    v_add_f32 v223, v223, v232
    v_exp_f32 v220, v220
    v_cvt_pk_bf16_f32 v16, v208, v209
    v_cvt_pk_bf16_f32 v17, v210, v211
    v_exp_f32 v221, v221
    v_add_f32 v253, v253, v208
    v_add_f32 v253, v253, v209
    v_exp_f32 v222, v222
    v_add_f32 v253, v253, v210
    v_add_f32 v253, v253, v211
    v_exp_f32 v223, v223
    v_add_f32 v212, v212, v236
    v_add_f32 v213, v213, v236
    v_add_f32 v214, v214, v236
    v_add_f32 v215, v215, v236
    v_exp_f32 v212, v212
    v_cvt_pk_bf16_f32 v18, v220, v221
    v_cvt_pk_bf16_f32 v19, v222, v223
    v_exp_f32 v213, v213
    v_add_f32 v253, v253, v220
    v_add_f32 v253, v253, v221
    v_exp_f32 v214, v214
    v_add_f32 v253, v253, v222
    v_add_f32 v253, v253, v223
    v_exp_f32 v215, v215
    v_add_f32 v224, v224, v236
    v_add_f32 v225, v225, v236
    v_add_f32 v226, v226, v236
    v_add_f32 v227, v227, v236
    v_exp_f32 v224, v224
    v_cvt_pk_bf16_f32 v20, v212, v213
    v_cvt_pk_bf16_f32 v21, v214, v215
    v_exp_f32 v225, v225
    v_add_f32 v254, v254, v212
    v_add_f32 v254, v254, v213
    v_exp_f32 v226, v226
    v_add_f32 v254, v254, v214
    v_add_f32 v254, v254, v215
    v_exp_f32 v227, v227
    v_cvt_pk_bf16_f32 v22, v224, v225
    v_cvt_pk_bf16_f32 v23, v226, v227
    v_add_f32 v254, v254, v224
    v_add_f32 v254, v254, v225
    v_add_f32 v254, v254, v226
    v_add_f32 v254, v254, v227
    v_mfma_f32_16x16x32_bf16 v[200:203], a[124:127], a[92:95], v[200:203]
    s_waitcnt lgkmcnt(6)
    v_mfma_f32_16x16x32_bf16 v[204:207], a[128:131], a[0:3], v[228:231]
    ds_read_b128 a[120:123], v242 offset:33024
    v_mfma_f32_16x16x32_bf16 v[204:207], a[132:135], a[12:15], v[204:207]
    v_mfma_f32_16x16x32_bf16 v[204:207], a[136:139], a[24:27], v[204:207]
    s_add_u32 m0, s10, 131072
    v_exp_f32 v180, v180
    v_mfma_f32_16x16x32_bf16 v[204:207], a[140:143], a[36:39], v[204:207]
    ds_read_b128 a[124:127], v243 offset:33024
    s_waitcnt vmcnt(3)
    buffer_load_dwordx4 v247, s[40:43], s8 offen offset:3072 nt lds
    v_mfma_f32_16x16x32_bf16 v[208:211], a[128:131], a[4:7], v[232:235]
    v_exp_f32 v181, v181
    v_mfma_f32_16x16x32_bf16 v[208:211], a[132:135], a[16:19], v[208:211]
    v_exp_f32 v182, v182
    v_mfma_f32_16x16x32_bf16 v[208:211], a[136:139], a[28:31], v[208:211]
    v_exp_f32 v183, v183
    v_mfma_f32_16x16x32_bf16 v[208:211], a[140:143], a[40:43], v[208:211]
    v_add_f32 v252, v252, v180
    v_add_f32 v252, v252, v181
    v_mfma_f32_16x16x32_bf16 v[212:215], a[128:131], a[8:11], v[236:239]
    ds_read_b128 a[128:131], v240 offset:41216
    v_cvt_pk_bf16_f32 v24, v180, v181
    v_mfma_f32_16x16x32_bf16 v[212:215], a[132:135], a[20:23], v[212:215]
    ds_read_b128 a[132:135], v241 offset:41216
    v_add_f32 v252, v252, v182
    v_mfma_f32_16x16x32_bf16 v[212:215], a[136:139], a[32:35], v[212:215]
    ds_read_b128 a[136:139], v242 offset:41216
    v_add_f32 v252, v252, v183
    v_mfma_f32_16x16x32_bf16 v[212:215], a[140:143], a[44:47], v[212:215]
    s_waitcnt lgkmcnt(7)
    v_exp_f32 v192, v192
    v_mfma_f32_16x16x32_bf16 v[216:219], a[96:99], a[0:3], v[228:231]
    v_exp_f32 v193, v193
    v_mfma_f32_16x16x32_bf16 v[216:219], a[100:103], a[12:15], v[216:219]
    ds_read_b128 a[140:143], v243 offset:41216
    v_cvt_pk_bf16_f32 v25, v182, v183
    v_mfma_f32_16x16x32_bf16 v[216:219], a[104:107], a[24:27], v[216:219]
    v_add_u32 v240, 0x10000, v240
    v_add_u32 v241, 0x10000, v241
    v_mfma_f32_16x16x32_bf16 v[216:219], a[108:111], a[36:39], v[216:219]
    v_add_u32 v242, 0x10000, v242
    v_add_u32 v243, 0x10000, v243
    v_mfma_f32_16x16x32_bf16 v[220:223], a[96:99], a[4:7], v[232:235]
    v_exp_f32 v194, v194
    v_mfma_f32_16x16x32_bf16 v[220:223], a[100:103], a[16:19], v[220:223]
    v_exp_f32 v195, v195
    v_mfma_f32_16x16x32_bf16 v[220:223], a[104:107], a[28:31], v[220:223]
    v_exp_f32 v184, v184
    v_mfma_f32_16x16x32_bf16 v[220:223], a[108:111], a[40:43], v[220:223]
    v_exp_f32 v185, v185
    v_mfma_f32_16x16x32_bf16 v[224:227], a[96:99], a[8:11], v[236:239]
    v_exp_f32 v186, v186
    v_mfma_f32_16x16x32_bf16 v[224:227], a[100:103], a[20:23], v[224:227]
    s_waitcnt lgkmcnt(0)
    s_barrier
    v_add_f32 v252, v252, v192
    v_mfma_f32_16x16x32_bf16 v[224:227], a[104:107], a[32:35], v[224:227]
    s_mov_b32 s8, 196608
    s_add_u32 m0, s10, 32768
    ds_read_b128 a[96:99], v240 offset:32768
    v_mfma_f32_16x16x32_bf16 v[224:227], a[108:111], a[44:47], v[224:227]
    s_waitcnt vmcnt(3)
    buffer_load_dwordx4 v244, s[40:43], s8 offen nt lds
    v_add_f32 v252, v252, v193
    v_mfma_f32_16x16x32_bf16 v[204:207], a[112:115], a[48:51], v[204:207]
    v_exp_f32 v187, v187
    v_mfma_f32_16x16x32_bf16 v[204:207], a[116:119], a[60:63], v[204:207]
    ds_read_b128 a[100:103], v241 offset:32768
    v_cvt_pk_bf16_f32 v26, v192, v193
    v_mfma_f32_16x16x32_bf16 v[204:207], a[120:123], a[72:75], v[204:207]
    s_add_u32 m0, s10, 32768
    v_exp_f32 v196, v196
    v_mfma_f32_16x16x32_bf16 v[204:207], a[124:127], a[84:87], v[204:207]
    ds_read_b128 a[104:107], v242 offset:32768
    s_waitcnt vmcnt(3)
    buffer_load_dwordx4 v245, s[40:43], s8 offen offset:1024 nt lds
    v_mfma_f32_16x16x32_bf16 v[208:211], a[112:115], a[52:55], v[208:211]
    v_exp_f32 v197, v197
    v_mfma_f32_16x16x32_bf16 v[208:211], a[116:119], a[64:67], v[208:211]
    v_exp_f32 v198, v198
    v_mfma_f32_16x16x32_bf16 v[208:211], a[120:123], a[76:79], v[208:211]
    ds_read_b128 a[108:111], v243 offset:32768
    v_add_f32 v252, v252, v194
    v_mfma_f32_16x16x32_bf16 v[208:211], a[124:127], a[88:91], v[208:211]
    v_exp_f32 v199, v199
    v_mfma_f32_16x16x32_bf16 v[212:215], a[112:115], a[56:59], v[212:215]
    ds_read_b128 a[112:115], v240 offset:40960
    v_add_f32 v252, v252, v195
    v_mfma_f32_16x16x32_bf16 v[212:215], a[116:119], a[68:71], v[212:215]
    v_exp_f32 v188, v188
    v_mfma_f32_16x16x32_bf16 v[212:215], a[120:123], a[80:83], v[212:215]
    v_exp_f32 v189, v189
    v_mfma_f32_16x16x32_bf16 v[212:215], a[124:127], a[92:95], v[212:215]
    ds_read_b128 a[116:119], v241 offset:40960
    v_cvt_pk_bf16_f32 v27, v194, v195
    v_mfma_f32_16x16x32_bf16 v[216:219], a[128:131], a[48:51], v[216:219]
    v_exp_f32 v190, v190
    v_mfma_f32_16x16x32_bf16 v[216:219], a[132:135], a[60:63], v[216:219]
    v_exp_f32 v191, v191
    v_add_f32 v254, v254, v190
    v_mfma_f32_16x16x32_bf16 v[216:219], a[136:139], a[72:75], v[216:219]
    s_add_u32 m0, s10, 32768
    ds_read_b128 a[120:123], v242 offset:40960
    v_add_f32 v253, v253, v184
    v_cvt_pk_bf16_f32 v32, v188, v189
    v_mfma_f32_16x16x32_bf16 v[216:219], a[140:143], a[84:87], v[216:219]
    s_waitcnt vmcnt(3)
    buffer_load_dwordx4 v246, s[40:43], s8 offen offset:2048 nt lds
    v_add_f32 v253, v253, v185
    v_add_f32 v254, v254, v189
    v_mfma_f32_16x16x32_bf16 v[220:223], a[128:131], a[52:55], v[220:223]
    ds_read_b128 a[124:127], v243 offset:40960
    v_cvt_pk_bf16_f32 v28, v184, v185
    v_add_f32 v254, v254, v188
    v_mfma_f32_16x16x32_bf16 v[220:223], a[132:135], a[64:67], v[220:223]
    v_exp_f32 v200, v200
    v_cvt_pk_bf16_f32 v31, v198, v199
    v_mfma_f32_16x16x32_bf16 v[220:223], a[136:139], a[76:79], v[220:223]
    v_exp_f32 v201, v201
    v_add_f32 v253, v253, v199
    v_mfma_f32_16x16x32_bf16 v[220:223], a[140:143], a[88:91], v[220:223]
    v_exp_f32 v202, v202
    v_exp_f32 v203, v203
    v_mfma_f32_16x16x32_bf16 v[224:227], a[128:131], a[56:59], v[224:227]
    ds_read_b128 a[128:131], v240 offset:33024
    v_add_f32 v253, v253, v186
    v_add_f32 v253, v253, v198
    v_add_f32 v254, v254, v200
    v_add_f32 v254, v254, v202
    v_mfma_f32_16x16x32_bf16 v[224:227], a[132:135], a[68:71], v[224:227]
    ds_read_b128 a[132:135], v241 offset:33024
    v_add_f32 v253, v253, v187
    v_cvt_pk_bf16_f32 v30, v196, v197
    v_cvt_pk_bf16_f32 v33, v190, v191
    v_cvt_pk_bf16_f32 v34, v200, v201
    v_cvt_pk_bf16_f32 v35, v202, v203
    v_mfma_f32_16x16x32_bf16 v[224:227], a[136:139], a[80:83], v[224:227]
    v_cvt_pk_bf16_f32 v29, v186, v187
    v_add_f32 v253, v253, v196
    v_add_f32 v253, v253, v197
    v_add_f32 v254, v254, v191
    v_add_f32 v254, v254, v201
    v_add_f32 v254, v254, v203
    v_mfma_f32_16x16x32_bf16 v[224:227], a[140:143], a[92:95], v[224:227]
    s_waitcnt lgkmcnt(6)
    v_mfma_f32_16x16x32_bf16 v[180:183], a[96:99], a[0:3], v[228:231]
    ds_read_b128 a[136:139], v242 offset:33024
    v_mfma_f32_16x16x32_bf16 v[180:183], a[100:103], a[12:15], v[180:183]
    v_mfma_f32_16x16x32_bf16 v[180:183], a[104:107], a[24:27], v[180:183]
    s_add_u32 m0, s10, 32768
    v_exp_f32 v204, v204
    v_mfma_f32_16x16x32_bf16 v[180:183], a[108:111], a[36:39], v[180:183]
    ds_read_b128 a[140:143], v243 offset:33024
    s_waitcnt vmcnt(3)
    buffer_load_dwordx4 v247, s[40:43], s8 offen offset:3072 nt lds
    v_mfma_f32_16x16x32_bf16 v[184:187], a[96:99], a[4:7], v[232:235]
    v_exp_f32 v205, v205
    v_mfma_f32_16x16x32_bf16 v[184:187], a[100:103], a[16:19], v[184:187]
    v_exp_f32 v206, v206
    v_mfma_f32_16x16x32_bf16 v[184:187], a[104:107], a[28:31], v[184:187]
    v_exp_f32 v207, v207
    v_mfma_f32_16x16x32_bf16 v[184:187], a[108:111], a[40:43], v[184:187]
    v_add_f32 v252, v252, v204
    v_add_f32 v252, v252, v205
    v_mfma_f32_16x16x32_bf16 v[188:191], a[96:99], a[8:11], v[236:239]
    ds_read_b128 a[96:99], v240 offset:41216
    v_cvt_pk_bf16_f32 v36, v204, v205
    v_mfma_f32_16x16x32_bf16 v[188:191], a[100:103], a[20:23], v[188:191]
    ds_read_b128 a[100:103], v241 offset:41216
    v_add_f32 v252, v252, v206
    v_mfma_f32_16x16x32_bf16 v[188:191], a[104:107], a[32:35], v[188:191]
    ds_read_b128 a[104:107], v242 offset:41216
    v_add_f32 v252, v252, v207
    v_mfma_f32_16x16x32_bf16 v[188:191], a[108:111], a[44:47], v[188:191]
    s_waitcnt lgkmcnt(7)
    v_exp_f32 v216, v216
    v_mfma_f32_16x16x32_bf16 v[192:195], a[112:115], a[0:3], v[228:231]
    v_exp_f32 v217, v217
    v_mfma_f32_16x16x32_bf16 v[192:195], a[116:119], a[12:15], v[192:195]
    ds_read_b128 a[108:111], v243 offset:41216
    v_cvt_pk_bf16_f32 v37, v206, v207
    v_mfma_f32_16x16x32_bf16 v[192:195], a[120:123], a[24:27], v[192:195]
    v_add_u32 v240, 0xffff0000, v240
    v_add_u32 v241, 0xffff0000, v241
    v_mfma_f32_16x16x32_bf16 v[192:195], a[124:127], a[36:39], v[192:195]
    v_add_u32 v242, 0xffff0000, v242
    v_add_u32 v243, 0xffff0000, v243
    v_mfma_f32_16x16x32_bf16 v[196:199], a[112:115], a[4:7], v[232:235]
    v_exp_f32 v218, v218
    v_mfma_f32_16x16x32_bf16 v[196:199], a[116:119], a[16:19], v[196:199]
    v_exp_f32 v219, v219
    v_mfma_f32_16x16x32_bf16 v[196:199], a[120:123], a[28:31], v[196:199]
    v_exp_f32 v208, v208
    v_mfma_f32_16x16x32_bf16 v[196:199], a[124:127], a[40:43], v[196:199]
    v_exp_f32 v209, v209
    v_mfma_f32_16x16x32_bf16 v[200:203], a[112:115], a[8:11], v[236:239]
    v_exp_f32 v210, v210
    v_mfma_f32_16x16x32_bf16 v[200:203], a[116:119], a[20:23], v[200:203]
    s_waitcnt lgkmcnt(0)
    s_barrier
    v_add_f32 v252, v252, v216
    v_mfma_f32_16x16x32_bf16 v[200:203], a[120:123], a[32:35], v[200:203]
    s_mov_b32 s8, 212992
    s_add_u32 m0, s10, 98304
    ds_read_b128 a[112:115], v240 offset:49152
    v_mfma_f32_16x16x32_bf16 v[200:203], a[124:127], a[44:47], v[200:203]
    s_waitcnt vmcnt(3)
    buffer_load_dwordx4 v244, s[40:43], s8 offen nt lds
    v_add_f32 v252, v252, v217
    v_mfma_f32_16x16x32_bf16 v[180:183], a[128:131], a[48:51], v[180:183]
    v_exp_f32 v211, v211
    v_mfma_f32_16x16x32_bf16 v[180:183], a[132:135], a[60:63], v[180:183]
    ds_read_b128 a[116:119], v241 offset:49152
    v_cvt_pk_bf16_f32 v38, v216, v217
    v_mfma_f32_16x16x32_bf16 v[180:183], a[136:139], a[72:75], v[180:183]
    s_add_u32 m0, s10, 98304
    v_exp_f32 v220, v220
    v_mfma_f32_16x16x32_bf16 v[180:183], a[140:143], a[84:87], v[180:183]
    ds_read_b128 a[120:123], v242 offset:49152
    s_waitcnt vmcnt(3)
    buffer_load_dwordx4 v245, s[40:43], s8 offen offset:1024 nt lds
    v_mfma_f32_16x16x32_bf16 v[184:187], a[128:131], a[52:55], v[184:187]
    v_exp_f32 v221, v221
    v_mfma_f32_16x16x32_bf16 v[184:187], a[132:135], a[64:67], v[184:187]
    v_exp_f32 v222, v222
    v_mfma_f32_16x16x32_bf16 v[184:187], a[136:139], a[76:79], v[184:187]
    ds_read_b128 a[124:127], v243 offset:49152
    v_add_f32 v252, v252, v218
    v_mfma_f32_16x16x32_bf16 v[184:187], a[140:143], a[88:91], v[184:187]
    v_exp_f32 v223, v223
    v_mfma_f32_16x16x32_bf16 v[188:191], a[128:131], a[56:59], v[188:191]
    ds_read_b128 a[128:131], v240 offset:57344
    v_add_f32 v252, v252, v219
    v_mfma_f32_16x16x32_bf16 v[188:191], a[132:135], a[68:71], v[188:191]
    v_exp_f32 v212, v212
    v_mfma_f32_16x16x32_bf16 v[188:191], a[136:139], a[80:83], v[188:191]
    v_exp_f32 v213, v213
    v_mfma_f32_16x16x32_bf16 v[188:191], a[140:143], a[92:95], v[188:191]
    ds_read_b128 a[132:135], v241 offset:57344
    v_cvt_pk_bf16_f32 v39, v218, v219
    v_mfma_f32_16x16x32_bf16 v[192:195], a[96:99], a[48:51], v[192:195]
    v_exp_f32 v214, v214
    v_mfma_f32_16x16x32_bf16 v[192:195], a[100:103], a[60:63], v[192:195]
    v_exp_f32 v215, v215
    v_add_f32 v254, v254, v214
    v_mfma_f32_16x16x32_bf16 v[192:195], a[104:107], a[72:75], v[192:195]
    s_add_u32 m0, s10, 98304
    ds_read_b128 a[136:139], v242 offset:57344
    v_add_f32 v253, v253, v208
    v_cvt_pk_bf16_f32 v44, v212, v213
    v_mfma_f32_16x16x32_bf16 v[192:195], a[108:111], a[84:87], v[192:195]
    s_waitcnt vmcnt(3)
    buffer_load_dwordx4 v246, s[40:43], s8 offen offset:2048 nt lds
    v_add_f32 v253, v253, v209
    v_add_f32 v254, v254, v213
    v_mfma_f32_16x16x32_bf16 v[196:199], a[96:99], a[52:55], v[196:199]
    ds_read_b128 a[140:143], v243 offset:57344
    v_cvt_pk_bf16_f32 v40, v208, v209
    v_add_f32 v254, v254, v212
    v_mfma_f32_16x16x32_bf16 v[196:199], a[100:103], a[64:67], v[196:199]
    v_exp_f32 v224, v224
    v_cvt_pk_bf16_f32 v43, v222, v223
    v_mfma_f32_16x16x32_bf16 v[196:199], a[104:107], a[76:79], v[196:199]
    v_exp_f32 v225, v225
    v_add_f32 v253, v253, v223
    v_mfma_f32_16x16x32_bf16 v[196:199], a[108:111], a[88:91], v[196:199]
    v_exp_f32 v226, v226
    v_exp_f32 v227, v227
    v_mfma_f32_16x16x32_bf16 v[200:203], a[96:99], a[56:59], v[200:203]
    ds_read_b128 a[96:99], v240 offset:49408
    v_add_f32 v253, v253, v210
    v_add_f32 v253, v253, v222
    v_add_f32 v254, v254, v224
    v_add_f32 v254, v254, v226
    v_mfma_f32_16x16x32_bf16 v[200:203], a[100:103], a[68:71], v[200:203]
    ds_read_b128 a[100:103], v241 offset:49408
    v_add_f32 v253, v253, v211
    v_cvt_pk_bf16_f32 v42, v220, v221
    v_cvt_pk_bf16_f32 v45, v214, v215
    v_cvt_pk_bf16_f32 v46, v224, v225
    v_cvt_pk_bf16_f32 v47, v226, v227
    v_mfma_f32_16x16x32_bf16 v[200:203], a[104:107], a[80:83], v[200:203]
    v_cvt_pk_bf16_f32 v41, v210, v211
    v_add_f32 v253, v253, v220
    v_add_f32 v253, v253, v221
    v_add_f32 v254, v254, v215
    v_add_f32 v254, v254, v225
    v_add_f32 v254, v254, v227
    v_mfma_f32_16x16x32_bf16 v[200:203], a[108:111], a[92:95], v[200:203]
    s_waitcnt lgkmcnt(6)
    v_mfma_f32_16x16x32_bf16 v[204:207], a[112:115], a[0:3], v[228:231]
    ds_read_b128 a[104:107], v242 offset:49408
    v_mfma_f32_16x16x32_bf16 v[204:207], a[116:119], a[12:15], v[204:207]
    v_mfma_f32_16x16x32_bf16 v[204:207], a[120:123], a[24:27], v[204:207]
    s_add_u32 m0, s10, 98304
    v_exp_f32 v180, v180
    v_mfma_f32_16x16x32_bf16 v[204:207], a[124:127], a[36:39], v[204:207]
    ds_read_b128 a[108:111], v243 offset:49408
    s_waitcnt vmcnt(3)
    buffer_load_dwordx4 v247, s[40:43], s8 offen offset:3072 nt lds
    v_mfma_f32_16x16x32_bf16 v[208:211], a[112:115], a[4:7], v[232:235]
    v_exp_f32 v181, v181
    v_mfma_f32_16x16x32_bf16 v[208:211], a[116:119], a[16:19], v[208:211]
    v_exp_f32 v182, v182
    v_mfma_f32_16x16x32_bf16 v[208:211], a[120:123], a[28:31], v[208:211]
    v_exp_f32 v183, v183
    v_mfma_f32_16x16x32_bf16 v[208:211], a[124:127], a[40:43], v[208:211]
    v_add_f32 v252, v252, v180
    v_add_f32 v252, v252, v181
    v_mfma_f32_16x16x32_bf16 v[212:215], a[112:115], a[8:11], v[236:239]
    ds_read_b128 a[112:115], v240 offset:57600
    v_cvt_pk_bf16_f32 v48, v180, v181
    v_mfma_f32_16x16x32_bf16 v[212:215], a[116:119], a[20:23], v[212:215]
    ds_read_b128 a[116:119], v241 offset:57600
    v_add_f32 v252, v252, v182
    v_mfma_f32_16x16x32_bf16 v[212:215], a[120:123], a[32:35], v[212:215]
    ds_read_b128 a[120:123], v242 offset:57600
    v_add_f32 v252, v252, v183
    v_mfma_f32_16x16x32_bf16 v[212:215], a[124:127], a[44:47], v[212:215]
    s_waitcnt lgkmcnt(7)
    v_exp_f32 v192, v192
    v_mfma_f32_16x16x32_bf16 v[216:219], a[128:131], a[0:3], v[228:231]
    v_exp_f32 v193, v193
    v_mfma_f32_16x16x32_bf16 v[216:219], a[132:135], a[12:15], v[216:219]
    ds_read_b128 a[124:127], v243 offset:57600
    v_cvt_pk_bf16_f32 v49, v182, v183
    v_mfma_f32_16x16x32_bf16 v[216:219], a[136:139], a[24:27], v[216:219]
    v_exp_f32 v194, v194
    v_mfma_f32_16x16x32_bf16 v[216:219], a[140:143], a[36:39], v[216:219]
    v_exp_f32 v195, v195
    v_mfma_f32_16x16x32_bf16 v[220:223], a[128:131], a[4:7], v[232:235]
    v_exp_f32 v184, v184
    v_mfma_f32_16x16x32_bf16 v[220:223], a[132:135], a[16:19], v[220:223]
    v_exp_f32 v185, v185
    v_mfma_f32_16x16x32_bf16 v[220:223], a[136:139], a[28:31], v[220:223]
    v_exp_f32 v186, v186
    v_mfma_f32_16x16x32_bf16 v[220:223], a[140:143], a[40:43], v[220:223]
    v_exp_f32 v187, v187
    v_mfma_f32_16x16x32_bf16 v[224:227], a[128:131], a[8:11], v[236:239]
    v_add_f32 v252, v252, v192
    v_add_f32 v252, v252, v193
    v_mfma_f32_16x16x32_bf16 v[224:227], a[132:135], a[20:23], v[224:227]
    s_waitcnt lgkmcnt(0)
    s_barrier
    v_cvt_pk_bf16_f32 v50, v192, v193
    v_mfma_f32_16x16x32_bf16 v[224:227], a[136:139], a[32:35], v[224:227]
    s_mov_b32 s8, 229376
    s_add_u32 m0, s10, 49152
    ds_read_b128 a[128:131], v240
    v_mfma_f32_16x16x32_bf16 v[224:227], a[140:143], a[44:47], v[224:227]
    s_waitcnt vmcnt(3)
    buffer_load_dwordx4 v244, s[40:43], s8 offen nt lds
    v_add_f32 v252, v252, v194
    v_mfma_f32_16x16x32_bf16 v[204:207], a[96:99], a[48:51], v[204:207]
    v_exp_f32 v196, v196
    v_mfma_f32_16x16x32_bf16 v[204:207], a[100:103], a[60:63], v[204:207]
    ds_read_b128 a[132:135], v241
    v_add_f32 v252, v252, v195
    v_mfma_f32_16x16x32_bf16 v[204:207], a[104:107], a[72:75], v[204:207]
    s_add_u32 m0, s10, 49152
    v_exp_f32 v197, v197
    v_mfma_f32_16x16x32_bf16 v[204:207], a[108:111], a[84:87], v[204:207]
    ds_read_b128 a[136:139], v242
    s_waitcnt vmcnt(3)
    buffer_load_dwordx4 v245, s[40:43], s8 offen offset:1024 nt lds
    v_mfma_f32_16x16x32_bf16 v[208:211], a[96:99], a[52:55], v[208:211]
    v_exp_f32 v198, v198
    v_mfma_f32_16x16x32_bf16 v[208:211], a[100:103], a[64:67], v[208:211]
    v_exp_f32 v199, v199
    v_mfma_f32_16x16x32_bf16 v[208:211], a[104:107], a[76:79], v[208:211]
    ds_read_b128 a[140:143], v243
    v_cvt_pk_bf16_f32 v51, v194, v195
    v_mfma_f32_16x16x32_bf16 v[208:211], a[108:111], a[88:91], v[208:211]
    v_exp_f32 v188, v188
    v_mfma_f32_16x16x32_bf16 v[212:215], a[96:99], a[56:59], v[212:215]
    ds_read_b128 a[96:99], v240 offset:8192
    v_add_f32 v253, v253, v184
    v_mfma_f32_16x16x32_bf16 v[212:215], a[100:103], a[68:71], v[212:215]
    v_exp_f32 v189, v189
    v_mfma_f32_16x16x32_bf16 v[212:215], a[104:107], a[80:83], v[212:215]
    v_exp_f32 v190, v190
    v_mfma_f32_16x16x32_bf16 v[212:215], a[108:111], a[92:95], v[212:215]
    ds_read_b128 a[100:103], v241 offset:8192
    v_add_f32 v253, v253, v185
    v_mfma_f32_16x16x32_bf16 v[216:219], a[112:115], a[48:51], v[216:219]
    v_exp_f32 v191, v191
    v_mfma_f32_16x16x32_bf16 v[216:219], a[116:119], a[60:63], v[216:219]
    v_exp_f32 v200, v200
    v_mfma_f32_16x16x32_bf16 v[216:219], a[120:123], a[72:75], v[216:219]
    s_add_u32 m0, s10, 49152
    ds_read_b128 a[104:107], v242 offset:8192
    v_cvt_pk_bf16_f32 v52, v184, v185
    v_cvt_pk_bf16_f32 v57, v190, v191
    v_mfma_f32_16x16x32_bf16 v[216:219], a[124:127], a[84:87], v[216:219]
    s_waitcnt vmcnt(3)
    buffer_load_dwordx4 v246, s[40:43], s8 offen offset:2048 nt lds
    v_add_f32 v253, v253, v186
    v_add_f32 v254, v254, v191
    v_mfma_f32_16x16x32_bf16 v[220:223], a[112:115], a[52:55], v[220:223]
    ds_read_b128 a[108:111], v243 offset:8192
    v_add_f32 v253, v253, v187
    v_add_f32 v254, v254, v190
    v_mfma_f32_16x16x32_bf16 v[220:223], a[116:119], a[64:67], v[220:223]
    v_exp_f32 v201, v201
    v_cvt_pk_bf16_f32 v56, v188, v189
    v_mfma_f32_16x16x32_bf16 v[220:223], a[120:123], a[76:79], v[220:223]
    v_exp_f32 v202, v202
    v_add_f32 v254, v254, v189
    v_mfma_f32_16x16x32_bf16 v[220:223], a[124:127], a[88:91], v[220:223]
    v_exp_f32 v203, v203
    v_add_f32 v254, v254, v188
    v_add_f32 v254, v254, v202
    v_mfma_f32_16x16x32_bf16 v[224:227], a[112:115], a[56:59], v[224:227]
    ds_read_b128 a[112:115], v240 offset:256
    v_cvt_pk_bf16_f32 v53, v186, v187
    v_cvt_pk_bf16_f32 v55, v198, v199
    v_cvt_pk_bf16_f32 v58, v200, v201
    v_mfma_f32_16x16x32_bf16 v[224:227], a[116:119], a[68:71], v[224:227]
    ds_read_b128 a[116:119], v241 offset:256
    v_add_f32 v253, v253, v196
    v_add_f32 v253, v253, v199
    v_add_f32 v254, v254, v201
    v_cvt_pk_bf16_f32 v59, v202, v203
    v_mfma_f32_16x16x32_bf16 v[224:227], a[120:123], a[80:83], v[224:227]
    v_add_f32 v253, v253, v197
    v_cvt_pk_bf16_f32 v54, v196, v197
    v_add_f32 v253, v253, v198
    v_add_f32 v254, v254, v200
    v_add_f32 v254, v254, v203
    v_mfma_f32_16x16x32_bf16 v[224:227], a[124:127], a[92:95], v[224:227]
    s_waitcnt lgkmcnt(6)
    v_mfma_f32_16x16x32_bf16 v[180:183], a[128:131], a[0:3], v[228:231]
    ds_read_b128 a[120:123], v242 offset:256
    v_mfma_f32_16x16x32_bf16 v[180:183], a[132:135], a[12:15], v[180:183]
    v_mfma_f32_16x16x32_bf16 v[180:183], a[136:139], a[24:27], v[180:183]
    s_add_u32 m0, s10, 49152
    v_exp_f32 v204, v204
    v_mfma_f32_16x16x32_bf16 v[180:183], a[140:143], a[36:39], v[180:183]
    ds_read_b128 a[124:127], v243 offset:256
    s_waitcnt vmcnt(3)
    buffer_load_dwordx4 v247, s[40:43], s8 offen offset:3072 nt lds
    v_mfma_f32_16x16x32_bf16 v[184:187], a[128:131], a[4:7], v[232:235]
    v_exp_f32 v205, v205
    v_mfma_f32_16x16x32_bf16 v[184:187], a[132:135], a[16:19], v[184:187]
    v_exp_f32 v206, v206
    v_mfma_f32_16x16x32_bf16 v[184:187], a[136:139], a[28:31], v[184:187]
    v_exp_f32 v207, v207
    v_mfma_f32_16x16x32_bf16 v[184:187], a[140:143], a[40:43], v[184:187]
    v_add_f32 v252, v252, v204
    v_add_f32 v252, v252, v205
    v_mfma_f32_16x16x32_bf16 v[188:191], a[128:131], a[8:11], v[236:239]
    ds_read_b128 a[128:131], v240 offset:8448
    v_cvt_pk_bf16_f32 v60, v204, v205
    v_mfma_f32_16x16x32_bf16 v[188:191], a[132:135], a[20:23], v[188:191]
    ds_read_b128 a[132:135], v241 offset:8448
    v_add_f32 v252, v252, v206
    v_mfma_f32_16x16x32_bf16 v[188:191], a[136:139], a[32:35], v[188:191]
    ds_read_b128 a[136:139], v242 offset:8448
    v_add_f32 v252, v252, v207
    v_mfma_f32_16x16x32_bf16 v[188:191], a[140:143], a[44:47], v[188:191]
    s_waitcnt lgkmcnt(7)
    v_exp_f32 v216, v216
    v_mfma_f32_16x16x32_bf16 v[192:195], a[96:99], a[0:3], v[228:231]
    v_exp_f32 v217, v217
    v_mfma_f32_16x16x32_bf16 v[192:195], a[100:103], a[12:15], v[192:195]
    ds_read_b128 a[140:143], v243 offset:8448
    v_cvt_pk_bf16_f32 v61, v206, v207
    v_mfma_f32_16x16x32_bf16 v[192:195], a[104:107], a[24:27], v[192:195]
    v_exp_f32 v218, v218
    v_mfma_f32_16x16x32_bf16 v[192:195], a[108:111], a[36:39], v[192:195]
    v_exp_f32 v219, v219
    v_mfma_f32_16x16x32_bf16 v[196:199], a[96:99], a[4:7], v[232:235]
    v_exp_f32 v208, v208
    v_mfma_f32_16x16x32_bf16 v[196:199], a[100:103], a[16:19], v[196:199]
    v_exp_f32 v209, v209
    v_mfma_f32_16x16x32_bf16 v[196:199], a[104:107], a[28:31], v[196:199]
    v_exp_f32 v210, v210
    v_mfma_f32_16x16x32_bf16 v[196:199], a[108:111], a[40:43], v[196:199]
    v_exp_f32 v211, v211
    v_mfma_f32_16x16x32_bf16 v[200:203], a[96:99], a[8:11], v[236:239]
    v_add_f32 v252, v252, v216
    v_add_f32 v252, v252, v217
    v_mfma_f32_16x16x32_bf16 v[200:203], a[100:103], a[20:23], v[200:203]
    s_waitcnt lgkmcnt(0)
    s_barrier
    v_cvt_pk_bf16_f32 v62, v216, v217
    v_mfma_f32_16x16x32_bf16 v[200:203], a[104:107], a[32:35], v[200:203]
    s_mov_b32 s8, 245760
    s_add_u32 m0, s10, 0
    ds_read_b128 a[96:99], v240 offset:16384
    v_mfma_f32_16x16x32_bf16 v[200:203], a[108:111], a[44:47], v[200:203]
    s_waitcnt vmcnt(3)
    buffer_load_dwordx4 v244, s[40:43], s8 offen nt lds
    v_add_f32 v252, v252, v218
    v_mfma_f32_16x16x32_bf16 v[180:183], a[112:115], a[48:51], v[180:183]
    v_exp_f32 v220, v220
    v_mfma_f32_16x16x32_bf16 v[180:183], a[116:119], a[60:63], v[180:183]
    ds_read_b128 a[100:103], v241 offset:16384
    v_add_f32 v252, v252, v219
    v_mfma_f32_16x16x32_bf16 v[180:183], a[120:123], a[72:75], v[180:183]
    s_add_u32 m0, s10, 0
    v_exp_f32 v221, v221
    v_mfma_f32_16x16x32_bf16 v[180:183], a[124:127], a[84:87], v[180:183]
    ds_read_b128 a[104:107], v242 offset:16384
    s_waitcnt vmcnt(3)
    buffer_load_dwordx4 v245, s[40:43], s8 offen offset:1024 nt lds
    v_mfma_f32_16x16x32_bf16 v[184:187], a[112:115], a[52:55], v[184:187]
    v_exp_f32 v222, v222
    v_mfma_f32_16x16x32_bf16 v[184:187], a[116:119], a[64:67], v[184:187]
    v_exp_f32 v223, v223
    v_mfma_f32_16x16x32_bf16 v[184:187], a[120:123], a[76:79], v[184:187]
    ds_read_b128 a[108:111], v243 offset:16384
    v_cvt_pk_bf16_f32 v63, v218, v219
    v_mfma_f32_16x16x32_bf16 v[184:187], a[124:127], a[88:91], v[184:187]
    v_exp_f32 v212, v212
    v_mfma_f32_16x16x32_bf16 v[188:191], a[112:115], a[56:59], v[188:191]
    ds_read_b128 a[112:115], v240 offset:24576
    v_add_f32 v253, v253, v208
    v_mfma_f32_16x16x32_bf16 v[188:191], a[116:119], a[68:71], v[188:191]
    v_exp_f32 v213, v213
    v_mfma_f32_16x16x32_bf16 v[188:191], a[120:123], a[80:83], v[188:191]
    v_exp_f32 v214, v214
    v_mfma_f32_16x16x32_bf16 v[188:191], a[124:127], a[92:95], v[188:191]
    ds_read_b128 a[116:119], v241 offset:24576
    v_add_f32 v253, v253, v209
    v_mfma_f32_16x16x32_bf16 v[192:195], a[128:131], a[48:51], v[192:195]
    v_exp_f32 v215, v215
    v_mfma_f32_16x16x32_bf16 v[192:195], a[132:135], a[60:63], v[192:195]
    v_exp_f32 v224, v224
    v_mfma_f32_16x16x32_bf16 v[192:195], a[136:139], a[72:75], v[192:195]
    s_add_u32 m0, s10, 0
    ds_read_b128 a[120:123], v242 offset:24576
    v_cvt_pk_bf16_f32 v64, v208, v209
    v_cvt_pk_bf16_f32 v69, v214, v215
    v_mfma_f32_16x16x32_bf16 v[192:195], a[140:143], a[84:87], v[192:195]
    s_waitcnt vmcnt(3)
    buffer_load_dwordx4 v246, s[40:43], s8 offen offset:2048 nt lds
    v_add_f32 v253, v253, v210
    v_add_f32 v254, v254, v215
    v_mfma_f32_16x16x32_bf16 v[196:199], a[128:131], a[52:55], v[196:199]
    ds_read_b128 a[124:127], v243 offset:24576
    v_add_f32 v253, v253, v211
    v_add_f32 v254, v254, v214
    v_mfma_f32_16x16x32_bf16 v[196:199], a[132:135], a[64:67], v[196:199]
    v_exp_f32 v225, v225
    v_cvt_pk_bf16_f32 v68, v212, v213
    v_mfma_f32_16x16x32_bf16 v[196:199], a[136:139], a[76:79], v[196:199]
    v_exp_f32 v226, v226
    v_add_f32 v254, v254, v213
    v_mfma_f32_16x16x32_bf16 v[196:199], a[140:143], a[88:91], v[196:199]
    v_exp_f32 v227, v227
    v_add_f32 v254, v254, v212
    v_add_f32 v254, v254, v226
    v_mfma_f32_16x16x32_bf16 v[200:203], a[128:131], a[56:59], v[200:203]
    ds_read_b128 a[128:131], v240 offset:16640
    v_cvt_pk_bf16_f32 v65, v210, v211
    v_cvt_pk_bf16_f32 v67, v222, v223
    v_cvt_pk_bf16_f32 v70, v224, v225
    v_mfma_f32_16x16x32_bf16 v[200:203], a[132:135], a[68:71], v[200:203]
    ds_read_b128 a[132:135], v241 offset:16640
    v_add_f32 v253, v253, v220
    v_add_f32 v253, v253, v223
    v_add_f32 v254, v254, v225
    v_cvt_pk_bf16_f32 v71, v226, v227
    v_mfma_f32_16x16x32_bf16 v[200:203], a[136:139], a[80:83], v[200:203]
    v_add_f32 v253, v253, v221
    v_cvt_pk_bf16_f32 v66, v220, v221
    v_add_f32 v253, v253, v222
    v_add_f32 v254, v254, v224
    v_add_f32 v254, v254, v227
    v_mfma_f32_16x16x32_bf16 v[200:203], a[140:143], a[92:95], v[200:203]
    s_waitcnt lgkmcnt(6)
    v_mfma_f32_16x16x32_bf16 v[204:207], a[96:99], a[0:3], v[228:231]
    ds_read_b128 a[136:139], v242 offset:16640
    v_mfma_f32_16x16x32_bf16 v[204:207], a[100:103], a[12:15], v[204:207]
    v_mfma_f32_16x16x32_bf16 v[204:207], a[104:107], a[24:27], v[204:207]
    s_add_u32 m0, s10, 0
    v_exp_f32 v180, v180
    v_mfma_f32_16x16x32_bf16 v[204:207], a[108:111], a[36:39], v[204:207]
    ds_read_b128 a[140:143], v243 offset:16640
    s_waitcnt vmcnt(3)
    buffer_load_dwordx4 v247, s[40:43], s8 offen offset:3072 nt lds
    v_mfma_f32_16x16x32_bf16 v[208:211], a[96:99], a[4:7], v[232:235]
    v_accvgpr_read_b32 v244, a188
    v_accvgpr_read_b32 v245, a189
    v_mfma_f32_16x16x32_bf16 v[208:211], a[100:103], a[16:19], v[208:211]
    v_accvgpr_read_b32 v246, a190
    v_accvgpr_read_b32 v247, a191
    v_mfma_f32_16x16x32_bf16 v[208:211], a[104:107], a[28:31], v[208:211]
    v_exp_f32 v181, v181
    v_mfma_f32_16x16x32_bf16 v[208:211], a[108:111], a[40:43], v[208:211]
    v_exp_f32 v182, v182
    v_mfma_f32_16x16x32_bf16 v[212:215], a[96:99], a[8:11], v[236:239]
    ds_read_b128 a[96:99], v240 offset:24832
    v_add_f32 v252, v252, v180
    v_mfma_f32_16x16x32_bf16 v[212:215], a[100:103], a[20:23], v[212:215]
    ds_read_b128 a[100:103], v241 offset:24832
    v_add_f32 v252, v252, v181
    v_mfma_f32_16x16x32_bf16 v[212:215], a[104:107], a[32:35], v[212:215]
    ds_read_b128 a[104:107], v242 offset:24832
    v_cvt_pk_bf16_f32 v72, v180, v181
    v_mfma_f32_16x16x32_bf16 v[212:215], a[108:111], a[44:47], v[212:215]
    s_waitcnt lgkmcnt(7)
    v_exp_f32 v183, v183
    v_mfma_f32_16x16x32_bf16 v[216:219], a[112:115], a[0:3], v[228:231]
    v_exp_f32 v192, v192
    v_mfma_f32_16x16x32_bf16 v[216:219], a[116:119], a[12:15], v[216:219]
    ds_read_b128 a[108:111], v243 offset:24832
    v_add_f32 v252, v252, v182
    v_mfma_f32_16x16x32_bf16 v[216:219], a[120:123], a[24:27], v[216:219]
    v_add_u32 v240, 0x10000, v240
    v_add_u32 v241, 0x10000, v241
    v_mfma_f32_16x16x32_bf16 v[216:219], a[124:127], a[36:39], v[216:219]
    v_add_u32 v242, 0x10000, v242
    v_add_u32 v243, 0x10000, v243
    v_mfma_f32_16x16x32_bf16 v[220:223], a[112:115], a[4:7], v[232:235]
    v_exp_f32 v193, v193
    v_mfma_f32_16x16x32_bf16 v[220:223], a[116:119], a[16:19], v[220:223]
    v_exp_f32 v194, v194
    v_mfma_f32_16x16x32_bf16 v[220:223], a[120:123], a[28:31], v[220:223]
    v_exp_f32 v195, v195
    v_mfma_f32_16x16x32_bf16 v[220:223], a[124:127], a[40:43], v[220:223]
    v_exp_f32 v184, v184
    v_mfma_f32_16x16x32_bf16 v[224:227], a[112:115], a[8:11], v[236:239]
    v_exp_f32 v185, v185
    v_mfma_f32_16x16x32_bf16 v[224:227], a[116:119], a[20:23], v[224:227]
    s_waitcnt lgkmcnt(0)
    s_barrier
    v_add_f32 v252, v252, v183
    v_mfma_f32_16x16x32_bf16 v[224:227], a[120:123], a[32:35], v[224:227]
    s_mov_b32 s8, 0
    s_add_u32 m0, s10, 16384
    ds_read_b128 a[112:115], v240
    v_mfma_f32_16x16x32_bf16 v[224:227], a[124:127], a[44:47], v[224:227]
    s_waitcnt vmcnt(3)
    buffer_load_dwordx4 v248, s[44:47], s8 offen nt lds
    v_cvt_pk_bf16_f32 v73, v182, v183
    v_mfma_f32_16x16x32_bf16 v[204:207], a[128:131], a[48:51], v[204:207]
    v_exp_f32 v186, v186
    v_mfma_f32_16x16x32_bf16 v[204:207], a[132:135], a[60:63], v[204:207]
    ds_read_b128 a[116:119], v241
    v_add_f32 v252, v252, v192
    v_mfma_f32_16x16x32_bf16 v[204:207], a[136:139], a[72:75], v[204:207]
    s_add_u32 m0, s10, 16384
    v_exp_f32 v187, v187
    v_mfma_f32_16x16x32_bf16 v[204:207], a[140:143], a[84:87], v[204:207]
    ds_read_b128 a[120:123], v242
    s_waitcnt vmcnt(3)
    buffer_load_dwordx4 v249, s[44:47], s8 offen offset:1024 nt lds
    v_mfma_f32_16x16x32_bf16 v[208:211], a[128:131], a[52:55], v[208:211]
    v_exp_f32 v196, v196
    v_mfma_f32_16x16x32_bf16 v[208:211], a[132:135], a[64:67], v[208:211]
    v_exp_f32 v197, v197
    v_mfma_f32_16x16x32_bf16 v[208:211], a[136:139], a[76:79], v[208:211]
    ds_read_b128 a[124:127], v243
    v_add_f32 v252, v252, v193
    v_mfma_f32_16x16x32_bf16 v[208:211], a[140:143], a[88:91], v[208:211]
    v_exp_f32 v198, v198
    v_mfma_f32_16x16x32_bf16 v[212:215], a[128:131], a[56:59], v[212:215]
    ds_read_b128 a[128:131], v240 offset:8192
    v_cvt_pk_bf16_f32 v74, v192, v193
    v_mfma_f32_16x16x32_bf16 v[212:215], a[132:135], a[68:71], v[212:215]
    v_exp_f32 v199, v199
    v_mfma_f32_16x16x32_bf16 v[212:215], a[136:139], a[80:83], v[212:215]
    v_exp_f32 v188, v188
    v_mfma_f32_16x16x32_bf16 v[212:215], a[140:143], a[92:95], v[212:215]
    ds_read_b128 a[132:135], v241 offset:8192
    v_add_f32 v252, v252, v194
    v_mfma_f32_16x16x32_bf16 v[216:219], a[96:99], a[48:51], v[216:219]
    v_exp_f32 v189, v189
    v_mfma_f32_16x16x32_bf16 v[216:219], a[100:103], a[60:63], v[216:219]
    v_exp_f32 v190, v190
    v_add_f32 v254, v254, v189
    v_mfma_f32_16x16x32_bf16 v[216:219], a[104:107], a[72:75], v[216:219]
    s_add_u32 m0, s10, 16384
    ds_read_b128 a[136:139], v242 offset:8192
    v_add_f32 v252, v252, v195
    v_add_f32 v254, v254, v188
    v_mfma_f32_16x16x32_bf16 v[216:219], a[108:111], a[84:87], v[216:219]
    s_waitcnt vmcnt(3)
    buffer_load_dwordx4 v250, s[44:47], s8 offen offset:2048 nt lds
    v_cvt_pk_bf16_f32 v75, v194, v195
    v_cvt_pk_bf16_f32 v79, v198, v199
    v_mfma_f32_16x16x32_bf16 v[220:223], a[96:99], a[52:55], v[220:223]
    ds_read_b128 a[140:143], v243 offset:8192
    v_add_f32 v253, v253, v184
    v_add_f32 v253, v253, v199
    v_mfma_f32_16x16x32_bf16 v[220:223], a[100:103], a[64:67], v[220:223]
    v_exp_f32 v191, v191
    v_add_f32 v253, v253, v198
    v_mfma_f32_16x16x32_bf16 v[220:223], a[104:107], a[76:79], v[220:223]
    v_exp_f32 v200, v200
    v_cvt_pk_bf16_f32 v78, v196, v197
    v_cvt_pk_bf16_f32 v81, v190, v191
    v_mfma_f32_16x16x32_bf16 v[220:223], a[108:111], a[88:91], v[220:223]
    v_exp_f32 v201, v201
    v_exp_f32 v202, v202
    v_exp_f32 v203, v203
    v_mfma_f32_16x16x32_bf16 v[224:227], a[96:99], a[56:59], v[224:227]
    ds_read_b128 a[96:99], v240 offset:256
    v_add_f32 v253, v253, v185
    v_add_f32 v253, v253, v197
    v_add_f32 v254, v254, v191
    v_cvt_pk_bf16_f32 v82, v200, v201
    v_cvt_pk_bf16_f32 v83, v202, v203
    v_mfma_f32_16x16x32_bf16 v[224:227], a[100:103], a[68:71], v[224:227]
    ds_read_b128 a[100:103], v241 offset:256
    v_cvt_pk_bf16_f32 v76, v184, v185
    v_add_f32 v253, v253, v196
    v_add_f32 v254, v254, v190
    v_add_f32 v254, v254, v201
    v_add_f32 v254, v254, v203
    v_mfma_f32_16x16x32_bf16 v[224:227], a[104:107], a[80:83], v[224:227]
    v_add_f32 v253, v253, v186
    v_add_f32 v253, v253, v187
    v_cvt_pk_bf16_f32 v77, v186, v187
    v_cvt_pk_bf16_f32 v80, v188, v189
    v_add_f32 v254, v254, v200
    v_add_f32 v254, v254, v202
    v_mfma_f32_16x16x32_bf16 v[224:227], a[108:111], a[92:95], v[224:227]
    s_waitcnt lgkmcnt(6)
    v_mfma_f32_16x16x32_bf16 v[180:183], a[112:115], a[0:3], v[228:231]
    ds_read_b128 a[104:107], v242 offset:256
    v_mfma_f32_16x16x32_bf16 v[180:183], a[116:119], a[12:15], v[180:183]
    v_mfma_f32_16x16x32_bf16 v[180:183], a[120:123], a[24:27], v[180:183]
    s_add_u32 m0, s10, 16384
    v_exp_f32 v204, v204
    v_mfma_f32_16x16x32_bf16 v[180:183], a[124:127], a[36:39], v[180:183]
    ds_read_b128 a[108:111], v243 offset:256
    s_waitcnt vmcnt(3)
    buffer_load_dwordx4 v251, s[44:47], s8 offen offset:3072 nt lds
    v_mfma_f32_16x16x32_bf16 v[184:187], a[112:115], a[4:7], v[232:235]
    v_exp_f32 v205, v205
    v_mfma_f32_16x16x32_bf16 v[184:187], a[116:119], a[16:19], v[184:187]
    v_exp_f32 v206, v206
    v_mfma_f32_16x16x32_bf16 v[184:187], a[120:123], a[28:31], v[184:187]
    v_exp_f32 v207, v207
    v_mfma_f32_16x16x32_bf16 v[184:187], a[124:127], a[40:43], v[184:187]
    v_add_f32 v252, v252, v204
    v_add_f32 v252, v252, v205
    v_mfma_f32_16x16x32_bf16 v[188:191], a[112:115], a[8:11], v[236:239]
    ds_read_b128 a[112:115], v240 offset:8448
    v_cvt_pk_bf16_f32 v84, v204, v205
    v_mfma_f32_16x16x32_bf16 v[188:191], a[116:119], a[20:23], v[188:191]
    ds_read_b128 a[116:119], v241 offset:8448
    v_add_f32 v252, v252, v206
    v_mfma_f32_16x16x32_bf16 v[188:191], a[120:123], a[32:35], v[188:191]
    ds_read_b128 a[120:123], v242 offset:8448
    v_add_f32 v252, v252, v207
    v_mfma_f32_16x16x32_bf16 v[188:191], a[124:127], a[44:47], v[188:191]
    s_waitcnt lgkmcnt(7)
    v_exp_f32 v216, v216
    v_mfma_f32_16x16x32_bf16 v[192:195], a[128:131], a[0:3], v[228:231]
    v_exp_f32 v217, v217
    v_mfma_f32_16x16x32_bf16 v[192:195], a[132:135], a[12:15], v[192:195]
    ds_read_b128 a[124:127], v243 offset:8448
    v_cvt_pk_bf16_f32 v85, v206, v207
    v_mfma_f32_16x16x32_bf16 v[192:195], a[136:139], a[24:27], v[192:195]
    v_exp_f32 v218, v218
    v_mfma_f32_16x16x32_bf16 v[192:195], a[140:143], a[36:39], v[192:195]
    v_exp_f32 v219, v219
    v_mfma_f32_16x16x32_bf16 v[196:199], a[128:131], a[4:7], v[232:235]
    v_exp_f32 v208, v208
    v_mfma_f32_16x16x32_bf16 v[196:199], a[132:135], a[16:19], v[196:199]
    v_exp_f32 v209, v209
    v_mfma_f32_16x16x32_bf16 v[196:199], a[136:139], a[28:31], v[196:199]
    v_exp_f32 v210, v210
    v_mfma_f32_16x16x32_bf16 v[196:199], a[140:143], a[40:43], v[196:199]
    v_exp_f32 v211, v211
    v_mfma_f32_16x16x32_bf16 v[200:203], a[128:131], a[8:11], v[236:239]
    v_add_f32 v252, v252, v216
    v_add_f32 v252, v252, v217
    v_mfma_f32_16x16x32_bf16 v[200:203], a[132:135], a[20:23], v[200:203]
    s_waitcnt lgkmcnt(0)
    s_barrier
    v_cvt_pk_bf16_f32 v86, v216, v217
    v_mfma_f32_16x16x32_bf16 v[200:203], a[136:139], a[32:35], v[200:203]
    s_mov_b32 s8, 65536
    s_add_u32 m0, s10, 65536
    ds_read_b128 a[128:131], v240 offset:16384
    v_mfma_f32_16x16x32_bf16 v[200:203], a[140:143], a[44:47], v[200:203]
    s_waitcnt vmcnt(3)
    buffer_load_dwordx4 v248, s[44:47], s8 offen nt lds
    v_add_f32 v252, v252, v218
    v_mfma_f32_16x16x32_bf16 v[180:183], a[96:99], a[48:51], v[180:183]
    v_exp_f32 v220, v220
    v_mfma_f32_16x16x32_bf16 v[180:183], a[100:103], a[60:63], v[180:183]
    ds_read_b128 a[132:135], v241 offset:16384
    v_add_f32 v252, v252, v219
    v_mfma_f32_16x16x32_bf16 v[180:183], a[104:107], a[72:75], v[180:183]
    s_add_u32 m0, s10, 65536
    v_exp_f32 v221, v221
    v_mfma_f32_16x16x32_bf16 v[180:183], a[108:111], a[84:87], v[180:183]
    ds_read_b128 a[136:139], v242 offset:16384
    s_waitcnt vmcnt(3)
    buffer_load_dwordx4 v249, s[44:47], s8 offen offset:1024 nt lds
    v_mfma_f32_16x16x32_bf16 v[184:187], a[96:99], a[52:55], v[184:187]
    v_exp_f32 v222, v222
    v_mfma_f32_16x16x32_bf16 v[184:187], a[100:103], a[64:67], v[184:187]
    v_exp_f32 v223, v223
    v_mfma_f32_16x16x32_bf16 v[184:187], a[104:107], a[76:79], v[184:187]
    ds_read_b128 a[140:143], v243 offset:16384
    v_cvt_pk_bf16_f32 v87, v218, v219
    v_mfma_f32_16x16x32_bf16 v[184:187], a[108:111], a[88:91], v[184:187]
    v_exp_f32 v212, v212
    v_mfma_f32_16x16x32_bf16 v[188:191], a[96:99], a[56:59], v[188:191]
    ds_read_b128 a[96:99], v240 offset:24576
    v_add_f32 v253, v253, v208
    v_mfma_f32_16x16x32_bf16 v[188:191], a[100:103], a[68:71], v[188:191]
    v_exp_f32 v213, v213
    v_mfma_f32_16x16x32_bf16 v[188:191], a[104:107], a[80:83], v[188:191]
    v_exp_f32 v214, v214
    v_mfma_f32_16x16x32_bf16 v[188:191], a[108:111], a[92:95], v[188:191]
    ds_read_b128 a[100:103], v241 offset:24576
    v_add_f32 v253, v253, v209
    v_mfma_f32_16x16x32_bf16 v[192:195], a[112:115], a[48:51], v[192:195]
    v_exp_f32 v215, v215
    v_mfma_f32_16x16x32_bf16 v[192:195], a[116:119], a[60:63], v[192:195]
    v_exp_f32 v224, v224
    v_mfma_f32_16x16x32_bf16 v[192:195], a[120:123], a[72:75], v[192:195]
    s_add_u32 m0, s10, 65536
    ds_read_b128 a[104:107], v242 offset:24576
    v_cvt_pk_bf16_f32 v88, v208, v209
    v_cvt_pk_bf16_f32 v93, v214, v215
    v_mfma_f32_16x16x32_bf16 v[192:195], a[124:127], a[84:87], v[192:195]
    s_waitcnt vmcnt(3)
    buffer_load_dwordx4 v250, s[44:47], s8 offen offset:2048 nt lds
    v_add_f32 v253, v253, v210
    v_add_f32 v254, v254, v215
    v_mfma_f32_16x16x32_bf16 v[196:199], a[112:115], a[52:55], v[196:199]
    ds_read_b128 a[108:111], v243 offset:24576
    v_add_f32 v253, v253, v211
    v_add_f32 v254, v254, v214
    v_mfma_f32_16x16x32_bf16 v[196:199], a[116:119], a[64:67], v[196:199]
    v_exp_f32 v225, v225
    v_cvt_pk_bf16_f32 v92, v212, v213
    v_mfma_f32_16x16x32_bf16 v[196:199], a[120:123], a[76:79], v[196:199]
    v_exp_f32 v226, v226
    v_add_f32 v254, v254, v213
    v_mfma_f32_16x16x32_bf16 v[196:199], a[124:127], a[88:91], v[196:199]
    v_exp_f32 v227, v227
    v_add_f32 v254, v254, v212
    v_add_f32 v254, v254, v226
    v_mfma_f32_16x16x32_bf16 v[200:203], a[112:115], a[56:59], v[200:203]
    ds_read_b128 a[112:115], v240 offset:16640
    v_cvt_pk_bf16_f32 v89, v210, v211
    v_cvt_pk_bf16_f32 v91, v222, v223
    v_cvt_pk_bf16_f32 v94, v224, v225
    v_mfma_f32_16x16x32_bf16 v[200:203], a[116:119], a[68:71], v[200:203]
    ds_read_b128 a[116:119], v241 offset:16640
    v_add_f32 v253, v253, v220
    v_add_f32 v253, v253, v223
    v_add_f32 v254, v254, v225
    v_cvt_pk_bf16_f32 v95, v226, v227
    v_mfma_f32_16x16x32_bf16 v[200:203], a[120:123], a[80:83], v[200:203]
    v_add_f32 v253, v253, v221
    v_cvt_pk_bf16_f32 v90, v220, v221
    v_add_f32 v253, v253, v222
    v_add_f32 v254, v254, v224
    v_add_f32 v254, v254, v227
    v_mfma_f32_16x16x32_bf16 v[200:203], a[124:127], a[92:95], v[200:203]
    s_waitcnt lgkmcnt(6)
    v_mfma_f32_16x16x32_bf16 v[204:207], a[128:131], a[0:3], v[228:231]
    ds_read_b128 a[120:123], v242 offset:16640
    v_mfma_f32_16x16x32_bf16 v[204:207], a[132:135], a[12:15], v[204:207]
    v_mfma_f32_16x16x32_bf16 v[204:207], a[136:139], a[24:27], v[204:207]
    s_add_u32 m0, s10, 65536
    v_exp_f32 v180, v180
    v_mfma_f32_16x16x32_bf16 v[204:207], a[140:143], a[36:39], v[204:207]
    ds_read_b128 a[124:127], v243 offset:16640
    s_waitcnt vmcnt(3)
    buffer_load_dwordx4 v251, s[44:47], s8 offen offset:3072 nt lds
    v_mfma_f32_16x16x32_bf16 v[208:211], a[128:131], a[4:7], v[232:235]
    v_exp_f32 v181, v181
    v_mfma_f32_16x16x32_bf16 v[208:211], a[132:135], a[16:19], v[208:211]
    v_exp_f32 v182, v182
    v_mfma_f32_16x16x32_bf16 v[208:211], a[136:139], a[28:31], v[208:211]
    v_exp_f32 v183, v183
    v_mfma_f32_16x16x32_bf16 v[208:211], a[140:143], a[40:43], v[208:211]
    v_add_f32 v252, v252, v180
    v_add_f32 v252, v252, v181
    v_mfma_f32_16x16x32_bf16 v[212:215], a[128:131], a[8:11], v[236:239]
    ds_read_b128 a[128:131], v240 offset:24832
    v_cvt_pk_bf16_f32 v96, v180, v181
    v_mfma_f32_16x16x32_bf16 v[212:215], a[132:135], a[20:23], v[212:215]
    ds_read_b128 a[132:135], v241 offset:24832
    v_add_f32 v252, v252, v182
    v_mfma_f32_16x16x32_bf16 v[212:215], a[136:139], a[32:35], v[212:215]
    ds_read_b128 a[136:139], v242 offset:24832
    v_add_f32 v252, v252, v183
    v_mfma_f32_16x16x32_bf16 v[212:215], a[140:143], a[44:47], v[212:215]
    s_waitcnt lgkmcnt(7)
    v_exp_f32 v192, v192
    v_mfma_f32_16x16x32_bf16 v[216:219], a[96:99], a[0:3], v[228:231]
    v_exp_f32 v193, v193
    v_mfma_f32_16x16x32_bf16 v[216:219], a[100:103], a[12:15], v[216:219]
    ds_read_b128 a[140:143], v243 offset:24832
    v_cvt_pk_bf16_f32 v97, v182, v183
    v_mfma_f32_16x16x32_bf16 v[216:219], a[104:107], a[24:27], v[216:219]
    v_exp_f32 v194, v194
    v_mfma_f32_16x16x32_bf16 v[216:219], a[108:111], a[36:39], v[216:219]
    v_exp_f32 v195, v195
    v_mfma_f32_16x16x32_bf16 v[220:223], a[96:99], a[4:7], v[232:235]
    v_exp_f32 v184, v184
    v_mfma_f32_16x16x32_bf16 v[220:223], a[100:103], a[16:19], v[220:223]
    v_exp_f32 v185, v185
    v_mfma_f32_16x16x32_bf16 v[220:223], a[104:107], a[28:31], v[220:223]
    v_exp_f32 v186, v186
    v_mfma_f32_16x16x32_bf16 v[220:223], a[108:111], a[40:43], v[220:223]
    v_exp_f32 v187, v187
    v_mfma_f32_16x16x32_bf16 v[224:227], a[96:99], a[8:11], v[236:239]
    v_add_f32 v252, v252, v192
    v_add_f32 v252, v252, v193
    v_mfma_f32_16x16x32_bf16 v[224:227], a[100:103], a[20:23], v[224:227]
    s_waitcnt lgkmcnt(0)
    s_barrier
    v_cvt_pk_bf16_f32 v98, v192, v193
    v_mfma_f32_16x16x32_bf16 v[224:227], a[104:107], a[32:35], v[224:227]
    s_mov_b32 s8, 131072
    s_add_u32 m0, s10, 81920
    ds_read_b128 a[96:99], v240 offset:49152
    v_mfma_f32_16x16x32_bf16 v[224:227], a[108:111], a[44:47], v[224:227]
    s_waitcnt vmcnt(3)
    buffer_load_dwordx4 v248, s[44:47], s8 offen nt lds
    v_add_f32 v252, v252, v194
    v_mfma_f32_16x16x32_bf16 v[204:207], a[112:115], a[48:51], v[204:207]
    v_exp_f32 v196, v196
    v_mfma_f32_16x16x32_bf16 v[204:207], a[116:119], a[60:63], v[204:207]
    ds_read_b128 a[100:103], v241 offset:49152
    v_add_f32 v252, v252, v195
    v_mfma_f32_16x16x32_bf16 v[204:207], a[120:123], a[72:75], v[204:207]
    s_add_u32 m0, s10, 81920
    v_exp_f32 v197, v197
    v_mfma_f32_16x16x32_bf16 v[204:207], a[124:127], a[84:87], v[204:207]
    ds_read_b128 a[104:107], v242 offset:49152
    s_waitcnt vmcnt(3)
    buffer_load_dwordx4 v249, s[44:47], s8 offen offset:1024 nt lds
    v_mfma_f32_16x16x32_bf16 v[208:211], a[112:115], a[52:55], v[208:211]
    v_exp_f32 v198, v198
    v_mfma_f32_16x16x32_bf16 v[208:211], a[116:119], a[64:67], v[208:211]
    v_exp_f32 v199, v199
    v_mfma_f32_16x16x32_bf16 v[208:211], a[120:123], a[76:79], v[208:211]
    ds_read_b128 a[108:111], v243 offset:49152
    v_cvt_pk_bf16_f32 v99, v194, v195
    v_mfma_f32_16x16x32_bf16 v[208:211], a[124:127], a[88:91], v[208:211]
    v_exp_f32 v188, v188
    v_mfma_f32_16x16x32_bf16 v[212:215], a[112:115], a[56:59], v[212:215]
    ds_read_b128 a[112:115], v240 offset:57344
    v_add_f32 v253, v253, v184
    v_mfma_f32_16x16x32_bf16 v[212:215], a[116:119], a[68:71], v[212:215]
    v_exp_f32 v189, v189
    v_mfma_f32_16x16x32_bf16 v[212:215], a[120:123], a[80:83], v[212:215]
    v_exp_f32 v190, v190
    v_mfma_f32_16x16x32_bf16 v[212:215], a[124:127], a[92:95], v[212:215]
    ds_read_b128 a[116:119], v241 offset:57344
    v_add_f32 v253, v253, v185
    v_mfma_f32_16x16x32_bf16 v[216:219], a[128:131], a[48:51], v[216:219]
    v_exp_f32 v191, v191
    v_mfma_f32_16x16x32_bf16 v[216:219], a[132:135], a[60:63], v[216:219]
    v_exp_f32 v200, v200
    v_mfma_f32_16x16x32_bf16 v[216:219], a[136:139], a[72:75], v[216:219]
    s_add_u32 m0, s10, 81920
    ds_read_b128 a[120:123], v242 offset:57344
    v_cvt_pk_bf16_f32 v100, v184, v185
    v_cvt_pk_bf16_f32 v105, v190, v191
    v_mfma_f32_16x16x32_bf16 v[216:219], a[140:143], a[84:87], v[216:219]
    s_waitcnt vmcnt(3)
    buffer_load_dwordx4 v250, s[44:47], s8 offen offset:2048 nt lds
    v_add_f32 v253, v253, v186
    v_add_f32 v254, v254, v191
    v_mfma_f32_16x16x32_bf16 v[220:223], a[128:131], a[52:55], v[220:223]
    ds_read_b128 a[124:127], v243 offset:57344
    v_add_f32 v253, v253, v187
    v_add_f32 v254, v254, v190
    v_mfma_f32_16x16x32_bf16 v[220:223], a[132:135], a[64:67], v[220:223]
    v_exp_f32 v201, v201
    v_cvt_pk_bf16_f32 v104, v188, v189
    v_mfma_f32_16x16x32_bf16 v[220:223], a[136:139], a[76:79], v[220:223]
    v_exp_f32 v202, v202
    v_add_f32 v254, v254, v189
    v_mfma_f32_16x16x32_bf16 v[220:223], a[140:143], a[88:91], v[220:223]
    v_exp_f32 v203, v203
    v_add_f32 v254, v254, v188
    v_add_f32 v254, v254, v202
    v_mfma_f32_16x16x32_bf16 v[224:227], a[128:131], a[56:59], v[224:227]
    ds_read_b128 a[128:131], v240 offset:49408
    v_cvt_pk_bf16_f32 v101, v186, v187
    v_cvt_pk_bf16_f32 v103, v198, v199
    v_cvt_pk_bf16_f32 v106, v200, v201
    v_mfma_f32_16x16x32_bf16 v[224:227], a[132:135], a[68:71], v[224:227]
    ds_read_b128 a[132:135], v241 offset:49408
    v_add_f32 v253, v253, v196
    v_add_f32 v253, v253, v199
    v_add_f32 v254, v254, v201
    v_cvt_pk_bf16_f32 v107, v202, v203
    v_mfma_f32_16x16x32_bf16 v[224:227], a[136:139], a[80:83], v[224:227]
    v_add_f32 v253, v253, v197
    v_cvt_pk_bf16_f32 v102, v196, v197
    v_add_f32 v253, v253, v198
    v_add_f32 v254, v254, v200
    v_add_f32 v254, v254, v203
    v_mfma_f32_16x16x32_bf16 v[224:227], a[140:143], a[92:95], v[224:227]
    s_waitcnt lgkmcnt(6)
    v_mfma_f32_16x16x32_bf16 v[180:183], a[96:99], a[0:3], v[228:231]
    ds_read_b128 a[136:139], v242 offset:49408
    v_accvgpr_read_b32 v170, a197
    v_mfma_f32_16x16x32_bf16 v[180:183], a[100:103], a[12:15], v[180:183]
    buffer_load_dword v171, v170, s[88:91], 0 offen sc1
    v_mfma_f32_16x16x32_bf16 v[180:183], a[104:107], a[24:27], v[180:183]
    s_add_u32 m0, s10, 81920
    v_exp_f32 v204, v204
    v_mfma_f32_16x16x32_bf16 v[180:183], a[108:111], a[36:39], v[180:183]
    ds_read_b128 a[140:143], v243 offset:49408
    s_waitcnt vmcnt(4)
    buffer_load_dwordx4 v251, s[44:47], s8 offen offset:3072 nt lds
    v_mfma_f32_16x16x32_bf16 v[184:187], a[96:99], a[4:7], v[232:235]
    v_exp_f32 v205, v205
    v_mfma_f32_16x16x32_bf16 v[184:187], a[100:103], a[16:19], v[184:187]
    v_exp_f32 v206, v206
    v_mfma_f32_16x16x32_bf16 v[184:187], a[104:107], a[28:31], v[184:187]
    v_exp_f32 v207, v207
    v_mfma_f32_16x16x32_bf16 v[184:187], a[108:111], a[40:43], v[184:187]
    v_add_f32 v252, v252, v204
    v_add_f32 v252, v252, v205
    v_mfma_f32_16x16x32_bf16 v[188:191], a[96:99], a[8:11], v[236:239]
    ds_read_b128 a[96:99], v240 offset:57600
    v_cvt_pk_bf16_f32 v108, v204, v205
    v_mfma_f32_16x16x32_bf16 v[188:191], a[100:103], a[20:23], v[188:191]
    ds_read_b128 a[100:103], v241 offset:57600
    v_add_f32 v252, v252, v206
    v_mfma_f32_16x16x32_bf16 v[188:191], a[104:107], a[32:35], v[188:191]
    ds_read_b128 a[104:107], v242 offset:57600
    v_add_f32 v252, v252, v207
    v_mfma_f32_16x16x32_bf16 v[188:191], a[108:111], a[44:47], v[188:191]
    s_waitcnt lgkmcnt(7)
    v_exp_f32 v216, v216
    v_mfma_f32_16x16x32_bf16 v[192:195], a[112:115], a[0:3], v[228:231]
    v_exp_f32 v217, v217
    v_mfma_f32_16x16x32_bf16 v[192:195], a[116:119], a[12:15], v[192:195]
    ds_read_b128 a[108:111], v243 offset:57600
    v_cvt_pk_bf16_f32 v109, v206, v207
    v_mfma_f32_16x16x32_bf16 v[192:195], a[120:123], a[24:27], v[192:195]
    v_add_u32 v240, 0x10000, v240
    v_add_u32 v241, 0x10000, v241
    v_mfma_f32_16x16x32_bf16 v[192:195], a[124:127], a[36:39], v[192:195]
    v_add_u32 v242, 0x10000, v242
    v_add_u32 v243, 0x10000, v243
    v_mfma_f32_16x16x32_bf16 v[196:199], a[112:115], a[4:7], v[232:235]
    v_exp_f32 v218, v218
    v_mfma_f32_16x16x32_bf16 v[196:199], a[116:119], a[16:19], v[196:199]
    v_exp_f32 v219, v219
    v_mfma_f32_16x16x32_bf16 v[196:199], a[120:123], a[28:31], v[196:199]
    v_exp_f32 v208, v208
    v_mfma_f32_16x16x32_bf16 v[196:199], a[124:127], a[40:43], v[196:199]
    v_exp_f32 v209, v209
    v_mfma_f32_16x16x32_bf16 v[200:203], a[112:115], a[8:11], v[236:239]
    v_exp_f32 v210, v210
    v_mfma_f32_16x16x32_bf16 v[200:203], a[116:119], a[20:23], v[200:203]
    s_waitcnt lgkmcnt(0)
    s_barrier
    v_add_f32 v252, v252, v216
    v_mfma_f32_16x16x32_bf16 v[200:203], a[120:123], a[32:35], v[200:203]
    s_mov_b32 s8, 196608
    s_add_u32 m0, s10, 114688
    ds_read_b128 a[112:115], v240
    v_mfma_f32_16x16x32_bf16 v[200:203], a[124:127], a[44:47], v[200:203]
    s_waitcnt vmcnt(4)
    buffer_load_dwordx4 v248, s[44:47], s8 offen nt lds
    v_add_f32 v252, v252, v217
    v_mfma_f32_16x16x32_bf16 v[180:183], a[128:131], a[48:51], v[180:183]
    v_exp_f32 v211, v211
    v_mfma_f32_16x16x32_bf16 v[180:183], a[132:135], a[60:63], v[180:183]
    ds_read_b128 a[116:119], v241
    v_cvt_pk_bf16_f32 v110, v216, v217
    v_mfma_f32_16x16x32_bf16 v[180:183], a[136:139], a[72:75], v[180:183]
    s_add_u32 m0, s10, 114688
    v_exp_f32 v220, v220
    v_mfma_f32_16x16x32_bf16 v[180:183], a[140:143], a[84:87], v[180:183]
    ds_read_b128 a[120:123], v242
    s_waitcnt vmcnt(4)
    buffer_load_dwordx4 v249, s[44:47], s8 offen offset:1024 nt lds
    v_mfma_f32_16x16x32_bf16 v[184:187], a[128:131], a[52:55], v[184:187]
    v_exp_f32 v221, v221
    v_mfma_f32_16x16x32_bf16 v[184:187], a[132:135], a[64:67], v[184:187]
    v_exp_f32 v222, v222
    v_mfma_f32_16x16x32_bf16 v[184:187], a[136:139], a[76:79], v[184:187]
    ds_read_b128 a[124:127], v243
    v_add_f32 v252, v252, v218
    v_mfma_f32_16x16x32_bf16 v[184:187], a[140:143], a[88:91], v[184:187]
    v_exp_f32 v223, v223
    v_mfma_f32_16x16x32_bf16 v[188:191], a[128:131], a[56:59], v[188:191]
    ds_read_b128 a[128:131], v240 offset:8192
    v_add_f32 v252, v252, v219
    v_mfma_f32_16x16x32_bf16 v[188:191], a[132:135], a[68:71], v[188:191]
    v_exp_f32 v212, v212
    v_mfma_f32_16x16x32_bf16 v[188:191], a[136:139], a[80:83], v[188:191]
    v_exp_f32 v213, v213
    v_mfma_f32_16x16x32_bf16 v[188:191], a[140:143], a[92:95], v[188:191]
    ds_read_b128 a[132:135], v241 offset:8192
    v_cvt_pk_bf16_f32 v111, v218, v219
    v_mfma_f32_16x16x32_bf16 v[192:195], a[96:99], a[48:51], v[192:195]
    v_exp_f32 v214, v214
    v_mfma_f32_16x16x32_bf16 v[192:195], a[100:103], a[60:63], v[192:195]
    v_exp_f32 v215, v215
    v_add_f32 v254, v254, v214
    v_mfma_f32_16x16x32_bf16 v[192:195], a[104:107], a[72:75], v[192:195]
    s_add_u32 m0, s10, 114688
    ds_read_b128 a[136:139], v242 offset:8192
    v_add_f32 v253, v253, v208
    v_cvt_pk_bf16_f32 v116, v212, v213
    v_mfma_f32_16x16x32_bf16 v[192:195], a[108:111], a[84:87], v[192:195]
    s_waitcnt vmcnt(4)
    buffer_load_dwordx4 v250, s[44:47], s8 offen offset:2048 nt lds
    v_add_f32 v253, v253, v209
    v_add_f32 v254, v254, v213
    v_mfma_f32_16x16x32_bf16 v[196:199], a[96:99], a[52:55], v[196:199]
    ds_read_b128 a[140:143], v243 offset:8192
    v_cvt_pk_bf16_f32 v112, v208, v209
    v_add_f32 v254, v254, v212
    v_mfma_f32_16x16x32_bf16 v[196:199], a[100:103], a[64:67], v[196:199]
    v_exp_f32 v224, v224
    v_cvt_pk_bf16_f32 v115, v222, v223
    v_mfma_f32_16x16x32_bf16 v[196:199], a[104:107], a[76:79], v[196:199]
    v_exp_f32 v225, v225
    v_add_f32 v253, v253, v223
    v_mfma_f32_16x16x32_bf16 v[196:199], a[108:111], a[88:91], v[196:199]
    v_exp_f32 v226, v226
    v_exp_f32 v227, v227
    v_mfma_f32_16x16x32_bf16 v[200:203], a[96:99], a[56:59], v[200:203]
    ds_read_b128 a[96:99], v240 offset:256
    v_add_f32 v253, v253, v210
    v_add_f32 v253, v253, v222
    v_add_f32 v254, v254, v224
    v_add_f32 v254, v254, v226
    v_mfma_f32_16x16x32_bf16 v[200:203], a[100:103], a[68:71], v[200:203]
    ds_read_b128 a[100:103], v241 offset:256
    v_add_f32 v253, v253, v211
    v_cvt_pk_bf16_f32 v114, v220, v221
    v_cvt_pk_bf16_f32 v117, v214, v215
    v_cvt_pk_bf16_f32 v118, v224, v225
    v_cvt_pk_bf16_f32 v119, v226, v227
    v_mfma_f32_16x16x32_bf16 v[200:203], a[104:107], a[80:83], v[200:203]
    v_cvt_pk_bf16_f32 v113, v210, v211
    v_add_f32 v253, v253, v220
    v_add_f32 v253, v253, v221
    v_add_f32 v254, v254, v215
    v_add_f32 v254, v254, v225
    v_add_f32 v254, v254, v227
    v_mfma_f32_16x16x32_bf16 v[200:203], a[108:111], a[92:95], v[200:203]
    s_waitcnt lgkmcnt(6)
    v_mfma_f32_16x16x32_bf16 v[204:207], a[112:115], a[0:3], v[228:231]
    ds_read_b128 a[104:107], v242 offset:256
    v_mfma_f32_16x16x32_bf16 v[204:207], a[116:119], a[12:15], v[204:207]
    v_mfma_f32_16x16x32_bf16 v[204:207], a[120:123], a[24:27], v[204:207]
    s_add_u32 m0, s10, 114688
    v_exp_f32 v180, v180
    v_mfma_f32_16x16x32_bf16 v[204:207], a[124:127], a[36:39], v[204:207]
    ds_read_b128 a[108:111], v243 offset:256
    s_waitcnt vmcnt(3)
    buffer_load_dwordx4 v251, s[44:47], s8 offen offset:3072 nt lds
    v_mfma_f32_16x16x32_bf16 v[208:211], a[112:115], a[4:7], v[232:235]
    v_exp_f32 v181, v181
    v_mfma_f32_16x16x32_bf16 v[208:211], a[116:119], a[16:19], v[208:211]
    v_exp_f32 v182, v182
    v_mfma_f32_16x16x32_bf16 v[208:211], a[120:123], a[28:31], v[208:211]
    v_exp_f32 v183, v183
    v_mfma_f32_16x16x32_bf16 v[208:211], a[124:127], a[40:43], v[208:211]
    v_add_f32 v252, v252, v180
    v_add_f32 v252, v252, v181
    v_mfma_f32_16x16x32_bf16 v[212:215], a[112:115], a[8:11], v[236:239]
    ds_read_b128 a[112:115], v240 offset:8448
    v_cvt_pk_bf16_f32 v120, v180, v181
    v_mfma_f32_16x16x32_bf16 v[212:215], a[116:119], a[20:23], v[212:215]
    ds_read_b128 a[116:119], v241 offset:8448
    v_add_f32 v252, v252, v182
    v_mfma_f32_16x16x32_bf16 v[212:215], a[120:123], a[32:35], v[212:215]
    ds_read_b128 a[120:123], v242 offset:8448
    v_add_f32 v252, v252, v183
    v_mfma_f32_16x16x32_bf16 v[212:215], a[124:127], a[44:47], v[212:215]
    s_waitcnt lgkmcnt(7)
    v_exp_f32 v192, v192
    v_mfma_f32_16x16x32_bf16 v[216:219], a[128:131], a[0:3], v[228:231]
    v_exp_f32 v193, v193
    v_mfma_f32_16x16x32_bf16 v[216:219], a[132:135], a[12:15], v[216:219]
    ds_read_b128 a[124:127], v243 offset:8448
    v_cvt_pk_bf16_f32 v121, v182, v183
    v_mfma_f32_16x16x32_bf16 v[216:219], a[136:139], a[24:27], v[216:219]
    v_add_u32 v240, 0xfffe0000, v240
    v_add_u32 v241, 0xfffe0000, v241
    v_mfma_f32_16x16x32_bf16 v[216:219], a[140:143], a[36:39], v[216:219]
    v_add_u32 v242, 0xfffe0000, v242
    v_add_u32 v243, 0xfffe0000, v243
    v_mfma_f32_16x16x32_bf16 v[220:223], a[128:131], a[4:7], v[232:235]
    v_exp_f32 v194, v194
    v_mfma_f32_16x16x32_bf16 v[220:223], a[132:135], a[16:19], v[220:223]
    v_exp_f32 v195, v195
    v_mfma_f32_16x16x32_bf16 v[220:223], a[136:139], a[28:31], v[220:223]
    v_exp_f32 v184, v184
    v_mfma_f32_16x16x32_bf16 v[220:223], a[140:143], a[40:43], v[220:223]
    v_exp_f32 v185, v185
    v_mfma_f32_16x16x32_bf16 v[224:227], a[128:131], a[8:11], v[236:239]
    v_exp_f32 v186, v186
    v_mfma_f32_16x16x32_bf16 v[224:227], a[132:135], a[20:23], v[224:227]
    s_waitcnt lgkmcnt(0)
    s_barrier
    v_add_f32 v252, v252, v192
    v_mfma_f32_16x16x32_bf16 v[224:227], a[136:139], a[32:35], v[224:227]
    s_mov_b32 s8, 128
    s_add_u32 m0, s10, 131072
    ds_read_b128 a[128:131], v240 offset:32768
    v_mfma_f32_16x16x32_bf16 v[224:227], a[140:143], a[44:47], v[224:227]
    s_waitcnt vmcnt(3)
    buffer_load_dwordx4 v248, s[44:47], s8 offen nt lds
    v_add_f32 v252, v252, v193
    v_mfma_f32_16x16x32_bf16 v[204:207], a[96:99], a[48:51], v[204:207]
    v_exp_f32 v187, v187
    v_mfma_f32_16x16x32_bf16 v[204:207], a[100:103], a[60:63], v[204:207]
    ds_read_b128 a[132:135], v241 offset:32768
    v_cvt_pk_bf16_f32 v122, v192, v193
    v_mfma_f32_16x16x32_bf16 v[204:207], a[104:107], a[72:75], v[204:207]
    s_add_u32 m0, s10, 131072
    v_exp_f32 v196, v196
    v_mfma_f32_16x16x32_bf16 v[204:207], a[108:111], a[84:87], v[204:207]
    ds_read_b128 a[136:139], v242 offset:32768
    s_waitcnt vmcnt(3)
    buffer_load_dwordx4 v249, s[44:47], s8 offen offset:1024 nt lds
    v_mfma_f32_16x16x32_bf16 v[208:211], a[96:99], a[52:55], v[208:211]
    v_exp_f32 v197, v197
    v_mfma_f32_16x16x32_bf16 v[208:211], a[100:103], a[64:67], v[208:211]
    v_exp_f32 v198, v198
    v_mfma_f32_16x16x32_bf16 v[208:211], a[104:107], a[76:79], v[208:211]
    ds_read_b128 a[140:143], v243 offset:32768
    v_add_f32 v252, v252, v194
    v_mfma_f32_16x16x32_bf16 v[208:211], a[108:111], a[88:91], v[208:211]
    v_exp_f32 v199, v199
    v_mfma_f32_16x16x32_bf16 v[212:215], a[96:99], a[56:59], v[212:215]
    ds_read_b128 a[96:99], v240 offset:40960
    v_add_f32 v252, v252, v195
    v_mfma_f32_16x16x32_bf16 v[212:215], a[100:103], a[68:71], v[212:215]
    v_exp_f32 v188, v188
    v_mfma_f32_16x16x32_bf16 v[212:215], a[104:107], a[80:83], v[212:215]
    v_exp_f32 v189, v189
    v_mfma_f32_16x16x32_bf16 v[212:215], a[108:111], a[92:95], v[212:215]
    ds_read_b128 a[100:103], v241 offset:40960
    v_cvt_pk_bf16_f32 v123, v194, v195
    v_mfma_f32_16x16x32_bf16 v[216:219], a[112:115], a[48:51], v[216:219]
    v_exp_f32 v190, v190
    v_mfma_f32_16x16x32_bf16 v[216:219], a[116:119], a[60:63], v[216:219]
    v_exp_f32 v191, v191
    v_add_f32 v254, v254, v190
    v_mfma_f32_16x16x32_bf16 v[216:219], a[120:123], a[72:75], v[216:219]
    s_add_u32 m0, s10, 131072
    ds_read_b128 a[104:107], v242 offset:40960
    v_add_f32 v253, v253, v184
    v_cvt_pk_bf16_f32 v128, v188, v189
    v_mfma_f32_16x16x32_bf16 v[216:219], a[124:127], a[84:87], v[216:219]
    s_waitcnt vmcnt(3)
    buffer_load_dwordx4 v250, s[44:47], s8 offen offset:2048 nt lds
    v_add_f32 v253, v253, v185
    v_add_f32 v254, v254, v189
    v_mfma_f32_16x16x32_bf16 v[220:223], a[112:115], a[52:55], v[220:223]
    ds_read_b128 a[108:111], v243 offset:40960
    v_cvt_pk_bf16_f32 v124, v184, v185
    v_add_f32 v254, v254, v188
    v_mfma_f32_16x16x32_bf16 v[220:223], a[116:119], a[64:67], v[220:223]
    v_exp_f32 v200, v200
    v_cvt_pk_bf16_f32 v127, v198, v199
    v_mfma_f32_16x16x32_bf16 v[220:223], a[120:123], a[76:79], v[220:223]
    v_exp_f32 v201, v201
    v_add_f32 v253, v253, v199
    v_mfma_f32_16x16x32_bf16 v[220:223], a[124:127], a[88:91], v[220:223]
    v_exp_f32 v202, v202
    v_exp_f32 v203, v203
    v_mfma_f32_16x16x32_bf16 v[224:227], a[112:115], a[56:59], v[224:227]
    ds_read_b128 a[112:115], v240 offset:33024
    v_add_f32 v253, v253, v186
    v_add_f32 v253, v253, v198
    v_add_f32 v254, v254, v200
    v_add_f32 v254, v254, v202
    v_mfma_f32_16x16x32_bf16 v[224:227], a[116:119], a[68:71], v[224:227]
    ds_read_b128 a[116:119], v241 offset:33024
    v_add_f32 v253, v253, v187
    v_cvt_pk_bf16_f32 v126, v196, v197
    v_cvt_pk_bf16_f32 v129, v190, v191
    v_cvt_pk_bf16_f32 v130, v200, v201
    v_cvt_pk_bf16_f32 v131, v202, v203
    v_mfma_f32_16x16x32_bf16 v[224:227], a[120:123], a[80:83], v[224:227]
    v_cvt_pk_bf16_f32 v125, v186, v187
    v_add_f32 v253, v253, v196
    v_add_f32 v253, v253, v197
    v_add_f32 v254, v254, v191
    v_add_f32 v254, v254, v201
    v_add_f32 v254, v254, v203
    v_mfma_f32_16x16x32_bf16 v[224:227], a[124:127], a[92:95], v[224:227]
    s_waitcnt lgkmcnt(6)
    v_mfma_f32_16x16x32_bf16 v[180:183], a[128:131], a[0:3], v[228:231]
    ds_read_b128 a[120:123], v242 offset:33024
    v_mfma_f32_16x16x32_bf16 v[180:183], a[132:135], a[12:15], v[180:183]
    v_mfma_f32_16x16x32_bf16 v[180:183], a[136:139], a[24:27], v[180:183]
    s_add_u32 m0, s10, 131072
    v_exp_f32 v204, v204
    v_mfma_f32_16x16x32_bf16 v[180:183], a[140:143], a[36:39], v[180:183]
    ds_read_b128 a[124:127], v243 offset:33024
    s_waitcnt vmcnt(3)
    buffer_load_dwordx4 v251, s[44:47], s8 offen offset:3072 nt lds
    v_mfma_f32_16x16x32_bf16 v[184:187], a[128:131], a[4:7], v[232:235]
    v_exp_f32 v205, v205
    v_mfma_f32_16x16x32_bf16 v[184:187], a[132:135], a[16:19], v[184:187]
    v_exp_f32 v206, v206
    v_mfma_f32_16x16x32_bf16 v[184:187], a[136:139], a[28:31], v[184:187]
    v_exp_f32 v207, v207
    v_mfma_f32_16x16x32_bf16 v[184:187], a[140:143], a[40:43], v[184:187]
    v_add_f32 v252, v252, v204
    v_add_f32 v252, v252, v205
    v_mfma_f32_16x16x32_bf16 v[188:191], a[128:131], a[8:11], v[236:239]
    ds_read_b128 a[128:131], v240 offset:41216
    v_cvt_pk_bf16_f32 v132, v204, v205
    v_mfma_f32_16x16x32_bf16 v[188:191], a[132:135], a[20:23], v[188:191]
    ds_read_b128 a[132:135], v241 offset:41216
    v_add_f32 v252, v252, v206
    v_mfma_f32_16x16x32_bf16 v[188:191], a[136:139], a[32:35], v[188:191]
    ds_read_b128 a[136:139], v242 offset:41216
    v_add_f32 v252, v252, v207
    v_mfma_f32_16x16x32_bf16 v[188:191], a[140:143], a[44:47], v[188:191]
    s_waitcnt lgkmcnt(7)
    v_exp_f32 v216, v216
    v_mfma_f32_16x16x32_bf16 v[192:195], a[96:99], a[0:3], v[228:231]
    v_exp_f32 v217, v217
    v_mfma_f32_16x16x32_bf16 v[192:195], a[100:103], a[12:15], v[192:195]
    ds_read_b128 a[140:143], v243 offset:41216
    v_cvt_pk_bf16_f32 v133, v206, v207
    v_mfma_f32_16x16x32_bf16 v[192:195], a[104:107], a[24:27], v[192:195]
    v_add_u32 v240, 0x10000, v240
    v_add_u32 v241, 0x10000, v241
    v_mfma_f32_16x16x32_bf16 v[192:195], a[108:111], a[36:39], v[192:195]
    v_add_u32 v242, 0x10000, v242
    v_add_u32 v243, 0x10000, v243
    v_mfma_f32_16x16x32_bf16 v[196:199], a[96:99], a[4:7], v[232:235]
    v_exp_f32 v218, v218
    v_mfma_f32_16x16x32_bf16 v[196:199], a[100:103], a[16:19], v[196:199]
    v_exp_f32 v219, v219
    v_mfma_f32_16x16x32_bf16 v[196:199], a[104:107], a[28:31], v[196:199]
    v_exp_f32 v208, v208
    v_mfma_f32_16x16x32_bf16 v[196:199], a[108:111], a[40:43], v[196:199]
    v_exp_f32 v209, v209
    v_mfma_f32_16x16x32_bf16 v[200:203], a[96:99], a[8:11], v[236:239]
    v_exp_f32 v210, v210
    v_mfma_f32_16x16x32_bf16 v[200:203], a[100:103], a[20:23], v[200:203]
    s_waitcnt lgkmcnt(0)
    s_barrier
    v_add_f32 v252, v252, v216
    v_mfma_f32_16x16x32_bf16 v[200:203], a[104:107], a[32:35], v[200:203]
    s_mov_b32 s8, 65664
    s_add_u32 m0, s10, 32768
    ds_read_b128 a[96:99], v240 offset:32768
    v_mfma_f32_16x16x32_bf16 v[200:203], a[108:111], a[44:47], v[200:203]
    s_waitcnt vmcnt(3)
    buffer_load_dwordx4 v248, s[44:47], s8 offen nt lds
    v_add_f32 v252, v252, v217
    v_mfma_f32_16x16x32_bf16 v[180:183], a[112:115], a[48:51], v[180:183]
    v_exp_f32 v211, v211
    v_mfma_f32_16x16x32_bf16 v[180:183], a[116:119], a[60:63], v[180:183]
    ds_read_b128 a[100:103], v241 offset:32768
    v_cvt_pk_bf16_f32 v134, v216, v217
    v_mfma_f32_16x16x32_bf16 v[180:183], a[120:123], a[72:75], v[180:183]
    s_add_u32 m0, s10, 32768
    v_exp_f32 v220, v220
    v_mfma_f32_16x16x32_bf16 v[180:183], a[124:127], a[84:87], v[180:183]
    ds_read_b128 a[104:107], v242 offset:32768
    s_waitcnt vmcnt(3)
    buffer_load_dwordx4 v249, s[44:47], s8 offen offset:1024 nt lds
    v_mfma_f32_16x16x32_bf16 v[184:187], a[112:115], a[52:55], v[184:187]
    v_exp_f32 v221, v221
    v_mfma_f32_16x16x32_bf16 v[184:187], a[116:119], a[64:67], v[184:187]
    v_exp_f32 v222, v222
    v_mfma_f32_16x16x32_bf16 v[184:187], a[120:123], a[76:79], v[184:187]
    ds_read_b128 a[108:111], v243 offset:32768
    v_add_f32 v252, v252, v218
    v_mfma_f32_16x16x32_bf16 v[184:187], a[124:127], a[88:91], v[184:187]
    v_exp_f32 v223, v223
    v_mfma_f32_16x16x32_bf16 v[188:191], a[112:115], a[56:59], v[188:191]
    ds_read_b128 a[112:115], v240 offset:40960
    v_add_f32 v252, v252, v219
    v_mfma_f32_16x16x32_bf16 v[188:191], a[116:119], a[68:71], v[188:191]
    v_exp_f32 v212, v212
    v_mfma_f32_16x16x32_bf16 v[188:191], a[120:123], a[80:83], v[188:191]
    v_exp_f32 v213, v213
    v_mfma_f32_16x16x32_bf16 v[188:191], a[124:127], a[92:95], v[188:191]
    ds_read_b128 a[116:119], v241 offset:40960
    v_cvt_pk_bf16_f32 v135, v218, v219
    v_mfma_f32_16x16x32_bf16 v[192:195], a[128:131], a[48:51], v[192:195]
    v_exp_f32 v214, v214
    v_mfma_f32_16x16x32_bf16 v[192:195], a[132:135], a[60:63], v[192:195]
    v_exp_f32 v215, v215
    v_add_f32 v254, v254, v214
    v_mfma_f32_16x16x32_bf16 v[192:195], a[136:139], a[72:75], v[192:195]
    s_add_u32 m0, s10, 32768
    ds_read_b128 a[120:123], v242 offset:40960
    v_add_f32 v253, v253, v208
    v_cvt_pk_bf16_f32 v140, v212, v213
    v_mfma_f32_16x16x32_bf16 v[192:195], a[140:143], a[84:87], v[192:195]
    s_waitcnt vmcnt(3)
    buffer_load_dwordx4 v250, s[44:47], s8 offen offset:2048 nt lds
    v_add_f32 v253, v253, v209
    v_add_f32 v254, v254, v213
    v_mfma_f32_16x16x32_bf16 v[196:199], a[128:131], a[52:55], v[196:199]
    ds_read_b128 a[124:127], v243 offset:40960
    v_cvt_pk_bf16_f32 v136, v208, v209
    v_add_f32 v254, v254, v212
    v_mfma_f32_16x16x32_bf16 v[196:199], a[132:135], a[64:67], v[196:199]
    v_exp_f32 v224, v224
    v_cvt_pk_bf16_f32 v139, v222, v223
    v_mfma_f32_16x16x32_bf16 v[196:199], a[136:139], a[76:79], v[196:199]
    v_exp_f32 v225, v225
    v_add_f32 v253, v253, v223
    v_mfma_f32_16x16x32_bf16 v[196:199], a[140:143], a[88:91], v[196:199]
    v_exp_f32 v226, v226
    v_exp_f32 v227, v227
    v_mfma_f32_16x16x32_bf16 v[200:203], a[128:131], a[56:59], v[200:203]
    ds_read_b128 a[128:131], v240 offset:33024
    v_add_f32 v253, v253, v210
    v_add_f32 v253, v253, v222
    v_add_f32 v254, v254, v224
    v_add_f32 v254, v254, v226
    v_mfma_f32_16x16x32_bf16 v[200:203], a[132:135], a[68:71], v[200:203]
    ds_read_b128 a[132:135], v241 offset:33024
    v_add_f32 v253, v253, v211
    v_cvt_pk_bf16_f32 v138, v220, v221
    v_cvt_pk_bf16_f32 v141, v214, v215
    v_cvt_pk_bf16_f32 v142, v224, v225
    v_cvt_pk_bf16_f32 v143, v226, v227
    v_mfma_f32_16x16x32_bf16 v[200:203], a[136:139], a[80:83], v[200:203]
    v_cvt_pk_bf16_f32 v137, v210, v211
    v_add_f32 v253, v253, v220
    v_add_f32 v253, v253, v221
    v_add_f32 v254, v254, v215
    v_add_f32 v254, v254, v225
    v_add_f32 v254, v254, v227
    v_mfma_f32_16x16x32_bf16 v[200:203], a[140:143], a[92:95], v[200:203]
    s_waitcnt lgkmcnt(6)
    v_mfma_f32_16x16x32_bf16 v[204:207], a[96:99], a[0:3], v[228:231]
    ds_read_b128 a[136:139], v242 offset:33024
    v_mfma_f32_16x16x32_bf16 v[204:207], a[100:103], a[12:15], v[204:207]
    v_mfma_f32_16x16x32_bf16 v[204:207], a[104:107], a[24:27], v[204:207]
    s_add_u32 m0, s10, 32768
    v_exp_f32 v180, v180
    v_mfma_f32_16x16x32_bf16 v[204:207], a[108:111], a[36:39], v[204:207]
    ds_read_b128 a[140:143], v243 offset:33024
    s_waitcnt vmcnt(3)
    buffer_load_dwordx4 v251, s[44:47], s8 offen offset:3072 nt lds
    v_mfma_f32_16x16x32_bf16 v[208:211], a[96:99], a[4:7], v[232:235]
    v_exp_f32 v181, v181
    v_mfma_f32_16x16x32_bf16 v[208:211], a[100:103], a[16:19], v[208:211]
    v_exp_f32 v182, v182
    v_mfma_f32_16x16x32_bf16 v[208:211], a[104:107], a[28:31], v[208:211]
    v_exp_f32 v183, v183
    v_mfma_f32_16x16x32_bf16 v[208:211], a[108:111], a[40:43], v[208:211]
    v_add_f32 v252, v252, v180
    v_add_f32 v252, v252, v181
    v_mfma_f32_16x16x32_bf16 v[212:215], a[96:99], a[8:11], v[236:239]
    ds_read_b128 a[96:99], v240 offset:41216
    v_cvt_pk_bf16_f32 v144, v180, v181
    v_mfma_f32_16x16x32_bf16 v[212:215], a[100:103], a[20:23], v[212:215]
    ds_read_b128 a[100:103], v241 offset:41216
    v_add_f32 v252, v252, v182
    v_mfma_f32_16x16x32_bf16 v[212:215], a[104:107], a[32:35], v[212:215]
    ds_read_b128 a[104:107], v242 offset:41216
    v_add_f32 v252, v252, v183
    v_mfma_f32_16x16x32_bf16 v[212:215], a[108:111], a[44:47], v[212:215]
    s_waitcnt lgkmcnt(7)
    v_exp_f32 v192, v192
    v_mfma_f32_16x16x32_bf16 v[216:219], a[112:115], a[0:3], v[228:231]
    v_exp_f32 v193, v193
    v_mfma_f32_16x16x32_bf16 v[216:219], a[116:119], a[12:15], v[216:219]
    ds_read_b128 a[108:111], v243 offset:41216
    v_cvt_pk_bf16_f32 v145, v182, v183
    v_mfma_f32_16x16x32_bf16 v[216:219], a[120:123], a[24:27], v[216:219]
    v_add_u32 v240, 0xffff0000, v240
    v_add_u32 v241, 0xffff0000, v241
    v_mfma_f32_16x16x32_bf16 v[216:219], a[124:127], a[36:39], v[216:219]
    v_add_u32 v242, 0xffff0000, v242
    v_add_u32 v243, 0xffff0000, v243
    v_mfma_f32_16x16x32_bf16 v[220:223], a[112:115], a[4:7], v[232:235]
    v_exp_f32 v194, v194
    v_mfma_f32_16x16x32_bf16 v[220:223], a[116:119], a[16:19], v[220:223]
    v_exp_f32 v195, v195
    v_mfma_f32_16x16x32_bf16 v[220:223], a[120:123], a[28:31], v[220:223]
    v_exp_f32 v184, v184
    v_mfma_f32_16x16x32_bf16 v[220:223], a[124:127], a[40:43], v[220:223]
    v_exp_f32 v185, v185
    v_mfma_f32_16x16x32_bf16 v[224:227], a[112:115], a[8:11], v[236:239]
    v_exp_f32 v186, v186
    v_mfma_f32_16x16x32_bf16 v[224:227], a[116:119], a[20:23], v[224:227]
    s_waitcnt lgkmcnt(0)
    s_barrier
    v_add_f32 v252, v252, v192
    v_mfma_f32_16x16x32_bf16 v[224:227], a[120:123], a[32:35], v[224:227]
    s_mov_b32 s8, 131200
    s_add_u32 m0, s10, 98304
    ds_read_b128 a[112:115], v240 offset:49152
    v_mfma_f32_16x16x32_bf16 v[224:227], a[124:127], a[44:47], v[224:227]
    s_waitcnt vmcnt(3)
    buffer_load_dwordx4 v248, s[44:47], s8 offen nt lds
    v_add_f32 v252, v252, v193
    v_mfma_f32_16x16x32_bf16 v[204:207], a[128:131], a[48:51], v[204:207]
    v_exp_f32 v187, v187
    v_mfma_f32_16x16x32_bf16 v[204:207], a[132:135], a[60:63], v[204:207]
    ds_read_b128 a[116:119], v241 offset:49152
    v_cvt_pk_bf16_f32 v146, v192, v193
    v_mfma_f32_16x16x32_bf16 v[204:207], a[136:139], a[72:75], v[204:207]
    s_add_u32 m0, s10, 98304
    v_exp_f32 v196, v196
    v_mfma_f32_16x16x32_bf16 v[204:207], a[140:143], a[84:87], v[204:207]
    ds_read_b128 a[120:123], v242 offset:49152
    s_waitcnt vmcnt(3)
    buffer_load_dwordx4 v249, s[44:47], s8 offen offset:1024 nt lds
    v_mfma_f32_16x16x32_bf16 v[208:211], a[128:131], a[52:55], v[208:211]
    v_exp_f32 v197, v197
    v_mfma_f32_16x16x32_bf16 v[208:211], a[132:135], a[64:67], v[208:211]
    v_exp_f32 v198, v198
    v_mfma_f32_16x16x32_bf16 v[208:211], a[136:139], a[76:79], v[208:211]
    ds_read_b128 a[124:127], v243 offset:49152
    v_add_f32 v252, v252, v194
    v_mfma_f32_16x16x32_bf16 v[208:211], a[140:143], a[88:91], v[208:211]
    v_exp_f32 v199, v199
    v_mfma_f32_16x16x32_bf16 v[212:215], a[128:131], a[56:59], v[212:215]
    ds_read_b128 a[128:131], v240 offset:57344
    v_add_f32 v252, v252, v195
    v_mfma_f32_16x16x32_bf16 v[212:215], a[132:135], a[68:71], v[212:215]
    v_exp_f32 v188, v188
    v_mfma_f32_16x16x32_bf16 v[212:215], a[136:139], a[80:83], v[212:215]
    v_exp_f32 v189, v189
    v_mfma_f32_16x16x32_bf16 v[212:215], a[140:143], a[92:95], v[212:215]
    ds_read_b128 a[132:135], v241 offset:57344
    v_cvt_pk_bf16_f32 v147, v194, v195
    v_mfma_f32_16x16x32_bf16 v[216:219], a[96:99], a[48:51], v[216:219]
    v_exp_f32 v190, v190
    v_mfma_f32_16x16x32_bf16 v[216:219], a[100:103], a[60:63], v[216:219]
    v_exp_f32 v191, v191
    v_add_f32 v254, v254, v190
    v_mfma_f32_16x16x32_bf16 v[216:219], a[104:107], a[72:75], v[216:219]
    s_add_u32 m0, s10, 98304
    ds_read_b128 a[136:139], v242 offset:57344
    v_add_f32 v253, v253, v184
    v_cvt_pk_bf16_f32 v152, v188, v189
    v_mfma_f32_16x16x32_bf16 v[216:219], a[108:111], a[84:87], v[216:219]
    s_waitcnt vmcnt(3)
    buffer_load_dwordx4 v250, s[44:47], s8 offen offset:2048 nt lds
    v_add_f32 v253, v253, v185
    v_add_f32 v254, v254, v189
    v_mfma_f32_16x16x32_bf16 v[220:223], a[96:99], a[52:55], v[220:223]
    ds_read_b128 a[140:143], v243 offset:57344
    v_cvt_pk_bf16_f32 v148, v184, v185
    v_add_f32 v254, v254, v188
    v_mfma_f32_16x16x32_bf16 v[220:223], a[100:103], a[64:67], v[220:223]
    v_exp_f32 v200, v200
    v_cvt_pk_bf16_f32 v151, v198, v199
    v_mfma_f32_16x16x32_bf16 v[220:223], a[104:107], a[76:79], v[220:223]
    v_exp_f32 v201, v201
    v_add_f32 v253, v253, v199
    v_mfma_f32_16x16x32_bf16 v[220:223], a[108:111], a[88:91], v[220:223]
    v_exp_f32 v202, v202
    v_exp_f32 v203, v203
    v_mfma_f32_16x16x32_bf16 v[224:227], a[96:99], a[56:59], v[224:227]
    ds_read_b128 a[96:99], v240 offset:49408
    v_add_f32 v253, v253, v186
    v_add_f32 v253, v253, v198
    v_add_f32 v254, v254, v200
    v_add_f32 v254, v254, v202
    v_mfma_f32_16x16x32_bf16 v[224:227], a[100:103], a[68:71], v[224:227]
    ds_read_b128 a[100:103], v241 offset:49408
    v_add_f32 v253, v253, v187
    v_cvt_pk_bf16_f32 v150, v196, v197
    v_cvt_pk_bf16_f32 v153, v190, v191
    v_cvt_pk_bf16_f32 v154, v200, v201
    v_cvt_pk_bf16_f32 v155, v202, v203
    v_mfma_f32_16x16x32_bf16 v[224:227], a[104:107], a[80:83], v[224:227]
    v_cvt_pk_bf16_f32 v149, v186, v187
    v_add_f32 v253, v253, v196
    v_add_f32 v253, v253, v197
    v_add_f32 v254, v254, v191
    v_add_f32 v254, v254, v201
    v_add_f32 v254, v254, v203
    v_mfma_f32_16x16x32_bf16 v[224:227], a[108:111], a[92:95], v[224:227]
    s_waitcnt lgkmcnt(6)
    v_mfma_f32_16x16x32_bf16 v[180:183], a[112:115], a[0:3], v[228:231]
    ds_read_b128 a[104:107], v242 offset:49408
    v_readfirstlane_b32 s78, v171
    s_lshl_b32 s6, s3, 4
    s_nop 2
    s_add_u32 s78, s78, s6
    s_cmp_lt_u32 s78, 16
    s_cbranch_scc1 L_spinI
L_retI:
    v_mfma_f32_16x16x32_bf16 v[180:183], a[116:119], a[12:15], v[180:183]
    v_mfma_f32_16x16x32_bf16 v[180:183], a[120:123], a[24:27], v[180:183]
    s_add_u32 m0, s10, 98304
    v_exp_f32 v204, v204
    v_mfma_f32_16x16x32_bf16 v[180:183], a[124:127], a[36:39], v[180:183]
    ds_read_b128 a[108:111], v243 offset:49408
    s_waitcnt vmcnt(3)
    buffer_load_dwordx4 v251, s[44:47], s8 offen offset:3072 nt lds
    v_mfma_f32_16x16x32_bf16 v[184:187], a[112:115], a[4:7], v[232:235]
    v_exp_f32 v205, v205
    v_mfma_f32_16x16x32_bf16 v[184:187], a[116:119], a[16:19], v[184:187]
    v_exp_f32 v206, v206
    v_mfma_f32_16x16x32_bf16 v[184:187], a[120:123], a[28:31], v[184:187]
    v_exp_f32 v207, v207
    v_mfma_f32_16x16x32_bf16 v[184:187], a[124:127], a[40:43], v[184:187]
    v_add_f32 v252, v252, v204
    v_add_f32 v252, v252, v205
    v_mfma_f32_16x16x32_bf16 v[188:191], a[112:115], a[8:11], v[236:239]
    ds_read_b128 a[112:115], v240 offset:57600
    v_cvt_pk_bf16_f32 v156, v204, v205
    v_mfma_f32_16x16x32_bf16 v[188:191], a[116:119], a[20:23], v[188:191]
    ds_read_b128 a[116:119], v241 offset:57600
    v_add_f32 v252, v252, v206
    v_mfma_f32_16x16x32_bf16 v[188:191], a[120:123], a[32:35], v[188:191]
    ds_read_b128 a[120:123], v242 offset:57600
    v_add_f32 v252, v252, v207
    v_mfma_f32_16x16x32_bf16 v[188:191], a[124:127], a[44:47], v[188:191]
    s_waitcnt lgkmcnt(7)
    v_exp_f32 v216, v216
    v_mfma_f32_16x16x32_bf16 v[192:195], a[128:131], a[0:3], v[228:231]
    v_exp_f32 v217, v217
    v_mfma_f32_16x16x32_bf16 v[192:195], a[132:135], a[12:15], v[192:195]
    ds_read_b128 a[124:127], v243 offset:57600
    v_cvt_pk_bf16_f32 v157, v206, v207
    v_mfma_f32_16x16x32_bf16 v[192:195], a[136:139], a[24:27], v[192:195]
    v_exp_f32 v218, v218
    v_mfma_f32_16x16x32_bf16 v[192:195], a[140:143], a[36:39], v[192:195]
    v_exp_f32 v219, v219
    v_mfma_f32_16x16x32_bf16 v[196:199], a[128:131], a[4:7], v[232:235]
    v_exp_f32 v208, v208
    v_mfma_f32_16x16x32_bf16 v[196:199], a[132:135], a[16:19], v[196:199]
    v_exp_f32 v209, v209
    v_mfma_f32_16x16x32_bf16 v[196:199], a[136:139], a[28:31], v[196:199]
    v_exp_f32 v210, v210
    v_mfma_f32_16x16x32_bf16 v[196:199], a[140:143], a[40:43], v[196:199]
    v_exp_f32 v211, v211
    v_mfma_f32_16x16x32_bf16 v[200:203], a[128:131], a[8:11], v[236:239]
    v_add_f32 v252, v252, v216
    v_add_f32 v252, v252, v217
    v_mfma_f32_16x16x32_bf16 v[200:203], a[132:135], a[20:23], v[200:203]
    s_waitcnt lgkmcnt(0)
    s_barrier
    v_cvt_pk_bf16_f32 v158, v216, v217
    v_mfma_f32_16x16x32_bf16 v[200:203], a[136:139], a[32:35], v[200:203]
    s_mov_b32 s8, 196736
    s_add_u32 m0, s10, 49152
    ds_read_b128 a[128:131], v240
    v_mfma_f32_16x16x32_bf16 v[200:203], a[140:143], a[44:47], v[200:203]
    s_waitcnt vmcnt(3)
    buffer_load_dwordx4 v248, s[44:47], s8 offen nt lds
    v_add_f32 v252, v252, v218
    v_mfma_f32_16x16x32_bf16 v[180:183], a[96:99], a[48:51], v[180:183]
    v_exp_f32 v220, v220
    v_mfma_f32_16x16x32_bf16 v[180:183], a[100:103], a[60:63], v[180:183]
    ds_read_b128 a[132:135], v241
    v_add_f32 v252, v252, v219
    v_mfma_f32_16x16x32_bf16 v[180:183], a[104:107], a[72:75], v[180:183]
    s_add_u32 m0, s10, 49152
    v_exp_f32 v221, v221
    v_mfma_f32_16x16x32_bf16 v[180:183], a[108:111], a[84:87], v[180:183]
    ds_read_b128 a[136:139], v242
    s_waitcnt vmcnt(3)
    buffer_load_dwordx4 v249, s[44:47], s8 offen offset:1024 nt lds
    v_mfma_f32_16x16x32_bf16 v[184:187], a[96:99], a[52:55], v[184:187]
    v_exp_f32 v222, v222
    v_mfma_f32_16x16x32_bf16 v[184:187], a[100:103], a[64:67], v[184:187]
    v_exp_f32 v223, v223
    v_mfma_f32_16x16x32_bf16 v[184:187], a[104:107], a[76:79], v[184:187]
    ds_read_b128 a[140:143], v243
    v_cvt_pk_bf16_f32 v159, v218, v219
    v_mfma_f32_16x16x32_bf16 v[184:187], a[108:111], a[88:91], v[184:187]
    v_exp_f32 v212, v212
    v_mfma_f32_16x16x32_bf16 v[188:191], a[96:99], a[56:59], v[188:191]
    ds_read_b128 a[96:99], v240 offset:8192
    v_add_f32 v253, v253, v208
    v_mfma_f32_16x16x32_bf16 v[188:191], a[100:103], a[68:71], v[188:191]
    v_exp_f32 v213, v213
    v_mfma_f32_16x16x32_bf16 v[188:191], a[104:107], a[80:83], v[188:191]
    v_exp_f32 v214, v214
    v_mfma_f32_16x16x32_bf16 v[188:191], a[108:111], a[92:95], v[188:191]
    ds_read_b128 a[100:103], v241 offset:8192
    v_add_f32 v253, v253, v209
    v_mfma_f32_16x16x32_bf16 v[192:195], a[112:115], a[48:51], v[192:195]
    v_exp_f32 v215, v215
    v_mfma_f32_16x16x32_bf16 v[192:195], a[116:119], a[60:63], v[192:195]
    v_exp_f32 v224, v224
    v_mfma_f32_16x16x32_bf16 v[192:195], a[120:123], a[72:75], v[192:195]
    s_add_u32 m0, s10, 49152
    ds_read_b128 a[104:107], v242 offset:8192
    v_cvt_pk_bf16_f32 v160, v208, v209
    v_cvt_pk_bf16_f32 v165, v214, v215
    v_mfma_f32_16x16x32_bf16 v[192:195], a[124:127], a[84:87], v[192:195]
    s_waitcnt vmcnt(3)
    buffer_load_dwordx4 v250, s[44:47], s8 offen offset:2048 nt lds
    v_add_f32 v253, v253, v210
    v_add_f32 v254, v254, v215
    v_mfma_f32_16x16x32_bf16 v[196:199], a[112:115], a[52:55], v[196:199]
    ds_read_b128 a[108:111], v243 offset:8192
    v_add_f32 v253, v253, v211
    v_add_f32 v254, v254, v214
    v_mfma_f32_16x16x32_bf16 v[196:199], a[116:119], a[64:67], v[196:199]
    v_exp_f32 v225, v225
    v_cvt_pk_bf16_f32 v164, v212, v213
    v_mfma_f32_16x16x32_bf16 v[196:199], a[120:123], a[76:79], v[196:199]
    v_exp_f32 v226, v226
    v_add_f32 v254, v254, v213
    v_mfma_f32_16x16x32_bf16 v[196:199], a[124:127], a[88:91], v[196:199]
    v_exp_f32 v227, v227
    v_add_f32 v254, v254, v212
    v_add_f32 v254, v254, v226
    v_mfma_f32_16x16x32_bf16 v[200:203], a[112:115], a[56:59], v[200:203]
    ds_read_b128 a[112:115], v240 offset:256
    v_cvt_pk_bf16_f32 v161, v210, v211
    v_cvt_pk_bf16_f32 v163, v222, v223
    v_cvt_pk_bf16_f32 v166, v224, v225
    v_mfma_f32_16x16x32_bf16 v[200:203], a[116:119], a[68:71], v[200:203]
    ds_read_b128 a[116:119], v241 offset:256
    v_add_f32 v253, v253, v220
    v_add_f32 v253, v253, v223
    v_add_f32 v254, v254, v225
    v_cvt_pk_bf16_f32 v167, v226, v227
    v_mfma_f32_16x16x32_bf16 v[200:203], a[120:123], a[80:83], v[200:203]
    v_add_f32 v253, v253, v221
    v_cvt_pk_bf16_f32 v162, v220, v221
    v_add_f32 v253, v253, v222
    v_add_f32 v254, v254, v224
    v_add_f32 v254, v254, v227
    v_mfma_f32_16x16x32_bf16 v[200:203], a[124:127], a[92:95], v[200:203]
    s_waitcnt lgkmcnt(6)
    v_mfma_f32_16x16x32_bf16 v[204:207], a[128:131], a[0:3], v[228:231]
    ds_read_b128 a[120:123], v242 offset:256
    v_mfma_f32_16x16x32_bf16 v[204:207], a[132:135], a[12:15], v[204:207]
    v_mfma_f32_16x16x32_bf16 v[204:207], a[136:139], a[24:27], v[204:207]
    s_add_u32 m0, s10, 49152
    v_exp_f32 v180, v180
    v_mfma_f32_16x16x32_bf16 v[204:207], a[140:143], a[36:39], v[204:207]
    ds_read_b128 a[124:127], v243 offset:256
    s_waitcnt vmcnt(3)
    buffer_load_dwordx4 v251, s[44:47], s8 offen offset:3072 nt lds
    v_mfma_f32_16x16x32_bf16 v[208:211], a[128:131], a[4:7], v[232:235]
    v_exp_f32 v181, v181
    v_mfma_f32_16x16x32_bf16 v[208:211], a[132:135], a[16:19], v[208:211]
    v_exp_f32 v182, v182
    v_mfma_f32_16x16x32_bf16 v[208:211], a[136:139], a[28:31], v[208:211]
    v_exp_f32 v183, v183
    v_mfma_f32_16x16x32_bf16 v[208:211], a[140:143], a[40:43], v[208:211]
    v_add_f32 v252, v252, v180
    v_add_f32 v252, v252, v181
    v_mfma_f32_16x16x32_bf16 v[212:215], a[128:131], a[8:11], v[236:239]
    ds_read_b128 a[128:131], v240 offset:8448
    v_cvt_pk_bf16_f32 v168, v180, v181
    v_mfma_f32_16x16x32_bf16 v[212:215], a[132:135], a[20:23], v[212:215]
    ds_read_b128 a[132:135], v241 offset:8448
    v_add_f32 v252, v252, v182
    v_mfma_f32_16x16x32_bf16 v[212:215], a[136:139], a[32:35], v[212:215]
    ds_read_b128 a[136:139], v242 offset:8448
    v_add_f32 v252, v252, v183
    v_mfma_f32_16x16x32_bf16 v[212:215], a[140:143], a[44:47], v[212:215]
    s_waitcnt lgkmcnt(7)
    v_exp_f32 v192, v192
    v_mfma_f32_16x16x32_bf16 v[216:219], a[96:99], a[0:3], v[228:231]
    v_exp_f32 v193, v193
    v_mfma_f32_16x16x32_bf16 v[216:219], a[100:103], a[12:15], v[216:219]
    ds_read_b128 a[140:143], v243 offset:8448
    v_cvt_pk_bf16_f32 v169, v182, v183
    v_mfma_f32_16x16x32_bf16 v[216:219], a[104:107], a[24:27], v[216:219]
    v_accvgpr_read_b32 v240, a184
    v_accvgpr_read_b32 v241, a185
    v_mfma_f32_16x16x32_bf16 v[216:219], a[108:111], a[36:39], v[216:219]
    v_accvgpr_read_b32 v242, a186
    v_accvgpr_read_b32 v243, a187
    v_mfma_f32_16x16x32_bf16 v[220:223], a[96:99], a[4:7], v[232:235]
    v_exp_f32 v194, v194
    v_mfma_f32_16x16x32_bf16 v[220:223], a[100:103], a[16:19], v[220:223]
    v_exp_f32 v195, v195
    v_mfma_f32_16x16x32_bf16 v[220:223], a[104:107], a[28:31], v[220:223]
    v_exp_f32 v184, v184
    v_mfma_f32_16x16x32_bf16 v[220:223], a[108:111], a[40:43], v[220:223]
    v_exp_f32 v185, v185
    v_mfma_f32_16x16x32_bf16 v[224:227], a[96:99], a[8:11], v[236:239]
    v_exp_f32 v186, v186
    v_mfma_f32_16x16x32_bf16 v[224:227], a[100:103], a[20:23], v[224:227]
    s_waitcnt lgkmcnt(0)
    s_barrier
    v_add_f32 v252, v252, v192
    v_mfma_f32_16x16x32_bf16 v[224:227], a[104:107], a[32:35], v[224:227]
    s_mov_b32 s8, 256
    s_add_u32 m0, s10, 0
    ds_read_b64_tr_b16 a[96:97], v240 offset:16384
    ds_read_b64_tr_b16 a[98:99], v240 offset:18432
    v_mfma_f32_16x16x32_bf16 v[224:227], a[108:111], a[44:47], v[224:227]
    s_waitcnt vmcnt(3)
    buffer_load_dwordx4 v248, s[44:47], s8 offen nt lds
    v_add_f32 v252, v252, v193
    v_mfma_f32_16x16x32_bf16 v[204:207], a[112:115], a[48:51], v[204:207]
    v_exp_f32 v187, v187
    v_mfma_f32_16x16x32_bf16 v[204:207], a[116:119], a[60:63], v[204:207]
    v_exp_f32 v196, v196
    v_mfma_f32_16x16x32_bf16 v[204:207], a[120:123], a[72:75], v[204:207]
    s_add_u32 m0, s10, 0
    ds_read_b64_tr_b16 a[100:101], v240 offset:20480
    ds_read_b64_tr_b16 a[102:103], v240 offset:22528
    v_mfma_f32_16x16x32_bf16 v[204:207], a[124:127], a[84:87], v[204:207]
    s_waitcnt vmcnt(3)
    buffer_load_dwordx4 v249, s[44:47], s8 offen offset:1024 nt lds
    v_cvt_pk_bf16_f32 v170, v192, v193
    v_mfma_f32_16x16x32_bf16 v[208:211], a[112:115], a[52:55], v[208:211]
    v_exp_f32 v197, v197
    v_mfma_f32_16x16x32_bf16 v[208:211], a[116:119], a[64:67], v[208:211]
    v_exp_f32 v198, v198
    v_mfma_f32_16x16x32_bf16 v[208:211], a[120:123], a[76:79], v[208:211]
    ds_read_b64_tr_b16 a[104:105], v240 offset:24576
    ds_read_b64_tr_b16 a[106:107], v240 offset:26624
    v_mfma_f32_16x16x32_bf16 v[208:211], a[124:127], a[88:91], v[208:211]
    v_exp_f32 v199, v199
    v_mfma_f32_16x16x32_bf16 v[212:215], a[112:115], a[56:59], v[212:215]
    v_exp_f32 v188, v188
    v_mfma_f32_16x16x32_bf16 v[212:215], a[116:119], a[68:71], v[212:215]
    v_exp_f32 v189, v189
    v_mfma_f32_16x16x32_bf16 v[212:215], a[120:123], a[80:83], v[212:215]
    ds_read_b64_tr_b16 a[108:109], v240 offset:28672
    ds_read_b64_tr_b16 a[110:111], v240 offset:30720
    v_cvt_pk_bf16_f32 v176, v188, v189
    v_mfma_f32_16x16x32_bf16 v[212:215], a[124:127], a[92:95], v[212:215]
    v_exp_f32 v190, v190
    v_add_f32 v254, v254, v189
    v_mfma_f32_16x16x32_bf16 v[216:219], a[128:131], a[48:51], v[216:219]
    v_exp_f32 v191, v191
    v_add_f32 v254, v254, v188
    v_mfma_f32_16x16x32_bf16 v[216:219], a[132:135], a[60:63], v[216:219]
    v_exp_f32 v200, v200
    v_cvt_pk_bf16_f32 v175, v198, v199
    v_mfma_f32_16x16x32_bf16 v[216:219], a[136:139], a[72:75], v[216:219]
    s_add_u32 m0, s10, 0
    ds_read_b64_tr_b16 a[112:113], v241 offset:16384
    ds_read_b64_tr_b16 a[114:115], v241 offset:18432
    v_add_f32 v253, v253, v199
    v_mfma_f32_16x16x32_bf16 v[216:219], a[140:143], a[84:87], v[216:219]
    s_waitcnt vmcnt(3)
    buffer_load_dwordx4 v250, s[44:47], s8 offen offset:2048 nt lds
    v_add_f32 v252, v252, v194
    v_add_f32 v253, v253, v198
    v_mfma_f32_16x16x32_bf16 v[220:223], a[128:131], a[52:55], v[220:223]
    v_exp_f32 v201, v201
    v_cvt_pk_bf16_f32 v174, v196, v197
    v_mfma_f32_16x16x32_bf16 v[220:223], a[132:135], a[64:67], v[220:223]
    v_exp_f32 v202, v202
    v_add_f32 v253, v253, v197
    v_cvt_pk_bf16_f32 v178, v200, v201
    v_mfma_f32_16x16x32_bf16 v[220:223], a[136:139], a[76:79], v[220:223]
    ds_read_b64_tr_b16 a[116:117], v241 offset:20480
    ds_read_b64_tr_b16 a[118:119], v241 offset:22528
    v_add_f32 v253, v253, v196
    v_add_f32 v254, v254, v201
    v_mfma_f32_16x16x32_bf16 v[220:223], a[140:143], a[88:91], v[220:223]
    v_exp_f32 v203, v203
    v_cvt_pk_bf16_f32 v173, v186, v187
    v_add_f32 v254, v254, v200
    v_mfma_f32_16x16x32_bf16 v[224:227], a[128:131], a[56:59], v[224:227]
    v_add_f32 v252, v252, v195
    v_cvt_pk_bf16_f32 v171, v194, v195
    v_add_f32 v253, v253, v187
    v_cvt_pk_bf16_f32 v177, v190, v191
    v_cvt_pk_bf16_f32 v179, v202, v203
    v_mfma_f32_16x16x32_bf16 v[224:227], a[132:135], a[68:71], v[224:227]
    v_add_f32 v253, v253, v184
    v_add_f32 v253, v253, v185
    v_add_f32 v253, v253, v186
    v_add_f32 v254, v254, v191
    v_add_f32 v254, v254, v203
    v_mfma_f32_16x16x32_bf16 v[224:227], a[136:139], a[80:83], v[224:227]
    ds_read_b64_tr_b16 a[120:121], v241 offset:24576
    ds_read_b64_tr_b16 a[122:123], v241 offset:26624
    v_cvt_pk_bf16_f32 v172, v184, v185
    v_add_f32 v254, v254, v190
    v_add_f32 v254, v254, v202
    v_mfma_f32_16x16x32_bf16 v[224:227], a[140:143], a[92:95], v[224:227]
    v_exp_f32 v204, v204
    v_exp_f32 v205, v205
    v_exp_f32 v206, v206
    v_exp_f32 v207, v207
    v_exp_f32 v216, v216
    v_cvt_pk_bf16_f32 v180, v204, v205
    v_cvt_pk_bf16_f32 v181, v206, v207
    s_add_u32 m0, s10, 0
    ds_read_b64_tr_b16 a[124:125], v241 offset:28672
    ds_read_b64_tr_b16 a[126:127], v241 offset:30720
    v_exp_f32 v217, v217
    v_add_f32 v252, v252, v204
    v_add_f32 v252, v252, v205
    s_waitcnt vmcnt(3)
    buffer_load_dwordx4 v251, s[44:47], s8 offen offset:3072 nt lds
    v_exp_f32 v218, v218
    v_add_f32 v252, v252, v206
    v_add_f32 v252, v252, v207
    v_exp_f32 v219, v219
    v_exp_f32 v208, v208
    v_cvt_pk_bf16_f32 v182, v216, v217
    v_cvt_pk_bf16_f32 v183, v218, v219
    v_exp_f32 v209, v209
    v_add_f32 v252, v252, v216
    v_add_f32 v252, v252, v217
    v_exp_f32 v210, v210
    ds_read_b64_tr_b16 a[128:129], v242 offset:16384
    ds_read_b64_tr_b16 a[130:131], v242 offset:18432
    v_add_f32 v252, v252, v218
    v_add_f32 v252, v252, v219
    v_exp_f32 v211, v211
    v_exp_f32 v220, v220
    v_cvt_pk_bf16_f32 v184, v208, v209
    v_cvt_pk_bf16_f32 v185, v210, v211
    v_exp_f32 v221, v221
    v_add_f32 v253, v253, v208
    v_add_f32 v253, v253, v209
    v_exp_f32 v222, v222
    v_add_f32 v253, v253, v210
    v_add_f32 v253, v253, v211
    ds_read_b64_tr_b16 a[132:133], v242 offset:20480
    ds_read_b64_tr_b16 a[134:135], v242 offset:22528
    v_exp_f32 v223, v223
    v_exp_f32 v212, v212
    v_cvt_pk_bf16_f32 v186, v220, v221
    v_cvt_pk_bf16_f32 v187, v222, v223
    v_exp_f32 v213, v213
    v_add_f32 v253, v253, v220
    v_add_f32 v253, v253, v221
    v_exp_f32 v214, v214
    v_add_f32 v253, v253, v222
    v_add_f32 v253, v253, v223
    v_exp_f32 v215, v215
    ds_read_b64_tr_b16 a[136:137], v242 offset:24576
    ds_read_b64_tr_b16 a[138:139], v242 offset:26624
    v_exp_f32 v224, v224
    v_cvt_pk_bf16_f32 v188, v212, v213
    v_cvt_pk_bf16_f32 v189, v214, v215
    v_exp_f32 v225, v225
    v_add_f32 v254, v254, v212
    v_add_f32 v254, v254, v213
    v_exp_f32 v226, v226
    v_add_f32 v254, v254, v214
    v_add_f32 v254, v254, v215
    v_exp_f32 v227, v227
    v_cvt_pk_bf16_f32 v190, v224, v225
    v_cvt_pk_bf16_f32 v191, v226, v227
    ds_read_b64_tr_b16 a[140:141], v242 offset:28672
    ds_read_b64_tr_b16 a[142:143], v242 offset:30720
    v_add_f32 v254, v254, v224
    v_add_f32 v254, v254, v225
    v_add_f32 v254, v254, v226
    v_add_f32 v254, v254, v227
    v_add_f32 v194, v252, v253
    v_add_f32 v194, v194, v254
    s_mov_b32 s6, 0x4b800000
    v_cmp_nge_f32 vcc, s6, v194
    s_nop 3
    s_cbranch_vccnz L_fallback
L_fb_ret:
    s_waitcnt lgkmcnt(14)
    v_mfma_f32_16x16x32_bf16 a[200:203], a[96:99], v[0:3], 0
    v_mov_b32 v192, v252
    v_mfma_f32_16x16x32_bf16 a[200:203], a[100:103], v[12:15], a[200:203]
    s_nop 0
    v_permlane16_swap_b32 v252, v192
    v_mfma_f32_16x16x32_bf16 a[200:203], a[104:107], v[24:27], a[200:203]
    v_add_f32 v252, v252, v192
    v_mov_b32 v192, v252
    v_mfma_f32_16x16x32_bf16 a[200:203], a[108:111], v[36:39], a[200:203]
    s_nop 0
    v_permlane32_swap_b32 v252, v192
    v_mfma_f32_16x16x32_bf16 a[204:207], a[96:99], v[4:7], 0
    v_add_f32 v252, v252, v192
    v_mfma_f32_16x16x32_bf16 a[204:207], a[100:103], v[16:19], a[204:207]
    v_rcp_f32 v228, v252
    v_mfma_f32_16x16x32_bf16 a[204:207], a[104:107], v[28:31], a[204:207]
    v_mov_b32 v193, v253
    v_mfma_f32_16x16x32_bf16 a[204:207], a[108:111], v[40:43], a[204:207]
    s_nop 0
    v_permlane16_swap_b32 v253, v193
    v_mfma_f32_16x16x32_bf16 a[208:211], a[96:99], v[8:11], 0
    ds_read_b64_tr_b16 a[96:97], v243 offset:16384
    ds_read_b64_tr_b16 a[98:99], v243 offset:18432
    v_mfma_f32_16x16x32_bf16 a[208:211], a[100:103], v[20:23], a[208:211]
    ds_read_b64_tr_b16 a[100:101], v243 offset:20480
    ds_read_b64_tr_b16 a[102:103], v243 offset:22528
    v_mfma_f32_16x16x32_bf16 a[208:211], a[104:107], v[32:35], a[208:211]
    ds_read_b64_tr_b16 a[104:105], v243 offset:24576
    ds_read_b64_tr_b16 a[106:107], v243 offset:26624
    v_mfma_f32_16x16x32_bf16 a[208:211], a[108:111], v[44:47], a[208:211]
    s_waitcnt lgkmcnt(14)
    v_add_f32 v253, v253, v193
    v_mov_b32 v193, v253
    v_mfma_f32_16x16x32_bf16 a[212:215], a[112:115], v[0:3], 0
    s_nop 0
    v_permlane32_swap_b32 v253, v193
    v_mfma_f32_16x16x32_bf16 a[212:215], a[116:119], v[12:15], a[212:215]
    ds_read_b64_tr_b16 a[108:109], v243 offset:28672
    ds_read_b64_tr_b16 a[110:111], v243 offset:30720
    v_mfma_f32_16x16x32_bf16 a[212:215], a[120:123], v[24:27], a[212:215]
    v_add_u32 v240, 0x10000, v240
    v_add_u32 v241, 0x10000, v241
    v_mfma_f32_16x16x32_bf16 a[212:215], a[124:127], v[36:39], a[212:215]
    v_add_u32 v242, 0x10000, v242
    v_add_u32 v243, 0x10000, v243
    v_mfma_f32_16x16x32_bf16 a[216:219], a[112:115], v[4:7], 0
    v_add_f32 v253, v253, v193
    v_mfma_f32_16x16x32_bf16 a[216:219], a[116:119], v[16:19], a[216:219]
    v_rcp_f32 v229, v253
    v_mfma_f32_16x16x32_bf16 a[216:219], a[120:123], v[28:31], a[216:219]
    v_mov_b32 v194, v254
    v_mfma_f32_16x16x32_bf16 a[216:219], a[124:127], v[40:43], a[216:219]
    s_nop 0
    v_permlane16_swap_b32 v254, v194
    v_mfma_f32_16x16x32_bf16 a[220:223], a[112:115], v[8:11], 0
    v_add_f32 v254, v254, v194
    v_mov_b32 v194, v254
    v_mfma_f32_16x16x32_bf16 a[220:223], a[116:119], v[20:23], a[220:223]
    s_waitcnt lgkmcnt(0)
    s_barrier
    v_mfma_f32_16x16x32_bf16 a[220:223], a[120:123], v[32:35], a[220:223]
    s_mov_b32 s8, 65792
    s_add_u32 m0, s10, 16384
    ds_read_b64_tr_b16 a[112:113], v240
    ds_read_b64_tr_b16 a[114:115], v240 offset:2048
    v_mfma_f32_16x16x32_bf16 a[220:223], a[124:127], v[44:47], a[220:223]
    s_waitcnt vmcnt(3)
    buffer_load_dwordx4 v248, s[44:47], s8 offen nt lds
    v_mfma_f32_16x16x32_bf16 a[224:227], a[128:131], v[0:3], 0
    v_permlane32_swap_b32 v254, v194
    v_mfma_f32_16x16x32_bf16 a[224:227], a[132:135], v[12:15], a[224:227]
    ds_read_b64_tr_b16 a[116:117], v240 offset:4096
    ds_read_b64_tr_b16 a[118:119], v240 offset:6144
    v_mfma_f32_16x16x32_bf16 a[224:227], a[136:139], v[24:27], a[224:227]
    v_add_f32 v254, v254, v194
    v_mfma_f32_16x16x32_bf16 a[224:227], a[140:143], v[36:39], a[224:227]
    s_add_u32 m0, s10, 16384
    ds_read_b64_tr_b16 a[120:121], v240 offset:8192
    ds_read_b64_tr_b16 a[122:123], v240 offset:10240
    v_mfma_f32_16x16x32_bf16 a[228:231], a[128:131], v[4:7], 0
    s_waitcnt vmcnt(3)
    buffer_load_dwordx4 v249, s[44:47], s8 offen offset:1024 nt lds
    v_mfma_f32_16x16x32_bf16 a[228:231], a[132:135], v[16:19], a[228:231]
    v_rcp_f32 v230, v254
    v_mfma_f32_16x16x32_bf16 a[228:231], a[136:139], v[28:31], a[228:231]
    ds_read_b64_tr_b16 a[124:125], v240 offset:12288
    ds_read_b64_tr_b16 a[126:127], v240 offset:14336
    v_mfma_f32_16x16x32_bf16 a[228:231], a[140:143], v[40:43], a[228:231]
    v_accvgpr_read_b32 v232, a193
    v_accvgpr_read_b32 v235, a196
    v_mfma_f32_16x16x32_bf16 a[232:235], a[128:131], v[8:11], 0
    ds_read_b64_tr_b16 a[128:129], v241
    ds_read_b64_tr_b16 a[130:131], v241 offset:2048
    v_mfma_f32_16x16x32_bf16 a[232:235], a[132:135], v[20:23], a[232:235]
    v_accvgpr_read_b32 v231, a192
    v_accvgpr_read_b32 v239, a194
    v_mfma_f32_16x16x32_bf16 a[232:235], a[136:139], v[32:35], a[232:235]
    v_mfma_f32_16x16x32_bf16 a[232:235], a[140:143], v[44:47], a[232:235]
    ds_read_b64_tr_b16 a[132:133], v241 offset:4096
    ds_read_b64_tr_b16 a[134:135], v241 offset:6144
    v_mfma_f32_16x16x32_bf16 a[236:239], a[96:99], v[0:3], 0
    v_mfma_f32_16x16x32_bf16 a[236:239], a[100:103], v[12:15], a[236:239]
    v_mfma_f32_16x16x32_bf16 a[236:239], a[104:107], v[24:27], a[236:239]
    s_add_u32 m0, s10, 16384
    ds_read_b64_tr_b16 a[136:137], v241 offset:8192
    ds_read_b64_tr_b16 a[138:139], v241 offset:10240
    v_mfma_f32_16x16x32_bf16 a[236:239], a[108:111], v[36:39], a[236:239]
    s_waitcnt vmcnt(3)
    buffer_load_dwordx4 v250, s[44:47], s8 offen offset:2048 nt lds
    v_mfma_f32_16x16x32_bf16 a[240:243], a[96:99], v[4:7], 0
    ds_read_b64_tr_b16 a[140:141], v241 offset:12288
    ds_read_b64_tr_b16 a[142:143], v241 offset:14336
    v_mfma_f32_16x16x32_bf16 a[240:243], a[100:103], v[16:19], a[240:243]
    v_mfma_f32_16x16x32_bf16 a[240:243], a[104:107], v[28:31], a[240:243]
    v_mfma_f32_16x16x32_bf16 a[240:243], a[108:111], v[40:43], a[240:243]
    v_mfma_f32_16x16x32_bf16 a[244:247], a[96:99], v[8:11], 0
    ds_read_b64_tr_b16 a[96:97], v242
    ds_read_b64_tr_b16 a[98:99], v242 offset:2048
    v_mfma_f32_16x16x32_bf16 a[244:247], a[100:103], v[20:23], a[244:247]
    ds_read_b64_tr_b16 a[100:101], v242 offset:4096
    ds_read_b64_tr_b16 a[102:103], v242 offset:6144
    v_mfma_f32_16x16x32_bf16 a[244:247], a[104:107], v[32:35], a[244:247]
    v_mfma_f32_16x16x32_bf16 a[244:247], a[108:111], v[44:47], a[244:247]
    s_waitcnt lgkmcnt(12)
    v_mfma_f32_16x16x32_bf16 a[200:203], a[112:115], v[48:51], a[200:203]
    ds_read_b64_tr_b16 a[104:105], v242 offset:8192
    ds_read_b64_tr_b16 a[106:107], v242 offset:10240
    v_mfma_f32_16x16x32_bf16 a[200:203], a[116:119], v[60:63], a[200:203]
    v_mfma_f32_16x16x32_bf16 a[200:203], a[120:123], v[72:75], a[200:203]
    v_mfma_f32_16x16x32_bf16 a[200:203], a[124:127], v[84:87], a[200:203]
    s_add_u32 m0, s10, 16384
    ds_read_b64_tr_b16 a[108:109], v242 offset:12288
    ds_read_b64_tr_b16 a[110:111], v242 offset:14336
    v_mfma_f32_16x16x32_bf16 a[204:207], a[112:115], v[52:55], a[204:207]
    s_waitcnt vmcnt(3)
    buffer_load_dwordx4 v251, s[44:47], s8 offen offset:3072 nt lds
    v_mfma_f32_16x16x32_bf16 a[204:207], a[116:119], v[64:67], a[204:207]
    v_mfma_f32_16x16x32_bf16 a[204:207], a[120:123], v[76:79], a[204:207]
    v_mfma_f32_16x16x32_bf16 a[204:207], a[124:127], v[88:91], a[204:207]
    v_mfma_f32_16x16x32_bf16 a[208:211], a[112:115], v[56:59], a[208:211]
    ds_read_b64_tr_b16 a[112:113], v243
    ds_read_b64_tr_b16 a[114:115], v243 offset:2048
    v_mfma_f32_16x16x32_bf16 a[208:211], a[116:119], v[68:71], a[208:211]
    ds_read_b64_tr_b16 a[116:117], v243 offset:4096
    ds_read_b64_tr_b16 a[118:119], v243 offset:6144
    v_mfma_f32_16x16x32_bf16 a[208:211], a[120:123], v[80:83], a[208:211]
    ds_read_b64_tr_b16 a[120:121], v243 offset:8192
    ds_read_b64_tr_b16 a[122:123], v243 offset:10240
    v_mfma_f32_16x16x32_bf16 a[208:211], a[124:127], v[92:95], a[208:211]
    s_waitcnt lgkmcnt(14)
    v_mfma_f32_16x16x32_bf16 a[212:215], a[128:131], v[48:51], a[212:215]
    v_mfma_f32_16x16x32_bf16 a[212:215], a[132:135], v[60:63], a[212:215]
    ds_read_b64_tr_b16 a[124:125], v243 offset:12288
    ds_read_b64_tr_b16 a[126:127], v243 offset:14336
    v_mfma_f32_16x16x32_bf16 a[212:215], a[136:139], v[72:75], a[212:215]
    v_mfma_f32_16x16x32_bf16 a[212:215], a[140:143], v[84:87], a[212:215]
    v_mfma_f32_16x16x32_bf16 a[216:219], a[128:131], v[52:55], a[216:219]
    v_mfma_f32_16x16x32_bf16 a[216:219], a[132:135], v[64:67], a[216:219]
    v_mfma_f32_16x16x32_bf16 a[216:219], a[136:139], v[76:79], a[216:219]
    v_mfma_f32_16x16x32_bf16 a[216:219], a[140:143], v[88:91], a[216:219]
    v_mfma_f32_16x16x32_bf16 a[220:223], a[128:131], v[56:59], a[220:223]
    v_mfma_f32_16x16x32_bf16 a[220:223], a[132:135], v[68:71], a[220:223]
    s_waitcnt lgkmcnt(0)
    s_barrier
    v_mfma_f32_16x16x32_bf16 a[220:223], a[136:139], v[80:83], a[220:223]
    s_mov_b32 s8, 131328
    s_add_u32 m0, s10, 65536
    ds_read_b64_tr_b16 a[128:129], v240 offset:16384
    ds_read_b64_tr_b16 a[130:131], v240 offset:18432
    v_mfma_f32_16x16x32_bf16 a[220:223], a[140:143], v[92:95], a[220:223]
    s_waitcnt vmcnt(3)
    buffer_load_dwordx4 v248, s[44:47], s8 offen nt lds
    v_mfma_f32_16x16x32_bf16 a[224:227], a[96:99], v[48:51], a[224:227]
    v_mfma_f32_16x16x32_bf16 a[224:227], a[100:103], v[60:63], a[224:227]
    ds_read_b64_tr_b16 a[132:133], v240 offset:20480
    ds_read_b64_tr_b16 a[134:135], v240 offset:22528
    v_mfma_f32_16x16x32_bf16 a[224:227], a[104:107], v[72:75], a[224:227]
    v_mfma_f32_16x16x32_bf16 a[224:227], a[108:111], v[84:87], a[224:227]
    s_add_u32 m0, s10, 65536
    ds_read_b64_tr_b16 a[136:137], v240 offset:24576
    ds_read_b64_tr_b16 a[138:139], v240 offset:26624
    v_mfma_f32_16x16x32_bf16 a[228:231], a[96:99], v[52:55], a[228:231]
    s_waitcnt vmcnt(3)
    buffer_load_dwordx4 v249, s[44:47], s8 offen offset:1024 nt lds
    v_mfma_f32_16x16x32_bf16 a[228:231], a[100:103], v[64:67], a[228:231]
    v_mfma_f32_16x16x32_bf16 a[228:231], a[104:107], v[76:79], a[228:231]
    ds_read_b64_tr_b16 a[140:141], v240 offset:28672
    ds_read_b64_tr_b16 a[142:143], v240 offset:30720
    v_mfma_f32_16x16x32_bf16 a[228:231], a[108:111], v[88:91], a[228:231]
    v_mfma_f32_16x16x32_bf16 a[232:235], a[96:99], v[56:59], a[232:235]
    ds_read_b64_tr_b16 a[96:97], v241 offset:16384
    ds_read_b64_tr_b16 a[98:99], v241 offset:18432
    v_mfma_f32_16x16x32_bf16 a[232:235], a[100:103], v[68:71], a[232:235]
    v_mfma_f32_16x16x32_bf16 a[232:235], a[104:107], v[80:83], a[232:235]
    v_mfma_f32_16x16x32_bf16 a[232:235], a[108:111], v[92:95], a[232:235]
    ds_read_b64_tr_b16 a[100:101], v241 offset:20480
    ds_read_b64_tr_b16 a[102:103], v241 offset:22528
    v_mfma_f32_16x16x32_bf16 a[236:239], a[112:115], v[48:51], a[236:239]
    v_mfma_f32_16x16x32_bf16 a[236:239], a[116:119], v[60:63], a[236:239]
    v_mfma_f32_16x16x32_bf16 a[236:239], a[120:123], v[72:75], a[236:239]
    s_add_u32 m0, s10, 65536
    ds_read_b64_tr_b16 a[104:105], v241 offset:24576
    ds_read_b64_tr_b16 a[106:107], v241 offset:26624
    v_mfma_f32_16x16x32_bf16 a[236:239], a[124:127], v[84:87], a[236:239]
    s_waitcnt vmcnt(3)
    buffer_load_dwordx4 v250, s[44:47], s8 offen offset:2048 nt lds
    v_mfma_f32_16x16x32_bf16 a[240:243], a[112:115], v[52:55], a[240:243]
    ds_read_b64_tr_b16 a[108:109], v241 offset:28672
    ds_read_b64_tr_b16 a[110:111], v241 offset:30720
    v_mfma_f32_16x16x32_bf16 a[240:243], a[116:119], v[64:67], a[240:243]
    v_mfma_f32_16x16x32_bf16 a[240:243], a[120:123], v[76:79], a[240:243]
    v_mfma_f32_16x16x32_bf16 a[240:243], a[124:127], v[88:91], a[240:243]
    v_mfma_f32_16x16x32_bf16 a[244:247], a[112:115], v[56:59], a[244:247]
    ds_read_b64_tr_b16 a[112:113], v242 offset:16384
    ds_read_b64_tr_b16 a[114:115], v242 offset:18432
    v_mfma_f32_16x16x32_bf16 a[244:247], a[116:119], v[68:71], a[244:247]
    ds_read_b64_tr_b16 a[116:117], v242 offset:20480
    ds_read_b64_tr_b16 a[118:119], v242 offset:22528
    v_mfma_f32_16x16x32_bf16 a[244:247], a[120:123], v[80:83], a[244:247]
    v_mfma_f32_16x16x32_bf16 a[244:247], a[124:127], v[92:95], a[244:247]
    s_waitcnt lgkmcnt(12)
    v_mfma_f32_16x16x32_bf16 a[200:203], a[128:131], v[96:99], a[200:203]
    ds_read_b64_tr_b16 a[120:121], v242 offset:24576
    ds_read_b64_tr_b16 a[122:123], v242 offset:26624
    v_mfma_f32_16x16x32_bf16 a[200:203], a[132:135], v[108:111], a[200:203]
    v_mfma_f32_16x16x32_bf16 a[200:203], a[136:139], v[120:123], a[200:203]
    v_mfma_f32_16x16x32_bf16 a[200:203], a[140:143], v[132:135], a[200:203]
    s_add_u32 m0, s10, 65536
    ds_read_b64_tr_b16 a[124:125], v242 offset:28672
    ds_read_b64_tr_b16 a[126:127], v242 offset:30720
    v_mfma_f32_16x16x32_bf16 a[204:207], a[128:131], v[100:103], a[204:207]
    s_waitcnt vmcnt(3)
    buffer_load_dwordx4 v251, s[44:47], s8 offen offset:3072 nt lds
    v_mfma_f32_16x16x32_bf16 a[204:207], a[132:135], v[112:115], a[204:207]
    v_mfma_f32_16x16x32_bf16 a[204:207], a[136:139], v[124:127], a[204:207]
    v_mfma_f32_16x16x32_bf16 a[204:207], a[140:143], v[136:139], a[204:207]
    v_mfma_f32_16x16x32_bf16 a[208:211], a[128:131], v[104:107], a[208:211]
    ds_read_b64_tr_b16 a[128:129], v243 offset:16384
    ds_read_b64_tr_b16 a[130:131], v243 offset:18432
    v_mfma_f32_16x16x32_bf16 a[208:211], a[132:135], v[116:119], a[208:211]
    ds_read_b64_tr_b16 a[132:133], v243 offset:20480
    ds_read_b64_tr_b16 a[134:135], v243 offset:22528
    v_mfma_f32_16x16x32_bf16 a[208:211], a[136:139], v[128:131], a[208:211]
    ds_read_b64_tr_b16 a[136:137], v243 offset:24576
    ds_read_b64_tr_b16 a[138:139], v243 offset:26624
    v_mfma_f32_16x16x32_bf16 a[208:211], a[140:143], v[140:143], a[208:211]
    s_waitcnt lgkmcnt(14)
    v_mfma_f32_16x16x32_bf16 a[212:215], a[96:99], v[96:99], a[212:215]
    v_mfma_f32_16x16x32_bf16 a[212:215], a[100:103], v[108:111], a[212:215]
    ds_read_b64_tr_b16 a[140:141], v243 offset:28672
    ds_read_b64_tr_b16 a[142:143], v243 offset:30720
    v_mfma_f32_16x16x32_bf16 a[212:215], a[104:107], v[120:123], a[212:215]
    v_mfma_f32_16x16x32_bf16 a[212:215], a[108:111], v[132:135], a[212:215]
    v_mfma_f32_16x16x32_bf16 a[216:219], a[96:99], v[100:103], a[216:219]
    v_mfma_f32_16x16x32_bf16 a[216:219], a[100:103], v[112:115], a[216:219]
    v_mfma_f32_16x16x32_bf16 a[216:219], a[104:107], v[124:127], a[216:219]
    v_mfma_f32_16x16x32_bf16 a[216:219], a[108:111], v[136:139], a[216:219]
    v_mfma_f32_16x16x32_bf16 a[220:223], a[96:99], v[104:107], a[220:223]
    v_mfma_f32_16x16x32_bf16 a[220:223], a[100:103], v[116:119], a[220:223]
    s_waitcnt lgkmcnt(0)
    s_barrier
    v_mfma_f32_16x16x32_bf16 a[220:223], a[104:107], v[128:131], a[220:223]
    s_mov_b32 s8, 196864
    s_add_u32 m0, s10, 81920
    ds_read_b64_tr_b16 a[96:97], v240 offset:49152
    ds_read_b64_tr_b16 a[98:99], v240 offset:51200
    v_mfma_f32_16x16x32_bf16 a[220:223], a[108:111], v[140:143], a[220:223]
    s_waitcnt vmcnt(3)
    buffer_load_dwordx4 v248, s[44:47], s8 offen nt lds
    v_mfma_f32_16x16x32_bf16 a[224:227], a[112:115], v[96:99], a[224:227]
    v_mfma_f32_16x16x32_bf16 a[224:227], a[116:119], v[108:111], a[224:227]
    ds_read_b64_tr_b16 a[100:101], v240 offset:53248
    ds_read_b64_tr_b16 a[102:103], v240 offset:55296
    v_mfma_f32_16x16x32_bf16 a[224:227], a[120:123], v[120:123], a[224:227]
    v_mfma_f32_16x16x32_bf16 a[224:227], a[124:127], v[132:135], a[224:227]
    s_add_u32 m0, s10, 81920
    ds_read_b64_tr_b16 a[104:105], v240 offset:57344
    ds_read_b64_tr_b16 a[106:107], v240 offset:59392
    v_mfma_f32_16x16x32_bf16 a[228:231], a[112:115], v[100:103], a[228:231]
    s_waitcnt vmcnt(3)
    buffer_load_dwordx4 v249, s[44:47], s8 offen offset:1024 nt lds
    v_mfma_f32_16x16x32_bf16 a[228:231], a[116:119], v[112:115], a[228:231]
    v_mfma_f32_16x16x32_bf16 a[228:231], a[120:123], v[124:127], a[228:231]
    ds_read_b64_tr_b16 a[108:109], v240 offset:61440
    ds_read_b64_tr_b16 a[110:111], v240 offset:63488
    v_mfma_f32_16x16x32_bf16 a[228:231], a[124:127], v[136:139], a[228:231]
    v_mfma_f32_16x16x32_bf16 a[232:235], a[112:115], v[104:107], a[232:235]
    ds_read_b64_tr_b16 a[112:113], v241 offset:49152
    ds_read_b64_tr_b16 a[114:115], v241 offset:51200
    v_mfma_f32_16x16x32_bf16 a[232:235], a[116:119], v[116:119], a[232:235]
    v_mfma_f32_16x16x32_bf16 a[232:235], a[120:123], v[128:131], a[232:235]
    v_mfma_f32_16x16x32_bf16 a[232:235], a[124:127], v[140:143], a[232:235]
    ds_read_b64_tr_b16 a[116:117], v241 offset:53248
    ds_read_b64_tr_b16 a[118:119], v241 offset:55296
    v_mfma_f32_16x16x32_bf16 a[236:239], a[128:131], v[96:99], a[236:239]
    v_mfma_f32_16x16x32_bf16 a[236:239], a[132:135], v[108:111], a[236:239]
    v_mfma_f32_16x16x32_bf16 a[236:239], a[136:139], v[120:123], a[236:239]
    s_add_u32 m0, s10, 81920
    ds_read_b64_tr_b16 a[120:121], v241 offset:57344
    ds_read_b64_tr_b16 a[122:123], v241 offset:59392
    v_mfma_f32_16x16x32_bf16 a[236:239], a[140:143], v[132:135], a[236:239]
    s_waitcnt vmcnt(3)
    buffer_load_dwordx4 v250, s[44:47], s8 offen offset:2048 nt lds
    v_mfma_f32_16x16x32_bf16 a[240:243], a[128:131], v[100:103], a[240:243]
    ds_read_b64_tr_b16 a[124:125], v241 offset:61440
    ds_read_b64_tr_b16 a[126:127], v241 offset:63488
    v_mfma_f32_16x16x32_bf16 a[240:243], a[132:135], v[112:115], a[240:243]
    v_mfma_f32_16x16x32_bf16 a[240:243], a[136:139], v[124:127], a[240:243]
    v_mfma_f32_16x16x32_bf16 a[240:243], a[140:143], v[136:139], a[240:243]
    v_mfma_f32_16x16x32_bf16 a[244:247], a[128:131], v[104:107], a[244:247]
    ds_read_b64_tr_b16 a[128:129], v242 offset:49152
    ds_read_b64_tr_b16 a[130:131], v242 offset:51200
    v_mfma_f32_16x16x32_bf16 a[244:247], a[132:135], v[116:119], a[244:247]
    ds_read_b64_tr_b16 a[132:133], v242 offset:53248
    ds_read_b64_tr_b16 a[134:135], v242 offset:55296
    v_mfma_f32_16x16x32_bf16 a[244:247], a[136:139], v[128:131], a[244:247]
    v_mfma_f32_16x16x32_bf16 a[244:247], a[140:143], v[140:143], a[244:247]
    s_waitcnt lgkmcnt(12)
    v_mfma_f32_16x16x32_bf16 a[200:203], a[96:99], v[144:147], a[200:203]
    ds_read_b64_tr_b16 a[136:137], v242 offset:57344
    ds_read_b64_tr_b16 a[138:139], v242 offset:59392
    v_mfma_f32_16x16x32_bf16 a[200:203], a[100:103], v[156:159], a[200:203]
    v_mfma_f32_16x16x32_bf16 a[200:203], a[104:107], v[168:171], a[200:203]
    v_mfma_f32_16x16x32_bf16 a[200:203], a[108:111], v[180:183], a[200:203]
    s_add_u32 m0, s10, 81920
    ds_read_b64_tr_b16 a[140:141], v242 offset:61440
    ds_read_b64_tr_b16 a[142:143], v242 offset:63488
    v_mfma_f32_16x16x32_bf16 a[204:207], a[96:99], v[148:151], a[204:207]
    s_waitcnt vmcnt(3)
    buffer_load_dwordx4 v251, s[44:47], s8 offen offset:3072 nt lds
    v_mfma_f32_16x16x32_bf16 a[204:207], a[100:103], v[160:163], a[204:207]
    v_mfma_f32_16x16x32_bf16 a[204:207], a[104:107], v[172:175], a[204:207]
    v_mfma_f32_16x16x32_bf16 a[204:207], a[108:111], v[184:187], a[204:207]
    v_mfma_f32_16x16x32_bf16 a[208:211], a[96:99], v[152:155], a[208:211]
    ds_read_b64_tr_b16 a[96:97], v243 offset:49152
    ds_read_b64_tr_b16 a[98:99], v243 offset:51200
    v_mfma_f32_16x16x32_bf16 a[208:211], a[100:103], v[164:167], a[208:211]
    ds_read_b64_tr_b16 a[100:101], v243 offset:53248
    ds_read_b64_tr_b16 a[102:103], v243 offset:55296
    v_mfma_f32_16x16x32_bf16 a[208:211], a[104:107], v[176:179], a[208:211]
    ds_read_b64_tr_b16 a[104:105], v243 offset:57344
    ds_read_b64_tr_b16 a[106:107], v243 offset:59392
    v_mfma_f32_16x16x32_bf16 a[208:211], a[108:111], v[188:191], a[208:211]
    s_waitcnt lgkmcnt(14)
    v_mfma_f32_16x16x32_bf16 a[212:215], a[112:115], v[144:147], a[212:215]
    v_mfma_f32_16x16x32_bf16 a[212:215], a[116:119], v[156:159], a[212:215]
    ds_read_b64_tr_b16 a[108:109], v243 offset:61440
    ds_read_b64_tr_b16 a[110:111], v243 offset:63488
    v_mfma_f32_16x16x32_bf16 a[212:215], a[120:123], v[168:171], a[212:215]
    v_add_u32 v240, 0x10000, v240
    v_add_u32 v241, 0x10000, v241
    v_mfma_f32_16x16x32_bf16 a[212:215], a[124:127], v[180:183], a[212:215]
    s_add_u32 s9, s82, 0
    s_add_u32 m0, s10, 147456
    v_add_u32 v242, 0x10000, v242
    v_add_u32 v243, 0x10000, v243
    v_mfma_f32_16x16x32_bf16 a[216:219], a[112:115], v[148:151], a[216:219]
    buffer_load_dwordx4 v244, s[48:51], s9 offen lds
    v_mfma_f32_16x16x32_bf16 a[216:219], a[116:119], v[160:163], a[216:219]
    v_mfma_f32_16x16x32_bf16 a[216:219], a[120:123], v[172:175], a[216:219]
    s_add_u32 m0, s10, 147456
    v_mfma_f32_16x16x32_bf16 a[216:219], a[124:127], v[184:187], a[216:219]
    buffer_load_dwordx4 v245, s[48:51], s9 offen offset:1024 lds
    v_mfma_f32_16x16x32_bf16 a[220:223], a[112:115], v[152:155], a[220:223]
    v_mfma_f32_16x16x32_bf16 a[220:223], a[116:119], v[164:167], a[220:223]
    s_waitcnt lgkmcnt(0)
    s_barrier
    v_mfma_f32_16x16x32_bf16 a[220:223], a[120:123], v[176:179], a[220:223]
    s_mov_b32 s8, 384
    s_add_u32 m0, s10, 114688
    ds_read_b64_tr_b16 a[112:113], v240
    ds_read_b64_tr_b16 a[114:115], v240 offset:2048
    v_mfma_f32_16x16x32_bf16 a[220:223], a[124:127], v[188:191], a[220:223]
    s_waitcnt vmcnt(5)
    buffer_load_dwordx4 v248, s[44:47], s8 offen nt lds
    v_mfma_f32_16x16x32_bf16 a[224:227], a[128:131], v[144:147], a[224:227]
    v_mfma_f32_16x16x32_bf16 a[224:227], a[132:135], v[156:159], a[224:227]
    ds_read_b64_tr_b16 a[116:117], v240 offset:4096
    ds_read_b64_tr_b16 a[118:119], v240 offset:6144
    v_mfma_f32_16x16x32_bf16 a[224:227], a[136:139], v[168:171], a[224:227]
    v_mfma_f32_16x16x32_bf16 a[224:227], a[140:143], v[180:183], a[224:227]
    s_add_u32 m0, s10, 114688
    ds_read_b64_tr_b16 a[120:121], v240 offset:8192
    ds_read_b64_tr_b16 a[122:123], v240 offset:10240
    v_mfma_f32_16x16x32_bf16 a[228:231], a[128:131], v[148:151], a[228:231]
    s_waitcnt vmcnt(5)
    buffer_load_dwordx4 v249, s[44:47], s8 offen offset:1024 nt lds
    v_mfma_f32_16x16x32_bf16 a[228:231], a[132:135], v[160:163], a[228:231]
    v_mfma_f32_16x16x32_bf16 a[228:231], a[136:139], v[172:175], a[228:231]
    s_add_u32 m0, s10, 147456
    ds_read_b64_tr_b16 a[124:125], v240 offset:12288
    ds_read_b64_tr_b16 a[126:127], v240 offset:14336
    v_mfma_f32_16x16x32_bf16 a[228:231], a[140:143], v[184:187], a[228:231]
    buffer_load_dwordx4 v246, s[48:51], s9 offen offset:2048 lds
    v_mfma_f32_16x16x32_bf16 a[232:235], a[128:131], v[152:155], a[232:235]
    ds_read_b64_tr_b16 a[128:129], v241
    ds_read_b64_tr_b16 a[130:131], v241 offset:2048
    v_mfma_f32_16x16x32_bf16 a[232:235], a[132:135], v[164:167], a[232:235]
    v_mfma_f32_16x16x32_bf16 a[232:235], a[136:139], v[176:179], a[232:235]
    v_mfma_f32_16x16x32_bf16 a[232:235], a[140:143], v[188:191], a[232:235]
    ds_read_b64_tr_b16 a[132:133], v241 offset:4096
    ds_read_b64_tr_b16 a[134:135], v241 offset:6144
    v_mfma_f32_16x16x32_bf16 a[236:239], a[96:99], v[144:147], a[236:239]
    s_add_u32 m0, s10, 147456
    v_mfma_f32_16x16x32_bf16 a[236:239], a[100:103], v[156:159], a[236:239]
    buffer_load_dwordx4 v247, s[48:51], s9 offen offset:3072 lds
    v_mfma_f32_16x16x32_bf16 a[236:239], a[104:107], v[168:171], a[236:239]
    s_add_u32 m0, s10, 114688
    ds_read_b64_tr_b16 a[136:137], v241 offset:8192
    ds_read_b64_tr_b16 a[138:139], v241 offset:10240
    v_mfma_f32_16x16x32_bf16 a[236:239], a[108:111], v[180:183], a[236:239]
    s_waitcnt vmcnt(7)
    buffer_load_dwordx4 v250, s[44:47], s8 offen offset:2048 nt lds
    v_mfma_f32_16x16x32_bf16 a[240:243], a[96:99], v[148:151], a[240:243]
    ds_read_b64_tr_b16 a[140:141], v241 offset:12288
    ds_read_b64_tr_b16 a[142:143], v241 offset:14336
    v_mfma_f32_16x16x32_bf16 a[240:243], a[100:103], v[160:163], a[240:243]
    v_mfma_f32_16x16x32_bf16 a[240:243], a[104:107], v[172:175], a[240:243]
    v_mfma_f32_16x16x32_bf16 a[240:243], a[108:111], v[184:187], a[240:243]
    v_mfma_f32_16x16x32_bf16 a[244:247], a[96:99], v[152:155], a[244:247]
    ds_read_b64_tr_b16 a[96:97], v242
    ds_read_b64_tr_b16 a[98:99], v242 offset:2048
    v_mfma_f32_16x16x32_bf16 a[244:247], a[100:103], v[164:167], a[244:247]
    ds_read_b64_tr_b16 a[100:101], v242 offset:4096
    ds_read_b64_tr_b16 a[102:103], v242 offset:6144
    v_mfma_f32_16x16x32_bf16 a[244:247], a[104:107], v[176:179], a[244:247]
    v_mfma_f32_16x16x32_bf16 a[244:247], a[108:111], v[188:191], a[244:247]
    s_waitcnt lgkmcnt(12)
    v_mfma_f32_16x16x32_bf16 a[0:3], a[112:115], v[0:3], 0
    ds_read_b64_tr_b16 a[104:105], v242 offset:8192
    ds_read_b64_tr_b16 a[106:107], v242 offset:10240
    v_mfma_f32_16x16x32_bf16 a[0:3], a[116:119], v[12:15], a[0:3]
    v_mfma_f32_16x16x32_bf16 a[0:3], a[120:123], v[24:27], a[0:3]
    v_mfma_f32_16x16x32_bf16 a[0:3], a[124:127], v[36:39], a[0:3]
    s_add_u32 m0, s10, 114688
    ds_read_b64_tr_b16 a[108:109], v242 offset:12288
    ds_read_b64_tr_b16 a[110:111], v242 offset:14336
    v_mfma_f32_16x16x32_bf16 a[4:7], a[112:115], v[4:7], 0
    s_waitcnt vmcnt(7)
    buffer_load_dwordx4 v251, s[44:47], s8 offen offset:3072 nt lds
    v_accvgpr_read_b32 v216, a200
    v_mfma_f32_16x16x32_bf16 a[4:7], a[116:119], v[16:19], a[4:7]
    v_accvgpr_read_b32 v217, a201
    v_accvgpr_read_b32 v218, a202
    v_mfma_f32_16x16x32_bf16 a[4:7], a[120:123], v[28:31], a[4:7]
    v_accvgpr_read_b32 v219, a203
    v_mul_f32 v216, v216, v228
    v_mfma_f32_16x16x32_bf16 a[4:7], a[124:127], v[40:43], a[4:7]
    v_mul_f32 v217, v217, v228
    v_mul_f32 v218, v218, v228
    v_mfma_f32_16x16x32_bf16 a[8:11], a[112:115], v[8:11], 0
    ds_read_b64_tr_b16 a[112:113], v243
    ds_read_b64_tr_b16 a[114:115], v243 offset:2048
    v_mfma_f32_16x16x32_bf16 a[8:11], a[116:119], v[20:23], a[8:11]
    ds_read_b64_tr_b16 a[116:117], v243 offset:4096
    ds_read_b64_tr_b16 a[118:119], v243 offset:6144
    v_mfma_f32_16x16x32_bf16 a[8:11], a[120:123], v[32:35], a[8:11]
    ds_read_b64_tr_b16 a[120:121], v243 offset:8192
    ds_read_b64_tr_b16 a[122:123], v243 offset:10240
    v_mfma_f32_16x16x32_bf16 a[8:11], a[124:127], v[44:47], a[8:11]
    s_waitcnt lgkmcnt(14)
    v_mul_f32 v219, v219, v228
    v_cvt_pk_bf16_f32 v192, v216, v217
    v_mfma_f32_16x16x32_bf16 a[12:15], a[128:131], v[0:3], 0
    v_cvt_pk_bf16_f32 v193, v218, v219
    v_accvgpr_read_b32 v220, a212
    v_mfma_f32_16x16x32_bf16 a[12:15], a[132:135], v[12:15], a[12:15]
    ds_read_b64_tr_b16 a[124:125], v243 offset:12288
    ds_read_b64_tr_b16 a[126:127], v243 offset:14336
    v_mfma_f32_16x16x32_bf16 a[12:15], a[136:139], v[24:27], a[12:15]
    v_add_u32 v240, 0xfffe0000, v240
    v_add_u32 v241, 0xfffe0000, v241
    v_mfma_f32_16x16x32_bf16 a[12:15], a[140:143], v[36:39], a[12:15]
    v_add_u32 v242, 0xfffe0000, v242
    v_add_u32 v243, 0xfffe0000, v243
    v_mfma_f32_16x16x32_bf16 a[16:19], a[128:131], v[4:7], 0
    v_accvgpr_read_b32 v221, a213
    v_accvgpr_read_b32 v222, a214
    v_mfma_f32_16x16x32_bf16 a[16:19], a[132:135], v[16:19], a[16:19]
    v_accvgpr_read_b32 v223, a215
    v_mul_f32 v220, v220, v228
    v_mfma_f32_16x16x32_bf16 a[16:19], a[136:139], v[28:31], a[16:19]
    v_mul_f32 v221, v221, v228
    v_mul_f32 v222, v222, v228
    v_mfma_f32_16x16x32_bf16 a[16:19], a[140:143], v[40:43], a[16:19]
    v_mul_f32 v223, v223, v228
    v_cvt_pk_bf16_f32 v194, v220, v221
    v_mfma_f32_16x16x32_bf16 a[20:23], a[128:131], v[8:11], 0
    v_cvt_pk_bf16_f32 v195, v222, v223
    v_mfma_f32_16x16x32_bf16 a[20:23], a[132:135], v[20:23], a[20:23]
    s_waitcnt lgkmcnt(0)
    s_barrier
    v_accvgpr_read_b32 v224, a204
    v_mfma_f32_16x16x32_bf16 a[20:23], a[136:139], v[32:35], a[20:23]
    s_mov_b32 s8, 65920
    s_add_u32 m0, s10, 131072
    ds_read_b64_tr_b16 a[128:129], v240 offset:32768
    ds_read_b64_tr_b16 a[130:131], v240 offset:34816
    v_mfma_f32_16x16x32_bf16 a[20:23], a[140:143], v[44:47], a[20:23]
    s_waitcnt vmcnt(5)
    buffer_load_dwordx4 v248, s[44:47], s8 offen nt lds
    v_accvgpr_read_b32 v225, a205
    v_mfma_f32_16x16x32_bf16 a[24:27], a[96:99], v[0:3], 0
    v_accvgpr_read_b32 v226, a206
    v_accvgpr_read_b32 v227, a207
    v_mfma_f32_16x16x32_bf16 a[24:27], a[100:103], v[12:15], a[24:27]
    ds_read_b64_tr_b16 a[132:133], v240 offset:36864
    ds_read_b64_tr_b16 a[134:135], v240 offset:38912
    v_mfma_f32_16x16x32_bf16 a[24:27], a[104:107], v[24:27], a[24:27]
    v_mul_f32 v224, v224, v229
    v_mul_f32 v225, v225, v229
    v_mfma_f32_16x16x32_bf16 a[24:27], a[108:111], v[36:39], a[24:27]
    ds_read_b64_tr_b16 a[136:137], v240 offset:40960
    ds_read_b64_tr_b16 a[138:139], v240 offset:43008
    v_mfma_f32_16x16x32_bf16 a[28:31], a[96:99], v[4:7], 0
    s_add_u32 s73, s77, 0
    buffer_store_dwordx4 v[192:195], v239, s[52:55], s73 offen sc1
    v_mul_f32 v226, v226, v229
    v_mfma_f32_16x16x32_bf16 a[28:31], a[100:103], v[16:19], a[28:31]
    v_mul_f32 v227, v227, v229
    v_cvt_pk_bf16_f32 v196, v224, v225
    v_mfma_f32_16x16x32_bf16 a[28:31], a[104:107], v[28:31], a[28:31]
    s_add_u32 m0, s10, 131072
    ds_read_b64_tr_b16 a[140:141], v240 offset:45056
    ds_read_b64_tr_b16 a[142:143], v240 offset:47104
    v_mfma_f32_16x16x32_bf16 a[28:31], a[108:111], v[40:43], a[28:31]
    s_waitcnt vmcnt(6)
    buffer_load_dwordx4 v249, s[44:47], s8 offen offset:1024 nt lds
    v_cvt_pk_bf16_f32 v197, v226, v227
    v_mfma_f32_16x16x32_bf16 a[32:35], a[96:99], v[8:11], 0
    ds_read_b64_tr_b16 a[96:97], v241 offset:32768
    ds_read_b64_tr_b16 a[98:99], v241 offset:34816
    v_mfma_f32_16x16x32_bf16 a[32:35], a[100:103], v[20:23], a[32:35]
    v_accvgpr_read_b32 v216, a216
    v_accvgpr_read_b32 v217, a217
    v_mfma_f32_16x16x32_bf16 a[32:35], a[104:107], v[32:35], a[32:35]
    v_accvgpr_read_b32 v218, a218
    v_accvgpr_read_b32 v219, a219
    v_mfma_f32_16x16x32_bf16 a[32:35], a[108:111], v[44:47], a[32:35]
    ds_read_b64_tr_b16 a[100:101], v241 offset:36864
    ds_read_b64_tr_b16 a[102:103], v241 offset:38912
    v_mfma_f32_16x16x32_bf16 a[36:39], a[112:115], v[0:3], 0
    v_mul_f32 v216, v216, v229
    v_mul_f32 v217, v217, v229
    v_mfma_f32_16x16x32_bf16 a[36:39], a[116:119], v[12:15], a[36:39]
    v_mul_f32 v218, v218, v229
    v_mul_f32 v219, v219, v229
    v_mfma_f32_16x16x32_bf16 a[36:39], a[120:123], v[24:27], a[36:39]
    s_add_u32 m0, s10, 131072
    ds_read_b64_tr_b16 a[104:105], v241 offset:40960
    ds_read_b64_tr_b16 a[106:107], v241 offset:43008
    v_mfma_f32_16x16x32_bf16 a[36:39], a[124:127], v[36:39], a[36:39]
    s_waitcnt vmcnt(4)
    buffer_load_dwordx4 v250, s[44:47], s8 offen offset:2048 nt lds
    v_cvt_pk_bf16_f32 v198, v216, v217
    v_mfma_f32_16x16x32_bf16 a[40:43], a[112:115], v[4:7], 0
    ds_read_b64_tr_b16 a[108:109], v241 offset:45056
    ds_read_b64_tr_b16 a[110:111], v241 offset:47104
    v_mfma_f32_16x16x32_bf16 a[40:43], a[116:119], v[16:19], a[40:43]
    v_cvt_pk_bf16_f32 v199, v218, v219
    v_mfma_f32_16x16x32_bf16 a[40:43], a[120:123], v[28:31], a[40:43]
    v_accvgpr_read_b32 v220, a208
    v_accvgpr_read_b32 v221, a209
    v_mfma_f32_16x16x32_bf16 a[40:43], a[124:127], v[40:43], a[40:43]
    v_accvgpr_read_b32 v222, a210
    v_accvgpr_read_b32 v223, a211
    v_mfma_f32_16x16x32_bf16 a[44:47], a[112:115], v[8:11], 0
    ds_read_b64_tr_b16 a[112:113], v242 offset:32768
    ds_read_b64_tr_b16 a[114:115], v242 offset:34816
    v_mfma_f32_16x16x32_bf16 a[44:47], a[116:119], v[20:23], a[44:47]
    ds_read_b64_tr_b16 a[116:117], v242 offset:36864
    ds_read_b64_tr_b16 a[118:119], v242 offset:38912
    v_mfma_f32_16x16x32_bf16 a[44:47], a[120:123], v[32:35], a[44:47]
    s_add_u32 s73, s77, 0
    buffer_store_dwordx4 v[196:199], v239, s[52:55], s73 offen offset:1024 sc1
    v_mul_f32 v220, v220, v230
    v_mfma_f32_16x16x32_bf16 a[44:47], a[124:127], v[44:47], a[44:47]
    s_waitcnt lgkmcnt(12)
    v_mul_f32 v221, v221, v230
    v_mul_f32 v222, v222, v230
    v_mfma_f32_16x16x32_bf16 a[0:3], a[128:131], v[48:51], a[0:3]
    ds_read_b64_tr_b16 a[120:121], v242 offset:40960
    ds_read_b64_tr_b16 a[122:123], v242 offset:43008
    v_mfma_f32_16x16x32_bf16 a[0:3], a[132:135], v[60:63], a[0:3]
    v_mul_f32 v223, v223, v230
    v_cvt_pk_bf16_f32 v200, v220, v221
    v_mfma_f32_16x16x32_bf16 a[0:3], a[136:139], v[72:75], a[0:3]
    v_cvt_pk_bf16_f32 v201, v222, v223
    v_accvgpr_read_b32 v224, a220
    v_mfma_f32_16x16x32_bf16 a[0:3], a[140:143], v[84:87], a[0:3]
    s_add_u32 m0, s10, 131072
    ds_read_b64_tr_b16 a[124:125], v242 offset:45056
    ds_read_b64_tr_b16 a[126:127], v242 offset:47104
    v_mfma_f32_16x16x32_bf16 a[4:7], a[128:131], v[52:55], a[4:7]
    s_waitcnt vmcnt(5)
    buffer_load_dwordx4 v251, s[44:47], s8 offen offset:3072 nt lds
    v_accvgpr_read_b32 v225, a221
    v_mfma_f32_16x16x32_bf16 a[4:7], a[132:135], v[64:67], a[4:7]
    v_accvgpr_read_b32 v226, a222
    v_accvgpr_read_b32 v227, a223
    v_mfma_f32_16x16x32_bf16 a[4:7], a[136:139], v[76:79], a[4:7]
    v_mul_f32 v224, v224, v230
    v_mul_f32 v225, v225, v230
    v_mfma_f32_16x16x32_bf16 a[4:7], a[140:143], v[88:91], a[4:7]
    v_mul_f32 v226, v226, v230
    v_mul_f32 v227, v227, v230
    v_mfma_f32_16x16x32_bf16 a[8:11], a[128:131], v[56:59], a[8:11]
    ds_read_b64_tr_b16 a[128:129], v243 offset:32768
    ds_read_b64_tr_b16 a[130:131], v243 offset:34816
    v_mfma_f32_16x16x32_bf16 a[8:11], a[132:135], v[68:71], a[8:11]
    ds_read_b64_tr_b16 a[132:133], v243 offset:36864
    ds_read_b64_tr_b16 a[134:135], v243 offset:38912
    v_mfma_f32_16x16x32_bf16 a[8:11], a[136:139], v[80:83], a[8:11]
    ds_read_b64_tr_b16 a[136:137], v243 offset:40960
    ds_read_b64_tr_b16 a[138:139], v243 offset:43008
    v_mfma_f32_16x16x32_bf16 a[8:11], a[140:143], v[92:95], a[8:11]
    s_waitcnt lgkmcnt(14)
    v_cvt_pk_bf16_f32 v202, v224, v225
    v_cvt_pk_bf16_f32 v203, v226, v227
    v_mfma_f32_16x16x32_bf16 a[12:15], a[96:99], v[48:51], a[12:15]
    v_accvgpr_read_b32 v216, a224
    v_accvgpr_read_b32 v217, a225
    v_mfma_f32_16x16x32_bf16 a[12:15], a[100:103], v[60:63], a[12:15]
    ds_read_b64_tr_b16 a[140:141], v243 offset:45056
    ds_read_b64_tr_b16 a[142:143], v243 offset:47104
    v_mfma_f32_16x16x32_bf16 a[12:15], a[104:107], v[72:75], a[12:15]
    v_add_u32 v240, 0x10000, v240
    v_add_u32 v241, 0x10000, v241
    v_mfma_f32_16x16x32_bf16 a[12:15], a[108:111], v[84:87], a[12:15]
    v_add_u32 v242, 0x10000, v242
    v_add_u32 v243, 0x10000, v243
    v_mfma_f32_16x16x32_bf16 a[16:19], a[96:99], v[52:55], a[16:19]
    v_accvgpr_read_b32 v218, a226
    v_accvgpr_read_b32 v219, a227
    v_mfma_f32_16x16x32_bf16 a[16:19], a[100:103], v[64:67], a[16:19]
    s_add_u32 s73, s77, 0
    buffer_store_dwordx4 v[200:203], v239, s[52:55], s73 offen offset:2048 sc1
    v_mul_f32 v216, v216, v228
    v_mfma_f32_16x16x32_bf16 a[16:19], a[104:107], v[76:79], a[16:19]
    v_mul_f32 v217, v217, v228
    v_mul_f32 v218, v218, v228
    v_mfma_f32_16x16x32_bf16 a[16:19], a[108:111], v[88:91], a[16:19]
    v_mul_f32 v219, v219, v228
    v_cvt_pk_bf16_f32 v204, v216, v217
    v_mfma_f32_16x16x32_bf16 a[20:23], a[96:99], v[56:59], a[20:23]
    v_cvt_pk_bf16_f32 v205, v218, v219
    v_accvgpr_read_b32 v220, a236
    v_mfma_f32_16x16x32_bf16 a[20:23], a[100:103], v[68:71], a[20:23]
    s_waitcnt lgkmcnt(0)
    s_barrier
    v_accvgpr_read_b32 v221, a237
    v_mfma_f32_16x16x32_bf16 a[20:23], a[104:107], v[80:83], a[20:23]
    s_mov_b32 s8, 131456
    s_add_u32 m0, s10, 32768
    ds_read_b64_tr_b16 a[96:97], v240 offset:32768
    ds_read_b64_tr_b16 a[98:99], v240 offset:34816
    v_mfma_f32_16x16x32_bf16 a[20:23], a[108:111], v[92:95], a[20:23]
    s_waitcnt vmcnt(6)
    buffer_load_dwordx4 v248, s[44:47], s8 offen nt lds
    v_accvgpr_read_b32 v222, a238
    v_mfma_f32_16x16x32_bf16 a[24:27], a[112:115], v[48:51], a[24:27]
    v_accvgpr_read_b32 v223, a239
    v_mul_f32 v220, v220, v228
    v_mfma_f32_16x16x32_bf16 a[24:27], a[116:119], v[60:63], a[24:27]
    ds_read_b64_tr_b16 a[100:101], v240 offset:36864
    ds_read_b64_tr_b16 a[102:103], v240 offset:38912
    v_mfma_f32_16x16x32_bf16 a[24:27], a[120:123], v[72:75], a[24:27]
    v_mul_f32 v221, v221, v228
    v_mul_f32 v222, v222, v228
    v_mfma_f32_16x16x32_bf16 a[24:27], a[124:127], v[84:87], a[24:27]
    s_add_u32 m0, s10, 32768
    ds_read_b64_tr_b16 a[104:105], v240 offset:40960
    ds_read_b64_tr_b16 a[106:107], v240 offset:43008
    v_mfma_f32_16x16x32_bf16 a[28:31], a[112:115], v[52:55], a[28:31]
    s_waitcnt vmcnt(5)
    buffer_load_dwordx4 v249, s[44:47], s8 offen offset:1024 nt lds
    v_mul_f32 v223, v223, v228
    v_mfma_f32_16x16x32_bf16 a[28:31], a[116:119], v[64:67], a[28:31]
    v_cvt_pk_bf16_f32 v206, v220, v221
    v_cvt_pk_bf16_f32 v207, v222, v223
    v_mfma_f32_16x16x32_bf16 a[28:31], a[120:123], v[76:79], a[28:31]
    ds_read_b64_tr_b16 a[108:109], v240 offset:45056
    ds_read_b64_tr_b16 a[110:111], v240 offset:47104
    v_mfma_f32_16x16x32_bf16 a[28:31], a[124:127], v[88:91], a[28:31]
    v_accvgpr_read_b32 v224, a228
    v_accvgpr_read_b32 v225, a229
    v_mfma_f32_16x16x32_bf16 a[32:35], a[112:115], v[56:59], a[32:35]
    ds_read_b64_tr_b16 a[112:113], v241 offset:32768
    ds_read_b64_tr_b16 a[114:115], v241 offset:34816
    v_mfma_f32_16x16x32_bf16 a[32:35], a[116:119], v[68:71], a[32:35]
    v_accvgpr_read_b32 v226, a230
    v_accvgpr_read_b32 v227, a231
    v_mfma_f32_16x16x32_bf16 a[32:35], a[120:123], v[80:83], a[32:35]
    v_mul_f32 v224, v224, v229
    v_mul_f32 v225, v225, v229
    v_mfma_f32_16x16x32_bf16 a[32:35], a[124:127], v[92:95], a[32:35]
    ds_read_b64_tr_b16 a[116:117], v241 offset:36864
    ds_read_b64_tr_b16 a[118:119], v241 offset:38912
    v_mfma_f32_16x16x32_bf16 a[36:39], a[128:131], v[48:51], a[36:39]
    v_mul_f32 v226, v226, v229
    v_mul_f32 v227, v227, v229
    v_mfma_f32_16x16x32_bf16 a[36:39], a[132:135], v[60:63], a[36:39]
    v_cvt_pk_bf16_f32 v208, v224, v225
    v_cvt_pk_bf16_f32 v209, v226, v227
    v_mfma_f32_16x16x32_bf16 a[36:39], a[136:139], v[72:75], a[36:39]
    s_add_u32 m0, s10, 32768
    ds_read_b64_tr_b16 a[120:121], v241 offset:40960
    ds_read_b64_tr_b16 a[122:123], v241 offset:43008
    v_mfma_f32_16x16x32_bf16 a[36:39], a[140:143], v[84:87], a[36:39]
    s_waitcnt vmcnt(5)
    buffer_load_dwordx4 v250, s[44:47], s8 offen offset:2048 nt lds
    v_accvgpr_read_b32 v216, a240
    v_mfma_f32_16x16x32_bf16 a[40:43], a[128:131], v[52:55], a[40:43]
    ds_read_b64_tr_b16 a[124:125], v241 offset:45056
    ds_read_b64_tr_b16 a[126:127], v241 offset:47104
    v_mfma_f32_16x16x32_bf16 a[40:43], a[132:135], v[64:67], a[40:43]
    v_accvgpr_read_b32 v217, a241
    v_accvgpr_read_b32 v218, a242
    v_mfma_f32_16x16x32_bf16 a[40:43], a[136:139], v[76:79], a[40:43]
    v_accvgpr_read_b32 v219, a243
    v_mul_f32 v216, v216, v229
    v_mfma_f32_16x16x32_bf16 a[40:43], a[140:143], v[88:91], a[40:43]
    v_mul_f32 v217, v217, v229
    v_mul_f32 v218, v218, v229
    v_mfma_f32_16x16x32_bf16 a[44:47], a[128:131], v[56:59], a[44:47]
    ds_read_b64_tr_b16 a[128:129], v242 offset:32768
    ds_read_b64_tr_b16 a[130:131], v242 offset:34816
    v_mfma_f32_16x16x32_bf16 a[44:47], a[132:135], v[68:71], a[44:47]
    ds_read_b64_tr_b16 a[132:133], v242 offset:36864
    ds_read_b64_tr_b16 a[134:135], v242 offset:38912
    v_mfma_f32_16x16x32_bf16 a[44:47], a[136:139], v[80:83], a[44:47]
    s_add_u32 s73, s77, 3072
    buffer_store_dwordx4 v[204:207], v239, s[52:55], s73 offen sc1
    v_mul_f32 v219, v219, v229
    v_mfma_f32_16x16x32_bf16 a[44:47], a[140:143], v[92:95], a[44:47]
    s_waitcnt lgkmcnt(12)
    v_cvt_pk_bf16_f32 v210, v216, v217
    v_cvt_pk_bf16_f32 v211, v218, v219
    v_mfma_f32_16x16x32_bf16 a[0:3], a[96:99], v[96:99], a[0:3]
    ds_read_b64_tr_b16 a[136:137], v242 offset:40960
    ds_read_b64_tr_b16 a[138:139], v242 offset:43008
    v_mfma_f32_16x16x32_bf16 a[0:3], a[100:103], v[108:111], a[0:3]
    v_accvgpr_read_b32 v220, a232
    v_accvgpr_read_b32 v221, a233
    v_mfma_f32_16x16x32_bf16 a[0:3], a[104:107], v[120:123], a[0:3]
    v_accvgpr_read_b32 v222, a234
    v_accvgpr_read_b32 v223, a235
    v_mfma_f32_16x16x32_bf16 a[0:3], a[108:111], v[132:135], a[0:3]
    s_add_u32 m0, s10, 32768
    ds_read_b64_tr_b16 a[140:141], v242 offset:45056
    ds_read_b64_tr_b16 a[142:143], v242 offset:47104
    v_mfma_f32_16x16x32_bf16 a[4:7], a[96:99], v[100:103], a[4:7]
    s_waitcnt vmcnt(5)
    buffer_load_dwordx4 v251, s[44:47], s8 offen offset:3072 nt lds
    v_mul_f32 v220, v220, v230
    v_mfma_f32_16x16x32_bf16 a[4:7], a[100:103], v[112:115], a[4:7]
    v_mul_f32 v221, v221, v230
    v_mul_f32 v222, v222, v230
    v_mfma_f32_16x16x32_bf16 a[4:7], a[104:107], v[124:127], a[4:7]
    v_mul_f32 v223, v223, v230
    v_cvt_pk_bf16_f32 v212, v220, v221
    v_mfma_f32_16x16x32_bf16 a[4:7], a[108:111], v[136:139], a[4:7]
    v_cvt_pk_bf16_f32 v213, v222, v223
    v_accvgpr_read_b32 v224, a244
    v_mfma_f32_16x16x32_bf16 a[8:11], a[96:99], v[104:107], a[8:11]
    ds_read_b64_tr_b16 a[96:97], v243 offset:32768
    ds_read_b64_tr_b16 a[98:99], v243 offset:34816
    v_mfma_f32_16x16x32_bf16 a[8:11], a[100:103], v[116:119], a[8:11]
    ds_read_b64_tr_b16 a[100:101], v243 offset:36864
    ds_read_b64_tr_b16 a[102:103], v243 offset:38912
    v_mfma_f32_16x16x32_bf16 a[8:11], a[104:107], v[128:131], a[8:11]
    ds_read_b64_tr_b16 a[104:105], v243 offset:40960
    ds_read_b64_tr_b16 a[106:107], v243 offset:43008
    v_mfma_f32_16x16x32_bf16 a[8:11], a[108:111], v[140:143], a[8:11]
    s_waitcnt lgkmcnt(14)
    v_accvgpr_read_b32 v225, a245
    v_accvgpr_read_b32 v226, a246
    v_mfma_f32_16x16x32_bf16 a[12:15], a[112:115], v[96:99], a[12:15]
    v_accvgpr_read_b32 v227, a247
    v_mul_f32 v224, v224, v230
    v_mfma_f32_16x16x32_bf16 a[12:15], a[116:119], v[108:111], a[12:15]
    ds_read_b64_tr_b16 a[108:109], v243 offset:45056
    ds_read_b64_tr_b16 a[110:111], v243 offset:47104
    v_mfma_f32_16x16x32_bf16 a[12:15], a[120:123], v[120:123], a[12:15]
    v_add_u32 v231, 0x20000, v231
    v_mul_f32 v225, v225, v230
    v_mfma_f32_16x16x32_bf16 a[12:15], a[124:127], v[132:135], a[12:15]
    v_mul_f32 v226, v226, v230
    v_mul_f32 v227, v227, v230
    v_mfma_f32_16x16x32_bf16 a[16:19], a[112:115], v[100:103], a[16:19]
    v_cvt_pk_bf16_f32 v214, v224, v225
    v_cvt_pk_bf16_f32 v215, v226, v227
    v_mfma_f32_16x16x32_bf16 a[16:19], a[116:119], v[112:115], a[16:19]
    v_mfma_f32_16x16x32_bf16 a[16:19], a[120:123], v[124:127], a[16:19]
    v_mfma_f32_16x16x32_bf16 a[16:19], a[124:127], v[136:139], a[16:19]
    v_mfma_f32_16x16x32_bf16 a[20:23], a[112:115], v[104:107], a[20:23]
    v_mfma_f32_16x16x32_bf16 a[20:23], a[116:119], v[116:119], a[20:23]
    s_waitcnt lgkmcnt(0)
    s_barrier
    v_mfma_f32_16x16x32_bf16 a[20:23], a[120:123], v[128:131], a[20:23]
    s_mov_b32 s8, 196992
    s_add_u32 m0, s10, 98304
    ds_read_b64_tr_b16 a[112:113], v231 offset:16384
    ds_read_b64_tr_b16 a[114:115], v231 offset:19968
    v_mfma_f32_16x16x32_bf16 a[20:23], a[124:127], v[140:143], a[20:23]
    s_waitcnt vmcnt(4)
    buffer_load_dwordx4 v248, s[44:47], s8 offen nt lds
    v_mfma_f32_16x16x32_bf16 a[24:27], a[128:131], v[96:99], a[24:27]
    v_mfma_f32_16x16x32_bf16 a[24:27], a[132:135], v[108:111], a[24:27]
    ds_read_b64_tr_b16 a[116:117], v231 offset:23552
    ds_read_b64_tr_b16 a[118:119], v231 offset:27136
    v_mfma_f32_16x16x32_bf16 a[24:27], a[136:139], v[120:123], a[24:27]
    v_mfma_f32_16x16x32_bf16 a[24:27], a[140:143], v[132:135], a[24:27]
    ds_read_b64_tr_b16 a[120:121], v231 offset:16416
    ds_read_b64_tr_b16 a[122:123], v231 offset:20000
    v_mfma_f32_16x16x32_bf16 a[28:31], a[128:131], v[100:103], a[28:31]
    s_add_u32 s73, s77, 3072
    buffer_store_dwordx4 v[208:211], v239, s[52:55], s73 offen offset:1024 sc1
    v_mfma_f32_16x16x32_bf16 a[28:31], a[132:135], v[112:115], a[28:31]
    v_mfma_f32_16x16x32_bf16 a[28:31], a[136:139], v[124:127], a[28:31]
    s_add_u32 m0, s10, 98304
    ds_read_b64_tr_b16 a[124:125], v231 offset:23584
    ds_read_b64_tr_b16 a[126:127], v231 offset:27168
    v_mfma_f32_16x16x32_bf16 a[28:31], a[140:143], v[136:139], a[28:31]
    s_waitcnt vmcnt(5)
    buffer_load_dwordx4 v249, s[44:47], s8 offen offset:1024 nt lds
    v_mfma_f32_16x16x32_bf16 a[32:35], a[128:131], v[104:107], a[32:35]
    ds_read_b64_tr_b16 a[128:129], v231 offset:16448
    ds_read_b64_tr_b16 a[130:131], v231 offset:20032
    v_mfma_f32_16x16x32_bf16 a[32:35], a[132:135], v[116:119], a[32:35]
    v_mfma_f32_16x16x32_bf16 a[32:35], a[136:139], v[128:131], a[32:35]
    v_mfma_f32_16x16x32_bf16 a[32:35], a[140:143], v[140:143], a[32:35]
    ds_read_b64_tr_b16 a[132:133], v231 offset:23616
    ds_read_b64_tr_b16 a[134:135], v231 offset:27200
    v_mfma_f32_16x16x32_bf16 a[36:39], a[96:99], v[96:99], a[36:39]
    v_mfma_f32_16x16x32_bf16 a[36:39], a[100:103], v[108:111], a[36:39]
    ds_read_b64_tr_b16 a[136:137], v231 offset:16480
    ds_read_b64_tr_b16 a[138:139], v231 offset:20064
    v_mfma_f32_16x16x32_bf16 a[36:39], a[104:107], v[120:123], a[36:39]
    s_add_u32 m0, s10, 98304
    v_mfma_f32_16x16x32_bf16 a[36:39], a[108:111], v[132:135], a[36:39]
    s_waitcnt vmcnt(5)
    buffer_load_dwordx4 v250, s[44:47], s8 offen offset:2048 nt lds
    v_mfma_f32_16x16x32_bf16 a[40:43], a[96:99], v[100:103], a[40:43]
    ds_read_b64_tr_b16 a[140:141], v231 offset:23648
    ds_read_b64_tr_b16 a[142:143], v231 offset:27232
    v_mfma_f32_16x16x32_bf16 a[40:43], a[100:103], v[112:115], a[40:43]
    v_mfma_f32_16x16x32_bf16 a[40:43], a[104:107], v[124:127], a[40:43]
    v_mfma_f32_16x16x32_bf16 a[40:43], a[108:111], v[136:139], a[40:43]
    v_mfma_f32_16x16x32_bf16 a[44:47], a[96:99], v[104:107], a[44:47]
    ds_read_b64_tr_b16 a[96:97], v231 offset:16512
    ds_read_b64_tr_b16 a[98:99], v231 offset:20096
    v_mfma_f32_16x16x32_bf16 a[44:47], a[100:103], v[116:119], a[44:47]
    ds_read_b64_tr_b16 a[100:101], v231 offset:23680
    ds_read_b64_tr_b16 a[102:103], v231 offset:27264
    v_mfma_f32_16x16x32_bf16 a[44:47], a[104:107], v[128:131], a[44:47]
    v_mfma_f32_16x16x32_bf16 a[44:47], a[108:111], v[140:143], a[44:47]
    s_waitcnt lgkmcnt(14)
    ds_read_b64_tr_b16 a[104:105], v231 offset:16544
    ds_read_b64_tr_b16 a[106:107], v231 offset:20128
    v_mfma_f32_16x16x32_bf16 a[172:175], a[112:115], v[192:195], 0
    v_mfma_f32_16x16x32_bf16 a[172:175], a[116:119], v[204:207], a[172:175]
    v_mfma_f32_16x16x32_bf16 a[176:179], a[112:115], v[196:199], 0
    s_add_u32 m0, s10, 98304
    ds_read_b64_tr_b16 a[108:109], v231 offset:23712
    ds_read_b64_tr_b16 a[110:111], v231 offset:27296
    v_mfma_f32_16x16x32_bf16 a[176:179], a[116:119], v[208:211], a[176:179]
    s_waitcnt vmcnt(4)
    buffer_load_dwordx4 v251, s[44:47], s8 offen offset:3072 nt lds
    v_mfma_f32_16x16x32_bf16 a[180:183], a[112:115], v[200:203], 0
    ds_read_b64_tr_b16 a[112:113], v231 offset:16576
    ds_read_b64_tr_b16 a[114:115], v231 offset:20160
    v_mfma_f32_16x16x32_bf16 a[180:183], a[116:119], v[212:215], a[180:183]
    s_waitcnt lgkmcnt(14)
    v_mfma_f32_16x16x32_bf16 a[184:187], a[120:123], v[192:195], 0
    v_mfma_f32_16x16x32_bf16 a[184:187], a[124:127], v[204:207], a[184:187]
    ds_read_b64_tr_b16 a[116:117], v231 offset:23744
    ds_read_b64_tr_b16 a[118:119], v231 offset:27328
    v_mfma_f32_16x16x32_bf16 a[188:191], a[120:123], v[196:199], 0
    v_add_u32 v240, 0xffff0000, v240
    v_add_u32 v241, 0xffff0000, v241
    v_mfma_f32_16x16x32_bf16 a[188:191], a[124:127], v[208:211], a[188:191]
    v_add_u32 v242, 0xffff0000, v242
    v_add_u32 v243, 0xffff0000, v243
    v_mfma_f32_16x16x32_bf16 a[192:195], a[120:123], v[200:203], 0
    s_add_u32 s73, s77, 3072
    buffer_store_dwordx4 v[212:215], v239, s[52:55], s73 offen offset:2048 sc1
    v_mfma_f32_16x16x32_bf16 a[192:195], a[124:127], v[212:215], a[192:195]
    v_mfma_f32_16x16x32_bf16 a[196:199], a[128:131], v[192:195], 0
    v_mfma_f32_16x16x32_bf16 a[196:199], a[132:135], v[204:207], a[196:199]
    v_mfma_f32_16x16x32_bf16 a[200:203], a[128:131], v[196:199], 0
    v_mfma_f32_16x16x32_bf16 a[200:203], a[132:135], v[208:211], a[200:203]
    s_waitcnt lgkmcnt(0)
    s_barrier
    v_mfma_f32_16x16x32_bf16 a[204:207], a[128:131], v[200:203], 0
    s_add_u32 s9, s82, 57344
    s_add_u32 m0, s10, 147456
    ds_read_b64_tr_b16 a[120:121], v240 offset:49152
    ds_read_b64_tr_b16 a[122:123], v240 offset:51200
    v_mfma_f32_16x16x32_bf16 a[204:207], a[132:135], v[212:215], a[204:207]
    buffer_load_dwordx4 v244, s[48:51], s9 offen lds
    v_mfma_f32_16x16x32_bf16 a[208:211], a[136:139], v[192:195], 0
    v_mfma_f32_16x16x32_bf16 a[208:211], a[140:143], v[204:207], a[208:211]
    ds_read_b64_tr_b16 a[124:125], v240 offset:53248
    ds_read_b64_tr_b16 a[126:127], v240 offset:55296
    v_mfma_f32_16x16x32_bf16 a[212:215], a[136:139], v[196:199], 0
    v_mfma_f32_16x16x32_bf16 a[212:215], a[140:143], v[208:211], a[212:215]
    s_add_u32 m0, s10, 147456
    ds_read_b64_tr_b16 a[128:129], v240 offset:57344
    ds_read_b64_tr_b16 a[130:131], v240 offset:59392
    v_mfma_f32_16x16x32_bf16 a[216:219], a[136:139], v[200:203], 0
    buffer_load_dwordx4 v245, s[48:51], s9 offen offset:1024 lds
    v_mfma_f32_16x16x32_bf16 a[216:219], a[140:143], v[212:215], a[216:219]
    v_mfma_f32_16x16x32_bf16 a[220:223], a[96:99], v[192:195], 0
    s_add_u32 m0, s10, 147456
    ds_read_b64_tr_b16 a[132:133], v240 offset:61440
    ds_read_b64_tr_b16 a[134:135], v240 offset:63488
    v_mfma_f32_16x16x32_bf16 a[220:223], a[100:103], v[204:207], a[220:223]
    buffer_load_dwordx4 v246, s[48:51], s9 offen offset:2048 lds
    v_mfma_f32_16x16x32_bf16 a[224:227], a[96:99], v[196:199], 0
    ds_read_b64_tr_b16 a[136:137], v241 offset:49152
    ds_read_b64_tr_b16 a[138:139], v241 offset:51200
    v_mfma_f32_16x16x32_bf16 a[224:227], a[100:103], v[208:211], a[224:227]
    v_mfma_f32_16x16x32_bf16 a[228:231], a[96:99], v[200:203], 0
    v_mfma_f32_16x16x32_bf16 a[228:231], a[100:103], v[212:215], a[228:231]
    ds_read_b64_tr_b16 a[140:141], v241 offset:53248
    ds_read_b64_tr_b16 a[142:143], v241 offset:55296
    v_mfma_f32_16x16x32_bf16 a[232:235], a[104:107], v[192:195], 0
    s_add_u32 m0, s10, 147456
    v_mfma_f32_16x16x32_bf16 a[232:235], a[108:111], v[204:207], a[232:235]
    buffer_load_dwordx4 v247, s[48:51], s9 offen offset:3072 lds
    v_mfma_f32_16x16x32_bf16 a[236:239], a[104:107], v[196:199], 0
    ds_read_b64_tr_b16 a[96:97], v241 offset:57344
    ds_read_b64_tr_b16 a[98:99], v241 offset:59392
    v_mfma_f32_16x16x32_bf16 a[236:239], a[108:111], v[208:211], a[236:239]
    v_mfma_f32_16x16x32_bf16 a[240:243], a[104:107], v[200:203], 0
    ds_read_b64_tr_b16 a[100:101], v241 offset:61440
    ds_read_b64_tr_b16 a[102:103], v241 offset:63488
    v_mfma_f32_16x16x32_bf16 a[240:243], a[108:111], v[212:215], a[240:243]
    v_mfma_f32_16x16x32_bf16 a[244:247], a[112:115], v[192:195], 0
    v_mfma_f32_16x16x32_bf16 a[244:247], a[116:119], v[204:207], a[244:247]
    ds_read_b64_tr_b16 a[104:105], v242 offset:49152
    ds_read_b64_tr_b16 a[106:107], v242 offset:51200
    v_mfma_f32_16x16x32_bf16 a[248:251], a[112:115], v[196:199], 0
    v_mfma_f32_16x16x32_bf16 a[248:251], a[116:119], v[208:211], a[248:251]
    ds_read_b64_tr_b16 a[108:109], v242 offset:53248
    ds_read_b64_tr_b16 a[110:111], v242 offset:55296
    v_mfma_f32_16x16x32_bf16 a[252:255], a[112:115], v[200:203], 0
    v_mfma_f32_16x16x32_bf16 a[252:255], a[116:119], v[212:215], a[252:255]
    s_waitcnt lgkmcnt(12)
    v_mfma_f32_16x16x32_bf16 a[0:3], a[120:123], v[144:147], a[0:3]
    ds_read_b64_tr_b16 a[112:113], v242 offset:57344
    ds_read_b64_tr_b16 a[114:115], v242 offset:59392
    v_mfma_f32_16x16x32_bf16 a[0:3], a[124:127], v[156:159], a[0:3]
    v_mfma_f32_16x16x32_bf16 a[0:3], a[128:131], v[168:171], a[0:3]
    v_mfma_f32_16x16x32_bf16 a[0:3], a[132:135], v[180:183], a[0:3]
    ds_read_b64_tr_b16 a[116:117], v242 offset:61440
    ds_read_b64_tr_b16 a[118:119], v242 offset:63488
    v_mfma_f32_16x16x32_bf16 a[4:7], a[120:123], v[148:151], a[4:7]
    v_mfma_f32_16x16x32_bf16 a[4:7], a[124:127], v[160:163], a[4:7]
    v_mfma_f32_16x16x32_bf16 a[4:7], a[128:131], v[172:175], a[4:7]
    v_mfma_f32_16x16x32_bf16 a[4:7], a[132:135], v[184:187], a[4:7]
    v_mfma_f32_16x16x32_bf16 a[8:11], a[120:123], v[152:155], a[8:11]
    ds_read_b64_tr_b16 a[120:121], v243 offset:49152
    ds_read_b64_tr_b16 a[122:123], v243 offset:51200
    v_mfma_f32_16x16x32_bf16 a[8:11], a[124:127], v[164:167], a[8:11]
    ds_read_b64_tr_b16 a[124:125], v243 offset:53248
    ds_read_b64_tr_b16 a[126:127], v243 offset:55296
    v_mfma_f32_16x16x32_bf16 a[8:11], a[128:131], v[176:179], a[8:11]
    ds_read_b64_tr_b16 a[128:129], v243 offset:57344
    ds_read_b64_tr_b16 a[130:131], v243 offset:59392
    v_mfma_f32_16x16x32_bf16 a[8:11], a[132:135], v[188:191], a[8:11]
    s_waitcnt lgkmcnt(14)
    v_mfma_f32_16x16x32_bf16 a[12:15], a[136:139], v[144:147], a[12:15]
    v_mfma_f32_16x16x32_bf16 a[12:15], a[140:143], v[156:159], a[12:15]
    ds_read_b64_tr_b16 a[132:133], v243 offset:61440
    ds_read_b64_tr_b16 a[134:135], v243 offset:63488
    v_mfma_f32_16x16x32_bf16 a[12:15], a[96:99], v[168:171], a[12:15]
    v_mfma_f32_16x16x32_bf16 a[12:15], a[100:103], v[180:183], a[12:15]
    v_mfma_f32_16x16x32_bf16 a[16:19], a[136:139], v[148:151], a[16:19]
    v_mfma_f32_16x16x32_bf16 a[16:19], a[140:143], v[160:163], a[16:19]
    v_mfma_f32_16x16x32_bf16 a[16:19], a[96:99], v[172:175], a[16:19]
    v_mfma_f32_16x16x32_bf16 a[16:19], a[100:103], v[184:187], a[16:19]
    v_mfma_f32_16x16x32_bf16 a[20:23], a[136:139], v[152:155], a[20:23]
    v_mfma_f32_16x16x32_bf16 a[20:23], a[140:143], v[164:167], a[20:23]
    s_waitcnt lgkmcnt(0)
    s_barrier
    v_mfma_f32_16x16x32_bf16 a[20:23], a[96:99], v[176:179], a[20:23]
    s_add_u32 s9, s82, 114688
    s_add_u32 m0, s10, 49152
    ds_read_b64_tr_b16 a[136:137], v240
    ds_read_b64_tr_b16 a[138:139], v240 offset:2048
    v_mfma_f32_16x16x32_bf16 a[20:23], a[100:103], v[188:191], a[20:23]
    buffer_load_dwordx4 v244, s[48:51], s9 offen lds
    v_mfma_f32_16x16x32_bf16 a[24:27], a[104:107], v[144:147], a[24:27]
    v_mfma_f32_16x16x32_bf16 a[24:27], a[108:111], v[156:159], a[24:27]
    ds_read_b64_tr_b16 a[140:141], v240 offset:4096
    ds_read_b64_tr_b16 a[142:143], v240 offset:6144
    v_mfma_f32_16x16x32_bf16 a[24:27], a[112:115], v[168:171], a[24:27]
    v_mfma_f32_16x16x32_bf16 a[24:27], a[116:119], v[180:183], a[24:27]
    s_add_u32 m0, s10, 49152
    ds_read_b64_tr_b16 a[96:97], v240 offset:8192
    ds_read_b64_tr_b16 a[98:99], v240 offset:10240
    v_mfma_f32_16x16x32_bf16 a[28:31], a[104:107], v[148:151], a[28:31]
    buffer_load_dwordx4 v245, s[48:51], s9 offen offset:1024 lds
    v_mfma_f32_16x16x32_bf16 a[28:31], a[108:111], v[160:163], a[28:31]
    v_mfma_f32_16x16x32_bf16 a[28:31], a[112:115], v[172:175], a[28:31]
    s_add_u32 m0, s10, 49152
    ds_read_b64_tr_b16 a[100:101], v240 offset:12288
    ds_read_b64_tr_b16 a[102:103], v240 offset:14336
    v_mfma_f32_16x16x32_bf16 a[28:31], a[116:119], v[184:187], a[28:31]
    buffer_load_dwordx4 v246, s[48:51], s9 offen offset:2048 lds
    v_mfma_f32_16x16x32_bf16 a[32:35], a[104:107], v[152:155], a[32:35]
    ds_read_b64_tr_b16 a[104:105], v241
    ds_read_b64_tr_b16 a[106:107], v241 offset:2048
    v_mfma_f32_16x16x32_bf16 a[32:35], a[108:111], v[164:167], a[32:35]
    v_mfma_f32_16x16x32_bf16 a[32:35], a[112:115], v[176:179], a[32:35]
    v_mfma_f32_16x16x32_bf16 a[32:35], a[116:119], v[188:191], a[32:35]
    ds_read_b64_tr_b16 a[108:109], v241 offset:4096
    ds_read_b64_tr_b16 a[110:111], v241 offset:6144
    v_mfma_f32_16x16x32_bf16 a[36:39], a[120:123], v[144:147], a[36:39]
    s_add_u32 m0, s10, 49152
    v_mfma_f32_16x16x32_bf16 a[36:39], a[124:127], v[156:159], a[36:39]
    buffer_load_dwordx4 v247, s[48:51], s9 offen offset:3072 lds
    v_mfma_f32_16x16x32_bf16 a[36:39], a[128:131], v[168:171], a[36:39]
    ds_read_b64_tr_b16 a[112:113], v241 offset:8192
    ds_read_b64_tr_b16 a[114:115], v241 offset:10240
    v_mfma_f32_16x16x32_bf16 a[36:39], a[132:135], v[180:183], a[36:39]
    v_mfma_f32_16x16x32_bf16 a[40:43], a[120:123], v[148:151], a[40:43]
    ds_read_b64_tr_b16 a[116:117], v241 offset:12288
    ds_read_b64_tr_b16 a[118:119], v241 offset:14336
    v_mfma_f32_16x16x32_bf16 a[40:43], a[124:127], v[160:163], a[40:43]
    v_mfma_f32_16x16x32_bf16 a[40:43], a[128:131], v[172:175], a[40:43]
    v_mfma_f32_16x16x32_bf16 a[40:43], a[132:135], v[184:187], a[40:43]
    v_mfma_f32_16x16x32_bf16 a[44:47], a[120:123], v[152:155], a[44:47]
    ds_read_b64_tr_b16 a[120:121], v242
    ds_read_b64_tr_b16 a[122:123], v242 offset:2048
    v_mfma_f32_16x16x32_bf16 a[44:47], a[124:127], v[164:167], a[44:47]
    ds_read_b64_tr_b16 a[124:125], v242 offset:4096
    ds_read_b64_tr_b16 a[126:127], v242 offset:6144
    v_mfma_f32_16x16x32_bf16 a[44:47], a[128:131], v[176:179], a[44:47]
    v_mfma_f32_16x16x32_bf16 a[44:47], a[132:135], v[188:191], a[44:47]
    s_waitcnt lgkmcnt(12)
    v_mfma_f32_16x16x32_bf16 a[48:51], a[136:139], v[0:3], 0
    ds_read_b64_tr_b16 a[128:129], v242 offset:8192
    ds_read_b64_tr_b16 a[130:131], v242 offset:10240
    v_mfma_f32_16x16x32_bf16 a[48:51], a[140:143], v[12:15], a[48:51]
    v_mfma_f32_16x16x32_bf16 a[48:51], a[96:99], v[24:27], a[48:51]
    v_mfma_f32_16x16x32_bf16 a[48:51], a[100:103], v[36:39], a[48:51]
    ds_read_b64_tr_b16 a[132:133], v242 offset:12288
    ds_read_b64_tr_b16 a[134:135], v242 offset:14336
    v_mfma_f32_16x16x32_bf16 a[52:55], a[136:139], v[4:7], 0
    v_accvgpr_read_b32 v216, a0
    v_accvgpr_read_b32 v217, a1
    v_mfma_f32_16x16x32_bf16 a[52:55], a[140:143], v[16:19], a[52:55]
    v_accvgpr_read_b32 v218, a2
    v_accvgpr_read_b32 v219, a3
    v_mfma_f32_16x16x32_bf16 a[52:55], a[96:99], v[28:31], a[52:55]
    v_mul_f32 v216, v216, v228
    v_mul_f32 v217, v217, v228
    v_mfma_f32_16x16x32_bf16 a[52:55], a[100:103], v[40:43], a[52:55]
    v_mul_f32 v218, v218, v228
    v_mul_f32 v219, v219, v228
    v_mfma_f32_16x16x32_bf16 a[56:59], a[136:139], v[8:11], 0
    ds_read_b64_tr_b16 a[136:137], v243
    ds_read_b64_tr_b16 a[138:139], v243 offset:2048
    v_mfma_f32_16x16x32_bf16 a[56:59], a[140:143], v[20:23], a[56:59]
    ds_read_b64_tr_b16 a[140:141], v243 offset:4096
    ds_read_b64_tr_b16 a[142:143], v243 offset:6144
    v_mfma_f32_16x16x32_bf16 a[56:59], a[96:99], v[32:35], a[56:59]
    ds_read_b64_tr_b16 a[96:97], v243 offset:8192
    ds_read_b64_tr_b16 a[98:99], v243 offset:10240
    v_mfma_f32_16x16x32_bf16 a[56:59], a[100:103], v[44:47], a[56:59]
    s_waitcnt lgkmcnt(14)
    v_cvt_pk_bf16_f32 v192, v216, v217
    v_cvt_pk_bf16_f32 v193, v218, v219
    v_mfma_f32_16x16x32_bf16 a[60:63], a[104:107], v[0:3], 0
    v_accvgpr_read_b32 v220, a12
    v_accvgpr_read_b32 v221, a13
    v_mfma_f32_16x16x32_bf16 a[60:63], a[108:111], v[12:15], a[60:63]
    ds_read_b64_tr_b16 a[100:101], v243 offset:12288
    ds_read_b64_tr_b16 a[102:103], v243 offset:14336
    v_mfma_f32_16x16x32_bf16 a[60:63], a[112:115], v[24:27], a[60:63]
    v_accvgpr_read_b32 v222, a14
    v_accvgpr_read_b32 v223, a15
    v_mfma_f32_16x16x32_bf16 a[60:63], a[116:119], v[36:39], a[60:63]
    v_mul_f32 v220, v220, v228
    v_mul_f32 v221, v221, v228
    v_mfma_f32_16x16x32_bf16 a[64:67], a[104:107], v[4:7], 0
    v_mul_f32 v222, v222, v228
    v_mul_f32 v223, v223, v228
    v_mfma_f32_16x16x32_bf16 a[64:67], a[108:111], v[16:19], a[64:67]
    v_cvt_pk_bf16_f32 v194, v220, v221
    v_cvt_pk_bf16_f32 v195, v222, v223
    v_mfma_f32_16x16x32_bf16 a[64:67], a[112:115], v[28:31], a[64:67]
    v_accvgpr_read_b32 v224, a4
    v_accvgpr_read_b32 v225, a5
    v_mfma_f32_16x16x32_bf16 a[64:67], a[116:119], v[40:43], a[64:67]
    v_accvgpr_read_b32 v226, a6
    v_accvgpr_read_b32 v227, a7
    v_mfma_f32_16x16x32_bf16 a[68:71], a[104:107], v[8:11], 0
    v_mul_f32 v224, v224, v229
    v_mul_f32 v225, v225, v229
    v_mfma_f32_16x16x32_bf16 a[68:71], a[108:111], v[20:23], a[68:71]
    s_waitcnt vmcnt(8) lgkmcnt(0)
    s_barrier
    v_mul_f32 v226, v226, v229
    v_mfma_f32_16x16x32_bf16 a[68:71], a[112:115], v[32:35], a[68:71]
    s_add_u32 s9, s99, 0
    s_add_u32 m0, s10, 0
    ds_read_b64_tr_b16 a[104:105], v240 offset:16384
    ds_read_b64_tr_b16 a[106:107], v240 offset:18432
    v_mfma_f32_16x16x32_bf16 a[68:71], a[116:119], v[44:47], a[68:71]
    buffer_load_dwordx4 v244, s[48:51], s9 offen lds
    v_mov_b32 v233, 1
    v_mfma_f32_16x16x32_bf16 a[72:75], a[120:123], v[0:3], 0
    buffer_store_dword v233, v232, s[68:71], 0 offen sc1
    v_mul_f32 v227, v227, v229
    v_mfma_f32_16x16x32_bf16 a[72:75], a[124:127], v[12:15], a[72:75]
    ds_read_b64_tr_b16 a[108:109], v240 offset:20480
    ds_read_b64_tr_b16 a[110:111], v240 offset:22528
    v_mfma_f32_16x16x32_bf16 a[72:75], a[128:131], v[24:27], a[72:75]
    v_cvt_pk_bf16_f32 v196, v224, v225
    v_cvt_pk_bf16_f32 v197, v226, v227
    v_mfma_f32_16x16x32_bf16 a[72:75], a[132:135], v[36:39], a[72:75]
    ds_read_b64_tr_b16 a[112:113], v240 offset:24576
    ds_read_b64_tr_b16 a[114:115], v240 offset:26624
    v_mfma_f32_16x16x32_bf16 a[76:79], a[120:123], v[4:7], 0
    s_add_u32 s73, s77, 6144
    buffer_store_dwordx4 v[192:195], v239, s[52:55], s73 offen sc1
    v_accvgpr_read_b32 v216, a16
    v_mfma_f32_16x16x32_bf16 a[76:79], a[124:127], v[16:19], a[76:79]
    v_accvgpr_read_b32 v217, a17
    v_accvgpr_read_b32 v218, a18
    v_mfma_f32_16x16x32_bf16 a[76:79], a[128:131], v[28:31], a[76:79]
    s_add_u32 m0, s10, 0
    ds_read_b64_tr_b16 a[116:117], v240 offset:28672
    ds_read_b64_tr_b16 a[118:119], v240 offset:30720
    v_mfma_f32_16x16x32_bf16 a[76:79], a[132:135], v[40:43], a[76:79]
    buffer_load_dwordx4 v245, s[48:51], s9 offen offset:1024 lds
    v_accvgpr_read_b32 v219, a19
    v_mfma_f32_16x16x32_bf16 a[80:83], a[120:123], v[8:11], 0
    ds_read_b64_tr_b16 a[120:121], v241 offset:16384
    ds_read_b64_tr_b16 a[122:123], v241 offset:18432
    v_mfma_f32_16x16x32_bf16 a[80:83], a[124:127], v[20:23], a[80:83]
    v_mul_f32 v216, v216, v229
    v_mul_f32 v217, v217, v229
    v_mfma_f32_16x16x32_bf16 a[80:83], a[128:131], v[32:35], a[80:83]
    v_mul_f32 v218, v218, v229
    v_mul_f32 v219, v219, v229
    v_mfma_f32_16x16x32_bf16 a[80:83], a[132:135], v[44:47], a[80:83]
    ds_read_b64_tr_b16 a[124:125], v241 offset:20480
    ds_read_b64_tr_b16 a[126:127], v241 offset:22528
    v_mfma_f32_16x16x32_bf16 a[84:87], a[136:139], v[0:3], 0
    s_add_u32 m0, s10, 0
    v_cvt_pk_bf16_f32 v198, v216, v217
    v_cvt_pk_bf16_f32 v199, v218, v219
    v_mfma_f32_16x16x32_bf16 a[84:87], a[140:143], v[12:15], a[84:87]
    buffer_load_dwordx4 v246, s[48:51], s9 offen offset:2048 lds
    v_accvgpr_read_b32 v220, a8
    v_mfma_f32_16x16x32_bf16 a[84:87], a[96:99], v[24:27], a[84:87]
    s_add_u32 m0, s10, 0
    ds_read_b64_tr_b16 a[128:129], v241 offset:24576
    ds_read_b64_tr_b16 a[130:131], v241 offset:26624
    v_mfma_f32_16x16x32_bf16 a[84:87], a[100:103], v[36:39], a[84:87]
    buffer_load_dwordx4 v247, s[48:51], s9 offen offset:3072 lds
    v_accvgpr_read_b32 v221, a9
    v_mfma_f32_16x16x32_bf16 a[88:91], a[136:139], v[4:7], 0
    ds_read_b64_tr_b16 a[132:133], v241 offset:28672
    ds_read_b64_tr_b16 a[134:135], v241 offset:30720
    v_mfma_f32_16x16x32_bf16 a[88:91], a[140:143], v[16:19], a[88:91]
    v_accvgpr_read_b32 v222, a10
    v_accvgpr_read_b32 v223, a11
    v_mfma_f32_16x16x32_bf16 a[88:91], a[96:99], v[28:31], a[88:91]
    v_mul_f32 v220, v220, v230
    v_mul_f32 v221, v221, v230
    v_mfma_f32_16x16x32_bf16 a[88:91], a[100:103], v[40:43], a[88:91]
    v_mul_f32 v222, v222, v230
    v_mul_f32 v223, v223, v230
    v_mfma_f32_16x16x32_bf16 a[92:95], a[136:139], v[8:11], 0
    ds_read_b64_tr_b16 a[136:137], v242 offset:16384
    ds_read_b64_tr_b16 a[138:139], v242 offset:18432
    v_mfma_f32_16x16x32_bf16 a[92:95], a[140:143], v[20:23], a[92:95]
    ds_read_b64_tr_b16 a[140:141], v242 offset:20480
    ds_read_b64_tr_b16 a[142:143], v242 offset:22528
    v_mfma_f32_16x16x32_bf16 a[92:95], a[96:99], v[32:35], a[92:95]
    s_add_u32 s73, s77, 6144
    buffer_store_dwordx4 v[196:199], v239, s[52:55], s73 offen offset:1024 sc1
    v_cvt_pk_bf16_f32 v200, v220, v221
    v_mfma_f32_16x16x32_bf16 a[92:95], a[100:103], v[44:47], a[92:95]
    s_waitcnt lgkmcnt(12)
    v_cvt_pk_bf16_f32 v201, v222, v223
    v_accvgpr_read_b32 v224, a20
    v_mfma_f32_16x16x32_bf16 a[48:51], a[104:107], v[48:51], a[48:51]
    ds_read_b64_tr_b16 a[96:97], v242 offset:24576
    ds_read_b64_tr_b16 a[98:99], v242 offset:26624
    v_mfma_f32_16x16x32_bf16 a[48:51], a[108:111], v[60:63], a[48:51]
    v_accvgpr_read_b32 v225, a21
    v_accvgpr_read_b32 v226, a22
    v_mfma_f32_16x16x32_bf16 a[48:51], a[112:115], v[72:75], a[48:51]
    v_accvgpr_read_b32 v227, a23
    v_mul_f32 v224, v224, v230
    v_mfma_f32_16x16x32_bf16 a[48:51], a[116:119], v[84:87], a[48:51]
    ds_read_b64_tr_b16 a[100:101], v242 offset:28672
    ds_read_b64_tr_b16 a[102:103], v242 offset:30720
    v_mfma_f32_16x16x32_bf16 a[52:55], a[104:107], v[52:55], a[52:55]
    v_mul_f32 v225, v225, v230
    v_mul_f32 v226, v226, v230
    v_mfma_f32_16x16x32_bf16 a[52:55], a[108:111], v[64:67], a[52:55]
    v_mul_f32 v227, v227, v230
    v_cvt_pk_bf16_f32 v202, v224, v225
    v_mfma_f32_16x16x32_bf16 a[52:55], a[112:115], v[76:79], a[52:55]
    v_cvt_pk_bf16_f32 v203, v226, v227
    v_mfma_f32_16x16x32_bf16 a[52:55], a[116:119], v[88:91], a[52:55]
    v_accvgpr_read_b32 v216, a24
    v_accvgpr_read_b32 v217, a25
    v_mfma_f32_16x16x32_bf16 a[56:59], a[104:107], v[56:59], a[56:59]
    ds_read_b64_tr_b16 a[104:105], v243 offset:16384
    ds_read_b64_tr_b16 a[106:107], v243 offset:18432
    v_mfma_f32_16x16x32_bf16 a[56:59], a[108:111], v[68:71], a[56:59]
    ds_read_b64_tr_b16 a[108:109], v243 offset:20480
    ds_read_b64_tr_b16 a[110:111], v243 offset:22528
    v_mfma_f32_16x16x32_bf16 a[56:59], a[112:115], v[80:83], a[56:59]
    ds_read_b64_tr_b16 a[112:113], v243 offset:24576
    ds_read_b64_tr_b16 a[114:115], v243 offset:26624
    v_mfma_f32_16x16x32_bf16 a[56:59], a[116:119], v[92:95], a[56:59]
    s_waitcnt lgkmcnt(14)
    v_accvgpr_read_b32 v218, a26
    v_accvgpr_read_b32 v219, a27
    v_mfma_f32_16x16x32_bf16 a[60:63], a[120:123], v[48:51], a[60:63]
    v_mul_f32 v216, v216, v228
    v_mul_f32 v217, v217, v228
    v_mfma_f32_16x16x32_bf16 a[60:63], a[124:127], v[60:63], a[60:63]
    ds_read_b64_tr_b16 a[116:117], v243 offset:28672
    ds_read_b64_tr_b16 a[118:119], v243 offset:30720
    v_mfma_f32_16x16x32_bf16 a[60:63], a[128:131], v[72:75], a[60:63]
    v_add_u32 v240, 0x10000, v240
    v_add_u32 v241, 0x10000, v241
    v_mfma_f32_16x16x32_bf16 a[60:63], a[132:135], v[84:87], a[60:63]
    v_add_u32 v242, 0x10000, v242
    v_add_u32 v243, 0x10000, v243
    v_mfma_f32_16x16x32_bf16 a[64:67], a[120:123], v[52:55], a[64:67]
    v_mul_f32 v218, v218, v228
    v_mul_f32 v219, v219, v228
    v_mfma_f32_16x16x32_bf16 a[64:67], a[124:127], v[64:67], a[64:67]
    s_add_u32 s73, s77, 6144
    buffer_store_dwordx4 v[200:203], v239, s[52:55], s73 offen offset:2048 sc1
    v_cvt_pk_bf16_f32 v204, v216, v217
    v_mfma_f32_16x16x32_bf16 a[64:67], a[128:131], v[76:79], a[64:67]
    v_cvt_pk_bf16_f32 v205, v218, v219
    v_accvgpr_read_b32 v220, a36
    v_mfma_f32_16x16x32_bf16 a[64:67], a[132:135], v[88:91], a[64:67]
    v_accvgpr_read_b32 v221, a37
    v_accvgpr_read_b32 v222, a38
    v_mfma_f32_16x16x32_bf16 a[68:71], a[120:123], v[56:59], a[68:71]
    v_accvgpr_read_b32 v223, a39
    v_mul_f32 v220, v220, v228
    v_mfma_f32_16x16x32_bf16 a[68:71], a[124:127], v[68:71], a[68:71]
    s_waitcnt lgkmcnt(0)
    s_barrier
    v_mul_f32 v221, v221, v228
    v_mfma_f32_16x16x32_bf16 a[68:71], a[128:131], v[80:83], a[68:71]
    s_add_u32 s9, s100, 0
    s_add_u32 m0, s10, 16384
    ds_read_b64_tr_b16 a[120:121], v240
    ds_read_b64_tr_b16 a[122:123], v240 offset:2048
    v_mfma_f32_16x16x32_bf16 a[68:71], a[132:135], v[92:95], a[68:71]
    buffer_load_dwordx4 v244, s[48:51], s9 offen lds
    v_mul_f32 v222, v222, v228
    v_mfma_f32_16x16x32_bf16 a[72:75], a[136:139], v[48:51], a[72:75]
    v_mul_f32 v223, v223, v228
    v_cvt_pk_bf16_f32 v206, v220, v221
    v_mfma_f32_16x16x32_bf16 a[72:75], a[140:143], v[60:63], a[72:75]
    ds_read_b64_tr_b16 a[124:125], v240 offset:4096
    ds_read_b64_tr_b16 a[126:127], v240 offset:6144
    v_mfma_f32_16x16x32_bf16 a[72:75], a[96:99], v[72:75], a[72:75]
    v_cvt_pk_bf16_f32 v207, v222, v223
    v_mfma_f32_16x16x32_bf16 a[72:75], a[100:103], v[84:87], a[72:75]
    s_add_u32 m0, s10, 16384
    ds_read_b64_tr_b16 a[128:129], v240 offset:8192
    ds_read_b64_tr_b16 a[130:131], v240 offset:10240
    v_mfma_f32_16x16x32_bf16 a[76:79], a[136:139], v[52:55], a[76:79]
    buffer_load_dwordx4 v245, s[48:51], s9 offen offset:1024 lds
    v_accvgpr_read_b32 v224, a28
    v_mfma_f32_16x16x32_bf16 a[76:79], a[140:143], v[64:67], a[76:79]
    v_accvgpr_read_b32 v225, a29
    v_accvgpr_read_b32 v226, a30
    v_mfma_f32_16x16x32_bf16 a[76:79], a[96:99], v[76:79], a[76:79]
    s_add_u32 m0, s10, 16384
    ds_read_b64_tr_b16 a[132:133], v240 offset:12288
    ds_read_b64_tr_b16 a[134:135], v240 offset:14336
    v_mfma_f32_16x16x32_bf16 a[76:79], a[100:103], v[88:91], a[76:79]
    buffer_load_dwordx4 v246, s[48:51], s9 offen offset:2048 lds
    v_accvgpr_read_b32 v227, a31
    v_mfma_f32_16x16x32_bf16 a[80:83], a[136:139], v[56:59], a[80:83]
    ds_read_b64_tr_b16 a[136:137], v241
    ds_read_b64_tr_b16 a[138:139], v241 offset:2048
    v_mfma_f32_16x16x32_bf16 a[80:83], a[140:143], v[68:71], a[80:83]
    v_mul_f32 v224, v224, v229
    v_mul_f32 v225, v225, v229
    v_mfma_f32_16x16x32_bf16 a[80:83], a[96:99], v[80:83], a[80:83]
    v_mul_f32 v226, v226, v229
    v_mul_f32 v227, v227, v229
    v_mfma_f32_16x16x32_bf16 a[80:83], a[100:103], v[92:95], a[80:83]
    ds_read_b64_tr_b16 a[140:141], v241 offset:4096
    ds_read_b64_tr_b16 a[142:143], v241 offset:6144
    v_mfma_f32_16x16x32_bf16 a[84:87], a[104:107], v[48:51], a[84:87]
    s_add_u32 m0, s10, 16384
    v_cvt_pk_bf16_f32 v208, v224, v225
    v_cvt_pk_bf16_f32 v209, v226, v227
    v_mfma_f32_16x16x32_bf16 a[84:87], a[108:111], v[60:63], a[84:87]
    buffer_load_dwordx4 v247, s[48:51], s9 offen offset:3072 lds
    v_accvgpr_read_b32 v216, a40
    v_mfma_f32_16x16x32_bf16 a[84:87], a[112:115], v[72:75], a[84:87]
    ds_read_b64_tr_b16 a[96:97], v241 offset:8192
    ds_read_b64_tr_b16 a[98:99], v241 offset:10240
    v_mfma_f32_16x16x32_bf16 a[84:87], a[116:119], v[84:87], a[84:87]
    v_accvgpr_read_b32 v217, a41
    v_accvgpr_read_b32 v218, a42
    v_mfma_f32_16x16x32_bf16 a[88:91], a[104:107], v[52:55], a[88:91]
    ds_read_b64_tr_b16 a[100:101], v241 offset:12288
    ds_read_b64_tr_b16 a[102:103], v241 offset:14336
    v_mfma_f32_16x16x32_bf16 a[88:91], a[108:111], v[64:67], a[88:91]
    v_accvgpr_read_b32 v219, a43
    v_mul_f32 v216, v216, v229
    v_mfma_f32_16x16x32_bf16 a[88:91], a[112:115], v[76:79], a[88:91]
    v_mul_f32 v217, v217, v229
    v_mul_f32 v218, v218, v229
    v_mfma_f32_16x16x32_bf16 a[88:91], a[116:119], v[88:91], a[88:91]
    v_mul_f32 v219, v219, v229
    v_cvt_pk_bf16_f32 v210, v216, v217
    v_mfma_f32_16x16x32_bf16 a[92:95], a[104:107], v[56:59], a[92:95]
    ds_read_b64_tr_b16 a[104:105], v242
    ds_read_b64_tr_b16 a[106:107], v242 offset:2048
    v_mfma_f32_16x16x32_bf16 a[92:95], a[108:111], v[68:71], a[92:95]
    ds_read_b64_tr_b16 a[108:109], v242 offset:4096
    ds_read_b64_tr_b16 a[110:111], v242 offset:6144
    v_mfma_f32_16x16x32_bf16 a[92:95], a[112:115], v[80:83], a[92:95]
    s_add_u32 s73, s77, 9216
    buffer_store_dwordx4 v[204:207], v239, s[52:55], s73 offen sc1
    v_cvt_pk_bf16_f32 v211, v218, v219
    v_mfma_f32_16x16x32_bf16 a[92:95], a[116:119], v[92:95], a[92:95]
    s_waitcnt lgkmcnt(12)
    v_accvgpr_read_b32 v220, a32
    v_accvgpr_read_b32 v221, a33
    v_mfma_f32_16x16x32_bf16 a[48:51], a[120:123], v[96:99], a[48:51]
    ds_read_b64_tr_b16 a[112:113], v242 offset:8192
    ds_read_b64_tr_b16 a[114:115], v242 offset:10240
    v_mfma_f32_16x16x32_bf16 a[48:51], a[124:127], v[108:111], a[48:51]
    v_accvgpr_read_b32 v222, a34
    v_accvgpr_read_b32 v223, a35
    v_mfma_f32_16x16x32_bf16 a[48:51], a[128:131], v[120:123], a[48:51]
    v_mul_f32 v220, v220, v230
    v_mul_f32 v221, v221, v230
    v_mfma_f32_16x16x32_bf16 a[48:51], a[132:135], v[132:135], a[48:51]
    ds_read_b64_tr_b16 a[116:117], v242 offset:12288
    ds_read_b64_tr_b16 a[118:119], v242 offset:14336
    v_mfma_f32_16x16x32_bf16 a[52:55], a[120:123], v[100:103], a[52:55]
    v_mul_f32 v222, v222, v230
    v_mul_f32 v223, v223, v230
    v_mfma_f32_16x16x32_bf16 a[52:55], a[124:127], v[112:115], a[52:55]
    v_cvt_pk_bf16_f32 v212, v220, v221
    v_cvt_pk_bf16_f32 v213, v222, v223
    v_mfma_f32_16x16x32_bf16 a[52:55], a[128:131], v[124:127], a[52:55]
    v_accvgpr_read_b32 v224, a44
    v_accvgpr_read_b32 v225, a45
    v_mfma_f32_16x16x32_bf16 a[52:55], a[132:135], v[136:139], a[52:55]
    v_accvgpr_read_b32 v226, a46
    v_accvgpr_read_b32 v227, a47
    v_mfma_f32_16x16x32_bf16 a[56:59], a[120:123], v[104:107], a[56:59]
    ds_read_b64_tr_b16 a[120:121], v243
    ds_read_b64_tr_b16 a[122:123], v243 offset:2048
    v_mfma_f32_16x16x32_bf16 a[56:59], a[124:127], v[116:119], a[56:59]
    ds_read_b64_tr_b16 a[124:125], v243 offset:4096
    ds_read_b64_tr_b16 a[126:127], v243 offset:6144
    v_mfma_f32_16x16x32_bf16 a[56:59], a[128:131], v[128:131], a[56:59]
    ds_read_b64_tr_b16 a[128:129], v243 offset:8192
    ds_read_b64_tr_b16 a[130:131], v243 offset:10240
    v_mfma_f32_16x16x32_bf16 a[56:59], a[132:135], v[140:143], a[56:59]
    s_waitcnt lgkmcnt(14)
    v_mul_f32 v224, v224, v230
    v_mul_f32 v225, v225, v230
    v_mfma_f32_16x16x32_bf16 a[60:63], a[136:139], v[96:99], a[60:63]
    v_mul_f32 v226, v226, v230
    v_mul_f32 v227, v227, v230
    v_mfma_f32_16x16x32_bf16 a[60:63], a[140:143], v[108:111], a[60:63]
    ds_read_b64_tr_b16 a[132:133], v243 offset:12288
    ds_read_b64_tr_b16 a[134:135], v243 offset:14336
    v_mfma_f32_16x16x32_bf16 a[60:63], a[96:99], v[120:123], a[60:63]
    v_cvt_pk_bf16_f32 v214, v224, v225
    v_cvt_pk_bf16_f32 v215, v226, v227
    v_mfma_f32_16x16x32_bf16 a[60:63], a[100:103], v[132:135], a[60:63]
    v_mfma_f32_16x16x32_bf16 a[64:67], a[136:139], v[100:103], a[64:67]
    v_mfma_f32_16x16x32_bf16 a[64:67], a[140:143], v[112:115], a[64:67]
    v_mfma_f32_16x16x32_bf16 a[64:67], a[96:99], v[124:127], a[64:67]
    v_mfma_f32_16x16x32_bf16 a[64:67], a[100:103], v[136:139], a[64:67]
    v_mfma_f32_16x16x32_bf16 a[68:71], a[136:139], v[104:107], a[68:71]
    v_mfma_f32_16x16x32_bf16 a[68:71], a[140:143], v[116:119], a[68:71]
    s_waitcnt vmcnt(17) lgkmcnt(0)
    s_barrier
    v_mfma_f32_16x16x32_bf16 a[68:71], a[96:99], v[128:131], a[68:71]
    s_add_u32 s9, s101, 0
    s_add_u32 m0, s10, 65536
    ds_read_b64_tr_b16 a[136:137], v231 offset:16384
    ds_read_b64_tr_b16 a[138:139], v231 offset:19968
    v_mfma_f32_16x16x32_bf16 a[68:71], a[100:103], v[140:143], a[68:71]
    buffer_load_dwordx4 v244, s[48:51], s9 offen lds
    v_mfma_f32_16x16x32_bf16 a[72:75], a[104:107], v[96:99], a[72:75]
    v_mfma_f32_16x16x32_bf16 a[72:75], a[108:111], v[108:111], a[72:75]
    ds_read_b64_tr_b16 a[140:141], v231 offset:23552
    ds_read_b64_tr_b16 a[142:143], v231 offset:27136
    buffer_load_dword v234, v235, s[68:71], 0 offen sc1
    v_mfma_f32_16x16x32_bf16 a[72:75], a[112:115], v[120:123], a[72:75]
    v_mfma_f32_16x16x32_bf16 a[72:75], a[116:119], v[132:135], a[72:75]
    ds_read_b64_tr_b16 a[96:97], v231 offset:16416
    ds_read_b64_tr_b16 a[98:99], v231 offset:20000
    v_mfma_f32_16x16x32_bf16 a[76:79], a[104:107], v[100:103], a[76:79]
    s_add_u32 s73, s77, 9216
    buffer_store_dwordx4 v[208:211], v239, s[52:55], s73 offen offset:1024 sc1
    v_mfma_f32_16x16x32_bf16 a[76:79], a[108:111], v[112:115], a[76:79]
    v_mfma_f32_16x16x32_bf16 a[76:79], a[112:115], v[124:127], a[76:79]
    s_add_u32 m0, s10, 65536
    ds_read_b64_tr_b16 a[100:101], v231 offset:23584
    ds_read_b64_tr_b16 a[102:103], v231 offset:27168
    v_mfma_f32_16x16x32_bf16 a[76:79], a[116:119], v[136:139], a[76:79]
    buffer_load_dwordx4 v245, s[48:51], s9 offen offset:1024 lds
    v_mfma_f32_16x16x32_bf16 a[80:83], a[104:107], v[104:107], a[80:83]
    ds_read_b64_tr_b16 a[104:105], v231 offset:16448
    ds_read_b64_tr_b16 a[106:107], v231 offset:20032
    v_mfma_f32_16x16x32_bf16 a[80:83], a[108:111], v[116:119], a[80:83]
    v_mfma_f32_16x16x32_bf16 a[80:83], a[112:115], v[128:131], a[80:83]
    v_mfma_f32_16x16x32_bf16 a[80:83], a[116:119], v[140:143], a[80:83]
    ds_read_b64_tr_b16 a[108:109], v231 offset:23616
    ds_read_b64_tr_b16 a[110:111], v231 offset:27200
    v_mfma_f32_16x16x32_bf16 a[84:87], a[120:123], v[96:99], a[84:87]
    v_mfma_f32_16x16x32_bf16 a[84:87], a[124:127], v[108:111], a[84:87]
    s_add_u32 m0, s10, 65536
    ds_read_b64_tr_b16 a[112:113], v231 offset:16480
    ds_read_b64_tr_b16 a[114:115], v231 offset:20064
    v_mfma_f32_16x16x32_bf16 a[84:87], a[128:131], v[120:123], a[84:87]
    buffer_load_dwordx4 v246, s[48:51], s9 offen offset:2048 lds
    v_mfma_f32_16x16x32_bf16 a[84:87], a[132:135], v[132:135], a[84:87]
    v_mfma_f32_16x16x32_bf16 a[88:91], a[120:123], v[100:103], a[88:91]
    s_add_u32 m0, s10, 65536
    ds_read_b64_tr_b16 a[116:117], v231 offset:23648
    ds_read_b64_tr_b16 a[118:119], v231 offset:27232
    v_mfma_f32_16x16x32_bf16 a[88:91], a[124:127], v[112:115], a[88:91]
    buffer_load_dwordx4 v247, s[48:51], s9 offen offset:3072 lds
    v_mfma_f32_16x16x32_bf16 a[88:91], a[128:131], v[124:127], a[88:91]
    v_mfma_f32_16x16x32_bf16 a[88:91], a[132:135], v[136:139], a[88:91]
    v_mfma_f32_16x16x32_bf16 a[92:95], a[120:123], v[104:107], a[92:95]
    ds_read_b64_tr_b16 a[120:121], v231 offset:16512
    ds_read_b64_tr_b16 a[122:123], v231 offset:20096
    v_mfma_f32_16x16x32_bf16 a[92:95], a[124:127], v[116:119], a[92:95]
    ds_read_b64_tr_b16 a[124:125], v231 offset:23680
    ds_read_b64_tr_b16 a[126:127], v231 offset:27264
    v_mfma_f32_16x16x32_bf16 a[92:95], a[128:131], v[128:131], a[92:95]
    v_mfma_f32_16x16x32_bf16 a[92:95], a[132:135], v[140:143], a[92:95]
    s_waitcnt lgkmcnt(14)
    ds_read_b64_tr_b16 a[128:129], v231 offset:16544
    ds_read_b64_tr_b16 a[130:131], v231 offset:20128
    v_mfma_f32_16x16x32_bf16 a[172:175], a[136:139], v[192:195], a[172:175]
    v_mfma_f32_16x16x32_bf16 a[172:175], a[140:143], v[204:207], a[172:175]
    v_mfma_f32_16x16x32_bf16 a[176:179], a[136:139], v[196:199], a[176:179]
    ds_read_b64_tr_b16 a[132:133], v231 offset:23712
    ds_read_b64_tr_b16 a[134:135], v231 offset:27296
    v_mfma_f32_16x16x32_bf16 a[176:179], a[140:143], v[208:211], a[176:179]
    v_mfma_f32_16x16x32_bf16 a[180:183], a[136:139], v[200:203], a[180:183]
    ds_read_b64_tr_b16 a[136:137], v231 offset:16576
    ds_read_b64_tr_b16 a[138:139], v231 offset:20160
    v_mfma_f32_16x16x32_bf16 a[180:183], a[140:143], v[212:215], a[180:183]
    s_waitcnt lgkmcnt(14)
    v_mfma_f32_16x16x32_bf16 a[184:187], a[96:99], v[192:195], a[184:187]
    v_mfma_f32_16x16x32_bf16 a[184:187], a[100:103], v[204:207], a[184:187]
    ds_read_b64_tr_b16 a[140:141], v231 offset:23744
    ds_read_b64_tr_b16 a[142:143], v231 offset:27328
    v_mfma_f32_16x16x32_bf16 a[188:191], a[96:99], v[196:199], a[188:191]
    v_mfma_f32_16x16x32_bf16 a[188:191], a[100:103], v[208:211], a[188:191]
    s_add_u32 s73, s77, 9216
    buffer_store_dwordx4 v[212:215], v239, s[52:55], s73 offen offset:2048 sc1
    v_mfma_f32_16x16x32_bf16 a[192:195], a[96:99], v[200:203], a[192:195]
    v_mfma_f32_16x16x32_bf16 a[192:195], a[100:103], v[212:215], a[192:195]
    v_mfma_f32_16x16x32_bf16 a[196:199], a[104:107], v[192:195], a[196:199]
    v_mfma_f32_16x16x32_bf16 a[196:199], a[108:111], v[204:207], a[196:199]
    v_mfma_f32_16x16x32_bf16 a[200:203], a[104:107], v[196:199], a[200:203]
    v_mfma_f32_16x16x32_bf16 a[200:203], a[108:111], v[208:211], a[200:203]
    s_waitcnt lgkmcnt(0)
    s_barrier
    v_mfma_f32_16x16x32_bf16 a[204:207], a[104:107], v[200:203], a[204:207]
    s_add_u32 s9, s82, 172032
    s_add_u32 m0, s10, 147456
    ds_read_b64_tr_b16 a[96:97], v240 offset:16384
    ds_read_b64_tr_b16 a[98:99], v240 offset:18432
    v_mfma_f32_16x16x32_bf16 a[204:207], a[108:111], v[212:215], a[204:207]
    buffer_load_dwordx4 v244, s[48:51], s9 offen lds
    v_mfma_f32_16x16x32_bf16 a[208:211], a[112:115], v[192:195], a[208:211]
    v_mfma_f32_16x16x32_bf16 a[208:211], a[116:119], v[204:207], a[208:211]
    ds_read_b64_tr_b16 a[100:101], v240 offset:20480
    ds_read_b64_tr_b16 a[102:103], v240 offset:22528
    v_mfma_f32_16x16x32_bf16 a[212:215], a[112:115], v[196:199], a[212:215]
    v_mfma_f32_16x16x32_bf16 a[212:215], a[116:119], v[208:211], a[212:215]
    s_add_u32 m0, s10, 147456
    ds_read_b64_tr_b16 a[104:105], v240 offset:24576
    ds_read_b64_tr_b16 a[106:107], v240 offset:26624
    v_mfma_f32_16x16x32_bf16 a[216:219], a[112:115], v[200:203], a[216:219]
    buffer_load_dwordx4 v245, s[48:51], s9 offen offset:1024 lds
    v_mfma_f32_16x16x32_bf16 a[216:219], a[116:119], v[212:215], a[216:219]
    v_mfma_f32_16x16x32_bf16 a[220:223], a[120:123], v[192:195], a[220:223]
    s_add_u32 m0, s10, 147456
    ds_read_b64_tr_b16 a[108:109], v240 offset:28672
    ds_read_b64_tr_b16 a[110:111], v240 offset:30720
    v_mfma_f32_16x16x32_bf16 a[220:223], a[124:127], v[204:207], a[220:223]
    buffer_load_dwordx4 v246, s[48:51], s9 offen offset:2048 lds
    v_mfma_f32_16x16x32_bf16 a[224:227], a[120:123], v[196:199], a[224:227]
    ds_read_b64_tr_b16 a[112:113], v241 offset:16384
    ds_read_b64_tr_b16 a[114:115], v241 offset:18432
    v_mfma_f32_16x16x32_bf16 a[224:227], a[124:127], v[208:211], a[224:227]
    v_mfma_f32_16x16x32_bf16 a[228:231], a[120:123], v[200:203], a[228:231]
    v_mfma_f32_16x16x32_bf16 a[228:231], a[124:127], v[212:215], a[228:231]
    ds_read_b64_tr_b16 a[116:117], v241 offset:20480
    ds_read_b64_tr_b16 a[118:119], v241 offset:22528
    v_mfma_f32_16x16x32_bf16 a[232:235], a[128:131], v[192:195], a[232:235]
    s_add_u32 m0, s10, 147456
    v_mfma_f32_16x16x32_bf16 a[232:235], a[132:135], v[204:207], a[232:235]
    buffer_load_dwordx4 v247, s[48:51], s9 offen offset:3072 lds
    v_mfma_f32_16x16x32_bf16 a[236:239], a[128:131], v[196:199], a[236:239]
    ds_read_b64_tr_b16 a[120:121], v241 offset:24576
    ds_read_b64_tr_b16 a[122:123], v241 offset:26624
    v_mfma_f32_16x16x32_bf16 a[236:239], a[132:135], v[208:211], a[236:239]
    v_mfma_f32_16x16x32_bf16 a[240:243], a[128:131], v[200:203], a[240:243]
    ds_read_b64_tr_b16 a[124:125], v241 offset:28672
    ds_read_b64_tr_b16 a[126:127], v241 offset:30720
    v_mfma_f32_16x16x32_bf16 a[240:243], a[132:135], v[212:215], a[240:243]
    v_mfma_f32_16x16x32_bf16 a[244:247], a[136:139], v[192:195], a[244:247]
    v_mfma_f32_16x16x32_bf16 a[244:247], a[140:143], v[204:207], a[244:247]
    ds_read_b64_tr_b16 a[128:129], v242 offset:16384
    ds_read_b64_tr_b16 a[130:131], v242 offset:18432
    v_mfma_f32_16x16x32_bf16 a[248:251], a[136:139], v[196:199], a[248:251]
    v_mfma_f32_16x16x32_bf16 a[248:251], a[140:143], v[208:211], a[248:251]
    ds_read_b64_tr_b16 a[132:133], v242 offset:20480
    ds_read_b64_tr_b16 a[134:135], v242 offset:22528
    v_mfma_f32_16x16x32_bf16 a[252:255], a[136:139], v[200:203], a[252:255]
    v_mfma_f32_16x16x32_bf16 a[252:255], a[140:143], v[212:215], a[252:255]
    s_waitcnt lgkmcnt(12)
    v_mfma_f32_16x16x32_bf16 a[48:51], a[96:99], v[144:147], a[48:51]
    ds_read_b64_tr_b16 a[136:137], v242 offset:24576
    ds_read_b64_tr_b16 a[138:139], v242 offset:26624
    v_mfma_f32_16x16x32_bf16 a[48:51], a[100:103], v[156:159], a[48:51]
    v_mfma_f32_16x16x32_bf16 a[48:51], a[104:107], v[168:171], a[48:51]
    v_mfma_f32_16x16x32_bf16 a[48:51], a[108:111], v[180:183], a[48:51]
    ds_read_b64_tr_b16 a[140:141], v242 offset:28672
    ds_read_b64_tr_b16 a[142:143], v242 offset:30720
    v_mfma_f32_16x16x32_bf16 a[52:55], a[96:99], v[148:151], a[52:55]
    v_mfma_f32_16x16x32_bf16 a[52:55], a[100:103], v[160:163], a[52:55]
    v_mfma_f32_16x16x32_bf16 a[52:55], a[104:107], v[172:175], a[52:55]
    v_mfma_f32_16x16x32_bf16 a[52:55], a[108:111], v[184:187], a[52:55]
    v_mfma_f32_16x16x32_bf16 a[56:59], a[96:99], v[152:155], a[56:59]
    ds_read_b64_tr_b16 a[96:97], v243 offset:16384
    ds_read_b64_tr_b16 a[98:99], v243 offset:18432
    v_mfma_f32_16x16x32_bf16 a[56:59], a[100:103], v[164:167], a[56:59]
    ds_read_b64_tr_b16 a[100:101], v243 offset:20480
    ds_read_b64_tr_b16 a[102:103], v243 offset:22528
    v_mfma_f32_16x16x32_bf16 a[56:59], a[104:107], v[176:179], a[56:59]
    ds_read_b64_tr_b16 a[104:105], v243 offset:24576
    ds_read_b64_tr_b16 a[106:107], v243 offset:26624
    v_mfma_f32_16x16x32_bf16 a[56:59], a[108:111], v[188:191], a[56:59]
    s_waitcnt lgkmcnt(14)
    v_mfma_f32_16x16x32_bf16 a[60:63], a[112:115], v[144:147], a[60:63]
    v_mfma_f32_16x16x32_bf16 a[60:63], a[116:119], v[156:159], a[60:63]
    ds_read_b64_tr_b16 a[108:109], v243 offset:28672
    ds_read_b64_tr_b16 a[110:111], v243 offset:30720
    v_mfma_f32_16x16x32_bf16 a[60:63], a[120:123], v[168:171], a[60:63]
    v_mfma_f32_16x16x32_bf16 a[60:63], a[124:127], v[180:183], a[60:63]
    v_mfma_f32_16x16x32_bf16 a[64:67], a[112:115], v[148:151], a[64:67]
    v_mfma_f32_16x16x32_bf16 a[64:67], a[116:119], v[160:163], a[64:67]
    v_mfma_f32_16x16x32_bf16 a[64:67], a[120:123], v[172:175], a[64:67]
    v_mfma_f32_16x16x32_bf16 a[64:67], a[124:127], v[184:187], a[64:67]
    v_mfma_f32_16x16x32_bf16 a[68:71], a[112:115], v[152:155], a[68:71]
    v_mfma_f32_16x16x32_bf16 a[68:71], a[116:119], v[164:167], a[68:71]
    s_waitcnt lgkmcnt(0)
    s_barrier
    v_mfma_f32_16x16x32_bf16 a[68:71], a[120:123], v[176:179], a[68:71]
    s_add_u32 s9, s99, 57344
    s_add_u32 m0, s10, 81920
    ds_read_b64_tr_b16 a[112:113], v240 offset:49152
    ds_read_b64_tr_b16 a[114:115], v240 offset:51200
    v_mfma_f32_16x16x32_bf16 a[68:71], a[124:127], v[188:191], a[68:71]
    buffer_load_dwordx4 v244, s[48:51], s9 offen lds
    v_mfma_f32_16x16x32_bf16 a[72:75], a[128:131], v[144:147], a[72:75]
    v_mfma_f32_16x16x32_bf16 a[72:75], a[132:135], v[156:159], a[72:75]
    ds_read_b64_tr_b16 a[116:117], v240 offset:53248
    ds_read_b64_tr_b16 a[118:119], v240 offset:55296
    v_mfma_f32_16x16x32_bf16 a[72:75], a[136:139], v[168:171], a[72:75]
    v_mfma_f32_16x16x32_bf16 a[72:75], a[140:143], v[180:183], a[72:75]
    s_add_u32 m0, s10, 81920
    ds_read_b64_tr_b16 a[120:121], v240 offset:57344
    ds_read_b64_tr_b16 a[122:123], v240 offset:59392
    v_mfma_f32_16x16x32_bf16 a[76:79], a[128:131], v[148:151], a[76:79]
    buffer_load_dwordx4 v245, s[48:51], s9 offen offset:1024 lds
    v_mfma_f32_16x16x32_bf16 a[76:79], a[132:135], v[160:163], a[76:79]
    v_mfma_f32_16x16x32_bf16 a[76:79], a[136:139], v[172:175], a[76:79]
    s_add_u32 m0, s10, 81920
    ds_read_b64_tr_b16 a[124:125], v240 offset:61440
    ds_read_b64_tr_b16 a[126:127], v240 offset:63488
    v_mfma_f32_16x16x32_bf16 a[76:79], a[140:143], v[184:187], a[76:79]
    buffer_load_dwordx4 v246, s[48:51], s9 offen offset:2048 lds
    v_mfma_f32_16x16x32_bf16 a[80:83], a[128:131], v[152:155], a[80:83]
    ds_read_b64_tr_b16 a[128:129], v241 offset:49152
    ds_read_b64_tr_b16 a[130:131], v241 offset:51200
    v_mfma_f32_16x16x32_bf16 a[80:83], a[132:135], v[164:167], a[80:83]
    v_mfma_f32_16x16x32_bf16 a[80:83], a[136:139], v[176:179], a[80:83]
    v_mfma_f32_16x16x32_bf16 a[80:83], a[140:143], v[188:191], a[80:83]
    ds_read_b64_tr_b16 a[132:133], v241 offset:53248
    ds_read_b64_tr_b16 a[134:135], v241 offset:55296
    s_waitcnt vmcnt(12)
    v_cmp_gt_u32 vcc, 1, v234
    s_nop 3
    s_cmp_lg_u64 vcc, 0
    s_cbranch_scc1 L_spin0
L_ret0:
    v_mfma_f32_16x16x32_bf16 a[84:87], a[96:99], v[144:147], a[84:87]
    s_add_u32 m0, s10, 81920
    v_mfma_f32_16x16x32_bf16 a[84:87], a[100:103], v[156:159], a[84:87]
    buffer_load_dwordx4 v247, s[48:51], s9 offen offset:3072 lds
    v_mfma_f32_16x16x32_bf16 a[84:87], a[104:107], v[168:171], a[84:87]
    ds_read_b64_tr_b16 a[136:137], v241 offset:57344
    ds_read_b64_tr_b16 a[138:139], v241 offset:59392
    v_mfma_f32_16x16x32_bf16 a[84:87], a[108:111], v[180:183], a[84:87]
    s_add_u32 s74, s96, 0
    buffer_load_dwordx4 a[144:147], v239, s[52:55], s74 offen sc1
    v_mfma_f32_16x16x32_bf16 a[88:91], a[96:99], v[148:151], a[88:91]
    ds_read_b64_tr_b16 a[140:141], v241 offset:61440
    ds_read_b64_tr_b16 a[142:143], v241 offset:63488
    v_mfma_f32_16x16x32_bf16 a[88:91], a[100:103], v[160:163], a[88:91]
    v_mfma_f32_16x16x32_bf16 a[88:91], a[104:107], v[172:175], a[88:91]
    v_mfma_f32_16x16x32_bf16 a[88:91], a[108:111], v[184:187], a[88:91]
    buffer_load_dwordx4 a[148:151], v239, s[52:55], s74 offen offset:1024 sc1
    v_mfma_f32_16x16x32_bf16 a[92:95], a[96:99], v[152:155], a[92:95]
    ds_read_b64_tr_b16 a[96:97], v242 offset:49152
    ds_read_b64_tr_b16 a[98:99], v242 offset:51200
    v_mfma_f32_16x16x32_bf16 a[92:95], a[100:103], v[164:167], a[92:95]
    ds_read_b64_tr_b16 a[100:101], v242 offset:53248
    ds_read_b64_tr_b16 a[102:103], v242 offset:55296
    v_mfma_f32_16x16x32_bf16 a[92:95], a[104:107], v[176:179], a[92:95]
    v_mfma_f32_16x16x32_bf16 a[92:95], a[108:111], v[188:191], a[92:95]
    s_waitcnt lgkmcnt(12)
    buffer_load_dwordx4 a[152:155], v239, s[52:55], s74 offen offset:2048 sc1
    v_mfma_f32_16x16x32_bf16 a[0:3], a[112:115], v[0:3], 0
    ds_read_b64_tr_b16 a[104:105], v242 offset:57344
    ds_read_b64_tr_b16 a[106:107], v242 offset:59392
    v_mfma_f32_16x16x32_bf16 a[0:3], a[116:119], v[12:15], a[0:3]
    v_mfma_f32_16x16x32_bf16 a[0:3], a[120:123], v[24:27], a[0:3]
    v_mfma_f32_16x16x32_bf16 a[0:3], a[124:127], v[36:39], a[0:3]
    ds_read_b64_tr_b16 a[108:109], v242 offset:61440
    ds_read_b64_tr_b16 a[110:111], v242 offset:63488
    v_mfma_f32_16x16x32_bf16 a[4:7], a[112:115], v[4:7], 0
    s_add_u32 s74, s96, 3072
    buffer_load_dwordx4 a[156:159], v239, s[52:55], s74 offen sc1
    v_accvgpr_read_b32 v216, a48
    v_mfma_f32_16x16x32_bf16 a[4:7], a[116:119], v[16:19], a[4:7]
    v_accvgpr_read_b32 v217, a49
    v_accvgpr_read_b32 v218, a50
    v_mfma_f32_16x16x32_bf16 a[4:7], a[120:123], v[28:31], a[4:7]
    v_accvgpr_read_b32 v219, a51
    v_mul_f32 v216, v216, v228
    v_mfma_f32_16x16x32_bf16 a[4:7], a[124:127], v[40:43], a[4:7]
    buffer_load_dwordx4 a[160:163], v239, s[52:55], s74 offen offset:1024 sc1
    v_mul_f32 v217, v217, v228
    v_mfma_f32_16x16x32_bf16 a[8:11], a[112:115], v[8:11], 0
    ds_read_b64_tr_b16 a[112:113], v243 offset:49152
    ds_read_b64_tr_b16 a[114:115], v243 offset:51200
    v_mfma_f32_16x16x32_bf16 a[8:11], a[116:119], v[20:23], a[8:11]
    ds_read_b64_tr_b16 a[116:117], v243 offset:53248
    ds_read_b64_tr_b16 a[118:119], v243 offset:55296
    v_mfma_f32_16x16x32_bf16 a[8:11], a[120:123], v[32:35], a[8:11]
    ds_read_b64_tr_b16 a[120:121], v243 offset:57344
    ds_read_b64_tr_b16 a[122:123], v243 offset:59392
    v_mfma_f32_16x16x32_bf16 a[8:11], a[124:127], v[44:47], a[8:11]
    s_waitcnt lgkmcnt(14)
    buffer_load_dwordx4 a[164:167], v239, s[52:55], s74 offen offset:2048 sc1
    v_mul_f32 v218, v218, v228
    v_mfma_f32_16x16x32_bf16 a[12:15], a[128:131], v[0:3], 0
    v_mul_f32 v219, v219, v228
    v_cvt_pk_bf16_f32 v192, v216, v217
    v_mfma_f32_16x16x32_bf16 a[12:15], a[132:135], v[12:15], a[12:15]
    ds_read_b64_tr_b16 a[124:125], v243 offset:61440
    ds_read_b64_tr_b16 a[126:127], v243 offset:63488
    v_mfma_f32_16x16x32_bf16 a[12:15], a[136:139], v[24:27], a[12:15]
    v_add_u32 v240, 0x10000, v240
    v_add_u32 v241, 0x10000, v241
    v_mfma_f32_16x16x32_bf16 a[12:15], a[140:143], v[36:39], a[12:15]
    v_add_u32 v242, 0x10000, v242
    v_add_u32 v243, 0x10000, v243
    v_mfma_f32_16x16x32_bf16 a[16:19], a[128:131], v[4:7], 0
    v_cvt_pk_bf16_f32 v193, v218, v219
    v_accvgpr_read_b32 v220, a60
    v_mfma_f32_16x16x32_bf16 a[16:19], a[132:135], v[16:19], a[16:19]
    v_accvgpr_read_b32 v221, a61
    v_accvgpr_read_b32 v222, a62
    v_mfma_f32_16x16x32_bf16 a[16:19], a[136:139], v[28:31], a[16:19]
    v_accvgpr_read_b32 v223, a63
    v_mul_f32 v220, v220, v228
    v_mfma_f32_16x16x32_bf16 a[16:19], a[140:143], v[40:43], a[16:19]
    v_mul_f32 v221, v221, v228
    v_mul_f32 v222, v222, v228
    v_mfma_f32_16x16x32_bf16 a[20:23], a[128:131], v[8:11], 0
    v_mul_f32 v223, v223, v228
    v_cvt_pk_bf16_f32 v194, v220, v221
    v_mfma_f32_16x16x32_bf16 a[20:23], a[132:135], v[20:23], a[20:23]
    s_waitcnt vmcnt(14) lgkmcnt(0)
    s_barrier
    v_cvt_pk_bf16_f32 v195, v222, v223
    v_mfma_f32_16x16x32_bf16 a[20:23], a[136:139], v[32:35], a[20:23]
    s_add_u32 s9, s100, 57344
    s_add_u32 m0, s10, 114688
    ds_read_b64_tr_b16 a[128:129], v240
    ds_read_b64_tr_b16 a[130:131], v240 offset:2048
    v_mfma_f32_16x16x32_bf16 a[20:23], a[140:143], v[44:47], a[20:23]
    buffer_load_dwordx4 v244, s[48:51], s9 offen lds
    v_mov_b32 v233, 2
    v_mfma_f32_16x16x32_bf16 a[24:27], a[96:99], v[0:3], 0
    buffer_store_dword v233, v232, s[68:71], 0 offen sc1
    v_accvgpr_read_b32 v224, a52
    v_mfma_f32_16x16x32_bf16 a[24:27], a[100:103], v[12:15], a[24:27]
    ds_read_b64_tr_b16 a[132:133], v240 offset:4096
    ds_read_b64_tr_b16 a[134:135], v240 offset:6144
    v_mfma_f32_16x16x32_bf16 a[24:27], a[104:107], v[24:27], a[24:27]
    v_accvgpr_read_b32 v225, a53
    v_accvgpr_read_b32 v226, a54
    v_mfma_f32_16x16x32_bf16 a[24:27], a[108:111], v[36:39], a[24:27]
    ds_read_b64_tr_b16 a[136:137], v240 offset:8192
    ds_read_b64_tr_b16 a[138:139], v240 offset:10240
    v_mfma_f32_16x16x32_bf16 a[28:31], a[96:99], v[4:7], 0
    s_add_u32 s73, s77, 12288
    buffer_store_dwordx4 v[192:195], v239, s[52:55], s73 offen sc1
    v_accvgpr_read_b32 v227, a55
    v_mfma_f32_16x16x32_bf16 a[28:31], a[100:103], v[16:19], a[28:31]
    v_mul_f32 v224, v224, v229
    v_mul_f32 v225, v225, v229
    v_mfma_f32_16x16x32_bf16 a[28:31], a[104:107], v[28:31], a[28:31]
    s_add_u32 m0, s10, 114688
    ds_read_b64_tr_b16 a[140:141], v240 offset:12288
    ds_read_b64_tr_b16 a[142:143], v240 offset:14336
    v_mfma_f32_16x16x32_bf16 a[28:31], a[108:111], v[40:43], a[28:31]
    buffer_load_dwordx4 v245, s[48:51], s9 offen offset:1024 lds
    v_mul_f32 v226, v226, v229
    v_mfma_f32_16x16x32_bf16 a[32:35], a[96:99], v[8:11], 0
    ds_read_b64_tr_b16 a[96:97], v241
    ds_read_b64_tr_b16 a[98:99], v241 offset:2048
    v_mfma_f32_16x16x32_bf16 a[32:35], a[100:103], v[20:23], a[32:35]
    v_mul_f32 v227, v227, v229
    v_cvt_pk_bf16_f32 v196, v224, v225
    v_mfma_f32_16x16x32_bf16 a[32:35], a[104:107], v[32:35], a[32:35]
    v_cvt_pk_bf16_f32 v197, v226, v227
    v_accvgpr_read_b32 v216, a64
    v_mfma_f32_16x16x32_bf16 a[32:35], a[108:111], v[44:47], a[32:35]
    ds_read_b64_tr_b16 a[100:101], v241 offset:4096
    ds_read_b64_tr_b16 a[102:103], v241 offset:6144
    v_mfma_f32_16x16x32_bf16 a[36:39], a[112:115], v[0:3], 0
    s_add_u32 m0, s10, 114688
    v_accvgpr_read_b32 v217, a65
    v_accvgpr_read_b32 v218, a66
    v_mfma_f32_16x16x32_bf16 a[36:39], a[116:119], v[12:15], a[36:39]
    buffer_load_dwordx4 v246, s[48:51], s9 offen offset:2048 lds
    v_accvgpr_read_b32 v219, a67
    v_mfma_f32_16x16x32_bf16 a[36:39], a[120:123], v[24:27], a[36:39]
    s_add_u32 m0, s10, 114688
    ds_read_b64_tr_b16 a[104:105], v241 offset:8192
    ds_read_b64_tr_b16 a[106:107], v241 offset:10240
    v_mfma_f32_16x16x32_bf16 a[36:39], a[124:127], v[36:39], a[36:39]
    buffer_load_dwordx4 v247, s[48:51], s9 offen offset:3072 lds
    v_mul_f32 v216, v216, v229
    v_mfma_f32_16x16x32_bf16 a[40:43], a[112:115], v[4:7], 0
    ds_read_b64_tr_b16 a[108:109], v241 offset:12288
    ds_read_b64_tr_b16 a[110:111], v241 offset:14336
    v_mfma_f32_16x16x32_bf16 a[40:43], a[116:119], v[16:19], a[40:43]
    v_mul_f32 v217, v217, v229
    v_mul_f32 v218, v218, v229
    v_mfma_f32_16x16x32_bf16 a[40:43], a[120:123], v[28:31], a[40:43]
    v_mul_f32 v219, v219, v229
    v_cvt_pk_bf16_f32 v198, v216, v217
    v_mfma_f32_16x16x32_bf16 a[40:43], a[124:127], v[40:43], a[40:43]
    v_cvt_pk_bf16_f32 v199, v218, v219
    v_mfma_f32_16x16x32_bf16 a[44:47], a[112:115], v[8:11], 0
    ds_read_b64_tr_b16 a[112:113], v242
    ds_read_b64_tr_b16 a[114:115], v242 offset:2048
    v_mfma_f32_16x16x32_bf16 a[44:47], a[116:119], v[20:23], a[44:47]
    ds_read_b64_tr_b16 a[116:117], v242 offset:4096
    ds_read_b64_tr_b16 a[118:119], v242 offset:6144
    v_mfma_f32_16x16x32_bf16 a[44:47], a[120:123], v[32:35], a[44:47]
    s_add_u32 s73, s77, 12288
    buffer_store_dwordx4 v[196:199], v239, s[52:55], s73 offen offset:1024 sc1
    v_accvgpr_read_b32 v220, a56
    v_mfma_f32_16x16x32_bf16 a[44:47], a[124:127], v[44:47], a[44:47]
    s_waitcnt lgkmcnt(12)
    v_accvgpr_read_b32 v221, a57
    v_accvgpr_read_b32 v222, a58
    v_mfma_f32_16x16x32_bf16 a[0:3], a[128:131], v[48:51], a[0:3]
    ds_read_b64_tr_b16 a[120:121], v242 offset:8192
    ds_read_b64_tr_b16 a[122:123], v242 offset:10240
    v_mfma_f32_16x16x32_bf16 a[0:3], a[132:135], v[60:63], a[0:3]
    s_add_u32 s74, s97, 0
    buffer_load_dwordx4 v[0:3], v239, s[52:55], s74 offen sc1
    v_accvgpr_read_b32 v223, a59
    v_mfma_f32_16x16x32_bf16 a[0:3], a[136:139], v[72:75], a[0:3]
    v_mul_f32 v220, v220, v230
    v_mul_f32 v221, v221, v230
    v_mfma_f32_16x16x32_bf16 a[0:3], a[140:143], v[84:87], a[0:3]
    ds_read_b64_tr_b16 a[124:125], v242 offset:12288
    ds_read_b64_tr_b16 a[126:127], v242 offset:14336
    v_mfma_f32_16x16x32_bf16 a[4:7], a[128:131], v[52:55], a[4:7]
    v_mul_f32 v222, v222, v230
    v_mul_f32 v223, v223, v230
    v_mfma_f32_16x16x32_bf16 a[4:7], a[132:135], v[64:67], a[4:7]
    buffer_load_dwordx4 v[4:7], v239, s[52:55], s74 offen offset:1024 sc1
    v_cvt_pk_bf16_f32 v200, v220, v221
    v_mfma_f32_16x16x32_bf16 a[4:7], a[136:139], v[76:79], a[4:7]
    v_cvt_pk_bf16_f32 v201, v222, v223
    v_accvgpr_read_b32 v224, a68
    v_mfma_f32_16x16x32_bf16 a[4:7], a[140:143], v[88:91], a[4:7]
    v_accvgpr_read_b32 v225, a69
    v_accvgpr_read_b32 v226, a70
    v_mfma_f32_16x16x32_bf16 a[8:11], a[128:131], v[56:59], a[8:11]
    ds_read_b64_tr_b16 a[128:129], v243
    ds_read_b64_tr_b16 a[130:131], v243 offset:2048
    v_mfma_f32_16x16x32_bf16 a[8:11], a[132:135], v[68:71], a[8:11]
    ds_read_b64_tr_b16 a[132:133], v243 offset:4096
    ds_read_b64_tr_b16 a[134:135], v243 offset:6144
    v_mfma_f32_16x16x32_bf16 a[8:11], a[136:139], v[80:83], a[8:11]
    ds_read_b64_tr_b16 a[136:137], v243 offset:8192
    ds_read_b64_tr_b16 a[138:139], v243 offset:10240
    v_mfma_f32_16x16x32_bf16 a[8:11], a[140:143], v[92:95], a[8:11]
    s_waitcnt lgkmcnt(14)
    buffer_load_dwordx4 v[8:11], v239, s[52:55], s74 offen offset:2048 sc1
    v_accvgpr_read_b32 v227, a71
    v_mfma_f32_16x16x32_bf16 a[12:15], a[96:99], v[48:51], a[12:15]
    v_mul_f32 v224, v224, v230
    v_mul_f32 v225, v225, v230
    v_mfma_f32_16x16x32_bf16 a[12:15], a[100:103], v[60:63], a[12:15]
    ds_read_b64_tr_b16 a[140:141], v243 offset:12288
    ds_read_b64_tr_b16 a[142:143], v243 offset:14336
    v_mfma_f32_16x16x32_bf16 a[12:15], a[104:107], v[72:75], a[12:15]
    v_add_u32 v240, 0xfffe0000, v240
    v_add_u32 v241, 0xfffe0000, v241
    v_mfma_f32_16x16x32_bf16 a[12:15], a[108:111], v[84:87], a[12:15]
    v_add_u32 v242, 0xfffe0000, v242
    v_add_u32 v243, 0xfffe0000, v243
    v_mul_f32 v226, v226, v230
    v_mul_f32 v227, v227, v230
    v_cvt_pk_bf16_f32 v202, v224, v225
    v_cvt_pk_bf16_f32 v203, v226, v227
    v_mfma_f32_16x16x32_bf16 a[16:19], a[96:99], v[52:55], a[16:19]
    s_add_u32 s74, s97, 3072
    buffer_load_dwordx4 v[12:15], v239, s[52:55], s74 offen sc1
    v_accvgpr_read_b32 v216, a72
    v_mfma_f32_16x16x32_bf16 a[16:19], a[100:103], v[64:67], a[16:19]
    s_add_u32 s73, s77, 12288
    buffer_store_dwordx4 v[200:203], v239, s[52:55], s73 offen offset:2048 sc1
    v_accvgpr_read_b32 v217, a73
    v_mfma_f32_16x16x32_bf16 a[16:19], a[104:107], v[76:79], a[16:19]
    v_accvgpr_read_b32 v218, a74
    v_accvgpr_read_b32 v219, a75
    v_mfma_f32_16x16x32_bf16 a[16:19], a[108:111], v[88:91], a[16:19]
    v_mul_f32 v216, v216, v228
    v_mul_f32 v217, v217, v228
    v_mfma_f32_16x16x32_bf16 a[20:23], a[96:99], v[56:59], a[20:23]
    v_mul_f32 v218, v218, v228
    v_mul_f32 v219, v219, v228
    v_mfma_f32_16x16x32_bf16 a[20:23], a[100:103], v[68:71], a[20:23]
    s_waitcnt lgkmcnt(0)
    s_barrier
    buffer_load_dwordx4 v[16:19], v239, s[52:55], s74 offen offset:1024 sc1
    v_mfma_f32_16x16x32_bf16 a[20:23], a[104:107], v[80:83], a[20:23]
    ds_read_b64_tr_b16 a[96:97], v240 offset:32768
    ds_read_b64_tr_b16 a[98:99], v240 offset:34816
    v_mfma_f32_16x16x32_bf16 a[20:23], a[108:111], v[92:95], a[20:23]
    v_cvt_pk_bf16_f32 v204, v216, v217
    v_cvt_pk_bf16_f32 v205, v218, v219
    v_mfma_f32_16x16x32_bf16 a[24:27], a[112:115], v[48:51], a[24:27]
    v_accvgpr_read_b32 v220, a84
    v_accvgpr_read_b32 v221, a85
    v_mfma_f32_16x16x32_bf16 a[24:27], a[116:119], v[60:63], a[24:27]
    ds_read_b64_tr_b16 a[100:101], v240 offset:36864
    ds_read_b64_tr_b16 a[102:103], v240 offset:38912
    v_mfma_f32_16x16x32_bf16 a[24:27], a[120:123], v[72:75], a[24:27]
    buffer_load_dwordx4 v[20:23], v239, s[52:55], s74 offen offset:2048 sc1
    v_accvgpr_read_b32 v222, a86
    v_mfma_f32_16x16x32_bf16 a[24:27], a[124:127], v[84:87], a[24:27]
    ds_read_b64_tr_b16 a[104:105], v240 offset:40960
    ds_read_b64_tr_b16 a[106:107], v240 offset:43008
    v_mfma_f32_16x16x32_bf16 a[28:31], a[112:115], v[52:55], a[28:31]
    v_accvgpr_read_b32 v223, a87
    v_mul_f32 v220, v220, v228
    v_mfma_f32_16x16x32_bf16 a[28:31], a[116:119], v[64:67], a[28:31]
    s_add_u32 s74, s98, 0
    buffer_load_dwordx4 v[24:27], v239, s[52:55], s74 offen sc1
    v_mul_f32 v221, v221, v228
    v_mfma_f32_16x16x32_bf16 a[28:31], a[120:123], v[76:79], a[28:31]
    ds_read_b64_tr_b16 a[108:109], v240 offset:45056
    ds_read_b64_tr_b16 a[110:111], v240 offset:47104
    v_mfma_f32_16x16x32_bf16 a[28:31], a[124:127], v[88:91], a[28:31]
    v_mul_f32 v222, v222, v228
    v_mul_f32 v223, v223, v228
    v_mfma_f32_16x16x32_bf16 a[32:35], a[112:115], v[56:59], a[32:35]
    ds_read_b64_tr_b16 a[112:113], v241 offset:32768
    ds_read_b64_tr_b16 a[114:115], v241 offset:34816
    v_mfma_f32_16x16x32_bf16 a[32:35], a[116:119], v[68:71], a[32:35]
    buffer_load_dwordx4 v[28:31], v239, s[52:55], s74 offen offset:1024 sc1
    v_cvt_pk_bf16_f32 v206, v220, v221
    v_mfma_f32_16x16x32_bf16 a[32:35], a[120:123], v[80:83], a[32:35]
    v_cvt_pk_bf16_f32 v207, v222, v223
    v_mfma_f32_16x16x32_bf16 a[32:35], a[124:127], v[92:95], a[32:35]
    ds_read_b64_tr_b16 a[116:117], v241 offset:36864
    ds_read_b64_tr_b16 a[118:119], v241 offset:38912
    v_mfma_f32_16x16x32_bf16 a[36:39], a[128:131], v[48:51], a[36:39]
    v_accvgpr_read_b32 v224, a76
    v_accvgpr_read_b32 v225, a77
    v_mfma_f32_16x16x32_bf16 a[36:39], a[132:135], v[60:63], a[36:39]
    buffer_load_dwordx4 v[32:35], v239, s[52:55], s74 offen offset:2048 sc1
    v_accvgpr_read_b32 v226, a78
    v_mfma_f32_16x16x32_bf16 a[36:39], a[136:139], v[72:75], a[36:39]
    ds_read_b64_tr_b16 a[120:121], v241 offset:40960
    ds_read_b64_tr_b16 a[122:123], v241 offset:43008
    v_mfma_f32_16x16x32_bf16 a[36:39], a[140:143], v[84:87], a[36:39]
    v_accvgpr_read_b32 v227, a79
    v_mul_f32 v224, v224, v229
    v_mfma_f32_16x16x32_bf16 a[40:43], a[128:131], v[52:55], a[40:43]
    ds_read_b64_tr_b16 a[124:125], v241 offset:45056
    ds_read_b64_tr_b16 a[126:127], v241 offset:47104
    v_mfma_f32_16x16x32_bf16 a[40:43], a[132:135], v[64:67], a[40:43]
    s_add_u32 s74, s98, 3072
    buffer_load_dwordx4 v[36:39], v239, s[52:55], s74 offen sc1
    v_mul_f32 v225, v225, v229
    v_mfma_f32_16x16x32_bf16 a[40:43], a[136:139], v[76:79], a[40:43]
    v_mul_f32 v226, v226, v229
    v_mul_f32 v227, v227, v229
    v_mfma_f32_16x16x32_bf16 a[40:43], a[140:143], v[88:91], a[40:43]
    v_cvt_pk_bf16_f32 v208, v224, v225
    v_cvt_pk_bf16_f32 v209, v226, v227
    v_mfma_f32_16x16x32_bf16 a[44:47], a[128:131], v[56:59], a[44:47]
    ds_read_b64_tr_b16 a[128:129], v242 offset:32768
    ds_read_b64_tr_b16 a[130:131], v242 offset:34816
    v_mfma_f32_16x16x32_bf16 a[44:47], a[132:135], v[68:71], a[44:47]
    ds_read_b64_tr_b16 a[132:133], v242 offset:36864
    ds_read_b64_tr_b16 a[134:135], v242 offset:38912
    v_mfma_f32_16x16x32_bf16 a[44:47], a[136:139], v[80:83], a[44:47]
    s_add_u32 s73, s77, 15360
    buffer_store_dwordx4 v[204:207], v239, s[52:55], s73 offen sc1
    v_accvgpr_read_b32 v216, a88
    v_mfma_f32_16x16x32_bf16 a[44:47], a[140:143], v[92:95], a[44:47]
    s_waitcnt lgkmcnt(12)
    v_accvgpr_read_b32 v217, a89
    v_accvgpr_read_b32 v218, a90
    v_mfma_f32_16x16x32_bf16 a[0:3], a[96:99], v[96:99], a[0:3]
    ds_read_b64_tr_b16 a[136:137], v242 offset:40960
    ds_read_b64_tr_b16 a[138:139], v242 offset:43008
    v_mfma_f32_16x16x32_bf16 a[0:3], a[100:103], v[108:111], a[0:3]
    buffer_load_dwordx4 v[40:43], v239, s[52:55], s74 offen offset:1024 sc1
    v_accvgpr_read_b32 v219, a91
    v_mfma_f32_16x16x32_bf16 a[0:3], a[104:107], v[120:123], a[0:3]
    v_mul_f32 v216, v216, v229
    v_mul_f32 v217, v217, v229
    v_mfma_f32_16x16x32_bf16 a[0:3], a[108:111], v[132:135], a[0:3]
    ds_read_b64_tr_b16 a[140:141], v242 offset:45056
    ds_read_b64_tr_b16 a[142:143], v242 offset:47104
    v_mfma_f32_16x16x32_bf16 a[4:7], a[96:99], v[100:103], a[4:7]
    v_mul_f32 v218, v218, v229
    v_mul_f32 v219, v219, v229
    v_mfma_f32_16x16x32_bf16 a[4:7], a[100:103], v[112:115], a[4:7]
    buffer_load_dwordx4 v[44:47], v239, s[52:55], s74 offen offset:2048 sc1
    v_cvt_pk_bf16_f32 v210, v216, v217
    v_mfma_f32_16x16x32_bf16 a[4:7], a[104:107], v[124:127], a[4:7]
    v_cvt_pk_bf16_f32 v211, v218, v219
    v_mfma_f32_16x16x32_bf16 a[4:7], a[108:111], v[136:139], a[4:7]
    v_accvgpr_read_b32 v220, a80
    v_accvgpr_read_b32 v221, a81
    v_mfma_f32_16x16x32_bf16 a[8:11], a[96:99], v[104:107], a[8:11]
    ds_read_b64_tr_b16 a[96:97], v243 offset:32768
    ds_read_b64_tr_b16 a[98:99], v243 offset:34816
    v_mfma_f32_16x16x32_bf16 a[8:11], a[100:103], v[116:119], a[8:11]
    ds_read_b64_tr_b16 a[100:101], v243 offset:36864
    ds_read_b64_tr_b16 a[102:103], v243 offset:38912
    v_mfma_f32_16x16x32_bf16 a[8:11], a[104:107], v[128:131], a[8:11]
    s_add_u32 s9, s101, 57344
    s_add_u32 m0, s10, 131072
    ds_read_b64_tr_b16 a[104:105], v243 offset:40960
    ds_read_b64_tr_b16 a[106:107], v243 offset:43008
    v_mfma_f32_16x16x32_bf16 a[8:11], a[108:111], v[140:143], a[8:11]
    s_waitcnt lgkmcnt(14)
    buffer_load_dwordx4 v244, s[48:51], s9 offen lds
    v_accvgpr_read_b32 v222, a82
    v_mfma_f32_16x16x32_bf16 a[12:15], a[112:115], v[96:99], a[12:15]
    v_accvgpr_read_b32 v223, a83
    v_mul_f32 v220, v220, v230
    v_mfma_f32_16x16x32_bf16 a[12:15], a[116:119], v[108:111], a[12:15]
    s_add_u32 m0, s10, 131072
    ds_read_b64_tr_b16 a[108:109], v243 offset:45056
    ds_read_b64_tr_b16 a[110:111], v243 offset:47104
    v_mfma_f32_16x16x32_bf16 a[12:15], a[120:123], v[120:123], a[12:15]
    buffer_load_dwordx4 v245, s[48:51], s9 offen offset:1024 lds
    v_add_u32 v231, 0xfffe0000, v231
    v_mfma_f32_16x16x32_bf16 a[12:15], a[124:127], v[132:135], a[12:15]
    v_mul_f32 v221, v221, v230
    v_mul_f32 v222, v222, v230
    v_mfma_f32_16x16x32_bf16 a[16:19], a[112:115], v[100:103], a[16:19]
    s_add_u32 m0, s10, 131072
    v_mul_f32 v223, v223, v230
    v_cvt_pk_bf16_f32 v212, v220, v221
    v_mfma_f32_16x16x32_bf16 a[16:19], a[116:119], v[112:115], a[16:19]
    buffer_load_dwordx4 v246, s[48:51], s9 offen offset:2048 lds
    v_cvt_pk_bf16_f32 v213, v222, v223
    v_mfma_f32_16x16x32_bf16 a[16:19], a[120:123], v[124:127], a[16:19]
    v_accvgpr_read_b32 v224, a92
    v_accvgpr_read_b32 v225, a93
    v_mfma_f32_16x16x32_bf16 a[16:19], a[124:127], v[136:139], a[16:19]
    v_accvgpr_read_b32 v226, a94
    v_accvgpr_read_b32 v227, a95
    v_mfma_f32_16x16x32_bf16 a[20:23], a[112:115], v[104:107], a[20:23]
    s_add_u32 m0, s10, 131072
    v_mul_f32 v224, v224, v230
    v_mul_f32 v225, v225, v230
    v_mfma_f32_16x16x32_bf16 a[20:23], a[116:119], v[116:119], a[20:23]
    s_waitcnt lgkmcnt(0)
    s_barrier
    buffer_load_dwordx4 v247, s[48:51], s9 offen offset:3072 lds
    v_mfma_f32_16x16x32_bf16 a[20:23], a[120:123], v[128:131], a[20:23]
    ds_read_b64_tr_b16 a[112:113], v231 offset:49152
    ds_read_b64_tr_b16 a[114:115], v231 offset:52736
    v_mfma_f32_16x16x32_bf16 a[20:23], a[124:127], v[140:143], a[20:23]
    v_mul_f32 v226, v226, v230
    v_mul_f32 v227, v227, v230
    v_mfma_f32_16x16x32_bf16 a[24:27], a[128:131], v[96:99], a[24:27]
    v_cvt_pk_bf16_f32 v214, v224, v225
    v_cvt_pk_bf16_f32 v215, v226, v227
    v_mfma_f32_16x16x32_bf16 a[24:27], a[132:135], v[108:111], a[24:27]
    s_add_u32 s9, s99, 114688
    s_add_u32 m0, s10, 32768
    ds_read_b64_tr_b16 a[116:117], v231 offset:56320
    ds_read_b64_tr_b16 a[118:119], v231 offset:59904
    buffer_load_dword v234, v235, s[68:71], 0 offen sc1
    v_mfma_f32_16x16x32_bf16 a[24:27], a[136:139], v[120:123], a[24:27]
    buffer_load_dwordx4 v244, s[48:51], s9 offen lds
    v_mfma_f32_16x16x32_bf16 a[24:27], a[140:143], v[132:135], a[24:27]
    ds_read_b64_tr_b16 a[120:121], v231 offset:49184
    ds_read_b64_tr_b16 a[122:123], v231 offset:52768
    v_mfma_f32_16x16x32_bf16 a[28:31], a[128:131], v[100:103], a[28:31]
    v_mfma_f32_16x16x32_bf16 a[28:31], a[132:135], v[112:115], a[28:31]
    s_add_u32 s73, s77, 15360
    buffer_store_dwordx4 v[208:211], v239, s[52:55], s73 offen offset:1024 sc1
    v_mfma_f32_16x16x32_bf16 a[28:31], a[136:139], v[124:127], a[28:31]
    ds_read_b64_tr_b16 a[124:125], v231 offset:56352
    ds_read_b64_tr_b16 a[126:127], v231 offset:59936
    v_mfma_f32_16x16x32_bf16 a[28:31], a[140:143], v[136:139], a[28:31]
    v_mfma_f32_16x16x32_bf16 a[32:35], a[128:131], v[104:107], a[32:35]
    s_add_u32 m0, s10, 32768
    ds_read_b64_tr_b16 a[128:129], v231 offset:49216
    ds_read_b64_tr_b16 a[130:131], v231 offset:52800
    v_mfma_f32_16x16x32_bf16 a[32:35], a[132:135], v[116:119], a[32:35]
    buffer_load_dwordx4 v245, s[48:51], s9 offen offset:1024 lds
    v_mfma_f32_16x16x32_bf16 a[32:35], a[136:139], v[128:131], a[32:35]
    v_mfma_f32_16x16x32_bf16 a[32:35], a[140:143], v[140:143], a[32:35]
    ds_read_b64_tr_b16 a[132:133], v231 offset:56384
    ds_read_b64_tr_b16 a[134:135], v231 offset:59968
    v_mfma_f32_16x16x32_bf16 a[36:39], a[96:99], v[96:99], a[36:39]
    v_mfma_f32_16x16x32_bf16 a[36:39], a[100:103], v[108:111], a[36:39]
    s_add_u32 m0, s10, 32768
    ds_read_b64_tr_b16 a[136:137], v231 offset:49248
    ds_read_b64_tr_b16 a[138:139], v231 offset:52832
    v_mfma_f32_16x16x32_bf16 a[36:39], a[104:107], v[120:123], a[36:39]
    buffer_load_dwordx4 v246, s[48:51], s9 offen offset:2048 lds
    v_mfma_f32_16x16x32_bf16 a[36:39], a[108:111], v[132:135], a[36:39]
    v_mfma_f32_16x16x32_bf16 a[40:43], a[96:99], v[100:103], a[40:43]
    s_add_u32 m0, s10, 32768
    ds_read_b64_tr_b16 a[140:141], v231 offset:56416
    ds_read_b64_tr_b16 a[142:143], v231 offset:60000
    v_mfma_f32_16x16x32_bf16 a[40:43], a[100:103], v[112:115], a[40:43]
    buffer_load_dwordx4 v247, s[48:51], s9 offen offset:3072 lds
    v_mfma_f32_16x16x32_bf16 a[40:43], a[104:107], v[124:127], a[40:43]
    v_mfma_f32_16x16x32_bf16 a[40:43], a[108:111], v[136:139], a[40:43]
    v_mfma_f32_16x16x32_bf16 a[44:47], a[96:99], v[104:107], a[44:47]
    ds_read_b64_tr_b16 a[96:97], v231 offset:49280
    ds_read_b64_tr_b16 a[98:99], v231 offset:52864
    v_mfma_f32_16x16x32_bf16 a[44:47], a[100:103], v[116:119], a[44:47]
    ds_read_b64_tr_b16 a[100:101], v231 offset:56448
    ds_read_b64_tr_b16 a[102:103], v231 offset:60032
    v_mfma_f32_16x16x32_bf16 a[44:47], a[104:107], v[128:131], a[44:47]
    v_mfma_f32_16x16x32_bf16 a[44:47], a[108:111], v[140:143], a[44:47]
    s_waitcnt lgkmcnt(14)
    ds_read_b64_tr_b16 a[104:105], v231 offset:49312
    ds_read_b64_tr_b16 a[106:107], v231 offset:52896
    v_mfma_f32_16x16x32_bf16 a[172:175], a[112:115], v[192:195], a[172:175]
    v_mfma_f32_16x16x32_bf16 a[172:175], a[116:119], v[204:207], a[172:175]
    v_mfma_f32_16x16x32_bf16 a[176:179], a[112:115], v[196:199], a[176:179]
    ds_read_b64_tr_b16 a[108:109], v231 offset:56480
    ds_read_b64_tr_b16 a[110:111], v231 offset:60064
    v_mfma_f32_16x16x32_bf16 a[176:179], a[116:119], v[208:211], a[176:179]
    v_mfma_f32_16x16x32_bf16 a[180:183], a[112:115], v[200:203], a[180:183]
    ds_read_b64_tr_b16 a[112:113], v231 offset:49344
    ds_read_b64_tr_b16 a[114:115], v231 offset:52928
    v_mfma_f32_16x16x32_bf16 a[180:183], a[116:119], v[212:215], a[180:183]
    s_waitcnt lgkmcnt(14)
    v_mfma_f32_16x16x32_bf16 a[184:187], a[120:123], v[192:195], a[184:187]
    v_mfma_f32_16x16x32_bf16 a[184:187], a[124:127], v[204:207], a[184:187]
    ds_read_b64_tr_b16 a[116:117], v231 offset:56512
    ds_read_b64_tr_b16 a[118:119], v231 offset:60096
    v_mfma_f32_16x16x32_bf16 a[188:191], a[120:123], v[196:199], a[188:191]
    v_add_u32 v240, 0x10000, v240
    v_add_u32 v241, 0x10000, v241
    v_mfma_f32_16x16x32_bf16 a[188:191], a[124:127], v[208:211], a[188:191]
    v_add_u32 v242, 0x10000, v242
    v_add_u32 v243, 0x10000, v243
    v_mfma_f32_16x16x32_bf16 a[192:195], a[120:123], v[200:203], a[192:195]
    s_add_u32 s73, s77, 15360
    buffer_store_dwordx4 v[212:215], v239, s[52:55], s73 offen offset:2048 sc1
    v_mfma_f32_16x16x32_bf16 a[192:195], a[124:127], v[212:215], a[192:195]
    v_mfma_f32_16x16x32_bf16 a[196:199], a[128:131], v[192:195], a[196:199]
    v_mfma_f32_16x16x32_bf16 a[196:199], a[132:135], v[204:207], a[196:199]
    v_mfma_f32_16x16x32_bf16 a[200:203], a[128:131], v[196:199], a[200:203]
    v_mfma_f32_16x16x32_bf16 a[200:203], a[132:135], v[208:211], a[200:203]
    s_waitcnt lgkmcnt(0)
    s_barrier
    v_mfma_f32_16x16x32_bf16 a[204:207], a[128:131], v[200:203], a[204:207]
    s_add_u32 s9, s100, 114688
    s_add_u32 m0, s10, 49152
    ds_read_b64_tr_b16 a[120:121], v240 offset:32768
    ds_read_b64_tr_b16 a[122:123], v240 offset:34816
    v_mfma_f32_16x16x32_bf16 a[204:207], a[132:135], v[212:215], a[204:207]
    buffer_load_dwordx4 v244, s[48:51], s9 offen lds
    v_mfma_f32_16x16x32_bf16 a[208:211], a[136:139], v[192:195], a[208:211]
    v_mfma_f32_16x16x32_bf16 a[208:211], a[140:143], v[204:207], a[208:211]
    ds_read_b64_tr_b16 a[124:125], v240 offset:36864
    ds_read_b64_tr_b16 a[126:127], v240 offset:38912
    v_mfma_f32_16x16x32_bf16 a[212:215], a[136:139], v[196:199], a[212:215]
    v_mfma_f32_16x16x32_bf16 a[212:215], a[140:143], v[208:211], a[212:215]
    s_add_u32 m0, s10, 49152
    ds_read_b64_tr_b16 a[128:129], v240 offset:40960
    ds_read_b64_tr_b16 a[130:131], v240 offset:43008
    v_mfma_f32_16x16x32_bf16 a[216:219], a[136:139], v[200:203], a[216:219]
    buffer_load_dwordx4 v245, s[48:51], s9 offen offset:1024 lds
    v_mfma_f32_16x16x32_bf16 a[216:219], a[140:143], v[212:215], a[216:219]
    v_mfma_f32_16x16x32_bf16 a[220:223], a[96:99], v[192:195], a[220:223]
    s_add_u32 m0, s10, 49152
    ds_read_b64_tr_b16 a[132:133], v240 offset:45056
    ds_read_b64_tr_b16 a[134:135], v240 offset:47104
    v_mfma_f32_16x16x32_bf16 a[220:223], a[100:103], v[204:207], a[220:223]
    buffer_load_dwordx4 v246, s[48:51], s9 offen offset:2048 lds
    v_mfma_f32_16x16x32_bf16 a[224:227], a[96:99], v[196:199], a[224:227]
    ds_read_b64_tr_b16 a[136:137], v241 offset:32768
    ds_read_b64_tr_b16 a[138:139], v241 offset:34816
    v_mfma_f32_16x16x32_bf16 a[224:227], a[100:103], v[208:211], a[224:227]
    v_mfma_f32_16x16x32_bf16 a[228:231], a[96:99], v[200:203], a[228:231]
    v_mfma_f32_16x16x32_bf16 a[228:231], a[100:103], v[212:215], a[228:231]
    ds_read_b64_tr_b16 a[140:141], v241 offset:36864
    ds_read_b64_tr_b16 a[142:143], v241 offset:38912
    v_mfma_f32_16x16x32_bf16 a[232:235], a[104:107], v[192:195], a[232:235]
    s_add_u32 m0, s10, 49152
    v_mfma_f32_16x16x32_bf16 a[232:235], a[108:111], v[204:207], a[232:235]
    buffer_load_dwordx4 v247, s[48:51], s9 offen offset:3072 lds
    v_mfma_f32_16x16x32_bf16 a[236:239], a[104:107], v[196:199], a[236:239]
    ds_read_b64_tr_b16 a[96:97], v241 offset:40960
    ds_read_b64_tr_b16 a[98:99], v241 offset:43008
    v_mfma_f32_16x16x32_bf16 a[236:239], a[108:111], v[208:211], a[236:239]
    v_mfma_f32_16x16x32_bf16 a[240:243], a[104:107], v[200:203], a[240:243]
    ds_read_b64_tr_b16 a[100:101], v241 offset:45056
    ds_read_b64_tr_b16 a[102:103], v241 offset:47104
    v_mfma_f32_16x16x32_bf16 a[240:243], a[108:111], v[212:215], a[240:243]
    v_mfma_f32_16x16x32_bf16 a[244:247], a[112:115], v[192:195], a[244:247]
    v_mfma_f32_16x16x32_bf16 a[244:247], a[116:119], v[204:207], a[244:247]
    ds_read_b64_tr_b16 a[104:105], v242 offset:32768
    ds_read_b64_tr_b16 a[106:107], v242 offset:34816
    v_mfma_f32_16x16x32_bf16 a[248:251], a[112:115], v[196:199], a[248:251]
    v_mfma_f32_16x16x32_bf16 a[248:251], a[116:119], v[208:211], a[248:251]
    ds_read_b64_tr_b16 a[108:109], v242 offset:36864
    ds_read_b64_tr_b16 a[110:111], v242 offset:38912
    v_mfma_f32_16x16x32_bf16 a[252:255], a[112:115], v[200:203], a[252:255]
    v_mfma_f32_16x16x32_bf16 a[252:255], a[116:119], v[212:215], a[252:255]
    s_waitcnt lgkmcnt(12)
    v_mfma_f32_16x16x32_bf16 a[0:3], a[120:123], v[144:147], a[0:3]
    ds_read_b64_tr_b16 a[112:113], v242 offset:40960
    ds_read_b64_tr_b16 a[114:115], v242 offset:43008
    v_mfma_f32_16x16x32_bf16 a[0:3], a[124:127], v[156:159], a[0:3]
    v_mfma_f32_16x16x32_bf16 a[0:3], a[128:131], v[168:171], a[0:3]
    v_mfma_f32_16x16x32_bf16 a[0:3], a[132:135], v[180:183], a[0:3]
    ds_read_b64_tr_b16 a[116:117], v242 offset:45056
    ds_read_b64_tr_b16 a[118:119], v242 offset:47104
    v_mfma_f32_16x16x32_bf16 a[4:7], a[120:123], v[148:151], a[4:7]
    v_mfma_f32_16x16x32_bf16 a[4:7], a[124:127], v[160:163], a[4:7]
    v_mfma_f32_16x16x32_bf16 a[4:7], a[128:131], v[172:175], a[4:7]
    v_mfma_f32_16x16x32_bf16 a[4:7], a[132:135], v[184:187], a[4:7]
    v_mfma_f32_16x16x32_bf16 a[8:11], a[120:123], v[152:155], a[8:11]
    ds_read_b64_tr_b16 a[120:121], v243 offset:32768
    ds_read_b64_tr_b16 a[122:123], v243 offset:34816
    v_mfma_f32_16x16x32_bf16 a[8:11], a[124:127], v[164:167], a[8:11]
    ds_read_b64_tr_b16 a[124:125], v243 offset:36864
    ds_read_b64_tr_b16 a[126:127], v243 offset:38912
    v_mfma_f32_16x16x32_bf16 a[8:11], a[128:131], v[176:179], a[8:11]
    ds_read_b64_tr_b16 a[128:129], v243 offset:40960
    ds_read_b64_tr_b16 a[130:131], v243 offset:43008
    v_mfma_f32_16x16x32_bf16 a[8:11], a[132:135], v[188:191], a[8:11]
    s_waitcnt lgkmcnt(14)
    v_mfma_f32_16x16x32_bf16 a[12:15], a[136:139], v[144:147], a[12:15]
    v_mfma_f32_16x16x32_bf16 a[12:15], a[140:143], v[156:159], a[12:15]
    ds_read_b64_tr_b16 a[132:133], v243 offset:45056
    ds_read_b64_tr_b16 a[134:135], v243 offset:47104
    v_mfma_f32_16x16x32_bf16 a[12:15], a[96:99], v[168:171], a[12:15]
    v_mfma_f32_16x16x32_bf16 a[12:15], a[100:103], v[180:183], a[12:15]
    v_mfma_f32_16x16x32_bf16 a[16:19], a[136:139], v[148:151], a[16:19]
    v_mfma_f32_16x16x32_bf16 a[16:19], a[140:143], v[160:163], a[16:19]
    v_mfma_f32_16x16x32_bf16 a[16:19], a[96:99], v[172:175], a[16:19]
    v_mfma_f32_16x16x32_bf16 a[16:19], a[100:103], v[184:187], a[16:19]
    v_mfma_f32_16x16x32_bf16 a[20:23], a[136:139], v[152:155], a[20:23]
    v_mfma_f32_16x16x32_bf16 a[20:23], a[140:143], v[164:167], a[20:23]
    s_waitcnt lgkmcnt(0)
    s_barrier
    v_mfma_f32_16x16x32_bf16 a[20:23], a[96:99], v[176:179], a[20:23]
    s_add_u32 s9, s101, 114688
    s_add_u32 m0, s10, 98304
    ds_read_b64_tr_b16 a[136:137], v231
    ds_read_b64_tr_b16 a[138:139], v231 offset:3584
    v_mfma_f32_16x16x32_bf16 a[20:23], a[100:103], v[188:191], a[20:23]
    buffer_load_dwordx4 v244, s[48:51], s9 offen lds
    v_mfma_f32_16x16x32_bf16 a[24:27], a[104:107], v[144:147], a[24:27]
    v_mfma_f32_16x16x32_bf16 a[24:27], a[108:111], v[156:159], a[24:27]
    ds_read_b64_tr_b16 a[140:141], v231 offset:7168
    ds_read_b64_tr_b16 a[142:143], v231 offset:10752
    v_mfma_f32_16x16x32_bf16 a[24:27], a[112:115], v[168:171], a[24:27]
    v_mfma_f32_16x16x32_bf16 a[24:27], a[116:119], v[180:183], a[24:27]
    s_add_u32 m0, s10, 98304
    ds_read_b64_tr_b16 a[96:97], v231 offset:32
    ds_read_b64_tr_b16 a[98:99], v231 offset:3616
    v_mfma_f32_16x16x32_bf16 a[28:31], a[104:107], v[148:151], a[28:31]
    buffer_load_dwordx4 v245, s[48:51], s9 offen offset:1024 lds
    v_mfma_f32_16x16x32_bf16 a[28:31], a[108:111], v[160:163], a[28:31]
    v_mfma_f32_16x16x32_bf16 a[28:31], a[112:115], v[172:175], a[28:31]
    s_add_u32 m0, s10, 98304
    ds_read_b64_tr_b16 a[100:101], v231 offset:7200
    ds_read_b64_tr_b16 a[102:103], v231 offset:10784
    v_mfma_f32_16x16x32_bf16 a[28:31], a[116:119], v[184:187], a[28:31]
    buffer_load_dwordx4 v246, s[48:51], s9 offen offset:2048 lds
    v_mfma_f32_16x16x32_bf16 a[32:35], a[104:107], v[152:155], a[32:35]
    ds_read_b64_tr_b16 a[104:105], v231 offset:64
    ds_read_b64_tr_b16 a[106:107], v231 offset:3648
    v_mfma_f32_16x16x32_bf16 a[32:35], a[108:111], v[164:167], a[32:35]
    v_mfma_f32_16x16x32_bf16 a[32:35], a[112:115], v[176:179], a[32:35]
    v_mfma_f32_16x16x32_bf16 a[32:35], a[116:119], v[188:191], a[32:35]
    ds_read_b64_tr_b16 a[108:109], v231 offset:7232
    ds_read_b64_tr_b16 a[110:111], v231 offset:10816
    s_waitcnt vmcnt(13)
    v_cmp_gt_u32 vcc, 2, v234
    s_nop 3
    s_cmp_lg_u64 vcc, 0
    s_cbranch_scc1 L_spin1
L_ret1:
    v_mfma_f32_16x16x32_bf16 a[36:39], a[120:123], v[144:147], a[36:39]
    v_mfma_f32_16x16x32_bf16 a[36:39], a[124:127], v[156:159], a[36:39]
    s_add_u32 m0, s10, 98304
    ds_read_b64_tr_b16 a[112:113], v231 offset:96
    ds_read_b64_tr_b16 a[114:115], v231 offset:3680
    v_mfma_f32_16x16x32_bf16 a[36:39], a[128:131], v[168:171], a[36:39]
    buffer_load_dwordx4 v247, s[48:51], s9 offen offset:3072 lds
    v_mfma_f32_16x16x32_bf16 a[36:39], a[132:135], v[180:183], a[36:39]
    s_add_u32 s74, s96, 6144
    buffer_load_dwordx4 v[48:51], v239, s[52:55], s74 offen sc1
    v_mfma_f32_16x16x32_bf16 a[40:43], a[120:123], v[148:151], a[40:43]
    ds_read_b64_tr_b16 a[116:117], v231 offset:7264
    ds_read_b64_tr_b16 a[118:119], v231 offset:10848
    v_mfma_f32_16x16x32_bf16 a[40:43], a[124:127], v[160:163], a[40:43]
    v_mfma_f32_16x16x32_bf16 a[40:43], a[128:131], v[172:175], a[40:43]
    v_mfma_f32_16x16x32_bf16 a[40:43], a[132:135], v[184:187], a[40:43]
    buffer_load_dwordx4 v[52:55], v239, s[52:55], s74 offen offset:1024 sc1
    v_mfma_f32_16x16x32_bf16 a[44:47], a[120:123], v[152:155], a[44:47]
    ds_read_b64_tr_b16 a[120:121], v231 offset:128
    ds_read_b64_tr_b16 a[122:123], v231 offset:3712
    v_mfma_f32_16x16x32_bf16 a[44:47], a[124:127], v[164:167], a[44:47]
    ds_read_b64_tr_b16 a[124:125], v231 offset:7296
    ds_read_b64_tr_b16 a[126:127], v231 offset:10880
    v_mfma_f32_16x16x32_bf16 a[44:47], a[128:131], v[176:179], a[44:47]
    v_mfma_f32_16x16x32_bf16 a[44:47], a[132:135], v[188:191], a[44:47]
    s_waitcnt lgkmcnt(14)
    ds_read_b64_tr_b16 a[128:129], v231 offset:160
    ds_read_b64_tr_b16 a[130:131], v231 offset:3744
    v_mfma_f32_16x16x32_bf16 a[172:175], a[136:139], a[144:147], a[172:175]
    buffer_load_dwordx4 v[56:59], v239, s[52:55], s74 offen offset:2048 sc1
    v_mfma_f32_16x16x32_bf16 a[172:175], a[140:143], a[156:159], a[172:175]
    v_mfma_f32_16x16x32_bf16 a[176:179], a[136:139], a[148:151], a[176:179]
    ds_read_b64_tr_b16 a[132:133], v231 offset:7328
    ds_read_b64_tr_b16 a[134:135], v231 offset:10912
    v_mfma_f32_16x16x32_bf16 a[176:179], a[140:143], a[160:163], a[176:179]
    s_add_u32 s74, s96, 9216
    buffer_load_dwordx4 v[60:63], v239, s[52:55], s74 offen sc1
    v_accvgpr_read_b32 v216, a0
    v_mfma_f32_16x16x32_bf16 a[180:183], a[136:139], a[152:155], a[180:183]
    ds_read_b64_tr_b16 a[136:137], v231 offset:192
    ds_read_b64_tr_b16 a[138:139], v231 offset:3776
    v_mfma_f32_16x16x32_bf16 a[180:183], a[140:143], a[164:167], a[180:183]
    s_waitcnt lgkmcnt(14)
    v_accvgpr_read_b32 v217, a1
    v_accvgpr_read_b32 v218, a2
    v_mfma_f32_16x16x32_bf16 a[184:187], a[96:99], a[144:147], a[184:187]
    v_accvgpr_read_b32 v219, a3
    v_mul_f32 v216, v216, v228
    v_mfma_f32_16x16x32_bf16 a[184:187], a[100:103], a[156:159], a[184:187]
    ds_read_b64_tr_b16 a[140:141], v231 offset:7360
    ds_read_b64_tr_b16 a[142:143], v231 offset:10944
    v_mfma_f32_16x16x32_bf16 a[188:191], a[96:99], a[148:151], a[188:191]
    buffer_load_dwordx4 v[64:67], v239, s[52:55], s74 offen offset:1024 sc1
    v_mul_f32 v217, v217, v228
    v_mfma_f32_16x16x32_bf16 a[188:191], a[100:103], a[160:163], a[188:191]
    v_mul_f32 v218, v218, v228
    v_mul_f32 v219, v219, v228
    v_mfma_f32_16x16x32_bf16 a[192:195], a[96:99], a[152:155], a[192:195]
    v_cvt_pk_bf16_f32 v192, v216, v217
    v_cvt_pk_bf16_f32 v193, v218, v219
    v_mfma_f32_16x16x32_bf16 a[192:195], a[100:103], a[164:167], a[192:195]
    buffer_load_dwordx4 v[68:71], v239, s[52:55], s74 offen offset:2048 sc1
    v_accvgpr_read_b32 v220, a12
    v_mfma_f32_16x16x32_bf16 a[196:199], a[104:107], a[144:147], a[196:199]
    v_accvgpr_read_b32 v221, a13
    v_accvgpr_read_b32 v222, a14
    v_mfma_f32_16x16x32_bf16 a[196:199], a[108:111], a[156:159], a[196:199]
    v_accvgpr_read_b32 v223, a15
    v_mul_f32 v220, v220, v228
    v_mfma_f32_16x16x32_bf16 a[200:203], a[104:107], a[148:151], a[200:203]
    v_mul_f32 v221, v221, v228
    v_mul_f32 v222, v222, v228
    v_mfma_f32_16x16x32_bf16 a[200:203], a[108:111], a[160:163], a[200:203]
    s_waitcnt vmcnt(14) lgkmcnt(0)
    s_barrier
    s_add_u32 s74, s97, 6144
    buffer_load_dwordx4 v[72:75], v239, s[52:55], s74 offen sc1
    v_mfma_f32_16x16x32_bf16 a[204:207], a[104:107], a[152:155], a[204:207]
    ds_read_b64_tr_b16 a[96:97], v231 offset:16384
    ds_read_b64_tr_b16 a[98:99], v231 offset:19968
    v_mfma_f32_16x16x32_bf16 a[204:207], a[108:111], a[164:167], a[204:207]
    v_mov_b32 v233, 3
    v_mul_f32 v223, v223, v228
    v_mfma_f32_16x16x32_bf16 a[208:211], a[112:115], a[144:147], a[208:211]
    buffer_store_dword v233, v232, s[68:71], 0 offen sc1
    v_cvt_pk_bf16_f32 v194, v220, v221
    v_mfma_f32_16x16x32_bf16 a[208:211], a[116:119], a[156:159], a[208:211]
    ds_read_b64_tr_b16 a[100:101], v231 offset:23552
    ds_read_b64_tr_b16 a[102:103], v231 offset:27136
    v_mfma_f32_16x16x32_bf16 a[212:215], a[112:115], a[148:151], a[212:215]
    buffer_load_dwordx4 v[76:79], v239, s[52:55], s74 offen offset:1024 sc1
    v_cvt_pk_bf16_f32 v195, v222, v223
    v_mfma_f32_16x16x32_bf16 a[212:215], a[116:119], a[160:163], a[212:215]
    ds_read_b64_tr_b16 a[104:105], v231 offset:16416
    ds_read_b64_tr_b16 a[106:107], v231 offset:20000
    v_mfma_f32_16x16x32_bf16 a[216:219], a[112:115], a[152:155], a[216:219]
    v_accvgpr_read_b32 v224, a4
    v_accvgpr_read_b32 v225, a5
    v_mfma_f32_16x16x32_bf16 a[216:219], a[116:119], a[164:167], a[216:219]
    s_add_u32 s73, s77, 18432
    buffer_store_dwordx4 v[192:195], v239, s[52:55], s73 offen sc1
    v_mfma_f32_16x16x32_bf16 a[220:223], a[120:123], a[144:147], a[220:223]
    ds_read_b64_tr_b16 a[108:109], v231 offset:23584
    ds_read_b64_tr_b16 a[110:111], v231 offset:27168
    v_mfma_f32_16x16x32_bf16 a[220:223], a[124:127], a[156:159], a[220:223]
    v_accvgpr_read_b32 v226, a6
    v_accvgpr_read_b32 v227, a7
    v_mfma_f32_16x16x32_bf16 a[224:227], a[120:123], a[148:151], a[224:227]
    ds_read_b64_tr_b16 a[112:113], v231 offset:16448
    ds_read_b64_tr_b16 a[114:115], v231 offset:20032
    v_mfma_f32_16x16x32_bf16 a[224:227], a[124:127], a[160:163], a[224:227]
    buffer_load_dwordx4 v[80:83], v239, s[52:55], s74 offen offset:2048 sc1
    v_mul_f32 v224, v224, v229
    v_mfma_f32_16x16x32_bf16 a[228:231], a[120:123], a[152:155], a[228:231]
    v_mul_f32 v225, v225, v229
    v_mul_f32 v226, v226, v229
    v_mfma_f32_16x16x32_bf16 a[228:231], a[124:127], a[164:167], a[228:231]
    ds_read_b64_tr_b16 a[116:117], v231 offset:23616
    ds_read_b64_tr_b16 a[118:119], v231 offset:27200
    v_mfma_f32_16x16x32_bf16 a[232:235], a[128:131], a[144:147], a[232:235]
    v_mul_f32 v227, v227, v229
    v_cvt_pk_bf16_f32 v196, v224, v225
    v_mfma_f32_16x16x32_bf16 a[232:235], a[132:135], a[156:159], a[232:235]
    ds_read_b64_tr_b16 a[120:121], v231 offset:16480
    ds_read_b64_tr_b16 a[122:123], v231 offset:20064
    v_mfma_f32_16x16x32_bf16 a[236:239], a[128:131], a[148:151], a[236:239]
    s_add_u32 s74, s97, 9216
    buffer_load_dwordx4 v[84:87], v239, s[52:55], s74 offen sc1
    v_cvt_pk_bf16_f32 v197, v226, v227
    v_mfma_f32_16x16x32_bf16 a[236:239], a[132:135], a[160:163], a[236:239]
    v_accvgpr_read_b32 v216, a16
    v_accvgpr_read_b32 v217, a17
    v_mfma_f32_16x16x32_bf16 a[240:243], a[128:131], a[152:155], a[240:243]
    ds_read_b64_tr_b16 a[124:125], v231 offset:23648
    ds_read_b64_tr_b16 a[126:127], v231 offset:27232
    v_mfma_f32_16x16x32_bf16 a[240:243], a[132:135], a[164:167], a[240:243]
    buffer_load_dwordx4 v[88:91], v239, s[52:55], s74 offen offset:1024 sc1
    v_accvgpr_read_b32 v218, a18
    v_mfma_f32_16x16x32_bf16 a[244:247], a[136:139], a[144:147], a[244:247]
    ds_read_b64_tr_b16 a[128:129], v231 offset:16512
    ds_read_b64_tr_b16 a[130:131], v231 offset:20096
    v_mfma_f32_16x16x32_bf16 a[244:247], a[140:143], a[156:159], a[244:247]
    v_accvgpr_read_b32 v219, a19
    v_mul_f32 v216, v216, v229
    v_mul_f32 v217, v217, v229
    v_mul_f32 v218, v218, v229
    v_mul_f32 v219, v219, v229
    v_cvt_pk_bf16_f32 v198, v216, v217
    v_cvt_pk_bf16_f32 v199, v218, v219
    v_mfma_f32_16x16x32_bf16 a[248:251], a[136:139], a[148:151], a[248:251]
    v_accvgpr_read_b32 v220, a8
    v_accvgpr_read_b32 v221, a9
    v_mfma_f32_16x16x32_bf16 a[248:251], a[140:143], a[160:163], a[248:251]
    ds_read_b64_tr_b16 a[132:133], v231 offset:23680
    ds_read_b64_tr_b16 a[134:135], v231 offset:27264
    v_mfma_f32_16x16x32_bf16 a[252:255], a[136:139], a[152:155], a[252:255]
    s_add_u32 s73, s77, 18432
    buffer_store_dwordx4 v[196:199], v239, s[52:55], s73 offen offset:1024 sc1
    v_accvgpr_read_b32 v222, a10
    v_mfma_f32_16x16x32_bf16 a[252:255], a[140:143], a[164:167], a[252:255]
    s_waitcnt lgkmcnt(14)
    ds_read_b64_tr_b16 a[136:137], v231 offset:16544
    ds_read_b64_tr_b16 a[138:139], v231 offset:20128
    v_mfma_f32_16x16x32_bf16 a[172:175], a[96:99], v[0:3], a[172:175]
    v_accvgpr_read_b32 v223, a11
    v_mul_f32 v220, v220, v230
    v_mfma_f32_16x16x32_bf16 a[172:175], a[100:103], v[12:15], a[172:175]
    buffer_load_dwordx4 v[92:95], v239, s[52:55], s74 offen offset:2048 sc1
    v_mul_f32 v221, v221, v230
    v_mfma_f32_16x16x32_bf16 a[176:179], a[96:99], v[4:7], a[176:179]
    ds_read_b64_tr_b16 a[140:141], v231 offset:23712
    ds_read_b64_tr_b16 a[142:143], v231 offset:27296
    v_mfma_f32_16x16x32_bf16 a[176:179], a[100:103], v[16:19], a[176:179]
    v_mul_f32 v222, v222, v230
    v_mul_f32 v223, v223, v230
    v_mfma_f32_16x16x32_bf16 a[180:183], a[96:99], v[8:11], a[180:183]
    ds_read_b64_tr_b16 a[96:97], v231 offset:16576
    ds_read_b64_tr_b16 a[98:99], v231 offset:20160
    v_mfma_f32_16x16x32_bf16 a[180:183], a[100:103], v[20:23], a[180:183]
    s_waitcnt lgkmcnt(14)
    s_add_u32 s74, s98, 6144
    buffer_load_dwordx4 v[96:99], v239, s[52:55], s74 offen sc1
    v_mfma_f32_16x16x32_bf16 a[184:187], a[104:107], v[0:3], a[184:187]
    v_cvt_pk_bf16_f32 v200, v220, v221
    v_cvt_pk_bf16_f32 v201, v222, v223
    v_mfma_f32_16x16x32_bf16 a[184:187], a[108:111], v[12:15], a[184:187]
    ds_read_b64_tr_b16 a[100:101], v231 offset:23744
    ds_read_b64_tr_b16 a[102:103], v231 offset:27328
    v_mfma_f32_16x16x32_bf16 a[188:191], a[104:107], v[4:7], a[188:191]
    v_add_u32 v231, 0x10000, v231
    v_accvgpr_read_b32 v224, a20
    v_mfma_f32_16x16x32_bf16 a[188:191], a[108:111], v[16:19], a[188:191]
    buffer_load_dwordx4 v[100:103], v239, s[52:55], s74 offen offset:1024 sc1
    v_accvgpr_read_b32 v225, a21
    v_mfma_f32_16x16x32_bf16 a[192:195], a[104:107], v[8:11], a[192:195]
    v_accvgpr_read_b32 v226, a22
    v_accvgpr_read_b32 v227, a23
    v_mfma_f32_16x16x32_bf16 a[192:195], a[108:111], v[20:23], a[192:195]
    v_mul_f32 v224, v224, v230
    v_mul_f32 v225, v225, v230
    v_mfma_f32_16x16x32_bf16 a[196:199], a[112:115], v[0:3], a[196:199]
    v_mul_f32 v226, v226, v230
    v_mul_f32 v227, v227, v230
    v_cvt_pk_bf16_f32 v202, v224, v225
    v_cvt_pk_bf16_f32 v203, v226, v227
    v_mfma_f32_16x16x32_bf16 a[196:199], a[116:119], v[12:15], a[196:199]
    buffer_load_dwordx4 v[104:107], v239, s[52:55], s74 offen offset:2048 sc1
    v_accvgpr_read_b32 v216, a24
    v_mfma_f32_16x16x32_bf16 a[200:203], a[112:115], v[4:7], a[200:203]
    v_accvgpr_read_b32 v217, a25
    v_accvgpr_read_b32 v218, a26
    v_mfma_f32_16x16x32_bf16 a[200:203], a[116:119], v[16:19], a[200:203]
    s_waitcnt lgkmcnt(0)
    s_barrier
    v_accvgpr_read_b32 v219, a27
    v_mfma_f32_16x16x32_bf16 a[204:207], a[112:115], v[8:11], a[204:207]
    ds_read_b64_tr_b16 a[104:105], v231
    ds_read_b64_tr_b16 a[106:107], v231 offset:3584
    v_mfma_f32_16x16x32_bf16 a[204:207], a[116:119], v[20:23], a[204:207]
    s_add_u32 s73, s77, 18432
    buffer_store_dwordx4 v[200:203], v239, s[52:55], s73 offen offset:2048 sc1
    v_mfma_f32_16x16x32_bf16 a[208:211], a[120:123], v[0:3], a[208:211]
    v_mul_f32 v216, v216, v228
    v_mul_f32 v217, v217, v228
    v_mfma_f32_16x16x32_bf16 a[208:211], a[124:127], v[12:15], a[208:211]
    ds_read_b64_tr_b16 a[108:109], v231 offset:7168
    ds_read_b64_tr_b16 a[110:111], v231 offset:10752
    v_mfma_f32_16x16x32_bf16 a[212:215], a[120:123], v[4:7], a[212:215]
    v_mul_f32 v218, v218, v228
    v_mul_f32 v219, v219, v228
    v_mfma_f32_16x16x32_bf16 a[212:215], a[124:127], v[16:19], a[212:215]
    ds_read_b64_tr_b16 a[112:113], v231 offset:32
    ds_read_b64_tr_b16 a[114:115], v231 offset:3616
    v_mfma_f32_16x16x32_bf16 a[216:219], a[120:123], v[8:11], a[216:219]
    s_add_u32 s74, s98, 9216
    buffer_load_dwordx4 v[108:111], v239, s[52:55], s74 offen sc1
    v_cvt_pk_bf16_f32 v204, v216, v217
    v_mfma_f32_16x16x32_bf16 a[216:219], a[124:127], v[20:23], a[216:219]
    v_cvt_pk_bf16_f32 v205, v218, v219
    v_accvgpr_read_b32 v220, a36
    v_mfma_f32_16x16x32_bf16 a[220:223], a[128:131], v[0:3], a[220:223]
    ds_read_b64_tr_b16 a[116:117], v231 offset:7200
    ds_read_b64_tr_b16 a[118:119], v231 offset:10784
    v_mfma_f32_16x16x32_bf16 a[220:223], a[132:135], v[12:15], a[220:223]
    buffer_load_dwordx4 v[112:115], v239, s[52:55], s74 offen offset:1024 sc1
    v_accvgpr_read_b32 v221, a37
    v_mfma_f32_16x16x32_bf16 a[224:227], a[128:131], v[4:7], a[224:227]
    ds_read_b64_tr_b16 a[120:121], v231 offset:64
    ds_read_b64_tr_b16 a[122:123], v231 offset:3648
    v_mfma_f32_16x16x32_bf16 a[224:227], a[132:135], v[16:19], a[224:227]
    v_accvgpr_read_b32 v222, a38
    v_accvgpr_read_b32 v223, a39
    v_mfma_f32_16x16x32_bf16 a[228:231], a[128:131], v[8:11], a[228:231]
    v_mul_f32 v220, v220, v228
    v_mul_f32 v221, v221, v228
    v_mfma_f32_16x16x32_bf16 a[228:231], a[132:135], v[20:23], a[228:231]
    ds_read_b64_tr_b16 a[124:125], v231 offset:7232
    ds_read_b64_tr_b16 a[126:127], v231 offset:10816
    v_mul_f32 v222, v222, v228
    v_mul_f32 v223, v223, v228
    v_cvt_pk_bf16_f32 v206, v220, v221
    v_cvt_pk_bf16_f32 v207, v222, v223
    v_mfma_f32_16x16x32_bf16 a[232:235], a[136:139], v[0:3], a[232:235]
    buffer_load_dwordx4 v[116:119], v239, s[52:55], s74 offen offset:2048 sc1
    v_accvgpr_read_b32 v224, a28
    v_mfma_f32_16x16x32_bf16 a[232:235], a[140:143], v[12:15], a[232:235]
    ds_read_b64_tr_b16 a[128:129], v231 offset:96
    ds_read_b64_tr_b16 a[130:131], v231 offset:3680
    v_mfma_f32_16x16x32_bf16 a[236:239], a[136:139], v[4:7], a[236:239]
    v_accvgpr_read_b32 v225, a29
    v_accvgpr_read_b32 v226, a30
    v_mfma_f32_16x16x32_bf16 a[236:239], a[140:143], v[16:19], a[236:239]
    s_add_u32 s73, s77, 21504
    buffer_store_dwordx4 v[204:207], v239, s[52:55], s73 offen sc1
    v_accvgpr_read_b32 v227, a31
    v_mfma_f32_16x16x32_bf16 a[240:243], a[136:139], v[8:11], a[240:243]
    ds_read_b64_tr_b16 a[132:133], v231 offset:7264
    ds_read_b64_tr_b16 a[134:135], v231 offset:10848
    v_mfma_f32_16x16x32_bf16 a[240:243], a[140:143], v[20:23], a[240:243]
    v_mul_f32 v224, v224, v229
    v_mul_f32 v225, v225, v229
    v_mfma_f32_16x16x32_bf16 a[244:247], a[96:99], v[0:3], a[244:247]
    s_add_u32 s9, s99, 172032
    s_add_u32 m0, s10, 0
    ds_read_b64_tr_b16 a[136:137], v231 offset:128
    ds_read_b64_tr_b16 a[138:139], v231 offset:3712
    v_mfma_f32_16x16x32_bf16 a[244:247], a[100:103], v[12:15], a[244:247]
    buffer_load_dwordx4 v244, s[48:51], s9 offen lds
    v_mul_f32 v226, v226, v229
    v_mfma_f32_16x16x32_bf16 a[248:251], a[96:99], v[4:7], a[248:251]
    v_mul_f32 v227, v227, v229
    v_cvt_pk_bf16_f32 v208, v224, v225
    v_mfma_f32_16x16x32_bf16 a[248:251], a[100:103], v[16:19], a[248:251]
    ds_read_b64_tr_b16 a[140:141], v231 offset:7296
    ds_read_b64_tr_b16 a[142:143], v231 offset:10880
    v_mfma_f32_16x16x32_bf16 a[252:255], a[96:99], v[8:11], a[252:255]
    v_cvt_pk_bf16_f32 v209, v226, v227
    v_accvgpr_read_b32 v216, a40
    v_mfma_f32_16x16x32_bf16 a[252:255], a[100:103], v[20:23], a[252:255]
    s_waitcnt lgkmcnt(14)
    ds_read_b64_tr_b16 a[96:97], v231 offset:160
    ds_read_b64_tr_b16 a[98:99], v231 offset:3744
    v_mfma_f32_16x16x32_bf16 a[172:175], a[104:107], v[24:27], a[172:175]
    s_add_u32 m0, s10, 0
    v_accvgpr_read_b32 v217, a41
    v_accvgpr_read_b32 v218, a42
    v_mfma_f32_16x16x32_bf16 a[172:175], a[108:111], v[36:39], a[172:175]
    buffer_load_dwordx4 v245, s[48:51], s9 offen offset:1024 lds
    v_accvgpr_read_b32 v219, a43
    v_mfma_f32_16x16x32_bf16 a[176:179], a[104:107], v[28:31], a[176:179]
    s_add_u32 m0, s10, 0
    ds_read_b64_tr_b16 a[100:101], v231 offset:7328
    ds_read_b64_tr_b16 a[102:103], v231 offset:10912
    v_mfma_f32_16x16x32_bf16 a[176:179], a[108:111], v[40:43], a[176:179]
    buffer_load_dwordx4 v246, s[48:51], s9 offen offset:2048 lds
    v_mul_f32 v216, v216, v229
    v_mfma_f32_16x16x32_bf16 a[180:183], a[104:107], v[32:35], a[180:183]
    ds_read_b64_tr_b16 a[104:105], v231 offset:192
    ds_read_b64_tr_b16 a[106:107], v231 offset:3776
    v_mul_f32 v217, v217, v229
    v_mul_f32 v218, v218, v229
    v_mul_f32 v219, v219, v229
    v_cvt_pk_bf16_f32 v210, v216, v217
    v_cvt_pk_bf16_f32 v211, v218, v219
    v_mfma_f32_16x16x32_bf16 a[180:183], a[108:111], v[44:47], a[180:183]
    s_waitcnt lgkmcnt(14)
    v_accvgpr_read_b32 v220, a32
    v_accvgpr_read_b32 v221, a33
    v_mfma_f32_16x16x32_bf16 a[184:187], a[112:115], v[24:27], a[184:187]
    v_accvgpr_read_b32 v222, a34
    v_accvgpr_read_b32 v223, a35
    v_mfma_f32_16x16x32_bf16 a[184:187], a[116:119], v[36:39], a[184:187]
    ds_read_b64_tr_b16 a[108:109], v231 offset:7360
    ds_read_b64_tr_b16 a[110:111], v231 offset:10944
    v_mfma_f32_16x16x32_bf16 a[188:191], a[112:115], v[28:31], a[188:191]
    s_add_u32 s73, s77, 21504
    buffer_store_dwordx4 v[208:211], v239, s[52:55], s73 offen offset:1024 sc1
    v_add_u32 v231, 0x10000, v231
    v_mfma_f32_16x16x32_bf16 a[188:191], a[116:119], v[40:43], a[188:191]
    buffer_load_dword v234, v235, s[68:71], 0 offen sc1
    v_mul_f32 v220, v220, v230
    v_mfma_f32_16x16x32_bf16 a[192:195], a[112:115], v[32:35], a[192:195]
    s_add_u32 m0, s10, 0
    v_mul_f32 v221, v221, v230
    v_mul_f32 v222, v222, v230
    v_mfma_f32_16x16x32_bf16 a[192:195], a[116:119], v[44:47], a[192:195]
    buffer_load_dwordx4 v247, s[48:51], s9 offen offset:3072 lds
    v_mul_f32 v223, v223, v230
    v_mfma_f32_16x16x32_bf16 a[196:199], a[120:123], v[24:27], a[196:199]
    v_cvt_pk_bf16_f32 v212, v220, v221
    v_cvt_pk_bf16_f32 v213, v222, v223
    v_mfma_f32_16x16x32_bf16 a[196:199], a[124:127], v[36:39], a[196:199]
    v_accvgpr_read_b32 v224, a44
    v_accvgpr_read_b32 v225, a45
    v_mfma_f32_16x16x32_bf16 a[200:203], a[120:123], v[28:31], a[200:203]
    s_add_u32 s9, s100, 172032
    s_add_u32 m0, s10, 16384
    v_accvgpr_read_b32 v226, a46
    v_mfma_f32_16x16x32_bf16 a[200:203], a[124:127], v[40:43], a[200:203]
    s_waitcnt lgkmcnt(0)
    s_barrier
    buffer_load_dwordx4 v244, s[48:51], s9 offen lds
    v_mfma_f32_16x16x32_bf16 a[204:207], a[120:123], v[32:35], a[204:207]
    ds_read_b64_tr_b16 a[112:113], v231 offset:16384
    ds_read_b64_tr_b16 a[114:115], v231 offset:19968
    v_mfma_f32_16x16x32_bf16 a[204:207], a[124:127], v[44:47], a[204:207]
    v_accvgpr_read_b32 v227, a47
    v_mul_f32 v224, v224, v230
    v_mfma_f32_16x16x32_bf16 a[208:211], a[128:131], v[24:27], a[208:211]
    v_mul_f32 v225, v225, v230
    v_mul_f32 v226, v226, v230
    v_mfma_f32_16x16x32_bf16 a[208:211], a[132:135], v[36:39], a[208:211]
    s_add_u32 m0, s10, 16384
    ds_read_b64_tr_b16 a[116:117], v231 offset:23552
    ds_read_b64_tr_b16 a[118:119], v231 offset:27136
    v_mul_f32 v227, v227, v230
    v_cvt_pk_bf16_f32 v214, v224, v225
    v_cvt_pk_bf16_f32 v215, v226, v227
    v_mfma_f32_16x16x32_bf16 a[212:215], a[128:131], v[28:31], a[212:215]
    buffer_load_dwordx4 v245, s[48:51], s9 offen offset:1024 lds
    v_mfma_f32_16x16x32_bf16 a[212:215], a[132:135], v[40:43], a[212:215]
    ds_read_b64_tr_b16 a[120:121], v231 offset:16416
    ds_read_b64_tr_b16 a[122:123], v231 offset:20000
    v_mfma_f32_16x16x32_bf16 a[216:219], a[128:131], v[32:35], a[216:219]
    v_mfma_f32_16x16x32_bf16 a[216:219], a[132:135], v[44:47], a[216:219]
    s_add_u32 s73, s77, 21504
    buffer_store_dwordx4 v[212:215], v239, s[52:55], s73 offen offset:2048 sc1
    v_mfma_f32_16x16x32_bf16 a[220:223], a[136:139], v[24:27], a[220:223]
    ds_read_b64_tr_b16 a[124:125], v231 offset:23584
    ds_read_b64_tr_b16 a[126:127], v231 offset:27168
    v_mfma_f32_16x16x32_bf16 a[220:223], a[140:143], v[36:39], a[220:223]
    v_mfma_f32_16x16x32_bf16 a[224:227], a[136:139], v[28:31], a[224:227]
    s_add_u32 m0, s10, 16384
    ds_read_b64_tr_b16 a[128:129], v231 offset:16448
    ds_read_b64_tr_b16 a[130:131], v231 offset:20032
    v_mfma_f32_16x16x32_bf16 a[224:227], a[140:143], v[40:43], a[224:227]
    buffer_load_dwordx4 v246, s[48:51], s9 offen offset:2048 lds
    v_mfma_f32_16x16x32_bf16 a[228:231], a[136:139], v[32:35], a[228:231]
    v_mfma_f32_16x16x32_bf16 a[228:231], a[140:143], v[44:47], a[228:231]
    ds_read_b64_tr_b16 a[132:133], v231 offset:23616
    ds_read_b64_tr_b16 a[134:135], v231 offset:27200
    v_mfma_f32_16x16x32_bf16 a[232:235], a[96:99], v[24:27], a[232:235]
    v_mfma_f32_16x16x32_bf16 a[232:235], a[100:103], v[36:39], a[232:235]
    s_add_u32 m0, s10, 16384
    ds_read_b64_tr_b16 a[136:137], v231 offset:16480
    ds_read_b64_tr_b16 a[138:139], v231 offset:20064
    v_mfma_f32_16x16x32_bf16 a[236:239], a[96:99], v[28:31], a[236:239]
    buffer_load_dwordx4 v247, s[48:51], s9 offen offset:3072 lds
    v_mfma_f32_16x16x32_bf16 a[236:239], a[100:103], v[40:43], a[236:239]
    v_mfma_f32_16x16x32_bf16 a[240:243], a[96:99], v[32:35], a[240:243]
    s_add_u32 s9, s101, 172032
    s_add_u32 m0, s10, 65536
    ds_read_b64_tr_b16 a[140:141], v231 offset:23648
    ds_read_b64_tr_b16 a[142:143], v231 offset:27232
    v_mfma_f32_16x16x32_bf16 a[240:243], a[100:103], v[44:47], a[240:243]
    buffer_load_dwordx4 v244, s[48:51], s9 offen lds
    v_mfma_f32_16x16x32_bf16 a[244:247], a[104:107], v[24:27], a[244:247]
    ds_read_b64_tr_b16 a[96:97], v231 offset:16512
    ds_read_b64_tr_b16 a[98:99], v231 offset:20096
    v_mfma_f32_16x16x32_bf16 a[244:247], a[108:111], v[36:39], a[244:247]
    v_mfma_f32_16x16x32_bf16 a[248:251], a[104:107], v[28:31], a[248:251]
    v_mfma_f32_16x16x32_bf16 a[248:251], a[108:111], v[40:43], a[248:251]
    s_add_u32 m0, s10, 65536
    ds_read_b64_tr_b16 a[100:101], v231 offset:23680
    ds_read_b64_tr_b16 a[102:103], v231 offset:27264
    v_mfma_f32_16x16x32_bf16 a[252:255], a[104:107], v[32:35], a[252:255]
    buffer_load_dwordx4 v245, s[48:51], s9 offen offset:1024 lds
    v_mfma_f32_16x16x32_bf16 a[252:255], a[108:111], v[44:47], a[252:255]
    s_waitcnt lgkmcnt(14)
    ds_read_b64_tr_b16 a[104:105], v231 offset:16544
    ds_read_b64_tr_b16 a[106:107], v231 offset:20128
    v_mfma_f32_16x16x32_bf16 a[172:175], a[112:115], v[192:195], a[172:175]
    s_add_u32 m0, s10, 65536
    v_mfma_f32_16x16x32_bf16 a[172:175], a[116:119], v[204:207], a[172:175]
    buffer_load_dwordx4 v246, s[48:51], s9 offen offset:2048 lds
    v_mfma_f32_16x16x32_bf16 a[176:179], a[112:115], v[196:199], a[176:179]
    ds_read_b64_tr_b16 a[108:109], v231 offset:23712
    ds_read_b64_tr_b16 a[110:111], v231 offset:27296
    v_mfma_f32_16x16x32_bf16 a[176:179], a[116:119], v[208:211], a[176:179]
    v_mfma_f32_16x16x32_bf16 a[180:183], a[112:115], v[200:203], a[180:183]
    s_add_u32 m0, s10, 65536
    ds_read_b64_tr_b16 a[112:113], v231 offset:16576
    ds_read_b64_tr_b16 a[114:115], v231 offset:20160
    v_mfma_f32_16x16x32_bf16 a[180:183], a[116:119], v[212:215], a[180:183]
    s_waitcnt lgkmcnt(14)
    buffer_load_dwordx4 v247, s[48:51], s9 offen offset:3072 lds
    v_mfma_f32_16x16x32_bf16 a[184:187], a[120:123], v[192:195], a[184:187]
    v_mfma_f32_16x16x32_bf16 a[184:187], a[124:127], v[204:207], a[184:187]
    ds_read_b64_tr_b16 a[116:117], v231 offset:23744
    ds_read_b64_tr_b16 a[118:119], v231 offset:27328
    v_mfma_f32_16x16x32_bf16 a[188:191], a[120:123], v[196:199], a[188:191]
    v_add_u32 v231, 0xffff0000, v231
    v_mfma_f32_16x16x32_bf16 a[188:191], a[124:127], v[208:211], a[188:191]
    v_mfma_f32_16x16x32_bf16 a[192:195], a[120:123], v[200:203], a[192:195]
    v_mfma_f32_16x16x32_bf16 a[192:195], a[124:127], v[212:215], a[192:195]
    v_mfma_f32_16x16x32_bf16 a[196:199], a[128:131], v[192:195], a[196:199]
    v_mfma_f32_16x16x32_bf16 a[196:199], a[132:135], v[204:207], a[196:199]
    v_mfma_f32_16x16x32_bf16 a[200:203], a[128:131], v[196:199], a[200:203]
    v_mfma_f32_16x16x32_bf16 a[200:203], a[132:135], v[208:211], a[200:203]
    s_waitcnt lgkmcnt(0)
    s_barrier
    v_mfma_f32_16x16x32_bf16 a[204:207], a[128:131], v[200:203], a[204:207]
    ds_read_b64_tr_b16 a[120:121], v231 offset:16384
    ds_read_b64_tr_b16 a[122:123], v231 offset:19968
    v_mfma_f32_16x16x32_bf16 a[204:207], a[132:135], v[212:215], a[204:207]
    v_mfma_f32_16x16x32_bf16 a[208:211], a[136:139], v[192:195], a[208:211]
    v_mfma_f32_16x16x32_bf16 a[208:211], a[140:143], v[204:207], a[208:211]
    ds_read_b64_tr_b16 a[124:125], v231 offset:23552
    ds_read_b64_tr_b16 a[126:127], v231 offset:27136
    v_mfma_f32_16x16x32_bf16 a[212:215], a[136:139], v[196:199], a[212:215]
    v_mfma_f32_16x16x32_bf16 a[212:215], a[140:143], v[208:211], a[212:215]
    ds_read_b64_tr_b16 a[128:129], v231 offset:16416
    ds_read_b64_tr_b16 a[130:131], v231 offset:20000
    v_mfma_f32_16x16x32_bf16 a[216:219], a[136:139], v[200:203], a[216:219]
    v_mfma_f32_16x16x32_bf16 a[216:219], a[140:143], v[212:215], a[216:219]
    v_mfma_f32_16x16x32_bf16 a[220:223], a[96:99], v[192:195], a[220:223]
    ds_read_b64_tr_b16 a[132:133], v231 offset:23584
    ds_read_b64_tr_b16 a[134:135], v231 offset:27168
    v_mfma_f32_16x16x32_bf16 a[220:223], a[100:103], v[204:207], a[220:223]
    v_mfma_f32_16x16x32_bf16 a[224:227], a[96:99], v[196:199], a[224:227]
    ds_read_b64_tr_b16 a[136:137], v231 offset:16448
    ds_read_b64_tr_b16 a[138:139], v231 offset:20032
    v_mfma_f32_16x16x32_bf16 a[224:227], a[100:103], v[208:211], a[224:227]
    v_mfma_f32_16x16x32_bf16 a[228:231], a[96:99], v[200:203], a[228:231]
    v_mfma_f32_16x16x32_bf16 a[228:231], a[100:103], v[212:215], a[228:231]
    ds_read_b64_tr_b16 a[140:141], v231 offset:23616
    ds_read_b64_tr_b16 a[142:143], v231 offset:27200
    v_mfma_f32_16x16x32_bf16 a[232:235], a[104:107], v[192:195], a[232:235]
    v_mfma_f32_16x16x32_bf16 a[232:235], a[108:111], v[204:207], a[232:235]
    ds_read_b64_tr_b16 a[96:97], v231 offset:16480
    ds_read_b64_tr_b16 a[98:99], v231 offset:20064
    v_mfma_f32_16x16x32_bf16 a[236:239], a[104:107], v[196:199], a[236:239]
    v_mfma_f32_16x16x32_bf16 a[236:239], a[108:111], v[208:211], a[236:239]
    v_mfma_f32_16x16x32_bf16 a[240:243], a[104:107], v[200:203], a[240:243]
    ds_read_b64_tr_b16 a[100:101], v231 offset:23648
    ds_read_b64_tr_b16 a[102:103], v231 offset:27232
    v_mfma_f32_16x16x32_bf16 a[240:243], a[108:111], v[212:215], a[240:243]
    v_mfma_f32_16x16x32_bf16 a[244:247], a[112:115], v[192:195], a[244:247]
    ds_read_b64_tr_b16 a[104:105], v231 offset:16512
    ds_read_b64_tr_b16 a[106:107], v231 offset:20096
    v_mfma_f32_16x16x32_bf16 a[244:247], a[116:119], v[204:207], a[244:247]
    v_mfma_f32_16x16x32_bf16 a[248:251], a[112:115], v[196:199], a[248:251]
    v_mfma_f32_16x16x32_bf16 a[248:251], a[116:119], v[208:211], a[248:251]
    ds_read_b64_tr_b16 a[108:109], v231 offset:23680
    ds_read_b64_tr_b16 a[110:111], v231 offset:27264
    v_mfma_f32_16x16x32_bf16 a[252:255], a[112:115], v[200:203], a[252:255]
    v_mfma_f32_16x16x32_bf16 a[252:255], a[116:119], v[212:215], a[252:255]
    s_waitcnt lgkmcnt(14)
    ds_read_b64_tr_b16 a[112:113], v231 offset:16544
    ds_read_b64_tr_b16 a[114:115], v231 offset:20128
    s_waitcnt vmcnt(37)
    v_mfma_f32_16x16x32_bf16 a[172:175], a[120:123], v[48:51], a[172:175]
    s_waitcnt vmcnt(34)
    v_mfma_f32_16x16x32_bf16 a[172:175], a[124:127], v[60:63], a[172:175]
    v_mfma_f32_16x16x32_bf16 a[176:179], a[120:123], v[52:55], a[176:179]
    ds_read_b64_tr_b16 a[116:117], v231 offset:23712
    ds_read_b64_tr_b16 a[118:119], v231 offset:27296
    s_waitcnt vmcnt(33)
    v_mfma_f32_16x16x32_bf16 a[176:179], a[124:127], v[64:67], a[176:179]
    v_mfma_f32_16x16x32_bf16 a[180:183], a[120:123], v[56:59], a[180:183]
    ds_read_b64_tr_b16 a[120:121], v231 offset:16576
    ds_read_b64_tr_b16 a[122:123], v231 offset:20160
    s_waitcnt vmcnt(32)
    v_mfma_f32_16x16x32_bf16 a[180:183], a[124:127], v[68:71], a[180:183]
    s_waitcnt lgkmcnt(14)
    v_mfma_f32_16x16x32_bf16 a[184:187], a[128:131], v[48:51], a[184:187]
    v_mfma_f32_16x16x32_bf16 a[184:187], a[132:135], v[60:63], a[184:187]
    ds_read_b64_tr_b16 a[124:125], v231 offset:23744
    ds_read_b64_tr_b16 a[126:127], v231 offset:27328
    v_mfma_f32_16x16x32_bf16 a[188:191], a[128:131], v[52:55], a[188:191]
    v_mfma_f32_16x16x32_bf16 a[188:191], a[132:135], v[64:67], a[188:191]
    v_mfma_f32_16x16x32_bf16 a[192:195], a[128:131], v[56:59], a[192:195]
    v_mfma_f32_16x16x32_bf16 a[192:195], a[132:135], v[68:71], a[192:195]
    v_mfma_f32_16x16x32_bf16 a[196:199], a[136:139], v[48:51], a[196:199]
    v_mfma_f32_16x16x32_bf16 a[196:199], a[140:143], v[60:63], a[196:199]
    v_mfma_f32_16x16x32_bf16 a[200:203], a[136:139], v[52:55], a[200:203]
    v_mfma_f32_16x16x32_bf16 a[200:203], a[140:143], v[64:67], a[200:203]
    s_waitcnt lgkmcnt(0)
    s_barrier
    v_mfma_f32_16x16x32_bf16 a[204:207], a[136:139], v[56:59], a[204:207]
    ds_read_b64_tr_b16 a[128:129], v231 offset:49152
    ds_read_b64_tr_b16 a[130:131], v231 offset:52736
    v_mfma_f32_16x16x32_bf16 a[204:207], a[140:143], v[68:71], a[204:207]
    v_mfma_f32_16x16x32_bf16 a[208:211], a[96:99], v[48:51], a[208:211]
    v_mfma_f32_16x16x32_bf16 a[208:211], a[100:103], v[60:63], a[208:211]
    ds_read_b64_tr_b16 a[132:133], v231 offset:56320
    ds_read_b64_tr_b16 a[134:135], v231 offset:59904
    v_mfma_f32_16x16x32_bf16 a[212:215], a[96:99], v[52:55], a[212:215]
    v_mfma_f32_16x16x32_bf16 a[212:215], a[100:103], v[64:67], a[212:215]
    ds_read_b64_tr_b16 a[136:137], v231 offset:49184
    ds_read_b64_tr_b16 a[138:139], v231 offset:52768
    v_mfma_f32_16x16x32_bf16 a[216:219], a[96:99], v[56:59], a[216:219]
    v_mfma_f32_16x16x32_bf16 a[216:219], a[100:103], v[68:71], a[216:219]
    v_mfma_f32_16x16x32_bf16 a[220:223], a[104:107], v[48:51], a[220:223]
    ds_read_b64_tr_b16 a[140:141], v231 offset:56352
    ds_read_b64_tr_b16 a[142:143], v231 offset:59936
    v_mfma_f32_16x16x32_bf16 a[220:223], a[108:111], v[60:63], a[220:223]
    s_waitcnt vmcnt(10)
    v_cmp_gt_u32 vcc, 3, v234
    s_nop 3
    s_cmp_lg_u64 vcc, 0
    s_cbranch_scc1 L_spin2
L_ret2:
    v_mfma_f32_16x16x32_bf16 a[224:227], a[104:107], v[52:55], a[224:227]
    ds_read_b64_tr_b16 a[96:97], v231 offset:49216
    ds_read_b64_tr_b16 a[98:99], v231 offset:52800
    v_mfma_f32_16x16x32_bf16 a[224:227], a[108:111], v[64:67], a[224:227]
    s_add_u32 s74, s96, 12288
    buffer_load_dwordx4 v[120:123], v239, s[52:55], s74 offen sc1
    v_mfma_f32_16x16x32_bf16 a[228:231], a[104:107], v[56:59], a[228:231]
    v_mfma_f32_16x16x32_bf16 a[228:231], a[108:111], v[68:71], a[228:231]
    ds_read_b64_tr_b16 a[100:101], v231 offset:56384
    ds_read_b64_tr_b16 a[102:103], v231 offset:59968
    v_mfma_f32_16x16x32_bf16 a[232:235], a[112:115], v[48:51], a[232:235]
    buffer_load_dwordx4 v[124:127], v239, s[52:55], s74 offen offset:1024 sc1
    v_mfma_f32_16x16x32_bf16 a[232:235], a[116:119], v[60:63], a[232:235]
    ds_read_b64_tr_b16 a[104:105], v231 offset:49248
    ds_read_b64_tr_b16 a[106:107], v231 offset:52832
    v_mfma_f32_16x16x32_bf16 a[236:239], a[112:115], v[52:55], a[236:239]
    v_mfma_f32_16x16x32_bf16 a[236:239], a[116:119], v[64:67], a[236:239]
    v_mfma_f32_16x16x32_bf16 a[240:243], a[112:115], v[56:59], a[240:243]
    ds_read_b64_tr_b16 a[108:109], v231 offset:56416
    ds_read_b64_tr_b16 a[110:111], v231 offset:60000
    v_mfma_f32_16x16x32_bf16 a[240:243], a[116:119], v[68:71], a[240:243]
    buffer_load_dwordx4 v[128:131], v239, s[52:55], s74 offen offset:2048 sc1
    v_mfma_f32_16x16x32_bf16 a[244:247], a[120:123], v[48:51], a[244:247]
    ds_read_b64_tr_b16 a[112:113], v231 offset:49280
    ds_read_b64_tr_b16 a[114:115], v231 offset:52864
    v_mfma_f32_16x16x32_bf16 a[244:247], a[124:127], v[60:63], a[244:247]
    v_mfma_f32_16x16x32_bf16 a[248:251], a[120:123], v[52:55], a[248:251]
    s_add_u32 s74, s96, 15360
    buffer_load_dwordx4 v[132:135], v239, s[52:55], s74 offen sc1
    v_mfma_f32_16x16x32_bf16 a[248:251], a[124:127], v[64:67], a[248:251]
    ds_read_b64_tr_b16 a[116:117], v231 offset:56448
    ds_read_b64_tr_b16 a[118:119], v231 offset:60032
    v_mfma_f32_16x16x32_bf16 a[252:255], a[120:123], v[56:59], a[252:255]
    v_mfma_f32_16x16x32_bf16 a[252:255], a[124:127], v[68:71], a[252:255]
    s_waitcnt lgkmcnt(14)
    ds_read_b64_tr_b16 a[120:121], v231 offset:49312
    ds_read_b64_tr_b16 a[122:123], v231 offset:52896
    v_mfma_f32_16x16x32_bf16 a[172:175], a[128:131], v[72:75], a[172:175]
    buffer_load_dwordx4 v[136:139], v239, s[52:55], s74 offen offset:1024 sc1
    v_mfma_f32_16x16x32_bf16 a[172:175], a[132:135], v[84:87], a[172:175]
    v_mfma_f32_16x16x32_bf16 a[176:179], a[128:131], v[76:79], a[176:179]
    ds_read_b64_tr_b16 a[124:125], v231 offset:56480
    ds_read_b64_tr_b16 a[126:127], v231 offset:60064
    v_mfma_f32_16x16x32_bf16 a[176:179], a[132:135], v[88:91], a[176:179]
    v_mfma_f32_16x16x32_bf16 a[180:183], a[128:131], v[80:83], a[180:183]
    ds_read_b64_tr_b16 a[128:129], v231 offset:49344
    ds_read_b64_tr_b16 a[130:131], v231 offset:52928
    v_mfma_f32_16x16x32_bf16 a[180:183], a[132:135], v[92:95], a[180:183]
    s_waitcnt lgkmcnt(14)
    buffer_load_dwordx4 v[140:143], v239, s[52:55], s74 offen offset:2048 sc1
    v_mfma_f32_16x16x32_bf16 a[184:187], a[136:139], v[72:75], a[184:187]
    v_mfma_f32_16x16x32_bf16 a[184:187], a[140:143], v[84:87], a[184:187]
    ds_read_b64_tr_b16 a[132:133], v231 offset:56512
    ds_read_b64_tr_b16 a[134:135], v231 offset:60096
    v_mfma_f32_16x16x32_bf16 a[188:191], a[136:139], v[76:79], a[188:191]
    s_add_u32 s74, s97, 12288
    buffer_load_dwordx4 a[48:51], v239, s[52:55], s74 offen sc1
    v_add_u32 v231, 0x10000, v231
    v_mfma_f32_16x16x32_bf16 a[188:191], a[140:143], v[88:91], a[188:191]
    v_mfma_f32_16x16x32_bf16 a[192:195], a[136:139], v[80:83], a[192:195]
    v_mfma_f32_16x16x32_bf16 a[192:195], a[140:143], v[92:95], a[192:195]
    v_mfma_f32_16x16x32_bf16 a[196:199], a[96:99], v[72:75], a[196:199]
    buffer_load_dwordx4 a[52:55], v239, s[52:55], s74 offen offset:1024 sc1
    v_mfma_f32_16x16x32_bf16 a[196:199], a[100:103], v[84:87], a[196:199]
    v_mfma_f32_16x16x32_bf16 a[200:203], a[96:99], v[76:79], a[200:203]
    v_mfma_f32_16x16x32_bf16 a[200:203], a[100:103], v[88:91], a[200:203]
    s_waitcnt vmcnt(14) lgkmcnt(0)
    s_barrier
    v_mfma_f32_16x16x32_bf16 a[204:207], a[96:99], v[80:83], a[204:207]
    ds_read_b64_tr_b16 a[136:137], v231
    ds_read_b64_tr_b16 a[138:139], v231 offset:3584
    v_mfma_f32_16x16x32_bf16 a[204:207], a[100:103], v[92:95], a[204:207]
    buffer_load_dwordx4 a[56:59], v239, s[52:55], s74 offen offset:2048 sc1
    v_mov_b32 v233, 4
    v_mfma_f32_16x16x32_bf16 a[208:211], a[104:107], v[72:75], a[208:211]
    buffer_store_dword v233, v232, s[68:71], 0 offen sc1
    v_mfma_f32_16x16x32_bf16 a[208:211], a[108:111], v[84:87], a[208:211]
    ds_read_b64_tr_b16 a[140:141], v231 offset:7168
    ds_read_b64_tr_b16 a[142:143], v231 offset:10752
    v_mfma_f32_16x16x32_bf16 a[212:215], a[104:107], v[76:79], a[212:215]
    s_add_u32 s74, s97, 15360
    buffer_load_dwordx4 a[60:63], v239, s[52:55], s74 offen sc1
    v_mfma_f32_16x16x32_bf16 a[212:215], a[108:111], v[88:91], a[212:215]
    ds_read_b64_tr_b16 a[96:97], v231 offset:32
    ds_read_b64_tr_b16 a[98:99], v231 offset:3616
    v_mfma_f32_16x16x32_bf16 a[216:219], a[104:107], v[80:83], a[216:219]
    v_mfma_f32_16x16x32_bf16 a[216:219], a[108:111], v[92:95], a[216:219]
    v_mfma_f32_16x16x32_bf16 a[220:223], a[112:115], v[72:75], a[220:223]
    ds_read_b64_tr_b16 a[100:101], v231 offset:7200
    ds_read_b64_tr_b16 a[102:103], v231 offset:10784
    v_mfma_f32_16x16x32_bf16 a[220:223], a[116:119], v[84:87], a[220:223]
    buffer_load_dwordx4 a[64:67], v239, s[52:55], s74 offen offset:1024 sc1
    v_mfma_f32_16x16x32_bf16 a[224:227], a[112:115], v[76:79], a[224:227]
    ds_read_b64_tr_b16 a[104:105], v231 offset:64
    ds_read_b64_tr_b16 a[106:107], v231 offset:3648
    v_mfma_f32_16x16x32_bf16 a[224:227], a[116:119], v[88:91], a[224:227]
    v_mfma_f32_16x16x32_bf16 a[228:231], a[112:115], v[80:83], a[228:231]
    buffer_load_dwordx4 a[68:71], v239, s[52:55], s74 offen offset:2048 sc1
    v_mfma_f32_16x16x32_bf16 a[228:231], a[116:119], v[92:95], a[228:231]
    ds_read_b64_tr_b16 a[108:109], v231 offset:7232
    ds_read_b64_tr_b16 a[110:111], v231 offset:10816
    v_mfma_f32_16x16x32_bf16 a[232:235], a[120:123], v[72:75], a[232:235]
    v_mfma_f32_16x16x32_bf16 a[232:235], a[124:127], v[84:87], a[232:235]
    ds_read_b64_tr_b16 a[112:113], v231 offset:96
    ds_read_b64_tr_b16 a[114:115], v231 offset:3680
    v_mfma_f32_16x16x32_bf16 a[236:239], a[120:123], v[76:79], a[236:239]
    s_add_u32 s74, s98, 12288
    buffer_load_dwordx4 a[72:75], v239, s[52:55], s74 offen sc1
    v_mfma_f32_16x16x32_bf16 a[236:239], a[124:127], v[88:91], a[236:239]
    v_mfma_f32_16x16x32_bf16 a[240:243], a[120:123], v[80:83], a[240:243]
    ds_read_b64_tr_b16 a[116:117], v231 offset:7264
    ds_read_b64_tr_b16 a[118:119], v231 offset:10848
    v_mfma_f32_16x16x32_bf16 a[240:243], a[124:127], v[92:95], a[240:243]
    v_mfma_f32_16x16x32_bf16 a[244:247], a[128:131], v[72:75], a[244:247]
    ds_read_b64_tr_b16 a[120:121], v231 offset:128
    ds_read_b64_tr_b16 a[122:123], v231 offset:3712
    v_mfma_f32_16x16x32_bf16 a[244:247], a[132:135], v[84:87], a[244:247]
    buffer_load_dwordx4 a[76:79], v239, s[52:55], s74 offen offset:1024 sc1
    v_mfma_f32_16x16x32_bf16 a[248:251], a[128:131], v[76:79], a[248:251]
    v_mfma_f32_16x16x32_bf16 a[248:251], a[132:135], v[88:91], a[248:251]
    ds_read_b64_tr_b16 a[124:125], v231 offset:7296
    ds_read_b64_tr_b16 a[126:127], v231 offset:10880
    v_mfma_f32_16x16x32_bf16 a[252:255], a[128:131], v[80:83], a[252:255]
    buffer_load_dwordx4 a[80:83], v239, s[52:55], s74 offen offset:2048 sc1
    v_mfma_f32_16x16x32_bf16 a[252:255], a[132:135], v[92:95], a[252:255]
    s_waitcnt lgkmcnt(14)
    ds_read_b64_tr_b16 a[128:129], v231 offset:160
    ds_read_b64_tr_b16 a[130:131], v231 offset:3744
    v_mfma_f32_16x16x32_bf16 a[172:175], a[136:139], v[96:99], a[172:175]
    v_mfma_f32_16x16x32_bf16 a[172:175], a[140:143], v[108:111], a[172:175]
    v_mfma_f32_16x16x32_bf16 a[176:179], a[136:139], v[100:103], a[176:179]
    ds_read_b64_tr_b16 a[132:133], v231 offset:7328
    ds_read_b64_tr_b16 a[134:135], v231 offset:10912
    v_mfma_f32_16x16x32_bf16 a[176:179], a[140:143], v[112:115], a[176:179]
    s_add_u32 s74, s98, 15360
    buffer_load_dwordx4 a[84:87], v239, s[52:55], s74 offen sc1
    v_mfma_f32_16x16x32_bf16 a[180:183], a[136:139], v[104:107], a[180:183]
    ds_read_b64_tr_b16 a[136:137], v231 offset:192
    ds_read_b64_tr_b16 a[138:139], v231 offset:3776
    v_mfma_f32_16x16x32_bf16 a[180:183], a[140:143], v[116:119], a[180:183]
    s_waitcnt lgkmcnt(14)
    v_mfma_f32_16x16x32_bf16 a[184:187], a[96:99], v[96:99], a[184:187]
    buffer_load_dwordx4 a[88:91], v239, s[52:55], s74 offen offset:1024 sc1
    v_mfma_f32_16x16x32_bf16 a[184:187], a[100:103], v[108:111], a[184:187]
    ds_read_b64_tr_b16 a[140:141], v231 offset:7360
    ds_read_b64_tr_b16 a[142:143], v231 offset:10944
    v_mfma_f32_16x16x32_bf16 a[188:191], a[96:99], v[100:103], a[188:191]
    v_add_u32 v231, 0xfffe0000, v231
    v_mfma_f32_16x16x32_bf16 a[188:191], a[100:103], v[112:115], a[188:191]
    v_mfma_f32_16x16x32_bf16 a[192:195], a[96:99], v[104:107], a[192:195]
    buffer_load_dwordx4 a[92:95], v239, s[52:55], s74 offen offset:2048 sc1
    v_mfma_f32_16x16x32_bf16 a[192:195], a[100:103], v[116:119], a[192:195]
    v_mfma_f32_16x16x32_bf16 a[196:199], a[104:107], v[96:99], a[196:199]
    v_mfma_f32_16x16x32_bf16 a[196:199], a[108:111], v[108:111], a[196:199]
    v_mfma_f32_16x16x32_bf16 a[200:203], a[104:107], v[100:103], a[200:203]
    v_mfma_f32_16x16x32_bf16 a[200:203], a[108:111], v[112:115], a[200:203]
    s_waitcnt lgkmcnt(0)
    s_barrier
    v_mfma_f32_16x16x32_bf16 a[204:207], a[104:107], v[104:107], a[204:207]
    ds_read_b64_tr_b16 a[96:97], v231 offset:32768
    ds_read_b64_tr_b16 a[98:99], v231 offset:36352
    v_mfma_f32_16x16x32_bf16 a[204:207], a[108:111], v[116:119], a[204:207]
    v_mfma_f32_16x16x32_bf16 a[208:211], a[112:115], v[96:99], a[208:211]
    buffer_load_dword v234, v235, s[68:71], 0 offen sc1
    v_mfma_f32_16x16x32_bf16 a[208:211], a[116:119], v[108:111], a[208:211]
    ds_read_b64_tr_b16 a[100:101], v231 offset:39936
    ds_read_b64_tr_b16 a[102:103], v231 offset:43520
    v_mfma_f32_16x16x32_bf16 a[212:215], a[112:115], v[100:103], a[212:215]
    v_mfma_f32_16x16x32_bf16 a[212:215], a[116:119], v[112:115], a[212:215]
    ds_read_b64_tr_b16 a[104:105], v231 offset:32800
    ds_read_b64_tr_b16 a[106:107], v231 offset:36384
    v_mfma_f32_16x16x32_bf16 a[216:219], a[112:115], v[104:107], a[216:219]
    v_mfma_f32_16x16x32_bf16 a[216:219], a[116:119], v[116:119], a[216:219]
    v_mfma_f32_16x16x32_bf16 a[220:223], a[120:123], v[96:99], a[220:223]
    ds_read_b64_tr_b16 a[108:109], v231 offset:39968
    ds_read_b64_tr_b16 a[110:111], v231 offset:43552
    v_mfma_f32_16x16x32_bf16 a[220:223], a[124:127], v[108:111], a[220:223]
    v_mfma_f32_16x16x32_bf16 a[224:227], a[120:123], v[100:103], a[224:227]
    ds_read_b64_tr_b16 a[112:113], v231 offset:32832
    ds_read_b64_tr_b16 a[114:115], v231 offset:36416
    v_mfma_f32_16x16x32_bf16 a[224:227], a[124:127], v[112:115], a[224:227]
    v_mfma_f32_16x16x32_bf16 a[228:231], a[120:123], v[104:107], a[228:231]
    v_mfma_f32_16x16x32_bf16 a[228:231], a[124:127], v[116:119], a[228:231]
    ds_read_b64_tr_b16 a[116:117], v231 offset:40000
    ds_read_b64_tr_b16 a[118:119], v231 offset:43584
    v_mfma_f32_16x16x32_bf16 a[232:235], a[128:131], v[96:99], a[232:235]
    v_mfma_f32_16x16x32_bf16 a[232:235], a[132:135], v[108:111], a[232:235]
    ds_read_b64_tr_b16 a[120:121], v231 offset:32864
    ds_read_b64_tr_b16 a[122:123], v231 offset:36448
    v_mfma_f32_16x16x32_bf16 a[236:239], a[128:131], v[100:103], a[236:239]
    v_mfma_f32_16x16x32_bf16 a[236:239], a[132:135], v[112:115], a[236:239]
    v_mfma_f32_16x16x32_bf16 a[240:243], a[128:131], v[104:107], a[240:243]
    ds_read_b64_tr_b16 a[124:125], v231 offset:40032
    ds_read_b64_tr_b16 a[126:127], v231 offset:43616
    v_mfma_f32_16x16x32_bf16 a[240:243], a[132:135], v[116:119], a[240:243]
    v_mfma_f32_16x16x32_bf16 a[244:247], a[136:139], v[96:99], a[244:247]
    ds_read_b64_tr_b16 a[128:129], v231 offset:32896
    ds_read_b64_tr_b16 a[130:131], v231 offset:36480
    v_mfma_f32_16x16x32_bf16 a[244:247], a[140:143], v[108:111], a[244:247]
    v_mfma_f32_16x16x32_bf16 a[248:251], a[136:139], v[100:103], a[248:251]
    v_mfma_f32_16x16x32_bf16 a[248:251], a[140:143], v[112:115], a[248:251]
    ds_read_b64_tr_b16 a[132:133], v231 offset:40064
    ds_read_b64_tr_b16 a[134:135], v231 offset:43648
    v_mfma_f32_16x16x32_bf16 a[252:255], a[136:139], v[104:107], a[252:255]
    v_mfma_f32_16x16x32_bf16 a[252:255], a[140:143], v[116:119], a[252:255]
    s_waitcnt lgkmcnt(14)
    ds_read_b64_tr_b16 a[136:137], v231 offset:32928
    ds_read_b64_tr_b16 a[138:139], v231 offset:36512
    s_waitcnt vmcnt(19)
    v_mfma_f32_16x16x32_bf16 a[172:175], a[96:99], v[120:123], a[172:175]
    s_waitcnt vmcnt(16)
    v_mfma_f32_16x16x32_bf16 a[172:175], a[100:103], v[132:135], a[172:175]
    v_mfma_f32_16x16x32_bf16 a[176:179], a[96:99], v[124:127], a[176:179]
    ds_read_b64_tr_b16 a[140:141], v231 offset:40096
    ds_read_b64_tr_b16 a[142:143], v231 offset:43680
    s_waitcnt vmcnt(15)
    v_mfma_f32_16x16x32_bf16 a[176:179], a[100:103], v[136:139], a[176:179]
    v_mfma_f32_16x16x32_bf16 a[180:183], a[96:99], v[128:131], a[180:183]
    ds_read_b64_tr_b16 a[96:97], v231 offset:32960
    ds_read_b64_tr_b16 a[98:99], v231 offset:36544
    s_waitcnt vmcnt(14)
    v_mfma_f32_16x16x32_bf16 a[180:183], a[100:103], v[140:143], a[180:183]
    s_waitcnt lgkmcnt(14)
    v_mfma_f32_16x16x32_bf16 a[184:187], a[104:107], v[120:123], a[184:187]
    v_mfma_f32_16x16x32_bf16 a[184:187], a[108:111], v[132:135], a[184:187]
    ds_read_b64_tr_b16 a[100:101], v231 offset:40128
    ds_read_b64_tr_b16 a[102:103], v231 offset:43712
    v_mfma_f32_16x16x32_bf16 a[188:191], a[104:107], v[124:127], a[188:191]
    v_mfma_f32_16x16x32_bf16 a[188:191], a[108:111], v[136:139], a[188:191]
    v_mfma_f32_16x16x32_bf16 a[192:195], a[104:107], v[128:131], a[192:195]
    v_mfma_f32_16x16x32_bf16 a[192:195], a[108:111], v[140:143], a[192:195]
    v_mfma_f32_16x16x32_bf16 a[196:199], a[112:115], v[120:123], a[196:199]
    v_mfma_f32_16x16x32_bf16 a[196:199], a[116:119], v[132:135], a[196:199]
    v_mfma_f32_16x16x32_bf16 a[200:203], a[112:115], v[124:127], a[200:203]
    v_mfma_f32_16x16x32_bf16 a[200:203], a[116:119], v[136:139], a[200:203]
    s_waitcnt lgkmcnt(0)
    s_barrier
    s_waitcnt vmcnt(0)
    v_cmp_gt_u32 vcc, 4, v234
    s_nop 3
    s_cmp_lg_u64 vcc, 0
    s_cbranch_scc1 L_spin3
L_ret3:
    v_mfma_f32_16x16x32_bf16 a[204:207], a[112:115], v[128:131], a[204:207]
    ds_read_b64_tr_b16 a[104:105], v231 offset:49152
    ds_read_b64_tr_b16 a[106:107], v231 offset:52736
    v_mfma_f32_16x16x32_bf16 a[204:207], a[116:119], v[140:143], a[204:207]
    s_add_u32 s74, s96, 18432
    buffer_load_dwordx4 v[144:147], v239, s[52:55], s74 offen sc1
    v_mfma_f32_16x16x32_bf16 a[208:211], a[120:123], v[120:123], a[208:211]
    v_mfma_f32_16x16x32_bf16 a[208:211], a[124:127], v[132:135], a[208:211]
    ds_read_b64_tr_b16 a[108:109], v231 offset:56320
    ds_read_b64_tr_b16 a[110:111], v231 offset:59904
    v_mfma_f32_16x16x32_bf16 a[212:215], a[120:123], v[124:127], a[212:215]
    buffer_load_dwordx4 v[148:151], v239, s[52:55], s74 offen offset:1024 sc1
    v_mfma_f32_16x16x32_bf16 a[212:215], a[124:127], v[136:139], a[212:215]
    ds_read_b64_tr_b16 a[112:113], v231 offset:49184
    ds_read_b64_tr_b16 a[114:115], v231 offset:52768
    v_mfma_f32_16x16x32_bf16 a[216:219], a[120:123], v[128:131], a[216:219]
    v_mfma_f32_16x16x32_bf16 a[216:219], a[124:127], v[140:143], a[216:219]
    v_mfma_f32_16x16x32_bf16 a[220:223], a[128:131], v[120:123], a[220:223]
    ds_read_b64_tr_b16 a[116:117], v231 offset:56352
    ds_read_b64_tr_b16 a[118:119], v231 offset:59936
    v_mfma_f32_16x16x32_bf16 a[220:223], a[132:135], v[132:135], a[220:223]
    buffer_load_dwordx4 v[152:155], v239, s[52:55], s74 offen offset:2048 sc1
    v_mfma_f32_16x16x32_bf16 a[224:227], a[128:131], v[124:127], a[224:227]
    ds_read_b64_tr_b16 a[120:121], v231 offset:49216
    ds_read_b64_tr_b16 a[122:123], v231 offset:52800
    v_mfma_f32_16x16x32_bf16 a[224:227], a[132:135], v[136:139], a[224:227]
    v_mfma_f32_16x16x32_bf16 a[228:231], a[128:131], v[128:131], a[228:231]
    s_add_u32 s74, s96, 21504
    buffer_load_dwordx4 v[156:159], v239, s[52:55], s74 offen sc1
    v_mfma_f32_16x16x32_bf16 a[228:231], a[132:135], v[140:143], a[228:231]
    ds_read_b64_tr_b16 a[124:125], v231 offset:56384
    ds_read_b64_tr_b16 a[126:127], v231 offset:59968
    v_mfma_f32_16x16x32_bf16 a[232:235], a[136:139], v[120:123], a[232:235]
    v_mfma_f32_16x16x32_bf16 a[232:235], a[140:143], v[132:135], a[232:235]
    ds_read_b64_tr_b16 a[128:129], v231 offset:49248
    ds_read_b64_tr_b16 a[130:131], v231 offset:52832
    v_mfma_f32_16x16x32_bf16 a[236:239], a[136:139], v[124:127], a[236:239]
    buffer_load_dwordx4 v[160:163], v239, s[52:55], s74 offen offset:1024 sc1
    v_mfma_f32_16x16x32_bf16 a[236:239], a[140:143], v[136:139], a[236:239]
    v_mfma_f32_16x16x32_bf16 a[240:243], a[136:139], v[128:131], a[240:243]
    ds_read_b64_tr_b16 a[132:133], v231 offset:56416
    ds_read_b64_tr_b16 a[134:135], v231 offset:60000
    v_mfma_f32_16x16x32_bf16 a[240:243], a[140:143], v[140:143], a[240:243]
    v_mfma_f32_16x16x32_bf16 a[244:247], a[96:99], v[120:123], a[244:247]
    ds_read_b64_tr_b16 a[136:137], v231 offset:49280
    ds_read_b64_tr_b16 a[138:139], v231 offset:52864
    v_mfma_f32_16x16x32_bf16 a[244:247], a[100:103], v[132:135], a[244:247]
    buffer_load_dwordx4 v[164:167], v239, s[52:55], s74 offen offset:2048 sc1
    v_mfma_f32_16x16x32_bf16 a[248:251], a[96:99], v[124:127], a[248:251]
    v_mfma_f32_16x16x32_bf16 a[248:251], a[100:103], v[136:139], a[248:251]
    ds_read_b64_tr_b16 a[140:141], v231 offset:56448
    ds_read_b64_tr_b16 a[142:143], v231 offset:60032
    v_mfma_f32_16x16x32_bf16 a[252:255], a[96:99], v[128:131], a[252:255]
    s_add_u32 s74, s97, 18432
    buffer_load_dwordx4 v[168:171], v239, s[52:55], s74 offen sc1
    v_mfma_f32_16x16x32_bf16 a[252:255], a[100:103], v[140:143], a[252:255]
    s_waitcnt lgkmcnt(14)
    ds_read_b64_tr_b16 a[96:97], v231 offset:49312
    ds_read_b64_tr_b16 a[98:99], v231 offset:52896
    v_mfma_f32_16x16x32_bf16 a[172:175], a[104:107], a[48:51], a[172:175]
    v_mfma_f32_16x16x32_bf16 a[172:175], a[108:111], a[60:63], a[172:175]
    v_mfma_f32_16x16x32_bf16 a[176:179], a[104:107], a[52:55], a[176:179]
    ds_read_b64_tr_b16 a[100:101], v231 offset:56480
    ds_read_b64_tr_b16 a[102:103], v231 offset:60064
    v_mfma_f32_16x16x32_bf16 a[176:179], a[108:111], a[64:67], a[176:179]
    buffer_load_dwordx4 v[172:175], v239, s[52:55], s74 offen offset:1024 sc1
    v_mfma_f32_16x16x32_bf16 a[180:183], a[104:107], a[56:59], a[180:183]
    ds_read_b64_tr_b16 a[104:105], v231 offset:49344
    ds_read_b64_tr_b16 a[106:107], v231 offset:52928
    v_mfma_f32_16x16x32_bf16 a[180:183], a[108:111], a[68:71], a[180:183]
    s_waitcnt lgkmcnt(14)
    v_mfma_f32_16x16x32_bf16 a[184:187], a[112:115], a[48:51], a[184:187]
    buffer_load_dwordx4 v[176:179], v239, s[52:55], s74 offen offset:2048 sc1
    v_mfma_f32_16x16x32_bf16 a[184:187], a[116:119], a[60:63], a[184:187]
    ds_read_b64_tr_b16 a[108:109], v231 offset:56512
    ds_read_b64_tr_b16 a[110:111], v231 offset:60096
    v_mfma_f32_16x16x32_bf16 a[188:191], a[112:115], a[52:55], a[188:191]
    v_add_u32 v231, 0x10000, v231
    v_mfma_f32_16x16x32_bf16 a[188:191], a[116:119], a[64:67], a[188:191]
    v_mfma_f32_16x16x32_bf16 a[192:195], a[112:115], a[56:59], a[192:195]
    s_add_u32 s74, s97, 21504
    buffer_load_dwordx4 v[180:183], v239, s[52:55], s74 offen sc1
    v_mfma_f32_16x16x32_bf16 a[192:195], a[116:119], a[68:71], a[192:195]
    v_mfma_f32_16x16x32_bf16 a[196:199], a[120:123], a[48:51], a[196:199]
    v_mfma_f32_16x16x32_bf16 a[196:199], a[124:127], a[60:63], a[196:199]
    v_mfma_f32_16x16x32_bf16 a[200:203], a[120:123], a[52:55], a[200:203]
    buffer_load_dwordx4 v[184:187], v239, s[52:55], s74 offen offset:1024 sc1
    v_mfma_f32_16x16x32_bf16 a[200:203], a[124:127], a[64:67], a[200:203]
    s_waitcnt lgkmcnt(0)
    s_barrier
    v_mfma_f32_16x16x32_bf16 a[204:207], a[120:123], a[56:59], a[204:207]
    ds_read_b64_tr_b16 a[112:113], v231 offset:32768
    ds_read_b64_tr_b16 a[114:115], v231 offset:36352
    v_mfma_f32_16x16x32_bf16 a[204:207], a[124:127], a[68:71], a[204:207]
    v_add_u32 v236, 0xffff0000, v231
    v_add_u32 v237, 0xffff4000, v231
    v_mfma_f32_16x16x32_bf16 a[208:211], a[128:131], a[48:51], a[208:211]
    buffer_load_dwordx4 v[188:191], v239, s[52:55], s74 offen offset:2048 sc1
    v_add_u32 v238, 0x0, v231
    v_mfma_f32_16x16x32_bf16 a[208:211], a[132:135], a[60:63], a[208:211]
    ds_read_b64_tr_b16 a[116:117], v231 offset:39936
    ds_read_b64_tr_b16 a[118:119], v231 offset:43520
    v_mfma_f32_16x16x32_bf16 a[212:215], a[128:131], a[52:55], a[212:215]
    v_mfma_f32_16x16x32_bf16 a[212:215], a[132:135], a[64:67], a[212:215]
    ds_read_b64_tr_b16 a[120:121], v231 offset:32800
    ds_read_b64_tr_b16 a[122:123], v231 offset:36384
    v_mfma_f32_16x16x32_bf16 a[216:219], a[128:131], a[56:59], a[216:219]
    s_add_u32 s74, s98, 18432
    buffer_load_dwordx4 a[0:3], v239, s[52:55], s74 offen sc1
    v_mfma_f32_16x16x32_bf16 a[216:219], a[132:135], a[68:71], a[216:219]
    v_mfma_f32_16x16x32_bf16 a[220:223], a[136:139], a[48:51], a[220:223]
    ds_read_b64_tr_b16 a[124:125], v231 offset:39968
    ds_read_b64_tr_b16 a[126:127], v231 offset:43552
    v_mfma_f32_16x16x32_bf16 a[220:223], a[140:143], a[60:63], a[220:223]
    v_mfma_f32_16x16x32_bf16 a[224:227], a[136:139], a[52:55], a[224:227]
    ds_read_b64_tr_b16 a[128:129], v231 offset:32832
    ds_read_b64_tr_b16 a[130:131], v231 offset:36416
    v_mfma_f32_16x16x32_bf16 a[224:227], a[140:143], a[64:67], a[224:227]
    buffer_load_dwordx4 a[4:7], v239, s[52:55], s74 offen offset:1024 sc1
    v_mfma_f32_16x16x32_bf16 a[228:231], a[136:139], a[56:59], a[228:231]
    v_mfma_f32_16x16x32_bf16 a[228:231], a[140:143], a[68:71], a[228:231]
    ds_read_b64_tr_b16 a[132:133], v231 offset:40000
    ds_read_b64_tr_b16 a[134:135], v231 offset:43584
    v_mfma_f32_16x16x32_bf16 a[232:235], a[96:99], a[48:51], a[232:235]
    buffer_load_dwordx4 a[8:11], v239, s[52:55], s74 offen offset:2048 sc1
    v_mfma_f32_16x16x32_bf16 a[232:235], a[100:103], a[60:63], a[232:235]
    ds_read_b64_tr_b16 a[136:137], v231 offset:32864
    ds_read_b64_tr_b16 a[138:139], v231 offset:36448
    v_mfma_f32_16x16x32_bf16 a[236:239], a[96:99], a[52:55], a[236:239]
    v_mfma_f32_16x16x32_bf16 a[236:239], a[100:103], a[64:67], a[236:239]
    v_mfma_f32_16x16x32_bf16 a[240:243], a[96:99], a[56:59], a[240:243]
    ds_read_b64_tr_b16 a[140:141], v231 offset:40032
    ds_read_b64_tr_b16 a[142:143], v231 offset:43616
    v_mfma_f32_16x16x32_bf16 a[240:243], a[100:103], a[68:71], a[240:243]
    s_add_u32 s74, s98, 21504
    buffer_load_dwordx4 a[12:15], v239, s[52:55], s74 offen sc1
    v_mfma_f32_16x16x32_bf16 a[244:247], a[104:107], a[48:51], a[244:247]
    ds_read_b64_tr_b16 a[96:97], v231 offset:32896
    ds_read_b64_tr_b16 a[98:99], v231 offset:36480
    v_mfma_f32_16x16x32_bf16 a[244:247], a[108:111], a[60:63], a[244:247]
    v_mfma_f32_16x16x32_bf16 a[248:251], a[104:107], a[52:55], a[248:251]
    buffer_load_dwordx4 a[16:19], v239, s[52:55], s74 offen offset:1024 sc1
    v_mfma_f32_16x16x32_bf16 a[248:251], a[108:111], a[64:67], a[248:251]
    ds_read_b64_tr_b16 a[100:101], v231 offset:40064
    ds_read_b64_tr_b16 a[102:103], v231 offset:43648
    v_mfma_f32_16x16x32_bf16 a[252:255], a[104:107], a[56:59], a[252:255]
    v_mfma_f32_16x16x32_bf16 a[252:255], a[108:111], a[68:71], a[252:255]
    s_waitcnt lgkmcnt(14)
    ds_read_b64_tr_b16 a[104:105], v231 offset:32928
    ds_read_b64_tr_b16 a[106:107], v231 offset:36512
    v_mfma_f32_16x16x32_bf16 a[172:175], a[112:115], a[72:75], a[172:175]
    buffer_load_dwordx4 a[20:23], v239, s[52:55], s74 offen offset:2048 sc1
    v_mbcnt_lo_u32_b32 v194, -1, 0
    v_mfma_f32_16x16x32_bf16 a[172:175], a[116:119], a[84:87], a[172:175]
    v_mbcnt_hi_u32_b32 v194, -1, v194
    v_lshlrev_b32 v192, 4, v194
    v_mfma_f32_16x16x32_bf16 a[176:179], a[112:115], a[76:79], a[176:179]
    ds_read_b64_tr_b16 a[108:109], v231 offset:40096
    ds_read_b64_tr_b16 a[110:111], v231 offset:43680
    v_mfma_f32_16x16x32_bf16 a[176:179], a[116:119], a[88:91], a[176:179]
    v_and_b32 v196, 15, v194
    v_lshrrev_b32 v197, 4, v194
    v_mfma_f32_16x16x32_bf16 a[180:183], a[112:115], a[80:83], a[180:183]
    ds_read_b64_tr_b16 a[112:113], v231 offset:32960
    ds_read_b64_tr_b16 a[114:115], v231 offset:36544
    v_mfma_f32_16x16x32_bf16 a[180:183], a[116:119], a[92:95], a[180:183]
    s_waitcnt lgkmcnt(14)
    v_mul_u32_u24 v193, 896, v196
    v_lshl_add_u32 v193, v197, 3, v193
    v_mfma_f32_16x16x32_bf16 a[184:187], a[120:123], a[72:75], a[184:187]
    s_lshl_b32 s12, s76, 8
    v_and_b32 v195, 3, v194
    v_lshlrev_b32 v195, 10, v195
    v_mfma_f32_16x16x32_bf16 a[184:187], a[124:127], a[84:87], a[184:187]
    ds_read_b64_tr_b16 a[116:117], v231 offset:40128
    ds_read_b64_tr_b16 a[118:119], v231 offset:43712
    v_mfma_f32_16x16x32_bf16 a[188:191], a[120:123], a[76:79], a[188:191]
    v_add_u32 v195, s12, v195
    v_add_u32 v199, 32768, v192
    v_mfma_f32_16x16x32_bf16 a[188:191], a[124:127], a[88:91], a[188:191]
    v_add_u32 v200, s11, v199
    v_mfma_f32_16x16x32_bf16 a[192:195], a[120:123], a[80:83], a[192:195]
    v_mfma_f32_16x16x32_bf16 a[192:195], a[124:127], a[92:95], a[192:195]
    v_mfma_f32_16x16x32_bf16 a[196:199], a[128:131], a[72:75], a[196:199]
    v_mfma_f32_16x16x32_bf16 a[196:199], a[132:135], a[84:87], a[196:199]
    v_mfma_f32_16x16x32_bf16 a[200:203], a[128:131], a[76:79], a[200:203]
    v_mfma_f32_16x16x32_bf16 a[200:203], a[132:135], a[88:91], a[200:203]
    s_waitcnt lgkmcnt(0)
    s_barrier
    v_mfma_f32_16x16x32_bf16 a[204:207], a[128:131], a[80:83], a[204:207]
    ds_read_b64_tr_b16 a[120:121], v236
    ds_read_b64_tr_b16 a[122:123], v236 offset:3584
    v_mfma_f32_16x16x32_bf16 a[204:207], a[132:135], a[92:95], a[204:207]
    v_mfma_f32_16x16x32_bf16 a[208:211], a[136:139], a[72:75], a[208:211]
    v_mfma_f32_16x16x32_bf16 a[208:211], a[140:143], a[84:87], a[208:211]
    ds_read_b64_tr_b16 a[124:125], v236 offset:7168
    ds_read_b64_tr_b16 a[126:127], v236 offset:10752
    v_mfma_f32_16x16x32_bf16 a[212:215], a[136:139], a[76:79], a[212:215]
    v_mfma_f32_16x16x32_bf16 a[212:215], a[140:143], a[88:91], a[212:215]
    v_mfma_f32_16x16x32_bf16 a[216:219], a[136:139], a[80:83], a[216:219]
    ds_read_b64_tr_b16 a[128:129], v236 offset:32
    ds_read_b64_tr_b16 a[130:131], v236 offset:3616
    v_mfma_f32_16x16x32_bf16 a[216:219], a[140:143], a[92:95], a[216:219]
    v_mfma_f32_16x16x32_bf16 a[220:223], a[96:99], a[72:75], a[220:223]
    v_mfma_f32_16x16x32_bf16 a[220:223], a[100:103], a[84:87], a[220:223]
    ds_read_b64_tr_b16 a[132:133], v236 offset:7200
    ds_read_b64_tr_b16 a[134:135], v236 offset:10784
    v_mfma_f32_16x16x32_bf16 a[224:227], a[96:99], a[76:79], a[224:227]
    v_mfma_f32_16x16x32_bf16 a[224:227], a[100:103], a[88:91], a[224:227]
    ds_read_b64_tr_b16 a[136:137], v237
    ds_read_b64_tr_b16 a[138:139], v237 offset:3584
    v_mfma_f32_16x16x32_bf16 a[228:231], a[96:99], a[80:83], a[228:231]
    v_mfma_f32_16x16x32_bf16 a[228:231], a[100:103], a[92:95], a[228:231]
    v_mfma_f32_16x16x32_bf16 a[232:235], a[104:107], a[72:75], a[232:235]
    ds_read_b64_tr_b16 a[140:141], v237 offset:7168
    ds_read_b64_tr_b16 a[142:143], v237 offset:10752
    v_mfma_f32_16x16x32_bf16 a[232:235], a[108:111], a[84:87], a[232:235]
    v_mfma_f32_16x16x32_bf16 a[236:239], a[104:107], a[76:79], a[236:239]
    v_mfma_f32_16x16x32_bf16 a[236:239], a[108:111], a[88:91], a[236:239]
    ds_read_b64_tr_b16 a[96:97], v237 offset:32
    ds_read_b64_tr_b16 a[98:99], v237 offset:3616
    v_mfma_f32_16x16x32_bf16 a[240:243], a[104:107], a[80:83], a[240:243]
    v_mfma_f32_16x16x32_bf16 a[240:243], a[108:111], a[92:95], a[240:243]
    v_mfma_f32_16x16x32_bf16 a[244:247], a[112:115], a[72:75], a[244:247]
    ds_read_b64_tr_b16 a[100:101], v237 offset:7200
    ds_read_b64_tr_b16 a[102:103], v237 offset:10784
    v_mfma_f32_16x16x32_bf16 a[244:247], a[116:119], a[84:87], a[244:247]
    v_mfma_f32_16x16x32_bf16 a[248:251], a[112:115], a[76:79], a[248:251]
    v_mfma_f32_16x16x32_bf16 a[248:251], a[116:119], a[88:91], a[248:251]
    ds_read_b64_tr_b16 a[104:105], v238
    ds_read_b64_tr_b16 a[106:107], v238 offset:3584
    v_mfma_f32_16x16x32_bf16 a[252:255], a[112:115], a[80:83], a[252:255]
    v_mfma_f32_16x16x32_bf16 a[252:255], a[116:119], a[92:95], a[252:255]
    s_waitcnt lgkmcnt(14)
    s_waitcnt vmcnt(17)
    v_mfma_f32_16x16x32_bf16 a[172:175], a[120:123], v[144:147], a[172:175]
    ds_read_b64_tr_b16 a[108:109], v238 offset:7168
    ds_read_b64_tr_b16 a[110:111], v238 offset:10752
    s_waitcnt vmcnt(14)
    v_mfma_f32_16x16x32_bf16 a[172:175], a[124:127], v[156:159], a[172:175]
    v_mfma_f32_16x16x32_bf16 a[176:179], a[120:123], v[148:151], a[176:179]
    s_waitcnt vmcnt(13)
    v_mfma_f32_16x16x32_bf16 a[176:179], a[124:127], v[160:163], a[176:179]
    ds_read_b64_tr_b16 a[112:113], v238 offset:32
    ds_read_b64_tr_b16 a[114:115], v238 offset:3616
    v_mfma_f32_16x16x32_bf16 a[180:183], a[120:123], v[152:155], a[180:183]
    s_waitcnt vmcnt(12)
    v_mfma_f32_16x16x32_bf16 a[180:183], a[124:127], v[164:167], a[180:183]
    s_waitcnt lgkmcnt(14)
    ds_read_b64_tr_b16 a[116:117], v238 offset:7200
    ds_read_b64_tr_b16 a[118:119], v238 offset:10784
    v_mfma_f32_16x16x32_bf16 a[184:187], a[128:131], v[144:147], a[184:187]
    v_mfma_f32_16x16x32_bf16 a[184:187], a[132:135], v[156:159], a[184:187]
    v_mfma_f32_16x16x32_bf16 a[188:191], a[128:131], v[148:151], a[188:191]
    ds_read_b64_tr_b16 a[120:121], v236 offset:64
    ds_read_b64_tr_b16 a[122:123], v236 offset:3648
    v_mfma_f32_16x16x32_bf16 a[188:191], a[132:135], v[160:163], a[188:191]
    v_mfma_f32_16x16x32_bf16 a[192:195], a[128:131], v[152:155], a[192:195]
    v_mfma_f32_16x16x32_bf16 a[192:195], a[132:135], v[164:167], a[192:195]
    s_waitcnt lgkmcnt(14)
    ds_read_b64_tr_b16 a[124:125], v236 offset:7232
    ds_read_b64_tr_b16 a[126:127], v236 offset:10816
    s_waitcnt vmcnt(11)
    v_mfma_f32_16x16x32_bf16 a[172:175], a[136:139], v[168:171], a[172:175]
    s_waitcnt vmcnt(8)
    v_mfma_f32_16x16x32_bf16 a[172:175], a[140:143], v[180:183], a[172:175]
    v_mfma_f32_16x16x32_bf16 a[176:179], a[136:139], v[172:175], a[176:179]
    ds_read_b64_tr_b16 a[128:129], v236 offset:96
    ds_read_b64_tr_b16 a[130:131], v236 offset:3680
    s_waitcnt vmcnt(7)
    v_mfma_f32_16x16x32_bf16 a[176:179], a[140:143], v[184:187], a[176:179]
    v_mfma_f32_16x16x32_bf16 a[180:183], a[136:139], v[176:179], a[180:183]
    s_waitcnt vmcnt(6)
    v_mfma_f32_16x16x32_bf16 a[180:183], a[140:143], v[188:191], a[180:183]
    s_waitcnt lgkmcnt(14)
    ds_read_b64_tr_b16 a[132:133], v236 offset:7264
    ds_read_b64_tr_b16 a[134:135], v236 offset:10848
    v_mfma_f32_16x16x32_bf16 a[184:187], a[96:99], v[168:171], a[184:187]
    v_mfma_f32_16x16x32_bf16 a[184:187], a[100:103], v[180:183], a[184:187]
    v_mfma_f32_16x16x32_bf16 a[188:191], a[96:99], v[172:175], a[188:191]
    ds_read_b64_tr_b16 a[136:137], v237 offset:64
    ds_read_b64_tr_b16 a[138:139], v237 offset:3648
    v_mfma_f32_16x16x32_bf16 a[188:191], a[100:103], v[184:187], a[188:191]
    v_mfma_f32_16x16x32_bf16 a[192:195], a[96:99], v[176:179], a[192:195]
    v_mfma_f32_16x16x32_bf16 a[192:195], a[100:103], v[188:191], a[192:195]
    s_waitcnt lgkmcnt(14)
    ds_read_b64_tr_b16 a[140:141], v237 offset:7232
    ds_read_b64_tr_b16 a[142:143], v237 offset:10816
    s_waitcnt vmcnt(5)
    v_mfma_f32_16x16x32_bf16 a[172:175], a[104:107], a[0:3], a[172:175]
    s_waitcnt vmcnt(2)
    v_mfma_f32_16x16x32_bf16 a[172:175], a[108:111], a[12:15], a[172:175]
    ds_read_b64_tr_b16 a[96:97], v237 offset:96
    ds_read_b64_tr_b16 a[98:99], v237 offset:3680
    v_mfma_f32_16x16x32_bf16 a[176:179], a[104:107], a[4:7], a[176:179]
    s_waitcnt vmcnt(1)
    v_mfma_f32_16x16x32_bf16 a[176:179], a[108:111], a[16:19], a[176:179]
    v_mfma_f32_16x16x32_bf16 a[180:183], a[104:107], a[8:11], a[180:183]
    ds_read_b64_tr_b16 a[100:101], v237 offset:7264
    ds_read_b64_tr_b16 a[102:103], v237 offset:10848
    s_waitcnt vmcnt(0)
    v_mfma_f32_16x16x32_bf16 a[180:183], a[108:111], a[20:23], a[180:183]
    s_waitcnt lgkmcnt(14)
    v_mfma_f32_16x16x32_bf16 a[184:187], a[112:115], a[0:3], a[184:187]
    v_mfma_f32_16x16x32_bf16 a[184:187], a[116:119], a[12:15], a[184:187]
    ds_read_b64_tr_b16 a[104:105], v238 offset:64
    ds_read_b64_tr_b16 a[106:107], v238 offset:3648
    v_mfma_f32_16x16x32_bf16 a[188:191], a[112:115], a[4:7], a[188:191]
    v_mfma_f32_16x16x32_bf16 a[188:191], a[116:119], a[16:19], a[188:191]
    v_mfma_f32_16x16x32_bf16 a[192:195], a[112:115], a[8:11], a[192:195]
    ds_read_b64_tr_b16 a[108:109], v238 offset:7232
    ds_read_b64_tr_b16 a[110:111], v238 offset:10816
    v_mfma_f32_16x16x32_bf16 a[192:195], a[116:119], a[20:23], a[192:195]
    s_waitcnt lgkmcnt(14)
    v_mfma_f32_16x16x32_bf16 a[196:199], a[120:123], v[144:147], a[196:199]
    v_mfma_f32_16x16x32_bf16 a[196:199], a[124:127], v[156:159], a[196:199]
    ds_read_b64_tr_b16 a[112:113], v238 offset:96
    ds_read_b64_tr_b16 a[114:115], v238 offset:3680
    v_mfma_f32_16x16x32_bf16 a[200:203], a[120:123], v[148:151], a[200:203]
    v_mfma_f32_16x16x32_bf16 a[200:203], a[124:127], v[160:163], a[200:203]
    v_accvgpr_read_b32 v0, a172
    v_accvgpr_read_b32 v1, a173
    v_mfma_f32_16x16x32_bf16 a[204:207], a[120:123], v[152:155], a[204:207]
    ds_read_b64_tr_b16 a[116:117], v238 offset:7264
    ds_read_b64_tr_b16 a[118:119], v238 offset:10848
    v_mfma_f32_16x16x32_bf16 a[204:207], a[124:127], v[164:167], a[204:207]
    s_waitcnt lgkmcnt(14)
    v_accvgpr_read_b32 v2, a174
    v_accvgpr_read_b32 v3, a175
    v_mfma_f32_16x16x32_bf16 a[208:211], a[128:131], v[144:147], a[208:211]
    ds_read_b64_tr_b16 a[120:121], v236 offset:128
    ds_read_b64_tr_b16 a[122:123], v236 offset:3712
    v_mfma_f32_16x16x32_bf16 a[208:211], a[132:135], v[156:159], a[208:211]
    v_accvgpr_read_b32 v4, a184
    v_accvgpr_read_b32 v5, a185
    v_mfma_f32_16x16x32_bf16 a[212:215], a[128:131], v[148:151], a[212:215]
    v_accvgpr_read_b32 v6, a186
    v_accvgpr_read_b32 v7, a187
    v_mfma_f32_16x16x32_bf16 a[212:215], a[132:135], v[160:163], a[212:215]
    ds_read_b64_tr_b16 a[124:125], v236 offset:7296
    ds_read_b64_tr_b16 a[126:127], v236 offset:10880
    v_mfma_f32_16x16x32_bf16 a[216:219], a[128:131], v[152:155], a[216:219]
    v_cvt_pk_bf16_f32 v8, v0, v1
    v_cvt_pk_bf16_f32 v9, v2, v3
    v_mfma_f32_16x16x32_bf16 a[216:219], a[132:135], v[164:167], a[216:219]
    s_waitcnt lgkmcnt(14)
    v_cvt_pk_bf16_f32 v10, v4, v5
    v_cvt_pk_bf16_f32 v11, v6, v7
    v_mfma_f32_16x16x32_bf16 a[196:199], a[136:139], v[168:171], a[196:199]
    s_add_u32 s7, s79, 0
    ds_read_b64_tr_b16 a[128:129], v236 offset:160
    ds_read_b64_tr_b16 a[130:131], v236 offset:3744
    v_mfma_f32_16x16x32_bf16 a[196:199], a[140:143], v[180:183], a[196:199]
    buffer_store_dwordx4 v[8:11], v192, s[56:59], s7 offen sc1
    v_accvgpr_read_b32 v12, a176
    v_mfma_f32_16x16x32_bf16 a[200:203], a[136:139], v[172:175], a[200:203]
    v_accvgpr_read_b32 v13, a177
    v_accvgpr_read_b32 v14, a178
    v_mfma_f32_16x16x32_bf16 a[200:203], a[140:143], v[184:187], a[200:203]
    ds_read_b64_tr_b16 a[132:133], v236 offset:7328
    ds_read_b64_tr_b16 a[134:135], v236 offset:10912
    v_mfma_f32_16x16x32_bf16 a[204:207], a[136:139], v[176:179], a[204:207]
    v_accvgpr_read_b32 v15, a179
    v_accvgpr_read_b32 v16, a188
    v_mfma_f32_16x16x32_bf16 a[204:207], a[140:143], v[188:191], a[204:207]
    s_waitcnt lgkmcnt(14)
    v_accvgpr_read_b32 v17, a189
    v_accvgpr_read_b32 v18, a190
    v_mfma_f32_16x16x32_bf16 a[208:211], a[96:99], v[168:171], a[208:211]
    ds_read_b64_tr_b16 a[136:137], v237 offset:128
    ds_read_b64_tr_b16 a[138:139], v237 offset:3712
    v_mfma_f32_16x16x32_bf16 a[208:211], a[100:103], v[180:183], a[208:211]
    v_accvgpr_read_b32 v19, a191
    v_cvt_pk_bf16_f32 v20, v12, v13
    v_mfma_f32_16x16x32_bf16 a[212:215], a[96:99], v[172:175], a[212:215]
    v_cvt_pk_bf16_f32 v21, v14, v15
    v_cvt_pk_bf16_f32 v22, v16, v17
    v_mfma_f32_16x16x32_bf16 a[212:215], a[100:103], v[184:187], a[212:215]
    ds_read_b64_tr_b16 a[140:141], v237 offset:7296
    ds_read_b64_tr_b16 a[142:143], v237 offset:10880
    v_mfma_f32_16x16x32_bf16 a[216:219], a[96:99], v[176:179], a[216:219]
    v_cvt_pk_bf16_f32 v23, v18, v19
    v_mfma_f32_16x16x32_bf16 a[216:219], a[100:103], v[188:191], a[216:219]
    s_waitcnt lgkmcnt(14)
    buffer_store_dwordx4 v[20:23], v192, s[56:59], s7 offen offset:1024 sc1
    v_accvgpr_read_b32 v24, a180
    v_mfma_f32_16x16x32_bf16 a[196:199], a[104:107], a[0:3], a[196:199]
    ds_read_b64_tr_b16 a[96:97], v237 offset:160
    ds_read_b64_tr_b16 a[98:99], v237 offset:3744
    v_mfma_f32_16x16x32_bf16 a[196:199], a[108:111], a[12:15], a[196:199]
    v_accvgpr_read_b32 v25, a181
    v_accvgpr_read_b32 v26, a182
    v_mfma_f32_16x16x32_bf16 a[200:203], a[104:107], a[4:7], a[200:203]
    ds_read_b64_tr_b16 a[100:101], v237 offset:7328
    ds_read_b64_tr_b16 a[102:103], v237 offset:10912
    v_mfma_f32_16x16x32_bf16 a[200:203], a[108:111], a[16:19], a[200:203]
    v_accvgpr_read_b32 v27, a183
    v_accvgpr_read_b32 v28, a192
    v_mfma_f32_16x16x32_bf16 a[204:207], a[104:107], a[8:11], a[204:207]
    v_accvgpr_read_b32 v29, a193
    v_accvgpr_read_b32 v30, a194
    v_mfma_f32_16x16x32_bf16 a[204:207], a[108:111], a[20:23], a[204:207]
    s_waitcnt lgkmcnt(14)
    ds_read_b64_tr_b16 a[104:105], v238 offset:128
    ds_read_b64_tr_b16 a[106:107], v238 offset:3712
    v_mfma_f32_16x16x32_bf16 a[208:211], a[112:115], a[0:3], a[208:211]
    v_accvgpr_read_b32 v31, a195
    v_cvt_pk_bf16_f32 v32, v24, v25
    v_mfma_f32_16x16x32_bf16 a[208:211], a[116:119], a[12:15], a[208:211]
    v_cvt_pk_bf16_f32 v33, v26, v27
    v_cvt_pk_bf16_f32 v34, v28, v29
    v_mfma_f32_16x16x32_bf16 a[212:215], a[112:115], a[4:7], a[212:215]
    ds_read_b64_tr_b16 a[108:109], v238 offset:7296
    ds_read_b64_tr_b16 a[110:111], v238 offset:10880
    v_mfma_f32_16x16x32_bf16 a[212:215], a[116:119], a[16:19], a[212:215]
    v_cvt_pk_bf16_f32 v35, v30, v31
    v_mfma_f32_16x16x32_bf16 a[216:219], a[112:115], a[8:11], a[216:219]
    buffer_store_dwordx4 v[32:35], v192, s[56:59], s7 offen offset:2048 sc1
    v_mfma_f32_16x16x32_bf16 a[216:219], a[116:119], a[20:23], a[216:219]
    s_waitcnt lgkmcnt(14)
    ds_read_b64_tr_b16 a[112:113], v238 offset:160
    ds_read_b64_tr_b16 a[114:115], v238 offset:3744
    v_mfma_f32_16x16x32_bf16 a[220:223], a[120:123], v[144:147], a[220:223]
    v_mfma_f32_16x16x32_bf16 a[220:223], a[124:127], v[156:159], a[220:223]
    v_mfma_f32_16x16x32_bf16 a[224:227], a[120:123], v[148:151], a[224:227]
    ds_read_b64_tr_b16 a[116:117], v238 offset:7328
    ds_read_b64_tr_b16 a[118:119], v238 offset:10912
    v_mfma_f32_16x16x32_bf16 a[224:227], a[124:127], v[160:163], a[224:227]
    v_accvgpr_read_b32 v36, a196
    v_accvgpr_read_b32 v37, a197
    v_mfma_f32_16x16x32_bf16 a[228:231], a[120:123], v[152:155], a[228:231]
    v_accvgpr_read_b32 v38, a198
    v_accvgpr_read_b32 v39, a199
    v_mfma_f32_16x16x32_bf16 a[228:231], a[124:127], v[164:167], a[228:231]
    s_waitcnt lgkmcnt(14)
    ds_read_b64_tr_b16 a[120:121], v236 offset:192
    ds_read_b64_tr_b16 a[122:123], v236 offset:3776
    v_mfma_f32_16x16x32_bf16 a[232:235], a[128:131], v[144:147], a[232:235]
    v_accvgpr_read_b32 v40, a208
    v_accvgpr_read_b32 v41, a209
    v_mfma_f32_16x16x32_bf16 a[232:235], a[132:135], v[156:159], a[232:235]
    v_accvgpr_read_b32 v42, a210
    v_accvgpr_read_b32 v43, a211
    v_mfma_f32_16x16x32_bf16 a[236:239], a[128:131], v[148:151], a[236:239]
    ds_read_b64_tr_b16 a[124:125], v236 offset:7360
    ds_read_b64_tr_b16 a[126:127], v236 offset:10944
    v_mfma_f32_16x16x32_bf16 a[236:239], a[132:135], v[160:163], a[236:239]
    v_cvt_pk_bf16_f32 v44, v36, v37
    v_cvt_pk_bf16_f32 v45, v38, v39
    v_mfma_f32_16x16x32_bf16 a[240:243], a[128:131], v[152:155], a[240:243]
    ds_read_b64_tr_b16 a[128:129], v237 offset:192
    ds_read_b64_tr_b16 a[130:131], v237 offset:3776
    v_mfma_f32_16x16x32_bf16 a[240:243], a[132:135], v[164:167], a[240:243]
    s_waitcnt lgkmcnt(14)
    v_cvt_pk_bf16_f32 v46, v40, v41
    v_cvt_pk_bf16_f32 v47, v42, v43
    v_mfma_f32_16x16x32_bf16 a[220:223], a[136:139], v[168:171], a[220:223]
    s_add_u32 s7, s79, 3072
    buffer_store_dwordx4 v[44:47], v192, s[56:59], s7 offen sc1
    v_accvgpr_read_b32 v48, a200
    v_mfma_f32_16x16x32_bf16 a[220:223], a[140:143], v[180:183], a[220:223]
    ds_read_b64_tr_b16 a[132:133], v237 offset:7360
    ds_read_b64_tr_b16 a[134:135], v237 offset:10944
    v_mfma_f32_16x16x32_bf16 a[224:227], a[136:139], v[172:175], a[224:227]
    v_accvgpr_read_b32 v49, a201
    v_accvgpr_read_b32 v50, a202
    v_mfma_f32_16x16x32_bf16 a[224:227], a[140:143], v[184:187], a[224:227]
    v_accvgpr_read_b32 v51, a203
    v_accvgpr_read_b32 v52, a212
    v_mfma_f32_16x16x32_bf16 a[228:231], a[136:139], v[176:179], a[228:231]
    ds_read_b64_tr_b16 a[136:137], v238 offset:192
    ds_read_b64_tr_b16 a[138:139], v238 offset:3776
    v_mfma_f32_16x16x32_bf16 a[228:231], a[140:143], v[188:191], a[228:231]
    v_accvgpr_read_b32 v53, a213
    v_accvgpr_read_b32 v54, a214
    v_mfma_f32_16x16x32_bf16 a[232:235], a[96:99], v[168:171], a[232:235]
    v_accvgpr_read_b32 v55, a215
    v_cvt_pk_bf16_f32 v56, v48, v49
    v_mfma_f32_16x16x32_bf16 a[232:235], a[100:103], v[180:183], a[232:235]
    ds_read_b64_tr_b16 a[140:141], v238 offset:7360
    ds_read_b64_tr_b16 a[142:143], v238 offset:10944
    v_mfma_f32_16x16x32_bf16 a[236:239], a[96:99], v[172:175], a[236:239]
    v_cvt_pk_bf16_f32 v57, v50, v51
    v_cvt_pk_bf16_f32 v58, v52, v53
    v_mfma_f32_16x16x32_bf16 a[236:239], a[100:103], v[184:187], a[236:239]
    v_cvt_pk_bf16_f32 v59, v54, v55
    v_mfma_f32_16x16x32_bf16 a[240:243], a[96:99], v[176:179], a[240:243]
    buffer_store_dwordx4 v[56:59], v192, s[56:59], s7 offen offset:1024 sc1
    v_accvgpr_read_b32 v60, a204
    v_mfma_f32_16x16x32_bf16 a[240:243], a[100:103], v[188:191], a[240:243]
    s_waitcnt lgkmcnt(14)
    v_accvgpr_read_b32 v61, a205
    v_accvgpr_read_b32 v62, a206
    v_mfma_f32_16x16x32_bf16 a[220:223], a[104:107], a[0:3], a[220:223]
    v_accvgpr_read_b32 v63, a207
    v_accvgpr_read_b32 v64, a216
    v_mfma_f32_16x16x32_bf16 a[220:223], a[108:111], a[12:15], a[220:223]
    v_accvgpr_read_b32 v65, a217
    v_accvgpr_read_b32 v66, a218
    v_mfma_f32_16x16x32_bf16 a[224:227], a[104:107], a[4:7], a[224:227]
    v_accvgpr_read_b32 v67, a219
    v_cvt_pk_bf16_f32 v68, v60, v61
    v_mfma_f32_16x16x32_bf16 a[224:227], a[108:111], a[16:19], a[224:227]
    v_cvt_pk_bf16_f32 v69, v62, v63
    v_cvt_pk_bf16_f32 v70, v64, v65
    v_mfma_f32_16x16x32_bf16 a[228:231], a[104:107], a[8:11], a[228:231]
    v_cvt_pk_bf16_f32 v71, v66, v67
    v_mfma_f32_16x16x32_bf16 a[228:231], a[108:111], a[20:23], a[228:231]
    s_waitcnt lgkmcnt(12)
    buffer_store_dwordx4 v[68:71], v192, s[56:59], s7 offen offset:2048 sc1
    v_mfma_f32_16x16x32_bf16 a[232:235], a[112:115], a[0:3], a[232:235]
    v_mfma_f32_16x16x32_bf16 a[232:235], a[116:119], a[12:15], a[232:235]
    v_mfma_f32_16x16x32_bf16 a[236:239], a[112:115], a[4:7], a[236:239]
    v_mfma_f32_16x16x32_bf16 a[236:239], a[116:119], a[16:19], a[236:239]
    v_mfma_f32_16x16x32_bf16 a[240:243], a[112:115], a[8:11], a[240:243]
    v_mfma_f32_16x16x32_bf16 a[240:243], a[116:119], a[20:23], a[240:243]
    s_waitcnt lgkmcnt(8)
    v_mfma_f32_16x16x32_bf16 a[244:247], a[120:123], v[144:147], a[244:247]
    v_mfma_f32_16x16x32_bf16 a[244:247], a[124:127], v[156:159], a[244:247]
    v_mfma_f32_16x16x32_bf16 a[248:251], a[120:123], v[148:151], a[248:251]
    v_mfma_f32_16x16x32_bf16 a[248:251], a[124:127], v[160:163], a[248:251]
    v_accvgpr_read_b32 v72, a220
    v_accvgpr_read_b32 v73, a221
    v_mfma_f32_16x16x32_bf16 a[252:255], a[120:123], v[152:155], a[252:255]
    v_accvgpr_read_b32 v74, a222
    v_accvgpr_read_b32 v75, a223
    v_mfma_f32_16x16x32_bf16 a[252:255], a[124:127], v[164:167], a[252:255]
    s_waitcnt lgkmcnt(4)
    v_accvgpr_read_b32 v76, a232
    v_accvgpr_read_b32 v77, a233
    v_mfma_f32_16x16x32_bf16 a[244:247], a[128:131], v[168:171], a[244:247]
    v_accvgpr_read_b32 v78, a234
    v_accvgpr_read_b32 v79, a235
    v_mfma_f32_16x16x32_bf16 a[244:247], a[132:135], v[180:183], a[244:247]
    v_cvt_pk_bf16_f32 v80, v72, v73
    v_cvt_pk_bf16_f32 v81, v74, v75
    v_mfma_f32_16x16x32_bf16 a[248:251], a[128:131], v[172:175], a[248:251]
    v_cvt_pk_bf16_f32 v82, v76, v77
    v_cvt_pk_bf16_f32 v83, v78, v79
    v_mfma_f32_16x16x32_bf16 a[248:251], a[132:135], v[184:187], a[248:251]
    s_add_u32 s7, s79, 6144
    buffer_store_dwordx4 v[80:83], v192, s[56:59], s7 offen sc1
    v_accvgpr_read_b32 v84, a224
    v_mfma_f32_16x16x32_bf16 a[252:255], a[128:131], v[176:179], a[252:255]
    v_accvgpr_read_b32 v85, a225
    v_accvgpr_read_b32 v86, a226
    v_mfma_f32_16x16x32_bf16 a[252:255], a[132:135], v[188:191], a[252:255]
    s_waitcnt lgkmcnt(0)
    v_accvgpr_read_b32 v87, a227
    v_accvgpr_read_b32 v88, a236
    v_mfma_f32_16x16x32_bf16 a[244:247], a[136:139], a[0:3], a[244:247]
    v_accvgpr_read_b32 v89, a237
    v_accvgpr_read_b32 v90, a238
    v_mfma_f32_16x16x32_bf16 a[244:247], a[140:143], a[12:15], a[244:247]
    v_accvgpr_read_b32 v91, a239
    v_cvt_pk_bf16_f32 v92, v84, v85
    v_mfma_f32_16x16x32_bf16 a[248:251], a[136:139], a[4:7], a[248:251]
    v_cvt_pk_bf16_f32 v93, v86, v87
    v_cvt_pk_bf16_f32 v94, v88, v89
    v_mfma_f32_16x16x32_bf16 a[248:251], a[140:143], a[16:19], a[248:251]
    v_cvt_pk_bf16_f32 v95, v90, v91
    v_mfma_f32_16x16x32_bf16 a[252:255], a[136:139], a[8:11], a[252:255]
    buffer_store_dwordx4 v[92:95], v192, s[56:59], s7 offen offset:1024 sc1
    v_accvgpr_read_b32 v0, a228
    v_accvgpr_read_b32 v1, a229
    v_accvgpr_read_b32 v2, a230
    v_accvgpr_read_b32 v3, a231
    v_accvgpr_read_b32 v4, a240
    v_accvgpr_read_b32 v5, a241
    v_accvgpr_read_b32 v6, a242
    v_accvgpr_read_b32 v7, a243
    v_cvt_pk_bf16_f32 v8, v0, v1
    v_cvt_pk_bf16_f32 v9, v2, v3
    v_cvt_pk_bf16_f32 v10, v4, v5
    v_cvt_pk_bf16_f32 v11, v6, v7
    buffer_store_dwordx4 v[8:11], v192, s[56:59], s7 offen offset:2048 sc1
    v_mfma_f32_16x16x32_bf16 a[252:255], a[140:143], a[20:23], a[252:255]
    v_accvgpr_read_b32 v12, a244
    v_accvgpr_read_b32 v13, a245
    v_accvgpr_read_b32 v14, a246
    v_accvgpr_read_b32 v15, a247
    v_cvt_pk_bf16_f32 v20, v12, v13
    v_cvt_pk_bf16_f32 v21, v14, v15
    s_add_u32 s7, s79, 9216
    buffer_store_dwordx2 v[20:21], v192, s[56:59], s7 offen sc1
    v_accvgpr_read_b32 v24, a248
    v_accvgpr_read_b32 v25, a249
    v_accvgpr_read_b32 v26, a250
    v_accvgpr_read_b32 v27, a251
    v_cvt_pk_bf16_f32 v32, v24, v25
    v_cvt_pk_bf16_f32 v33, v26, v27
    buffer_store_dwordx2 v[32:33], v192, s[56:59], s7 offen offset:1024 sc1
    v_accvgpr_read_b32 v36, a252
    v_accvgpr_read_b32 v37, a253
    v_accvgpr_read_b32 v38, a254
    v_accvgpr_read_b32 v39, a255
    v_cvt_pk_bf16_f32 v44, v36, v37
    v_cvt_pk_bf16_f32 v45, v38, v39
    buffer_store_dwordx2 v[44:45], v192, s[56:59], s7 offen offset:2048 sc1
    v_mov_b32 v233, 5
    s_cmp_lg_u32 s3, s75
    s_cbranch_scc1 L_partdone
    ds_write_b128 v199, a[172:175]
    ds_write_b128 v199, a[176:179] offset:1024
    ds_write_b128 v199, a[180:183] offset:2048
    ds_write_b128 v199, a[184:187] offset:3072
    ds_write_b128 v199, a[188:191] offset:4096
    ds_write_b128 v199, a[192:195] offset:5120
    ds_write_b128 v199, a[196:199] offset:6144
    ds_write_b128 v199, a[200:203] offset:7168
    ds_write_b128 v199, a[204:207] offset:8192
    ds_write_b128 v199, a[208:211] offset:9216
    ds_write_b128 v199, a[212:215] offset:10240
    ds_write_b128 v199, a[216:219] offset:11264
    ds_write_b128 v199, a[220:223] offset:12288
    ds_write_b128 v199, a[224:227] offset:13312
    ds_write_b128 v199, a[228:231] offset:14336
    ds_write_b128 v199, a[232:235] offset:15360
    ds_write_b128 v199, a[236:239] offset:16384
    ds_write_b128 v199, a[240:243] offset:17408
    ds_write_b128 v199, a[244:247] offset:18432
    ds_write_b128 v199, a[248:251] offset:19456
    ds_write_b128 v199, a[252:255] offset:20480
L_partdone:
    s_waitcnt vmcnt(0) lgkmcnt(0)
    s_barrier
    buffer_store_dword v233, v232, s[68:71], 0 offen sc1
    ds_read_b128 v[64:67], v200
    ds_read_b128 v[68:71], v200 offset:3072
    ds_read_b128 v[72:75], v200 offset:1024
    ds_read_b128 v[76:79], v200 offset:4096
    ds_read_b128 v[80:83], v200 offset:2048
    ds_read_b128 v[84:87], v200 offset:5120
L_poll:
    buffer_load_dword v198, v195, s[68:71], 0 offen sc1
    s_waitcnt vmcnt(0)
    v_cmp_gt_u32 vcc, 5, v198
    s_nop 4
    s_cmp_eq_u64 vcc, 0
    s_cbranch_scc1 L_pollskip
    s_sleep 1
    s_add_u32 s86, s86, 1
    s_cmp_gt_u32 s86, 0x40000
    s_cbranch_scc0 L_poll
L_pollskip:
    buffer_load_dwordx4 v[0:3], v192, s[56:59], s17 offen sc1
    buffer_load_dwordx4 v[4:7], v192, s[56:59], s18 offen sc1
    buffer_load_dwordx4 v[8:11], v192, s[56:59], s19 offen sc1
    buffer_load_dwordx4 v[16:19], v192, s[56:59], s17 offen offset:1024 sc1
    buffer_load_dwordx4 v[20:23], v192, s[56:59], s18 offen offset:1024 sc1
    buffer_load_dwordx4 v[24:27], v192, s[56:59], s19 offen offset:1024 sc1
    buffer_load_dwordx4 v[32:35], v192, s[56:59], s17 offen offset:2048 sc1
    buffer_load_dwordx4 v[36:39], v192, s[56:59], s18 offen offset:2048 sc1
    buffer_load_dwordx4 v[40:43], v192, s[56:59], s19 offen offset:2048 sc1
    s_mov_b32 s6, 0xffff0000
    s_waitcnt vmcnt(8)
    v_lshlrev_b32 v96, 16, v0
    v_and_b32 v97, s6, v0
    s_waitcnt lgkmcnt(4)
    v_add_f32 v64, v64, v96
    v_add_f32 v65, v65, v97
    v_lshlrev_b32 v98, 16, v1
    v_and_b32 v99, s6, v1
    v_add_f32 v66, v66, v98
    v_add_f32 v67, v67, v99
    v_lshlrev_b32 v96, 16, v2
    v_and_b32 v97, s6, v2
    v_add_f32 v68, v68, v96
    v_add_f32 v69, v69, v97
    v_lshlrev_b32 v98, 16, v3
    v_and_b32 v99, s6, v3
    v_add_f32 v70, v70, v98
    v_add_f32 v71, v71, v99
    s_waitcnt vmcnt(7)
    v_lshlrev_b32 v96, 16, v4
    v_and_b32 v97, s6, v4
    v_add_f32 v64, v64, v96
    v_add_f32 v65, v65, v97
    v_lshlrev_b32 v98, 16, v5
    v_and_b32 v99, s6, v5
    v_add_f32 v66, v66, v98
    v_add_f32 v67, v67, v99
    v_lshlrev_b32 v96, 16, v6
    v_and_b32 v97, s6, v6
    v_add_f32 v68, v68, v96
    v_add_f32 v69, v69, v97
    v_lshlrev_b32 v98, 16, v7
    v_and_b32 v99, s6, v7
    v_add_f32 v70, v70, v98
    v_add_f32 v71, v71, v99
    s_waitcnt vmcnt(6)
    v_lshlrev_b32 v96, 16, v8
    v_and_b32 v97, s6, v8
    v_add_f32 v64, v64, v96
    v_add_f32 v65, v65, v97
    v_lshlrev_b32 v98, 16, v9
    v_and_b32 v99, s6, v9
    v_add_f32 v66, v66, v98
    v_add_f32 v67, v67, v99
    v_lshlrev_b32 v96, 16, v10
    v_and_b32 v97, s6, v10
    v_add_f32 v68, v68, v96
    v_add_f32 v69, v69, v97
    v_lshlrev_b32 v98, 16, v11
    v_and_b32 v99, s6, v11
    v_add_f32 v70, v70, v98
    v_add_f32 v71, v71, v99
    v_cvt_pk_bf16_f32 v100, v64, v65
    v_cvt_pk_bf16_f32 v101, v66, v67
    v_cvt_pk_bf16_f32 v102, v68, v69
    v_cvt_pk_bf16_f32 v103, v70, v71
    buffer_store_dwordx2 v[100:101], v193, s[60:63], s83 offen
    buffer_store_dwordx2 v[102:103], v193, s[60:63], s16 offen
    s_waitcnt vmcnt(7)
    v_lshlrev_b32 v96, 16, v16
    v_and_b32 v97, s6, v16
    s_waitcnt lgkmcnt(2)
    v_add_f32 v72, v72, v96
    v_add_f32 v73, v73, v97
    v_lshlrev_b32 v98, 16, v17
    v_and_b32 v99, s6, v17
    v_add_f32 v74, v74, v98
    v_add_f32 v75, v75, v99
    v_lshlrev_b32 v96, 16, v18
    v_and_b32 v97, s6, v18
    v_add_f32 v76, v76, v96
    v_add_f32 v77, v77, v97
    v_lshlrev_b32 v98, 16, v19
    v_and_b32 v99, s6, v19
    v_add_f32 v78, v78, v98
    v_add_f32 v79, v79, v99
    s_waitcnt vmcnt(6)
    v_lshlrev_b32 v96, 16, v20
    v_and_b32 v97, s6, v20
    v_add_f32 v72, v72, v96
    v_add_f32 v73, v73, v97
    v_lshlrev_b32 v98, 16, v21
    v_and_b32 v99, s6, v21
    v_add_f32 v74, v74, v98
    v_add_f32 v75, v75, v99
    v_lshlrev_b32 v96, 16, v22
    v_and_b32 v97, s6, v22
    v_add_f32 v76, v76, v96
    v_add_f32 v77, v77, v97
    v_lshlrev_b32 v98, 16, v23
    v_and_b32 v99, s6, v23
    v_add_f32 v78, v78, v98
    v_add_f32 v79, v79, v99
    s_waitcnt vmcnt(5)
    v_lshlrev_b32 v96, 16, v24
    v_and_b32 v97, s6, v24
    v_add_f32 v72, v72, v96
    v_add_f32 v73, v73, v97
    v_lshlrev_b32 v98, 16, v25
    v_and_b32 v99, s6, v25
    v_add_f32 v74, v74, v98
    v_add_f32 v75, v75, v99
    v_lshlrev_b32 v96, 16, v26
    v_and_b32 v97, s6, v26
    v_add_f32 v76, v76, v96
    v_add_f32 v77, v77, v97
    v_lshlrev_b32 v98, 16, v27
    v_and_b32 v99, s6, v27
    v_add_f32 v78, v78, v98
    v_add_f32 v79, v79, v99
    v_cvt_pk_bf16_f32 v104, v72, v73
    v_cvt_pk_bf16_f32 v105, v74, v75
    v_cvt_pk_bf16_f32 v106, v76, v77
    v_cvt_pk_bf16_f32 v107, v78, v79
    v_add_u32 v193, 14336, v193
    buffer_store_dwordx2 v[104:105], v193, s[60:63], s83 offen
    buffer_store_dwordx2 v[106:107], v193, s[60:63], s16 offen
    s_waitcnt vmcnt(6)
    v_lshlrev_b32 v96, 16, v32
    v_and_b32 v97, s6, v32
    s_waitcnt lgkmcnt(0)
    v_add_f32 v80, v80, v96
    v_add_f32 v81, v81, v97
    v_lshlrev_b32 v98, 16, v33
    v_and_b32 v99, s6, v33
    v_add_f32 v82, v82, v98
    v_add_f32 v83, v83, v99
    v_lshlrev_b32 v96, 16, v34
    v_and_b32 v97, s6, v34
    v_add_f32 v84, v84, v96
    v_add_f32 v85, v85, v97
    v_lshlrev_b32 v98, 16, v35
    v_and_b32 v99, s6, v35
    v_add_f32 v86, v86, v98
    v_add_f32 v87, v87, v99
    s_waitcnt vmcnt(5)
    v_lshlrev_b32 v96, 16, v36
    v_and_b32 v97, s6, v36
    v_add_f32 v80, v80, v96
    v_add_f32 v81, v81, v97
    v_lshlrev_b32 v98, 16, v37
    v_and_b32 v99, s6, v37
    v_add_f32 v82, v82, v98
    v_add_f32 v83, v83, v99
    v_lshlrev_b32 v96, 16, v38
    v_and_b32 v97, s6, v38
    v_add_f32 v84, v84, v96
    v_add_f32 v85, v85, v97
    v_lshlrev_b32 v98, 16, v39
    v_and_b32 v99, s6, v39
    v_add_f32 v86, v86, v98
    v_add_f32 v87, v87, v99
    s_waitcnt vmcnt(4)
    v_lshlrev_b32 v96, 16, v40
    v_and_b32 v97, s6, v40
    v_add_f32 v80, v80, v96
    v_add_f32 v81, v81, v97
    v_lshlrev_b32 v98, 16, v41
    v_and_b32 v99, s6, v41
    v_add_f32 v82, v82, v98
    v_add_f32 v83, v83, v99
    v_lshlrev_b32 v96, 16, v42
    v_and_b32 v97, s6, v42
    v_add_f32 v84, v84, v96
    v_add_f32 v85, v85, v97
    v_lshlrev_b32 v98, 16, v43
    v_and_b32 v99, s6, v43
    v_add_f32 v86, v86, v98
    v_add_f32 v87, v87, v99
    v_cvt_pk_bf16_f32 v108, v80, v81
    v_cvt_pk_bf16_f32 v109, v82, v83
    v_cvt_pk_bf16_f32 v110, v84, v85
    v_cvt_pk_bf16_f32 v111, v86, v87
    v_add_u32 v193, 14336, v193
    buffer_store_dwordx2 v[108:109], v193, s[60:63], s83 offen
    buffer_store_dwordx2 v[110:111], v193, s[60:63], s16 offen
L_end:
    s_endpgm
L_spinI:
    s_sleep 2
    s_add_u32 s86, s86, 1
    s_cmp_gt_u32 s86, 0x40000
    s_cbranch_scc1 L_retI
    buffer_load_dword v171, v170, s[88:91], 0 offen sc1
    s_waitcnt vmcnt(0)
    v_readfirstlane_b32 s78, v171
    s_nop 4
    s_cmp_lt_u32 s78, 16
    s_cbranch_scc1 L_spinI
    s_branch L_retI
L_spin0:
    s_sleep 2
    s_add_u32 s86, s86, 1
    s_cmp_gt_u32 s86, 0x40000
    s_cbranch_scc1 L_ret0
    buffer_load_dword v234, v235, s[68:71], 0 offen sc1
    s_waitcnt vmcnt(0)
    v_cmp_gt_u32 vcc, 1, v234
    s_nop 4
    s_cmp_lg_u64 vcc, 0
    s_cbranch_scc1 L_spin0
    s_branch L_ret0
L_spin1:
    s_sleep 2
    s_add_u32 s86, s86, 1
    s_cmp_gt_u32 s86, 0x40000
    s_cbranch_scc1 L_ret1
    buffer_load_dword v234, v235, s[68:71], 0 offen sc1
    s_waitcnt vmcnt(0)
    v_cmp_gt_u32 vcc, 2, v234
    s_nop 4
    s_cmp_lg_u64 vcc, 0
    s_cbranch_scc1 L_spin1
    s_branch L_ret1
L_spin2:
    s_sleep 2
    s_add_u32 s86, s86, 1
    s_cmp_gt_u32 s86, 0x40000
    s_cbranch_scc1 L_ret2
    buffer_load_dword v234, v235, s[68:71], 0 offen sc1
    s_waitcnt vmcnt(0)
    v_cmp_gt_u32 vcc, 3, v234
    s_nop 4
    s_cmp_lg_u64 vcc, 0
    s_cbranch_scc1 L_spin2
    s_branch L_ret2
L_spin3:
    s_sleep 2
    s_add_u32 s86, s86, 1
    s_cmp_gt_u32 s86, 0x40000
    s_cbranch_scc1 L_ret3
    buffer_load_dword v234, v235, s[68:71], 0 offen sc1
    s_waitcnt vmcnt(0)
    v_cmp_gt_u32 vcc, 4, v234
    s_nop 4
    s_cmp_lg_u64 vcc, 0
    s_cbranch_scc1 L_spin3
    s_branch L_ret3
L_fallback:
    s_nop 15
    s_waitcnt vmcnt(0) lgkmcnt(0)
    v_accvgpr_read_b32 v216, a195
    v_mov_b32 v217, 0xff800000
    v_mov_b32 v218, 0xff800000
    v_mov_b32 v219, 0xff800000
    s_mov_b32 s84, 0
    s_mov_b32 s85, 8192
L_fb_max:
    buffer_load_dwordx4 a[144:147], v216, s[40:43], s84 offen
    buffer_load_dwordx4 a[148:151], v216, s[40:43], s85 offen
    buffer_load_dwordx4 a[152:155], v216, s[40:43], s84 offen offset:64
    buffer_load_dwordx4 a[156:159], v216, s[40:43], s85 offen offset:64
    s_waitcnt vmcnt(3)
    v_mfma_f32_16x16x32_bf16 v[192:195], a[144:147], a[0:3], 0
    v_mfma_f32_16x16x32_bf16 v[196:199], a[144:147], a[4:7], 0
    v_mfma_f32_16x16x32_bf16 v[200:203], a[144:147], a[8:11], 0
    s_waitcnt vmcnt(2)
    v_mfma_f32_16x16x32_bf16 v[204:207], a[148:151], a[0:3], 0
    v_mfma_f32_16x16x32_bf16 v[208:211], a[148:151], a[4:7], 0
    v_mfma_f32_16x16x32_bf16 v[212:215], a[148:151], a[8:11], 0
    s_waitcnt vmcnt(1)
    v_mfma_f32_16x16x32_bf16 v[192:195], a[152:155], a[12:15], v[192:195]
    v_mfma_f32_16x16x32_bf16 v[196:199], a[152:155], a[16:19], v[196:199]
    v_mfma_f32_16x16x32_bf16 v[200:203], a[152:155], a[20:23], v[200:203]
    s_waitcnt vmcnt(0)
    v_mfma_f32_16x16x32_bf16 v[204:207], a[156:159], a[12:15], v[204:207]
    v_mfma_f32_16x16x32_bf16 v[208:211], a[156:159], a[16:19], v[208:211]
    v_mfma_f32_16x16x32_bf16 v[212:215], a[156:159], a[20:23], v[212:215]
    s_nop 7
    buffer_load_dwordx4 a[144:147], v216, s[40:43], s84 offen offset:128
    buffer_load_dwordx4 a[148:151], v216, s[40:43], s85 offen offset:128
    buffer_load_dwordx4 a[152:155], v216, s[40:43], s84 offen offset:192
    buffer_load_dwordx4 a[156:159], v216, s[40:43], s85 offen offset:192
    s_waitcnt vmcnt(3)
    v_mfma_f32_16x16x32_bf16 v[192:195], a[144:147], a[24:27], v[192:195]
    v_mfma_f32_16x16x32_bf16 v[196:199], a[144:147], a[28:31], v[196:199]
    v_mfma_f32_16x16x32_bf16 v[200:203], a[144:147], a[32:35], v[200:203]
    s_waitcnt vmcnt(2)
    v_mfma_f32_16x16x32_bf16 v[204:207], a[148:151], a[24:27], v[204:207]
    v_mfma_f32_16x16x32_bf16 v[208:211], a[148:151], a[28:31], v[208:211]
    v_mfma_f32_16x16x32_bf16 v[212:215], a[148:151], a[32:35], v[212:215]
    s_waitcnt vmcnt(1)
    v_mfma_f32_16x16x32_bf16 v[192:195], a[152:155], a[36:39], v[192:195]
    v_mfma_f32_16x16x32_bf16 v[196:199], a[152:155], a[40:43], v[196:199]
    v_mfma_f32_16x16x32_bf16 v[200:203], a[152:155], a[44:47], v[200:203]
    s_waitcnt vmcnt(0)
    v_mfma_f32_16x16x32_bf16 v[204:207], a[156:159], a[36:39], v[204:207]
    v_mfma_f32_16x16x32_bf16 v[208:211], a[156:159], a[40:43], v[208:211]
    v_mfma_f32_16x16x32_bf16 v[212:215], a[156:159], a[44:47], v[212:215]
    s_nop 7
    buffer_load_dwordx4 a[144:147], v216, s[40:43], s84 offen offset:256
    buffer_load_dwordx4 a[148:151], v216, s[40:43], s85 offen offset:256
    buffer_load_dwordx4 a[152:155], v216, s[40:43], s84 offen offset:320
    buffer_load_dwordx4 a[156:159], v216, s[40:43], s85 offen offset:320
    s_waitcnt vmcnt(3)
    v_mfma_f32_16x16x32_bf16 v[192:195], a[144:147], a[48:51], v[192:195]
    v_mfma_f32_16x16x32_bf16 v[196:199], a[144:147], a[52:55], v[196:199]
    v_mfma_f32_16x16x32_bf16 v[200:203], a[144:147], a[56:59], v[200:203]
    s_waitcnt vmcnt(2)
    v_mfma_f32_16x16x32_bf16 v[204:207], a[148:151], a[48:51], v[204:207]
    v_mfma_f32_16x16x32_bf16 v[208:211], a[148:151], a[52:55], v[208:211]
    v_mfma_f32_16x16x32_bf16 v[212:215], a[148:151], a[56:59], v[212:215]
    s_waitcnt vmcnt(1)
    v_mfma_f32_16x16x32_bf16 v[192:195], a[152:155], a[60:63], v[192:195]
    v_mfma_f32_16x16x32_bf16 v[196:199], a[152:155], a[64:67], v[196:199]
    v_mfma_f32_16x16x32_bf16 v[200:203], a[152:155], a[68:71], v[200:203]
    s_waitcnt vmcnt(0)
    v_mfma_f32_16x16x32_bf16 v[204:207], a[156:159], a[60:63], v[204:207]
    v_mfma_f32_16x16x32_bf16 v[208:211], a[156:159], a[64:67], v[208:211]
    v_mfma_f32_16x16x32_bf16 v[212:215], a[156:159], a[68:71], v[212:215]
    s_nop 7
    buffer_load_dwordx4 a[144:147], v216, s[40:43], s84 offen offset:384
    buffer_load_dwordx4 a[148:151], v216, s[40:43], s85 offen offset:384
    buffer_load_dwordx4 a[152:155], v216, s[40:43], s84 offen offset:448
    buffer_load_dwordx4 a[156:159], v216, s[40:43], s85 offen offset:448
    s_waitcnt vmcnt(3)
    v_mfma_f32_16x16x32_bf16 v[192:195], a[144:147], a[72:75], v[192:195]
    v_mfma_f32_16x16x32_bf16 v[196:199], a[144:147], a[76:79], v[196:199]
    v_mfma_f32_16x16x32_bf16 v[200:203], a[144:147], a[80:83], v[200:203]
    s_waitcnt vmcnt(2)
    v_mfma_f32_16x16x32_bf16 v[204:207], a[148:151], a[72:75], v[204:207]
    v_mfma_f32_16x16x32_bf16 v[208:211], a[148:151], a[76:79], v[208:211]
    v_mfma_f32_16x16x32_bf16 v[212:215], a[148:151], a[80:83], v[212:215]
    s_waitcnt vmcnt(1)
    v_mfma_f32_16x16x32_bf16 v[192:195], a[152:155], a[84:87], v[192:195]
    v_mfma_f32_16x16x32_bf16 v[196:199], a[152:155], a[88:91], v[196:199]
    v_mfma_f32_16x16x32_bf16 v[200:203], a[152:155], a[92:95], v[200:203]
    s_waitcnt vmcnt(0)
    v_mfma_f32_16x16x32_bf16 v[204:207], a[156:159], a[84:87], v[204:207]
    v_mfma_f32_16x16x32_bf16 v[208:211], a[156:159], a[88:91], v[208:211]
    v_mfma_f32_16x16x32_bf16 v[212:215], a[156:159], a[92:95], v[212:215]
    s_nop 7
    v_max3_f32 v217, v217, v192, v193
    v_max3_f32 v217, v217, v194, v195
    v_max3_f32 v217, v217, v204, v205
    v_max3_f32 v217, v217, v206, v207
    v_max3_f32 v218, v218, v196, v197
    v_max3_f32 v218, v218, v198, v199
    v_max3_f32 v218, v218, v208, v209
    v_max3_f32 v218, v218, v210, v211
    v_max3_f32 v219, v219, v200, v201
    v_max3_f32 v219, v219, v202, v203
    v_max3_f32 v219, v219, v212, v213
    v_max3_f32 v219, v219, v214, v215
    s_add_u32 s84, s84, 16384
    s_add_u32 s85, s85, 16384
    s_cmp_lt_u32 s84, 262144
    s_cbranch_scc1 L_fb_max
    v_max3_f32 v220, v217, v217, v217
    v_mov_b32 v221, v220
    s_nop 1
    v_permlane16_swap_b32 v220, v221
    v_max_f32 v220, v220, v221
    v_mov_b32 v221, v220
    s_nop 1
    v_permlane32_swap_b32 v220, v221
    v_max_f32 v220, v220, v221
    v_sub_f32 v228, 0, v220
    v_sub_f32 v229, 0, v220
    v_sub_f32 v230, 0, v220
    v_sub_f32 v231, 0, v220
    v_max3_f32 v220, v218, v218, v218
    v_mov_b32 v221, v220
    s_nop 1
    v_permlane16_swap_b32 v220, v221
    v_max_f32 v220, v220, v221
    v_mov_b32 v221, v220
    s_nop 1
    v_permlane32_swap_b32 v220, v221
    v_max_f32 v220, v220, v221
    v_sub_f32 v232, 0, v220
    v_sub_f32 v233, 0, v220
    v_sub_f32 v234, 0, v220
    v_sub_f32 v235, 0, v220
    v_max3_f32 v220, v219, v219, v219
    v_mov_b32 v221, v220
    s_nop 1
    v_permlane16_swap_b32 v220, v221
    v_max_f32 v220, v220, v221
    v_mov_b32 v221, v220
    s_nop 1
    v_permlane32_swap_b32 v220, v221
    v_max_f32 v220, v220, v221
    v_sub_f32 v236, 0, v220
    v_sub_f32 v237, 0, v220
    v_sub_f32 v238, 0, v220
    v_sub_f32 v239, 0, v220
    v_mov_b32 v252, 0
    v_mov_b32 v253, 0
    v_mov_b32 v254, 0
    s_mov_b32 s84, 0
    s_mov_b32 s85, 8192
    buffer_load_dwordx4 a[144:147], v216, s[40:43], s84 offen
    buffer_load_dwordx4 a[148:151], v216, s[40:43], s85 offen
    buffer_load_dwordx4 a[152:155], v216, s[40:43], s84 offen offset:64
    buffer_load_dwordx4 a[156:159], v216, s[40:43], s85 offen offset:64
    s_waitcnt vmcnt(3)
    v_mfma_f32_16x16x32_bf16 v[192:195], a[144:147], a[0:3], v[228:231]
    v_mfma_f32_16x16x32_bf16 v[196:199], a[144:147], a[4:7], v[232:235]
    v_mfma_f32_16x16x32_bf16 v[200:203], a[144:147], a[8:11], v[236:239]
    s_waitcnt vmcnt(2)
    v_mfma_f32_16x16x32_bf16 v[204:207], a[148:151], a[0:3], v[228:231]
    v_mfma_f32_16x16x32_bf16 v[208:211], a[148:151], a[4:7], v[232:235]
    v_mfma_f32_16x16x32_bf16 v[212:215], a[148:151], a[8:11], v[236:239]
    s_waitcnt vmcnt(1)
    v_mfma_f32_16x16x32_bf16 v[192:195], a[152:155], a[12:15], v[192:195]
    v_mfma_f32_16x16x32_bf16 v[196:199], a[152:155], a[16:19], v[196:199]
    v_mfma_f32_16x16x32_bf16 v[200:203], a[152:155], a[20:23], v[200:203]
    s_waitcnt vmcnt(0)
    v_mfma_f32_16x16x32_bf16 v[204:207], a[156:159], a[12:15], v[204:207]
    v_mfma_f32_16x16x32_bf16 v[208:211], a[156:159], a[16:19], v[208:211]
    v_mfma_f32_16x16x32_bf16 v[212:215], a[156:159], a[20:23], v[212:215]
    s_nop 7
    buffer_load_dwordx4 a[144:147], v216, s[40:43], s84 offen offset:128
    buffer_load_dwordx4 a[148:151], v216, s[40:43], s85 offen offset:128
    buffer_load_dwordx4 a[152:155], v216, s[40:43], s84 offen offset:192
    buffer_load_dwordx4 a[156:159], v216, s[40:43], s85 offen offset:192
    s_waitcnt vmcnt(3)
    v_mfma_f32_16x16x32_bf16 v[192:195], a[144:147], a[24:27], v[192:195]
    v_mfma_f32_16x16x32_bf16 v[196:199], a[144:147], a[28:31], v[196:199]
    v_mfma_f32_16x16x32_bf16 v[200:203], a[144:147], a[32:35], v[200:203]
    s_waitcnt vmcnt(2)
    v_mfma_f32_16x16x32_bf16 v[204:207], a[148:151], a[24:27], v[204:207]
    v_mfma_f32_16x16x32_bf16 v[208:211], a[148:151], a[28:31], v[208:211]
    v_mfma_f32_16x16x32_bf16 v[212:215], a[148:151], a[32:35], v[212:215]
    s_waitcnt vmcnt(1)
    v_mfma_f32_16x16x32_bf16 v[192:195], a[152:155], a[36:39], v[192:195]
    v_mfma_f32_16x16x32_bf16 v[196:199], a[152:155], a[40:43], v[196:199]
    v_mfma_f32_16x16x32_bf16 v[200:203], a[152:155], a[44:47], v[200:203]
    s_waitcnt vmcnt(0)
    v_mfma_f32_16x16x32_bf16 v[204:207], a[156:159], a[36:39], v[204:207]
    v_mfma_f32_16x16x32_bf16 v[208:211], a[156:159], a[40:43], v[208:211]
    v_mfma_f32_16x16x32_bf16 v[212:215], a[156:159], a[44:47], v[212:215]
    s_nop 7
    buffer_load_dwordx4 a[144:147], v216, s[40:43], s84 offen offset:256
    buffer_load_dwordx4 a[148:151], v216, s[40:43], s85 offen offset:256
    buffer_load_dwordx4 a[152:155], v216, s[40:43], s84 offen offset:320
    buffer_load_dwordx4 a[156:159], v216, s[40:43], s85 offen offset:320
    s_waitcnt vmcnt(3)
    v_mfma_f32_16x16x32_bf16 v[192:195], a[144:147], a[48:51], v[192:195]
    v_mfma_f32_16x16x32_bf16 v[196:199], a[144:147], a[52:55], v[196:199]
    v_mfma_f32_16x16x32_bf16 v[200:203], a[144:147], a[56:59], v[200:203]
    s_waitcnt vmcnt(2)
    v_mfma_f32_16x16x32_bf16 v[204:207], a[148:151], a[48:51], v[204:207]
    v_mfma_f32_16x16x32_bf16 v[208:211], a[148:151], a[52:55], v[208:211]
    v_mfma_f32_16x16x32_bf16 v[212:215], a[148:151], a[56:59], v[212:215]
    s_waitcnt vmcnt(1)
    v_mfma_f32_16x16x32_bf16 v[192:195], a[152:155], a[60:63], v[192:195]
    v_mfma_f32_16x16x32_bf16 v[196:199], a[152:155], a[64:67], v[196:199]
    v_mfma_f32_16x16x32_bf16 v[200:203], a[152:155], a[68:71], v[200:203]
    s_waitcnt vmcnt(0)
    v_mfma_f32_16x16x32_bf16 v[204:207], a[156:159], a[60:63], v[204:207]
    v_mfma_f32_16x16x32_bf16 v[208:211], a[156:159], a[64:67], v[208:211]
    v_mfma_f32_16x16x32_bf16 v[212:215], a[156:159], a[68:71], v[212:215]
    s_nop 7
    buffer_load_dwordx4 a[144:147], v216, s[40:43], s84 offen offset:384
    buffer_load_dwordx4 a[148:151], v216, s[40:43], s85 offen offset:384
    buffer_load_dwordx4 a[152:155], v216, s[40:43], s84 offen offset:448
    buffer_load_dwordx4 a[156:159], v216, s[40:43], s85 offen offset:448
    s_waitcnt vmcnt(3)
    v_mfma_f32_16x16x32_bf16 v[192:195], a[144:147], a[72:75], v[192:195]
    v_mfma_f32_16x16x32_bf16 v[196:199], a[144:147], a[76:79], v[196:199]
    v_mfma_f32_16x16x32_bf16 v[200:203], a[144:147], a[80:83], v[200:203]
    s_waitcnt vmcnt(2)
    v_mfma_f32_16x16x32_bf16 v[204:207], a[148:151], a[72:75], v[204:207]
    v_mfma_f32_16x16x32_bf16 v[208:211], a[148:151], a[76:79], v[208:211]
    v_mfma_f32_16x16x32_bf16 v[212:215], a[148:151], a[80:83], v[212:215]
    s_waitcnt vmcnt(1)
    v_mfma_f32_16x16x32_bf16 v[192:195], a[152:155], a[84:87], v[192:195]
    v_mfma_f32_16x16x32_bf16 v[196:199], a[152:155], a[88:91], v[196:199]
    v_mfma_f32_16x16x32_bf16 v[200:203], a[152:155], a[92:95], v[200:203]
    s_waitcnt vmcnt(0)
    v_mfma_f32_16x16x32_bf16 v[204:207], a[156:159], a[84:87], v[204:207]
    v_mfma_f32_16x16x32_bf16 v[208:211], a[156:159], a[88:91], v[208:211]
    v_mfma_f32_16x16x32_bf16 v[212:215], a[156:159], a[92:95], v[212:215]
    s_nop 7
    v_exp_f32 v192, v192
    v_exp_f32 v193, v193
    v_exp_f32 v194, v194
    v_exp_f32 v195, v195
    v_exp_f32 v204, v204
    v_cvt_pk_bf16_f32 v0, v192, v193
    v_cvt_pk_bf16_f32 v1, v194, v195
    v_exp_f32 v205, v205
    v_add_f32 v252, v252, v192
    v_add_f32 v252, v252, v193
    v_exp_f32 v206, v206
    v_add_f32 v252, v252, v194
    v_add_f32 v252, v252, v195
    v_exp_f32 v207, v207
    v_exp_f32 v196, v196
    v_cvt_pk_bf16_f32 v2, v204, v205
    v_cvt_pk_bf16_f32 v3, v206, v207
    v_exp_f32 v197, v197
    v_add_f32 v252, v252, v204
    v_add_f32 v252, v252, v205
    v_exp_f32 v198, v198
    v_add_f32 v252, v252, v206
    v_add_f32 v252, v252, v207
    v_exp_f32 v199, v199
    v_exp_f32 v208, v208
    v_cvt_pk_bf16_f32 v4, v196, v197
    v_cvt_pk_bf16_f32 v5, v198, v199
    v_exp_f32 v209, v209
    v_add_f32 v253, v253, v196
    v_add_f32 v253, v253, v197
    v_exp_f32 v210, v210
    v_add_f32 v253, v253, v198
    v_add_f32 v253, v253, v199
    v_exp_f32 v211, v211
    v_exp_f32 v200, v200
    v_cvt_pk_bf16_f32 v6, v208, v209
    v_cvt_pk_bf16_f32 v7, v210, v211
    v_exp_f32 v201, v201
    v_add_f32 v253, v253, v208
    v_add_f32 v253, v253, v209
    v_exp_f32 v202, v202
    v_add_f32 v253, v253, v210
    v_add_f32 v253, v253, v211
    v_exp_f32 v203, v203
    v_exp_f32 v212, v212
    v_cvt_pk_bf16_f32 v8, v200, v201
    v_cvt_pk_bf16_f32 v9, v202, v203
    v_exp_f32 v213, v213
    v_add_f32 v254, v254, v200
    v_add_f32 v254, v254, v201
    v_exp_f32 v214, v214
    v_add_f32 v254, v254, v202
    v_add_f32 v254, v254, v203
    v_exp_f32 v215, v215
    v_cvt_pk_bf16_f32 v10, v212, v213
    v_cvt_pk_bf16_f32 v11, v214, v215
    v_add_f32 v254, v254, v212
    v_add_f32 v254, v254, v213
    v_add_f32 v254, v254, v214
    v_add_f32 v254, v254, v215
    s_mov_b32 s84, 16384
    s_mov_b32 s85, 24576
    buffer_load_dwordx4 a[144:147], v216, s[40:43], s84 offen
    buffer_load_dwordx4 a[148:151], v216, s[40:43], s85 offen
    buffer_load_dwordx4 a[152:155], v216, s[40:43], s84 offen offset:64
    buffer_load_dwordx4 a[156:159], v216, s[40:43], s85 offen offset:64
    s_waitcnt vmcnt(3)
    v_mfma_f32_16x16x32_bf16 v[192:195], a[144:147], a[0:3], v[228:231]
    v_mfma_f32_16x16x32_bf16 v[196:199], a[144:147], a[4:7], v[232:235]
    v_mfma_f32_16x16x32_bf16 v[200:203], a[144:147], a[8:11], v[236:239]
    s_waitcnt vmcnt(2)
    v_mfma_f32_16x16x32_bf16 v[204:207], a[148:151], a[0:3], v[228:231]
    v_mfma_f32_16x16x32_bf16 v[208:211], a[148:151], a[4:7], v[232:235]
    v_mfma_f32_16x16x32_bf16 v[212:215], a[148:151], a[8:11], v[236:239]
    s_waitcnt vmcnt(1)
    v_mfma_f32_16x16x32_bf16 v[192:195], a[152:155], a[12:15], v[192:195]
    v_mfma_f32_16x16x32_bf16 v[196:199], a[152:155], a[16:19], v[196:199]
    v_mfma_f32_16x16x32_bf16 v[200:203], a[152:155], a[20:23], v[200:203]
    s_waitcnt vmcnt(0)
    v_mfma_f32_16x16x32_bf16 v[204:207], a[156:159], a[12:15], v[204:207]
    v_mfma_f32_16x16x32_bf16 v[208:211], a[156:159], a[16:19], v[208:211]
    v_mfma_f32_16x16x32_bf16 v[212:215], a[156:159], a[20:23], v[212:215]
    s_nop 7
    buffer_load_dwordx4 a[144:147], v216, s[40:43], s84 offen offset:128
    buffer_load_dwordx4 a[148:151], v216, s[40:43], s85 offen offset:128
    buffer_load_dwordx4 a[152:155], v216, s[40:43], s84 offen offset:192
    buffer_load_dwordx4 a[156:159], v216, s[40:43], s85 offen offset:192
    s_waitcnt vmcnt(3)
    v_mfma_f32_16x16x32_bf16 v[192:195], a[144:147], a[24:27], v[192:195]
    v_mfma_f32_16x16x32_bf16 v[196:199], a[144:147], a[28:31], v[196:199]
    v_mfma_f32_16x16x32_bf16 v[200:203], a[144:147], a[32:35], v[200:203]
    s_waitcnt vmcnt(2)
    v_mfma_f32_16x16x32_bf16 v[204:207], a[148:151], a[24:27], v[204:207]
    v_mfma_f32_16x16x32_bf16 v[208:211], a[148:151], a[28:31], v[208:211]
    v_mfma_f32_16x16x32_bf16 v[212:215], a[148:151], a[32:35], v[212:215]
    s_waitcnt vmcnt(1)
    v_mfma_f32_16x16x32_bf16 v[192:195], a[152:155], a[36:39], v[192:195]
    v_mfma_f32_16x16x32_bf16 v[196:199], a[152:155], a[40:43], v[196:199]
    v_mfma_f32_16x16x32_bf16 v[200:203], a[152:155], a[44:47], v[200:203]
    s_waitcnt vmcnt(0)
    v_mfma_f32_16x16x32_bf16 v[204:207], a[156:159], a[36:39], v[204:207]
    v_mfma_f32_16x16x32_bf16 v[208:211], a[156:159], a[40:43], v[208:211]
    v_mfma_f32_16x16x32_bf16 v[212:215], a[156:159], a[44:47], v[212:215]
    s_nop 7
    buffer_load_dwordx4 a[144:147], v216, s[40:43], s84 offen offset:256
    buffer_load_dwordx4 a[148:151], v216, s[40:43], s85 offen offset:256
    buffer_load_dwordx4 a[152:155], v216, s[40:43], s84 offen offset:320
    buffer_load_dwordx4 a[156:159], v216, s[40:43], s85 offen offset:320
    s_waitcnt vmcnt(3)
    v_mfma_f32_16x16x32_bf16 v[192:195], a[144:147], a[48:51], v[192:195]
    v_mfma_f32_16x16x32_bf16 v[196:199], a[144:147], a[52:55], v[196:199]
    v_mfma_f32_16x16x32_bf16 v[200:203], a[144:147], a[56:59], v[200:203]
    s_waitcnt vmcnt(2)
    v_mfma_f32_16x16x32_bf16 v[204:207], a[148:151], a[48:51], v[204:207]
    v_mfma_f32_16x16x32_bf16 v[208:211], a[148:151], a[52:55], v[208:211]
    v_mfma_f32_16x16x32_bf16 v[212:215], a[148:151], a[56:59], v[212:215]
    s_waitcnt vmcnt(1)
    v_mfma_f32_16x16x32_bf16 v[192:195], a[152:155], a[60:63], v[192:195]
    v_mfma_f32_16x16x32_bf16 v[196:199], a[152:155], a[64:67], v[196:199]
    v_mfma_f32_16x16x32_bf16 v[200:203], a[152:155], a[68:71], v[200:203]
    s_waitcnt vmcnt(0)
    v_mfma_f32_16x16x32_bf16 v[204:207], a[156:159], a[60:63], v[204:207]
    v_mfma_f32_16x16x32_bf16 v[208:211], a[156:159], a[64:67], v[208:211]
    v_mfma_f32_16x16x32_bf16 v[212:215], a[156:159], a[68:71], v[212:215]
    s_nop 7
    buffer_load_dwordx4 a[144:147], v216, s[40:43], s84 offen offset:384
    buffer_load_dwordx4 a[148:151], v216, s[40:43], s85 offen offset:384
    buffer_load_dwordx4 a[152:155], v216, s[40:43], s84 offen offset:448
    buffer_load_dwordx4 a[156:159], v216, s[40:43], s85 offen offset:448
    s_waitcnt vmcnt(3)
    v_mfma_f32_16x16x32_bf16 v[192:195], a[144:147], a[72:75], v[192:195]
    v_mfma_f32_16x16x32_bf16 v[196:199], a[144:147], a[76:79], v[196:199]
    v_mfma_f32_16x16x32_bf16 v[200:203], a[144:147], a[80:83], v[200:203]
    s_waitcnt vmcnt(2)
    v_mfma_f32_16x16x32_bf16 v[204:207], a[148:151], a[72:75], v[204:207]
    v_mfma_f32_16x16x32_bf16 v[208:211], a[148:151], a[76:79], v[208:211]
    v_mfma_f32_16x16x32_bf16 v[212:215], a[148:151], a[80:83], v[212:215]
    s_waitcnt vmcnt(1)
    v_mfma_f32_16x16x32_bf16 v[192:195], a[152:155], a[84:87], v[192:195]
    v_mfma_f32_16x16x32_bf16 v[196:199], a[152:155], a[88:91], v[196:199]
    v_mfma_f32_16x16x32_bf16 v[200:203], a[152:155], a[92:95], v[200:203]
    s_waitcnt vmcnt(0)
    v_mfma_f32_16x16x32_bf16 v[204:207], a[156:159], a[84:87], v[204:207]
    v_mfma_f32_16x16x32_bf16 v[208:211], a[156:159], a[88:91], v[208:211]
    v_mfma_f32_16x16x32_bf16 v[212:215], a[156:159], a[92:95], v[212:215]
    s_nop 7
    v_exp_f32 v192, v192
    v_exp_f32 v193, v193
    v_exp_f32 v194, v194
    v_exp_f32 v195, v195
    v_exp_f32 v204, v204
    v_cvt_pk_bf16_f32 v12, v192, v193
    v_cvt_pk_bf16_f32 v13, v194, v195
    v_exp_f32 v205, v205
    v_add_f32 v252, v252, v192
    v_add_f32 v252, v252, v193
    v_exp_f32 v206, v206
    v_add_f32 v252, v252, v194
    v_add_f32 v252, v252, v195
    v_exp_f32 v207, v207
    v_exp_f32 v196, v196
    v_cvt_pk_bf16_f32 v14, v204, v205
    v_cvt_pk_bf16_f32 v15, v206, v207
    v_exp_f32 v197, v197
    v_add_f32 v252, v252, v204
    v_add_f32 v252, v252, v205
    v_exp_f32 v198, v198
    v_add_f32 v252, v252, v206
    v_add_f32 v252, v252, v207
    v_exp_f32 v199, v199
    v_exp_f32 v208, v208
    v_cvt_pk_bf16_f32 v16, v196, v197
    v_cvt_pk_bf16_f32 v17, v198, v199
    v_exp_f32 v209, v209
    v_add_f32 v253, v253, v196
    v_add_f32 v253, v253, v197
    v_exp_f32 v210, v210
    v_add_f32 v253, v253, v198
    v_add_f32 v253, v253, v199
    v_exp_f32 v211, v211
    v_exp_f32 v200, v200
    v_cvt_pk_bf16_f32 v18, v208, v209
    v_cvt_pk_bf16_f32 v19, v210, v211
    v_exp_f32 v201, v201
    v_add_f32 v253, v253, v208
    v_add_f32 v253, v253, v209
    v_exp_f32 v202, v202
    v_add_f32 v253, v253, v210
    v_add_f32 v253, v253, v211
    v_exp_f32 v203, v203
    v_exp_f32 v212, v212
    v_cvt_pk_bf16_f32 v20, v200, v201
    v_cvt_pk_bf16_f32 v21, v202, v203
    v_exp_f32 v213, v213
    v_add_f32 v254, v254, v200
    v_add_f32 v254, v254, v201
    v_exp_f32 v214, v214
    v_add_f32 v254, v254, v202
    v_add_f32 v254, v254, v203
    v_exp_f32 v215, v215
    v_cvt_pk_bf16_f32 v22, v212, v213
    v_cvt_pk_bf16_f32 v23, v214, v215
    v_add_f32 v254, v254, v212
    v_add_f32 v254, v254, v213
    v_add_f32 v254, v254, v214
    v_add_f32 v254, v254, v215
    s_mov_b32 s84, 32768
    s_mov_b32 s85, 40960
    buffer_load_dwordx4 a[144:147], v216, s[40:43], s84 offen
    buffer_load_dwordx4 a[148:151], v216, s[40:43], s85 offen
    buffer_load_dwordx4 a[152:155], v216, s[40:43], s84 offen offset:64
    buffer_load_dwordx4 a[156:159], v216, s[40:43], s85 offen offset:64
    s_waitcnt vmcnt(3)
    v_mfma_f32_16x16x32_bf16 v[192:195], a[144:147], a[0:3], v[228:231]
    v_mfma_f32_16x16x32_bf16 v[196:199], a[144:147], a[4:7], v[232:235]
    v_mfma_f32_16x16x32_bf16 v[200:203], a[144:147], a[8:11], v[236:239]
    s_waitcnt vmcnt(2)
    v_mfma_f32_16x16x32_bf16 v[204:207], a[148:151], a[0:3], v[228:231]
    v_mfma_f32_16x16x32_bf16 v[208:211], a[148:151], a[4:7], v[232:235]
    v_mfma_f32_16x16x32_bf16 v[212:215], a[148:151], a[8:11], v[236:239]
    s_waitcnt vmcnt(1)
    v_mfma_f32_16x16x32_bf16 v[192:195], a[152:155], a[12:15], v[192:195]
    v_mfma_f32_16x16x32_bf16 v[196:199], a[152:155], a[16:19], v[196:199]
    v_mfma_f32_16x16x32_bf16 v[200:203], a[152:155], a[20:23], v[200:203]
    s_waitcnt vmcnt(0)
    v_mfma_f32_16x16x32_bf16 v[204:207], a[156:159], a[12:15], v[204:207]
    v_mfma_f32_16x16x32_bf16 v[208:211], a[156:159], a[16:19], v[208:211]
    v_mfma_f32_16x16x32_bf16 v[212:215], a[156:159], a[20:23], v[212:215]
    s_nop 7
    buffer_load_dwordx4 a[144:147], v216, s[40:43], s84 offen offset:128
    buffer_load_dwordx4 a[148:151], v216, s[40:43], s85 offen offset:128
    buffer_load_dwordx4 a[152:155], v216, s[40:43], s84 offen offset:192
    buffer_load_dwordx4 a[156:159], v216, s[40:43], s85 offen offset:192
    s_waitcnt vmcnt(3)
    v_mfma_f32_16x16x32_bf16 v[192:195], a[144:147], a[24:27], v[192:195]
    v_mfma_f32_16x16x32_bf16 v[196:199], a[144:147], a[28:31], v[196:199]
    v_mfma_f32_16x16x32_bf16 v[200:203], a[144:147], a[32:35], v[200:203]
    s_waitcnt vmcnt(2)
    v_mfma_f32_16x16x32_bf16 v[204:207], a[148:151], a[24:27], v[204:207]
    v_mfma_f32_16x16x32_bf16 v[208:211], a[148:151], a[28:31], v[208:211]
    v_mfma_f32_16x16x32_bf16 v[212:215], a[148:151], a[32:35], v[212:215]
    s_waitcnt vmcnt(1)
    v_mfma_f32_16x16x32_bf16 v[192:195], a[152:155], a[36:39], v[192:195]
    v_mfma_f32_16x16x32_bf16 v[196:199], a[152:155], a[40:43], v[196:199]
    v_mfma_f32_16x16x32_bf16 v[200:203], a[152:155], a[44:47], v[200:203]
    s_waitcnt vmcnt(0)
    v_mfma_f32_16x16x32_bf16 v[204:207], a[156:159], a[36:39], v[204:207]
    v_mfma_f32_16x16x32_bf16 v[208:211], a[156:159], a[40:43], v[208:211]
    v_mfma_f32_16x16x32_bf16 v[212:215], a[156:159], a[44:47], v[212:215]
    s_nop 7
    buffer_load_dwordx4 a[144:147], v216, s[40:43], s84 offen offset:256
    buffer_load_dwordx4 a[148:151], v216, s[40:43], s85 offen offset:256
    buffer_load_dwordx4 a[152:155], v216, s[40:43], s84 offen offset:320
    buffer_load_dwordx4 a[156:159], v216, s[40:43], s85 offen offset:320
    s_waitcnt vmcnt(3)
    v_mfma_f32_16x16x32_bf16 v[192:195], a[144:147], a[48:51], v[192:195]
    v_mfma_f32_16x16x32_bf16 v[196:199], a[144:147], a[52:55], v[196:199]
    v_mfma_f32_16x16x32_bf16 v[200:203], a[144:147], a[56:59], v[200:203]
    s_waitcnt vmcnt(2)
    v_mfma_f32_16x16x32_bf16 v[204:207], a[148:151], a[48:51], v[204:207]
    v_mfma_f32_16x16x32_bf16 v[208:211], a[148:151], a[52:55], v[208:211]
    v_mfma_f32_16x16x32_bf16 v[212:215], a[148:151], a[56:59], v[212:215]
    s_waitcnt vmcnt(1)
    v_mfma_f32_16x16x32_bf16 v[192:195], a[152:155], a[60:63], v[192:195]
    v_mfma_f32_16x16x32_bf16 v[196:199], a[152:155], a[64:67], v[196:199]
    v_mfma_f32_16x16x32_bf16 v[200:203], a[152:155], a[68:71], v[200:203]
    s_waitcnt vmcnt(0)
    v_mfma_f32_16x16x32_bf16 v[204:207], a[156:159], a[60:63], v[204:207]
    v_mfma_f32_16x16x32_bf16 v[208:211], a[156:159], a[64:67], v[208:211]
    v_mfma_f32_16x16x32_bf16 v[212:215], a[156:159], a[68:71], v[212:215]
    s_nop 7
    buffer_load_dwordx4 a[144:147], v216, s[40:43], s84 offen offset:384
    buffer_load_dwordx4 a[148:151], v216, s[40:43], s85 offen offset:384
    buffer_load_dwordx4 a[152:155], v216, s[40:43], s84 offen offset:448
    buffer_load_dwordx4 a[156:159], v216, s[40:43], s85 offen offset:448
    s_waitcnt vmcnt(3)
    v_mfma_f32_16x16x32_bf16 v[192:195], a[144:147], a[72:75], v[192:195]
    v_mfma_f32_16x16x32_bf16 v[196:199], a[144:147], a[76:79], v[196:199]
    v_mfma_f32_16x16x32_bf16 v[200:203], a[144:147], a[80:83], v[200:203]
    s_waitcnt vmcnt(2)
    v_mfma_f32_16x16x32_bf16 v[204:207], a[148:151], a[72:75], v[204:207]
    v_mfma_f32_16x16x32_bf16 v[208:211], a[148:151], a[76:79], v[208:211]
    v_mfma_f32_16x16x32_bf16 v[212:215], a[148:151], a[80:83], v[212:215]
    s_waitcnt vmcnt(1)
    v_mfma_f32_16x16x32_bf16 v[192:195], a[152:155], a[84:87], v[192:195]
    v_mfma_f32_16x16x32_bf16 v[196:199], a[152:155], a[88:91], v[196:199]
    v_mfma_f32_16x16x32_bf16 v[200:203], a[152:155], a[92:95], v[200:203]
    s_waitcnt vmcnt(0)
    v_mfma_f32_16x16x32_bf16 v[204:207], a[156:159], a[84:87], v[204:207]
    v_mfma_f32_16x16x32_bf16 v[208:211], a[156:159], a[88:91], v[208:211]
    v_mfma_f32_16x16x32_bf16 v[212:215], a[156:159], a[92:95], v[212:215]
    s_nop 7
    v_exp_f32 v192, v192
    v_exp_f32 v193, v193
    v_exp_f32 v194, v194
    v_exp_f32 v195, v195
    v_exp_f32 v204, v204
    v_cvt_pk_bf16_f32 v24, v192, v193
    v_cvt_pk_bf16_f32 v25, v194, v195
    v_exp_f32 v205, v205
    v_add_f32 v252, v252, v192
    v_add_f32 v252, v252, v193
    v_exp_f32 v206, v206
    v_add_f32 v252, v252, v194
    v_add_f32 v252, v252, v195
    v_exp_f32 v207, v207
    v_exp_f32 v196, v196
    v_cvt_pk_bf16_f32 v26, v204, v205
    v_cvt_pk_bf16_f32 v27, v206, v207
    v_exp_f32 v197, v197
    v_add_f32 v252, v252, v204
    v_add_f32 v252, v252, v205
    v_exp_f32 v198, v198
    v_add_f32 v252, v252, v206
    v_add_f32 v252, v252, v207
    v_exp_f32 v199, v199
    v_exp_f32 v208, v208
    v_cvt_pk_bf16_f32 v28, v196, v197
    v_cvt_pk_bf16_f32 v29, v198, v199
    v_exp_f32 v209, v209
    v_add_f32 v253, v253, v196
    v_add_f32 v253, v253, v197
    v_exp_f32 v210, v210
    v_add_f32 v253, v253, v198
    v_add_f32 v253, v253, v199
    v_exp_f32 v211, v211
    v_exp_f32 v200, v200
    v_cvt_pk_bf16_f32 v30, v208, v209
    v_cvt_pk_bf16_f32 v31, v210, v211
    v_exp_f32 v201, v201
    v_add_f32 v253, v253, v208
    v_add_f32 v253, v253, v209
    v_exp_f32 v202, v202
    v_add_f32 v253, v253, v210
    v_add_f32 v253, v253, v211
    v_exp_f32 v203, v203
    v_exp_f32 v212, v212
    v_cvt_pk_bf16_f32 v32, v200, v201
    v_cvt_pk_bf16_f32 v33, v202, v203
    v_exp_f32 v213, v213
    v_add_f32 v254, v254, v200
    v_add_f32 v254, v254, v201
    v_exp_f32 v214, v214
    v_add_f32 v254, v254, v202
    v_add_f32 v254, v254, v203
    v_exp_f32 v215, v215
    v_cvt_pk_bf16_f32 v34, v212, v213
    v_cvt_pk_bf16_f32 v35, v214, v215
    v_add_f32 v254, v254, v212
    v_add_f32 v254, v254, v213
    v_add_f32 v254, v254, v214
    v_add_f32 v254, v254, v215
    s_mov_b32 s84, 49152
    s_mov_b32 s85, 57344
    buffer_load_dwordx4 a[144:147], v216, s[40:43], s84 offen
    buffer_load_dwordx4 a[148:151], v216, s[40:43], s85 offen
    buffer_load_dwordx4 a[152:155], v216, s[40:43], s84 offen offset:64
    buffer_load_dwordx4 a[156:159], v216, s[40:43], s85 offen offset:64
    s_waitcnt vmcnt(3)
    v_mfma_f32_16x16x32_bf16 v[192:195], a[144:147], a[0:3], v[228:231]
    v_mfma_f32_16x16x32_bf16 v[196:199], a[144:147], a[4:7], v[232:235]
    v_mfma_f32_16x16x32_bf16 v[200:203], a[144:147], a[8:11], v[236:239]
    s_waitcnt vmcnt(2)
    v_mfma_f32_16x16x32_bf16 v[204:207], a[148:151], a[0:3], v[228:231]
    v_mfma_f32_16x16x32_bf16 v[208:211], a[148:151], a[4:7], v[232:235]
    v_mfma_f32_16x16x32_bf16 v[212:215], a[148:151], a[8:11], v[236:239]
    s_waitcnt vmcnt(1)
    v_mfma_f32_16x16x32_bf16 v[192:195], a[152:155], a[12:15], v[192:195]
    v_mfma_f32_16x16x32_bf16 v[196:199], a[152:155], a[16:19], v[196:199]
    v_mfma_f32_16x16x32_bf16 v[200:203], a[152:155], a[20:23], v[200:203]
    s_waitcnt vmcnt(0)
    v_mfma_f32_16x16x32_bf16 v[204:207], a[156:159], a[12:15], v[204:207]
    v_mfma_f32_16x16x32_bf16 v[208:211], a[156:159], a[16:19], v[208:211]
    v_mfma_f32_16x16x32_bf16 v[212:215], a[156:159], a[20:23], v[212:215]
    s_nop 7
    buffer_load_dwordx4 a[144:147], v216, s[40:43], s84 offen offset:128
    buffer_load_dwordx4 a[148:151], v216, s[40:43], s85 offen offset:128
    buffer_load_dwordx4 a[152:155], v216, s[40:43], s84 offen offset:192
    buffer_load_dwordx4 a[156:159], v216, s[40:43], s85 offen offset:192
    s_waitcnt vmcnt(3)
    v_mfma_f32_16x16x32_bf16 v[192:195], a[144:147], a[24:27], v[192:195]
    v_mfma_f32_16x16x32_bf16 v[196:199], a[144:147], a[28:31], v[196:199]
    v_mfma_f32_16x16x32_bf16 v[200:203], a[144:147], a[32:35], v[200:203]
    s_waitcnt vmcnt(2)
    v_mfma_f32_16x16x32_bf16 v[204:207], a[148:151], a[24:27], v[204:207]
    v_mfma_f32_16x16x32_bf16 v[208:211], a[148:151], a[28:31], v[208:211]
    v_mfma_f32_16x16x32_bf16 v[212:215], a[148:151], a[32:35], v[212:215]
    s_waitcnt vmcnt(1)
    v_mfma_f32_16x16x32_bf16 v[192:195], a[152:155], a[36:39], v[192:195]
    v_mfma_f32_16x16x32_bf16 v[196:199], a[152:155], a[40:43], v[196:199]
    v_mfma_f32_16x16x32_bf16 v[200:203], a[152:155], a[44:47], v[200:203]
    s_waitcnt vmcnt(0)
    v_mfma_f32_16x16x32_bf16 v[204:207], a[156:159], a[36:39], v[204:207]
    v_mfma_f32_16x16x32_bf16 v[208:211], a[156:159], a[40:43], v[208:211]
    v_mfma_f32_16x16x32_bf16 v[212:215], a[156:159], a[44:47], v[212:215]
    s_nop 7
    buffer_load_dwordx4 a[144:147], v216, s[40:43], s84 offen offset:256
    buffer_load_dwordx4 a[148:151], v216, s[40:43], s85 offen offset:256
    buffer_load_dwordx4 a[152:155], v216, s[40:43], s84 offen offset:320
    buffer_load_dwordx4 a[156:159], v216, s[40:43], s85 offen offset:320
    s_waitcnt vmcnt(3)
    v_mfma_f32_16x16x32_bf16 v[192:195], a[144:147], a[48:51], v[192:195]
    v_mfma_f32_16x16x32_bf16 v[196:199], a[144:147], a[52:55], v[196:199]
    v_mfma_f32_16x16x32_bf16 v[200:203], a[144:147], a[56:59], v[200:203]
    s_waitcnt vmcnt(2)
    v_mfma_f32_16x16x32_bf16 v[204:207], a[148:151], a[48:51], v[204:207]
    v_mfma_f32_16x16x32_bf16 v[208:211], a[148:151], a[52:55], v[208:211]
    v_mfma_f32_16x16x32_bf16 v[212:215], a[148:151], a[56:59], v[212:215]
    s_waitcnt vmcnt(1)
    v_mfma_f32_16x16x32_bf16 v[192:195], a[152:155], a[60:63], v[192:195]
    v_mfma_f32_16x16x32_bf16 v[196:199], a[152:155], a[64:67], v[196:199]
    v_mfma_f32_16x16x32_bf16 v[200:203], a[152:155], a[68:71], v[200:203]
    s_waitcnt vmcnt(0)
    v_mfma_f32_16x16x32_bf16 v[204:207], a[156:159], a[60:63], v[204:207]
    v_mfma_f32_16x16x32_bf16 v[208:211], a[156:159], a[64:67], v[208:211]
    v_mfma_f32_16x16x32_bf16 v[212:215], a[156:159], a[68:71], v[212:215]
    s_nop 7
    buffer_load_dwordx4 a[144:147], v216, s[40:43], s84 offen offset:384
    buffer_load_dwordx4 a[148:151], v216, s[40:43], s85 offen offset:384
    buffer_load_dwordx4 a[152:155], v216, s[40:43], s84 offen offset:448
    buffer_load_dwordx4 a[156:159], v216, s[40:43], s85 offen offset:448
    s_waitcnt vmcnt(3)
    v_mfma_f32_16x16x32_bf16 v[192:195], a[144:147], a[72:75], v[192:195]
    v_mfma_f32_16x16x32_bf16 v[196:199], a[144:147], a[76:79], v[196:199]
    v_mfma_f32_16x16x32_bf16 v[200:203], a[144:147], a[80:83], v[200:203]
    s_waitcnt vmcnt(2)
    v_mfma_f32_16x16x32_bf16 v[204:207], a[148:151], a[72:75], v[204:207]
    v_mfma_f32_16x16x32_bf16 v[208:211], a[148:151], a[76:79], v[208:211]
    v_mfma_f32_16x16x32_bf16 v[212:215], a[148:151], a[80:83], v[212:215]
    s_waitcnt vmcnt(1)
    v_mfma_f32_16x16x32_bf16 v[192:195], a[152:155], a[84:87], v[192:195]
    v_mfma_f32_16x16x32_bf16 v[196:199], a[152:155], a[88:91], v[196:199]
    v_mfma_f32_16x16x32_bf16 v[200:203], a[152:155], a[92:95], v[200:203]
    s_waitcnt vmcnt(0)
    v_mfma_f32_16x16x32_bf16 v[204:207], a[156:159], a[84:87], v[204:207]
    v_mfma_f32_16x16x32_bf16 v[208:211], a[156:159], a[88:91], v[208:211]
    v_mfma_f32_16x16x32_bf16 v[212:215], a[156:159], a[92:95], v[212:215]
    s_nop 7
    v_exp_f32 v192, v192
    v_exp_f32 v193, v193
    v_exp_f32 v194, v194
    v_exp_f32 v195, v195
    v_exp_f32 v204, v204
    v_cvt_pk_bf16_f32 v36, v192, v193
    v_cvt_pk_bf16_f32 v37, v194, v195
    v_exp_f32 v205, v205
    v_add_f32 v252, v252, v192
    v_add_f32 v252, v252, v193
    v_exp_f32 v206, v206
    v_add_f32 v252, v252, v194
    v_add_f32 v252, v252, v195
    v_exp_f32 v207, v207
    v_exp_f32 v196, v196
    v_cvt_pk_bf16_f32 v38, v204, v205
    v_cvt_pk_bf16_f32 v39, v206, v207
    v_exp_f32 v197, v197
    v_add_f32 v252, v252, v204
    v_add_f32 v252, v252, v205
    v_exp_f32 v198, v198
    v_add_f32 v252, v252, v206
    v_add_f32 v252, v252, v207
    v_exp_f32 v199, v199
    v_exp_f32 v208, v208
    v_cvt_pk_bf16_f32 v40, v196, v197
    v_cvt_pk_bf16_f32 v41, v198, v199
    v_exp_f32 v209, v209
    v_add_f32 v253, v253, v196
    v_add_f32 v253, v253, v197
    v_exp_f32 v210, v210
    v_add_f32 v253, v253, v198
    v_add_f32 v253, v253, v199
    v_exp_f32 v211, v211
    v_exp_f32 v200, v200
    v_cvt_pk_bf16_f32 v42, v208, v209
    v_cvt_pk_bf16_f32 v43, v210, v211
    v_exp_f32 v201, v201
    v_add_f32 v253, v253, v208
    v_add_f32 v253, v253, v209
    v_exp_f32 v202, v202
    v_add_f32 v253, v253, v210
    v_add_f32 v253, v253, v211
    v_exp_f32 v203, v203
    v_exp_f32 v212, v212
    v_cvt_pk_bf16_f32 v44, v200, v201
    v_cvt_pk_bf16_f32 v45, v202, v203
    v_exp_f32 v213, v213
    v_add_f32 v254, v254, v200
    v_add_f32 v254, v254, v201
    v_exp_f32 v214, v214
    v_add_f32 v254, v254, v202
    v_add_f32 v254, v254, v203
    v_exp_f32 v215, v215
    v_cvt_pk_bf16_f32 v46, v212, v213
    v_cvt_pk_bf16_f32 v47, v214, v215
    v_add_f32 v254, v254, v212
    v_add_f32 v254, v254, v213
    v_add_f32 v254, v254, v214
    v_add_f32 v254, v254, v215
    s_mov_b32 s84, 65536
    s_mov_b32 s85, 73728
    buffer_load_dwordx4 a[144:147], v216, s[40:43], s84 offen
    buffer_load_dwordx4 a[148:151], v216, s[40:43], s85 offen
    buffer_load_dwordx4 a[152:155], v216, s[40:43], s84 offen offset:64
    buffer_load_dwordx4 a[156:159], v216, s[40:43], s85 offen offset:64
    s_waitcnt vmcnt(3)
    v_mfma_f32_16x16x32_bf16 v[192:195], a[144:147], a[0:3], v[228:231]
    v_mfma_f32_16x16x32_bf16 v[196:199], a[144:147], a[4:7], v[232:235]
    v_mfma_f32_16x16x32_bf16 v[200:203], a[144:147], a[8:11], v[236:239]
    s_waitcnt vmcnt(2)
    v_mfma_f32_16x16x32_bf16 v[204:207], a[148:151], a[0:3], v[228:231]
    v_mfma_f32_16x16x32_bf16 v[208:211], a[148:151], a[4:7], v[232:235]
    v_mfma_f32_16x16x32_bf16 v[212:215], a[148:151], a[8:11], v[236:239]
    s_waitcnt vmcnt(1)
    v_mfma_f32_16x16x32_bf16 v[192:195], a[152:155], a[12:15], v[192:195]
    v_mfma_f32_16x16x32_bf16 v[196:199], a[152:155], a[16:19], v[196:199]
    v_mfma_f32_16x16x32_bf16 v[200:203], a[152:155], a[20:23], v[200:203]
    s_waitcnt vmcnt(0)
    v_mfma_f32_16x16x32_bf16 v[204:207], a[156:159], a[12:15], v[204:207]
    v_mfma_f32_16x16x32_bf16 v[208:211], a[156:159], a[16:19], v[208:211]
    v_mfma_f32_16x16x32_bf16 v[212:215], a[156:159], a[20:23], v[212:215]
    s_nop 7
    buffer_load_dwordx4 a[144:147], v216, s[40:43], s84 offen offset:128
    buffer_load_dwordx4 a[148:151], v216, s[40:43], s85 offen offset:128
    buffer_load_dwordx4 a[152:155], v216, s[40:43], s84 offen offset:192
    buffer_load_dwordx4 a[156:159], v216, s[40:43], s85 offen offset:192
    s_waitcnt vmcnt(3)
    v_mfma_f32_16x16x32_bf16 v[192:195], a[144:147], a[24:27], v[192:195]
    v_mfma_f32_16x16x32_bf16 v[196:199], a[144:147], a[28:31], v[196:199]
    v_mfma_f32_16x16x32_bf16 v[200:203], a[144:147], a[32:35], v[200:203]
    s_waitcnt vmcnt(2)
    v_mfma_f32_16x16x32_bf16 v[204:207], a[148:151], a[24:27], v[204:207]
    v_mfma_f32_16x16x32_bf16 v[208:211], a[148:151], a[28:31], v[208:211]
    v_mfma_f32_16x16x32_bf16 v[212:215], a[148:151], a[32:35], v[212:215]
    s_waitcnt vmcnt(1)
    v_mfma_f32_16x16x32_bf16 v[192:195], a[152:155], a[36:39], v[192:195]
    v_mfma_f32_16x16x32_bf16 v[196:199], a[152:155], a[40:43], v[196:199]
    v_mfma_f32_16x16x32_bf16 v[200:203], a[152:155], a[44:47], v[200:203]
    s_waitcnt vmcnt(0)
    v_mfma_f32_16x16x32_bf16 v[204:207], a[156:159], a[36:39], v[204:207]
    v_mfma_f32_16x16x32_bf16 v[208:211], a[156:159], a[40:43], v[208:211]
    v_mfma_f32_16x16x32_bf16 v[212:215], a[156:159], a[44:47], v[212:215]
    s_nop 7
    buffer_load_dwordx4 a[144:147], v216, s[40:43], s84 offen offset:256
    buffer_load_dwordx4 a[148:151], v216, s[40:43], s85 offen offset:256
    buffer_load_dwordx4 a[152:155], v216, s[40:43], s84 offen offset:320
    buffer_load_dwordx4 a[156:159], v216, s[40:43], s85 offen offset:320
    s_waitcnt vmcnt(3)
    v_mfma_f32_16x16x32_bf16 v[192:195], a[144:147], a[48:51], v[192:195]
    v_mfma_f32_16x16x32_bf16 v[196:199], a[144:147], a[52:55], v[196:199]
    v_mfma_f32_16x16x32_bf16 v[200:203], a[144:147], a[56:59], v[200:203]
    s_waitcnt vmcnt(2)
    v_mfma_f32_16x16x32_bf16 v[204:207], a[148:151], a[48:51], v[204:207]
    v_mfma_f32_16x16x32_bf16 v[208:211], a[148:151], a[52:55], v[208:211]
    v_mfma_f32_16x16x32_bf16 v[212:215], a[148:151], a[56:59], v[212:215]
    s_waitcnt vmcnt(1)
    v_mfma_f32_16x16x32_bf16 v[192:195], a[152:155], a[60:63], v[192:195]
    v_mfma_f32_16x16x32_bf16 v[196:199], a[152:155], a[64:67], v[196:199]
    v_mfma_f32_16x16x32_bf16 v[200:203], a[152:155], a[68:71], v[200:203]
    s_waitcnt vmcnt(0)
    v_mfma_f32_16x16x32_bf16 v[204:207], a[156:159], a[60:63], v[204:207]
    v_mfma_f32_16x16x32_bf16 v[208:211], a[156:159], a[64:67], v[208:211]
    v_mfma_f32_16x16x32_bf16 v[212:215], a[156:159], a[68:71], v[212:215]
    s_nop 7
    buffer_load_dwordx4 a[144:147], v216, s[40:43], s84 offen offset:384
    buffer_load_dwordx4 a[148:151], v216, s[40:43], s85 offen offset:384
    buffer_load_dwordx4 a[152:155], v216, s[40:43], s84 offen offset:448
    buffer_load_dwordx4 a[156:159], v216, s[40:43], s85 offen offset:448
    s_waitcnt vmcnt(3)
    v_mfma_f32_16x16x32_bf16 v[192:195], a[144:147], a[72:75], v[192:195]
    v_mfma_f32_16x16x32_bf16 v[196:199], a[144:147], a[76:79], v[196:199]
    v_mfma_f32_16x16x32_bf16 v[200:203], a[144:147], a[80:83], v[200:203]
    s_waitcnt vmcnt(2)
    v_mfma_f32_16x16x32_bf16 v[204:207], a[148:151], a[72:75], v[204:207]
    v_mfma_f32_16x16x32_bf16 v[208:211], a[148:151], a[76:79], v[208:211]
    v_mfma_f32_16x16x32_bf16 v[212:215], a[148:151], a[80:83], v[212:215]
    s_waitcnt vmcnt(1)
    v_mfma_f32_16x16x32_bf16 v[192:195], a[152:155], a[84:87], v[192:195]
    v_mfma_f32_16x16x32_bf16 v[196:199], a[152:155], a[88:91], v[196:199]
    v_mfma_f32_16x16x32_bf16 v[200:203], a[152:155], a[92:95], v[200:203]
    s_waitcnt vmcnt(0)
    v_mfma_f32_16x16x32_bf16 v[204:207], a[156:159], a[84:87], v[204:207]
    v_mfma_f32_16x16x32_bf16 v[208:211], a[156:159], a[88:91], v[208:211]
    v_mfma_f32_16x16x32_bf16 v[212:215], a[156:159], a[92:95], v[212:215]
    s_nop 7
    v_exp_f32 v192, v192
    v_exp_f32 v193, v193
    v_exp_f32 v194, v194
    v_exp_f32 v195, v195
    v_exp_f32 v204, v204
    v_cvt_pk_bf16_f32 v48, v192, v193
    v_cvt_pk_bf16_f32 v49, v194, v195
    v_exp_f32 v205, v205
    v_add_f32 v252, v252, v192
    v_add_f32 v252, v252, v193
    v_exp_f32 v206, v206
    v_add_f32 v252, v252, v194
    v_add_f32 v252, v252, v195
    v_exp_f32 v207, v207
    v_exp_f32 v196, v196
    v_cvt_pk_bf16_f32 v50, v204, v205
    v_cvt_pk_bf16_f32 v51, v206, v207
    v_exp_f32 v197, v197
    v_add_f32 v252, v252, v204
    v_add_f32 v252, v252, v205
    v_exp_f32 v198, v198
    v_add_f32 v252, v252, v206
    v_add_f32 v252, v252, v207
    v_exp_f32 v199, v199
    v_exp_f32 v208, v208
    v_cvt_pk_bf16_f32 v52, v196, v197
    v_cvt_pk_bf16_f32 v53, v198, v199
    v_exp_f32 v209, v209
    v_add_f32 v253, v253, v196
    v_add_f32 v253, v253, v197
    v_exp_f32 v210, v210
    v_add_f32 v253, v253, v198
    v_add_f32 v253, v253, v199
    v_exp_f32 v211, v211
    v_exp_f32 v200, v200
    v_cvt_pk_bf16_f32 v54, v208, v209
    v_cvt_pk_bf16_f32 v55, v210, v211
    v_exp_f32 v201, v201
    v_add_f32 v253, v253, v208
    v_add_f32 v253, v253, v209
    v_exp_f32 v202, v202
    v_add_f32 v253, v253, v210
    v_add_f32 v253, v253, v211
    v_exp_f32 v203, v203
    v_exp_f32 v212, v212
    v_cvt_pk_bf16_f32 v56, v200, v201
    v_cvt_pk_bf16_f32 v57, v202, v203
    v_exp_f32 v213, v213
    v_add_f32 v254, v254, v200
    v_add_f32 v254, v254, v201
    v_exp_f32 v214, v214
    v_add_f32 v254, v254, v202
    v_add_f32 v254, v254, v203
    v_exp_f32 v215, v215
    v_cvt_pk_bf16_f32 v58, v212, v213
    v_cvt_pk_bf16_f32 v59, v214, v215
    v_add_f32 v254, v254, v212
    v_add_f32 v254, v254, v213
    v_add_f32 v254, v254, v214
    v_add_f32 v254, v254, v215
    s_mov_b32 s84, 81920
    s_mov_b32 s85, 90112
    buffer_load_dwordx4 a[144:147], v216, s[40:43], s84 offen
    buffer_load_dwordx4 a[148:151], v216, s[40:43], s85 offen
    buffer_load_dwordx4 a[152:155], v216, s[40:43], s84 offen offset:64
    buffer_load_dwordx4 a[156:159], v216, s[40:43], s85 offen offset:64
    s_waitcnt vmcnt(3)
    v_mfma_f32_16x16x32_bf16 v[192:195], a[144:147], a[0:3], v[228:231]
    v_mfma_f32_16x16x32_bf16 v[196:199], a[144:147], a[4:7], v[232:235]
    v_mfma_f32_16x16x32_bf16 v[200:203], a[144:147], a[8:11], v[236:239]
    s_waitcnt vmcnt(2)
    v_mfma_f32_16x16x32_bf16 v[204:207], a[148:151], a[0:3], v[228:231]
    v_mfma_f32_16x16x32_bf16 v[208:211], a[148:151], a[4:7], v[232:235]
    v_mfma_f32_16x16x32_bf16 v[212:215], a[148:151], a[8:11], v[236:239]
    s_waitcnt vmcnt(1)
    v_mfma_f32_16x16x32_bf16 v[192:195], a[152:155], a[12:15], v[192:195]
    v_mfma_f32_16x16x32_bf16 v[196:199], a[152:155], a[16:19], v[196:199]
    v_mfma_f32_16x16x32_bf16 v[200:203], a[152:155], a[20:23], v[200:203]
    s_waitcnt vmcnt(0)
    v_mfma_f32_16x16x32_bf16 v[204:207], a[156:159], a[12:15], v[204:207]
    v_mfma_f32_16x16x32_bf16 v[208:211], a[156:159], a[16:19], v[208:211]
    v_mfma_f32_16x16x32_bf16 v[212:215], a[156:159], a[20:23], v[212:215]
    s_nop 7
    buffer_load_dwordx4 a[144:147], v216, s[40:43], s84 offen offset:128
    buffer_load_dwordx4 a[148:151], v216, s[40:43], s85 offen offset:128
    buffer_load_dwordx4 a[152:155], v216, s[40:43], s84 offen offset:192
    buffer_load_dwordx4 a[156:159], v216, s[40:43], s85 offen offset:192
    s_waitcnt vmcnt(3)
    v_mfma_f32_16x16x32_bf16 v[192:195], a[144:147], a[24:27], v[192:195]
    v_mfma_f32_16x16x32_bf16 v[196:199], a[144:147], a[28:31], v[196:199]
    v_mfma_f32_16x16x32_bf16 v[200:203], a[144:147], a[32:35], v[200:203]
    s_waitcnt vmcnt(2)
    v_mfma_f32_16x16x32_bf16 v[204:207], a[148:151], a[24:27], v[204:207]
    v_mfma_f32_16x16x32_bf16 v[208:211], a[148:151], a[28:31], v[208:211]
    v_mfma_f32_16x16x32_bf16 v[212:215], a[148:151], a[32:35], v[212:215]
    s_waitcnt vmcnt(1)
    v_mfma_f32_16x16x32_bf16 v[192:195], a[152:155], a[36:39], v[192:195]
    v_mfma_f32_16x16x32_bf16 v[196:199], a[152:155], a[40:43], v[196:199]
    v_mfma_f32_16x16x32_bf16 v[200:203], a[152:155], a[44:47], v[200:203]
    s_waitcnt vmcnt(0)
    v_mfma_f32_16x16x32_bf16 v[204:207], a[156:159], a[36:39], v[204:207]
    v_mfma_f32_16x16x32_bf16 v[208:211], a[156:159], a[40:43], v[208:211]
    v_mfma_f32_16x16x32_bf16 v[212:215], a[156:159], a[44:47], v[212:215]
    s_nop 7
    buffer_load_dwordx4 a[144:147], v216, s[40:43], s84 offen offset:256
    buffer_load_dwordx4 a[148:151], v216, s[40:43], s85 offen offset:256
    buffer_load_dwordx4 a[152:155], v216, s[40:43], s84 offen offset:320
    buffer_load_dwordx4 a[156:159], v216, s[40:43], s85 offen offset:320
    s_waitcnt vmcnt(3)
    v_mfma_f32_16x16x32_bf16 v[192:195], a[144:147], a[48:51], v[192:195]
    v_mfma_f32_16x16x32_bf16 v[196:199], a[144:147], a[52:55], v[196:199]
    v_mfma_f32_16x16x32_bf16 v[200:203], a[144:147], a[56:59], v[200:203]
    s_waitcnt vmcnt(2)
    v_mfma_f32_16x16x32_bf16 v[204:207], a[148:151], a[48:51], v[204:207]
    v_mfma_f32_16x16x32_bf16 v[208:211], a[148:151], a[52:55], v[208:211]
    v_mfma_f32_16x16x32_bf16 v[212:215], a[148:151], a[56:59], v[212:215]
    s_waitcnt vmcnt(1)
    v_mfma_f32_16x16x32_bf16 v[192:195], a[152:155], a[60:63], v[192:195]
    v_mfma_f32_16x16x32_bf16 v[196:199], a[152:155], a[64:67], v[196:199]
    v_mfma_f32_16x16x32_bf16 v[200:203], a[152:155], a[68:71], v[200:203]
    s_waitcnt vmcnt(0)
    v_mfma_f32_16x16x32_bf16 v[204:207], a[156:159], a[60:63], v[204:207]
    v_mfma_f32_16x16x32_bf16 v[208:211], a[156:159], a[64:67], v[208:211]
    v_mfma_f32_16x16x32_bf16 v[212:215], a[156:159], a[68:71], v[212:215]
    s_nop 7
    buffer_load_dwordx4 a[144:147], v216, s[40:43], s84 offen offset:384
    buffer_load_dwordx4 a[148:151], v216, s[40:43], s85 offen offset:384
    buffer_load_dwordx4 a[152:155], v216, s[40:43], s84 offen offset:448
    buffer_load_dwordx4 a[156:159], v216, s[40:43], s85 offen offset:448
    s_waitcnt vmcnt(3)
    v_mfma_f32_16x16x32_bf16 v[192:195], a[144:147], a[72:75], v[192:195]
    v_mfma_f32_16x16x32_bf16 v[196:199], a[144:147], a[76:79], v[196:199]
    v_mfma_f32_16x16x32_bf16 v[200:203], a[144:147], a[80:83], v[200:203]
    s_waitcnt vmcnt(2)
    v_mfma_f32_16x16x32_bf16 v[204:207], a[148:151], a[72:75], v[204:207]
    v_mfma_f32_16x16x32_bf16 v[208:211], a[148:151], a[76:79], v[208:211]
    v_mfma_f32_16x16x32_bf16 v[212:215], a[148:151], a[80:83], v[212:215]
    s_waitcnt vmcnt(1)
    v_mfma_f32_16x16x32_bf16 v[192:195], a[152:155], a[84:87], v[192:195]
    v_mfma_f32_16x16x32_bf16 v[196:199], a[152:155], a[88:91], v[196:199]
    v_mfma_f32_16x16x32_bf16 v[200:203], a[152:155], a[92:95], v[200:203]
    s_waitcnt vmcnt(0)
    v_mfma_f32_16x16x32_bf16 v[204:207], a[156:159], a[84:87], v[204:207]
    v_mfma_f32_16x16x32_bf16 v[208:211], a[156:159], a[88:91], v[208:211]
    v_mfma_f32_16x16x32_bf16 v[212:215], a[156:159], a[92:95], v[212:215]
    s_nop 7
    v_exp_f32 v192, v192
    v_exp_f32 v193, v193
    v_exp_f32 v194, v194
    v_exp_f32 v195, v195
    v_exp_f32 v204, v204
    v_cvt_pk_bf16_f32 v60, v192, v193
    v_cvt_pk_bf16_f32 v61, v194, v195
    v_exp_f32 v205, v205
    v_add_f32 v252, v252, v192
    v_add_f32 v252, v252, v193
    v_exp_f32 v206, v206
    v_add_f32 v252, v252, v194
    v_add_f32 v252, v252, v195
    v_exp_f32 v207, v207
    v_exp_f32 v196, v196
    v_cvt_pk_bf16_f32 v62, v204, v205
    v_cvt_pk_bf16_f32 v63, v206, v207
    v_exp_f32 v197, v197
    v_add_f32 v252, v252, v204
    v_add_f32 v252, v252, v205
    v_exp_f32 v198, v198
    v_add_f32 v252, v252, v206
    v_add_f32 v252, v252, v207
    v_exp_f32 v199, v199
    v_exp_f32 v208, v208
    v_cvt_pk_bf16_f32 v64, v196, v197
    v_cvt_pk_bf16_f32 v65, v198, v199
    v_exp_f32 v209, v209
    v_add_f32 v253, v253, v196
    v_add_f32 v253, v253, v197
    v_exp_f32 v210, v210
    v_add_f32 v253, v253, v198
    v_add_f32 v253, v253, v199
    v_exp_f32 v211, v211
    v_exp_f32 v200, v200
    v_cvt_pk_bf16_f32 v66, v208, v209
    v_cvt_pk_bf16_f32 v67, v210, v211
    v_exp_f32 v201, v201
    v_add_f32 v253, v253, v208
    v_add_f32 v253, v253, v209
    v_exp_f32 v202, v202
    v_add_f32 v253, v253, v210
    v_add_f32 v253, v253, v211
    v_exp_f32 v203, v203
    v_exp_f32 v212, v212
    v_cvt_pk_bf16_f32 v68, v200, v201
    v_cvt_pk_bf16_f32 v69, v202, v203
    v_exp_f32 v213, v213
    v_add_f32 v254, v254, v200
    v_add_f32 v254, v254, v201
    v_exp_f32 v214, v214
    v_add_f32 v254, v254, v202
    v_add_f32 v254, v254, v203
    v_exp_f32 v215, v215
    v_cvt_pk_bf16_f32 v70, v212, v213
    v_cvt_pk_bf16_f32 v71, v214, v215
    v_add_f32 v254, v254, v212
    v_add_f32 v254, v254, v213
    v_add_f32 v254, v254, v214
    v_add_f32 v254, v254, v215
    s_mov_b32 s84, 98304
    s_mov_b32 s85, 106496
    buffer_load_dwordx4 a[144:147], v216, s[40:43], s84 offen
    buffer_load_dwordx4 a[148:151], v216, s[40:43], s85 offen
    buffer_load_dwordx4 a[152:155], v216, s[40:43], s84 offen offset:64
    buffer_load_dwordx4 a[156:159], v216, s[40:43], s85 offen offset:64
    s_waitcnt vmcnt(3)
    v_mfma_f32_16x16x32_bf16 v[192:195], a[144:147], a[0:3], v[228:231]
    v_mfma_f32_16x16x32_bf16 v[196:199], a[144:147], a[4:7], v[232:235]
    v_mfma_f32_16x16x32_bf16 v[200:203], a[144:147], a[8:11], v[236:239]
    s_waitcnt vmcnt(2)
    v_mfma_f32_16x16x32_bf16 v[204:207], a[148:151], a[0:3], v[228:231]
    v_mfma_f32_16x16x32_bf16 v[208:211], a[148:151], a[4:7], v[232:235]
    v_mfma_f32_16x16x32_bf16 v[212:215], a[148:151], a[8:11], v[236:239]
    s_waitcnt vmcnt(1)
    v_mfma_f32_16x16x32_bf16 v[192:195], a[152:155], a[12:15], v[192:195]
    v_mfma_f32_16x16x32_bf16 v[196:199], a[152:155], a[16:19], v[196:199]
    v_mfma_f32_16x16x32_bf16 v[200:203], a[152:155], a[20:23], v[200:203]
    s_waitcnt vmcnt(0)
    v_mfma_f32_16x16x32_bf16 v[204:207], a[156:159], a[12:15], v[204:207]
    v_mfma_f32_16x16x32_bf16 v[208:211], a[156:159], a[16:19], v[208:211]
    v_mfma_f32_16x16x32_bf16 v[212:215], a[156:159], a[20:23], v[212:215]
    s_nop 7
    buffer_load_dwordx4 a[144:147], v216, s[40:43], s84 offen offset:128
    buffer_load_dwordx4 a[148:151], v216, s[40:43], s85 offen offset:128
    buffer_load_dwordx4 a[152:155], v216, s[40:43], s84 offen offset:192
    buffer_load_dwordx4 a[156:159], v216, s[40:43], s85 offen offset:192
    s_waitcnt vmcnt(3)
    v_mfma_f32_16x16x32_bf16 v[192:195], a[144:147], a[24:27], v[192:195]
    v_mfma_f32_16x16x32_bf16 v[196:199], a[144:147], a[28:31], v[196:199]
    v_mfma_f32_16x16x32_bf16 v[200:203], a[144:147], a[32:35], v[200:203]
    s_waitcnt vmcnt(2)
    v_mfma_f32_16x16x32_bf16 v[204:207], a[148:151], a[24:27], v[204:207]
    v_mfma_f32_16x16x32_bf16 v[208:211], a[148:151], a[28:31], v[208:211]
    v_mfma_f32_16x16x32_bf16 v[212:215], a[148:151], a[32:35], v[212:215]
    s_waitcnt vmcnt(1)
    v_mfma_f32_16x16x32_bf16 v[192:195], a[152:155], a[36:39], v[192:195]
    v_mfma_f32_16x16x32_bf16 v[196:199], a[152:155], a[40:43], v[196:199]
    v_mfma_f32_16x16x32_bf16 v[200:203], a[152:155], a[44:47], v[200:203]
    s_waitcnt vmcnt(0)
    v_mfma_f32_16x16x32_bf16 v[204:207], a[156:159], a[36:39], v[204:207]
    v_mfma_f32_16x16x32_bf16 v[208:211], a[156:159], a[40:43], v[208:211]
    v_mfma_f32_16x16x32_bf16 v[212:215], a[156:159], a[44:47], v[212:215]
    s_nop 7
    buffer_load_dwordx4 a[144:147], v216, s[40:43], s84 offen offset:256
    buffer_load_dwordx4 a[148:151], v216, s[40:43], s85 offen offset:256
    buffer_load_dwordx4 a[152:155], v216, s[40:43], s84 offen offset:320
    buffer_load_dwordx4 a[156:159], v216, s[40:43], s85 offen offset:320
    s_waitcnt vmcnt(3)
    v_mfma_f32_16x16x32_bf16 v[192:195], a[144:147], a[48:51], v[192:195]
    v_mfma_f32_16x16x32_bf16 v[196:199], a[144:147], a[52:55], v[196:199]
    v_mfma_f32_16x16x32_bf16 v[200:203], a[144:147], a[56:59], v[200:203]
    s_waitcnt vmcnt(2)
    v_mfma_f32_16x16x32_bf16 v[204:207], a[148:151], a[48:51], v[204:207]
    v_mfma_f32_16x16x32_bf16 v[208:211], a[148:151], a[52:55], v[208:211]
    v_mfma_f32_16x16x32_bf16 v[212:215], a[148:151], a[56:59], v[212:215]
    s_waitcnt vmcnt(1)
    v_mfma_f32_16x16x32_bf16 v[192:195], a[152:155], a[60:63], v[192:195]
    v_mfma_f32_16x16x32_bf16 v[196:199], a[152:155], a[64:67], v[196:199]
    v_mfma_f32_16x16x32_bf16 v[200:203], a[152:155], a[68:71], v[200:203]
    s_waitcnt vmcnt(0)
    v_mfma_f32_16x16x32_bf16 v[204:207], a[156:159], a[60:63], v[204:207]
    v_mfma_f32_16x16x32_bf16 v[208:211], a[156:159], a[64:67], v[208:211]
    v_mfma_f32_16x16x32_bf16 v[212:215], a[156:159], a[68:71], v[212:215]
    s_nop 7
    buffer_load_dwordx4 a[144:147], v216, s[40:43], s84 offen offset:384
    buffer_load_dwordx4 a[148:151], v216, s[40:43], s85 offen offset:384
    buffer_load_dwordx4 a[152:155], v216, s[40:43], s84 offen offset:448
    buffer_load_dwordx4 a[156:159], v216, s[40:43], s85 offen offset:448
    s_waitcnt vmcnt(3)
    v_mfma_f32_16x16x32_bf16 v[192:195], a[144:147], a[72:75], v[192:195]
    v_mfma_f32_16x16x32_bf16 v[196:199], a[144:147], a[76:79], v[196:199]
    v_mfma_f32_16x16x32_bf16 v[200:203], a[144:147], a[80:83], v[200:203]
    s_waitcnt vmcnt(2)
    v_mfma_f32_16x16x32_bf16 v[204:207], a[148:151], a[72:75], v[204:207]
    v_mfma_f32_16x16x32_bf16 v[208:211], a[148:151], a[76:79], v[208:211]
    v_mfma_f32_16x16x32_bf16 v[212:215], a[148:151], a[80:83], v[212:215]
    s_waitcnt vmcnt(1)
    v_mfma_f32_16x16x32_bf16 v[192:195], a[152:155], a[84:87], v[192:195]
    v_mfma_f32_16x16x32_bf16 v[196:199], a[152:155], a[88:91], v[196:199]
    v_mfma_f32_16x16x32_bf16 v[200:203], a[152:155], a[92:95], v[200:203]
    s_waitcnt vmcnt(0)
    v_mfma_f32_16x16x32_bf16 v[204:207], a[156:159], a[84:87], v[204:207]
    v_mfma_f32_16x16x32_bf16 v[208:211], a[156:159], a[88:91], v[208:211]
    v_mfma_f32_16x16x32_bf16 v[212:215], a[156:159], a[92:95], v[212:215]
    s_nop 7
    v_exp_f32 v192, v192
    v_exp_f32 v193, v193
    v_exp_f32 v194, v194
    v_exp_f32 v195, v195
    v_exp_f32 v204, v204
    v_cvt_pk_bf16_f32 v72, v192, v193
    v_cvt_pk_bf16_f32 v73, v194, v195
    v_exp_f32 v205, v205
    v_add_f32 v252, v252, v192
    v_add_f32 v252, v252, v193
    v_exp_f32 v206, v206
    v_add_f32 v252, v252, v194
    v_add_f32 v252, v252, v195
    v_exp_f32 v207, v207
    v_exp_f32 v196, v196
    v_cvt_pk_bf16_f32 v74, v204, v205
    v_cvt_pk_bf16_f32 v75, v206, v207
    v_exp_f32 v197, v197
    v_add_f32 v252, v252, v204
    v_add_f32 v252, v252, v205
    v_exp_f32 v198, v198
    v_add_f32 v252, v252, v206
    v_add_f32 v252, v252, v207
    v_exp_f32 v199, v199
    v_exp_f32 v208, v208
    v_cvt_pk_bf16_f32 v76, v196, v197
    v_cvt_pk_bf16_f32 v77, v198, v199
    v_exp_f32 v209, v209
    v_add_f32 v253, v253, v196
    v_add_f32 v253, v253, v197
    v_exp_f32 v210, v210
    v_add_f32 v253, v253, v198
    v_add_f32 v253, v253, v199
    v_exp_f32 v211, v211
    v_exp_f32 v200, v200
    v_cvt_pk_bf16_f32 v78, v208, v209
    v_cvt_pk_bf16_f32 v79, v210, v211
    v_exp_f32 v201, v201
    v_add_f32 v253, v253, v208
    v_add_f32 v253, v253, v209
    v_exp_f32 v202, v202
    v_add_f32 v253, v253, v210
    v_add_f32 v253, v253, v211
    v_exp_f32 v203, v203
    v_exp_f32 v212, v212
    v_cvt_pk_bf16_f32 v80, v200, v201
    v_cvt_pk_bf16_f32 v81, v202, v203
    v_exp_f32 v213, v213
    v_add_f32 v254, v254, v200
    v_add_f32 v254, v254, v201
    v_exp_f32 v214, v214
    v_add_f32 v254, v254, v202
    v_add_f32 v254, v254, v203
    v_exp_f32 v215, v215
    v_cvt_pk_bf16_f32 v82, v212, v213
    v_cvt_pk_bf16_f32 v83, v214, v215
    v_add_f32 v254, v254, v212
    v_add_f32 v254, v254, v213
    v_add_f32 v254, v254, v214
    v_add_f32 v254, v254, v215
    s_mov_b32 s84, 114688
    s_mov_b32 s85, 122880
    buffer_load_dwordx4 a[144:147], v216, s[40:43], s84 offen
    buffer_load_dwordx4 a[148:151], v216, s[40:43], s85 offen
    buffer_load_dwordx4 a[152:155], v216, s[40:43], s84 offen offset:64
    buffer_load_dwordx4 a[156:159], v216, s[40:43], s85 offen offset:64
    s_waitcnt vmcnt(3)
    v_mfma_f32_16x16x32_bf16 v[192:195], a[144:147], a[0:3], v[228:231]
    v_mfma_f32_16x16x32_bf16 v[196:199], a[144:147], a[4:7], v[232:235]
    v_mfma_f32_16x16x32_bf16 v[200:203], a[144:147], a[8:11], v[236:239]
    s_waitcnt vmcnt(2)
    v_mfma_f32_16x16x32_bf16 v[204:207], a[148:151], a[0:3], v[228:231]
    v_mfma_f32_16x16x32_bf16 v[208:211], a[148:151], a[4:7], v[232:235]
    v_mfma_f32_16x16x32_bf16 v[212:215], a[148:151], a[8:11], v[236:239]
    s_waitcnt vmcnt(1)
    v_mfma_f32_16x16x32_bf16 v[192:195], a[152:155], a[12:15], v[192:195]
    v_mfma_f32_16x16x32_bf16 v[196:199], a[152:155], a[16:19], v[196:199]
    v_mfma_f32_16x16x32_bf16 v[200:203], a[152:155], a[20:23], v[200:203]
    s_waitcnt vmcnt(0)
    v_mfma_f32_16x16x32_bf16 v[204:207], a[156:159], a[12:15], v[204:207]
    v_mfma_f32_16x16x32_bf16 v[208:211], a[156:159], a[16:19], v[208:211]
    v_mfma_f32_16x16x32_bf16 v[212:215], a[156:159], a[20:23], v[212:215]
    s_nop 7
    buffer_load_dwordx4 a[144:147], v216, s[40:43], s84 offen offset:128
    buffer_load_dwordx4 a[148:151], v216, s[40:43], s85 offen offset:128
    buffer_load_dwordx4 a[152:155], v216, s[40:43], s84 offen offset:192
    buffer_load_dwordx4 a[156:159], v216, s[40:43], s85 offen offset:192
    s_waitcnt vmcnt(3)
    v_mfma_f32_16x16x32_bf16 v[192:195], a[144:147], a[24:27], v[192:195]
    v_mfma_f32_16x16x32_bf16 v[196:199], a[144:147], a[28:31], v[196:199]
    v_mfma_f32_16x16x32_bf16 v[200:203], a[144:147], a[32:35], v[200:203]
    s_waitcnt vmcnt(2)
    v_mfma_f32_16x16x32_bf16 v[204:207], a[148:151], a[24:27], v[204:207]
    v_mfma_f32_16x16x32_bf16 v[208:211], a[148:151], a[28:31], v[208:211]
    v_mfma_f32_16x16x32_bf16 v[212:215], a[148:151], a[32:35], v[212:215]
    s_waitcnt vmcnt(1)
    v_mfma_f32_16x16x32_bf16 v[192:195], a[152:155], a[36:39], v[192:195]
    v_mfma_f32_16x16x32_bf16 v[196:199], a[152:155], a[40:43], v[196:199]
    v_mfma_f32_16x16x32_bf16 v[200:203], a[152:155], a[44:47], v[200:203]
    s_waitcnt vmcnt(0)
    v_mfma_f32_16x16x32_bf16 v[204:207], a[156:159], a[36:39], v[204:207]
    v_mfma_f32_16x16x32_bf16 v[208:211], a[156:159], a[40:43], v[208:211]
    v_mfma_f32_16x16x32_bf16 v[212:215], a[156:159], a[44:47], v[212:215]
    s_nop 7
    buffer_load_dwordx4 a[144:147], v216, s[40:43], s84 offen offset:256
    buffer_load_dwordx4 a[148:151], v216, s[40:43], s85 offen offset:256
    buffer_load_dwordx4 a[152:155], v216, s[40:43], s84 offen offset:320
    buffer_load_dwordx4 a[156:159], v216, s[40:43], s85 offen offset:320
    s_waitcnt vmcnt(3)
    v_mfma_f32_16x16x32_bf16 v[192:195], a[144:147], a[48:51], v[192:195]
    v_mfma_f32_16x16x32_bf16 v[196:199], a[144:147], a[52:55], v[196:199]
    v_mfma_f32_16x16x32_bf16 v[200:203], a[144:147], a[56:59], v[200:203]
    s_waitcnt vmcnt(2)
    v_mfma_f32_16x16x32_bf16 v[204:207], a[148:151], a[48:51], v[204:207]
    v_mfma_f32_16x16x32_bf16 v[208:211], a[148:151], a[52:55], v[208:211]
    v_mfma_f32_16x16x32_bf16 v[212:215], a[148:151], a[56:59], v[212:215]
    s_waitcnt vmcnt(1)
    v_mfma_f32_16x16x32_bf16 v[192:195], a[152:155], a[60:63], v[192:195]
    v_mfma_f32_16x16x32_bf16 v[196:199], a[152:155], a[64:67], v[196:199]
    v_mfma_f32_16x16x32_bf16 v[200:203], a[152:155], a[68:71], v[200:203]
    s_waitcnt vmcnt(0)
    v_mfma_f32_16x16x32_bf16 v[204:207], a[156:159], a[60:63], v[204:207]
    v_mfma_f32_16x16x32_bf16 v[208:211], a[156:159], a[64:67], v[208:211]
    v_mfma_f32_16x16x32_bf16 v[212:215], a[156:159], a[68:71], v[212:215]
    s_nop 7
    buffer_load_dwordx4 a[144:147], v216, s[40:43], s84 offen offset:384
    buffer_load_dwordx4 a[148:151], v216, s[40:43], s85 offen offset:384
    buffer_load_dwordx4 a[152:155], v216, s[40:43], s84 offen offset:448
    buffer_load_dwordx4 a[156:159], v216, s[40:43], s85 offen offset:448
    s_waitcnt vmcnt(3)
    v_mfma_f32_16x16x32_bf16 v[192:195], a[144:147], a[72:75], v[192:195]
    v_mfma_f32_16x16x32_bf16 v[196:199], a[144:147], a[76:79], v[196:199]
    v_mfma_f32_16x16x32_bf16 v[200:203], a[144:147], a[80:83], v[200:203]
    s_waitcnt vmcnt(2)
    v_mfma_f32_16x16x32_bf16 v[204:207], a[148:151], a[72:75], v[204:207]
    v_mfma_f32_16x16x32_bf16 v[208:211], a[148:151], a[76:79], v[208:211]
    v_mfma_f32_16x16x32_bf16 v[212:215], a[148:151], a[80:83], v[212:215]
    s_waitcnt vmcnt(1)
    v_mfma_f32_16x16x32_bf16 v[192:195], a[152:155], a[84:87], v[192:195]
    v_mfma_f32_16x16x32_bf16 v[196:199], a[152:155], a[88:91], v[196:199]
    v_mfma_f32_16x16x32_bf16 v[200:203], a[152:155], a[92:95], v[200:203]
    s_waitcnt vmcnt(0)
    v_mfma_f32_16x16x32_bf16 v[204:207], a[156:159], a[84:87], v[204:207]
    v_mfma_f32_16x16x32_bf16 v[208:211], a[156:159], a[88:91], v[208:211]
    v_mfma_f32_16x16x32_bf16 v[212:215], a[156:159], a[92:95], v[212:215]
    s_nop 7
    v_exp_f32 v192, v192
    v_exp_f32 v193, v193
    v_exp_f32 v194, v194
    v_exp_f32 v195, v195
    v_exp_f32 v204, v204
    v_cvt_pk_bf16_f32 v84, v192, v193
    v_cvt_pk_bf16_f32 v85, v194, v195
    v_exp_f32 v205, v205
    v_add_f32 v252, v252, v192
    v_add_f32 v252, v252, v193
    v_exp_f32 v206, v206
    v_add_f32 v252, v252, v194
    v_add_f32 v252, v252, v195
    v_exp_f32 v207, v207
    v_exp_f32 v196, v196
    v_cvt_pk_bf16_f32 v86, v204, v205
    v_cvt_pk_bf16_f32 v87, v206, v207
    v_exp_f32 v197, v197
    v_add_f32 v252, v252, v204
    v_add_f32 v252, v252, v205
    v_exp_f32 v198, v198
    v_add_f32 v252, v252, v206
    v_add_f32 v252, v252, v207
    v_exp_f32 v199, v199
    v_exp_f32 v208, v208
    v_cvt_pk_bf16_f32 v88, v196, v197
    v_cvt_pk_bf16_f32 v89, v198, v199
    v_exp_f32 v209, v209
    v_add_f32 v253, v253, v196
    v_add_f32 v253, v253, v197
    v_exp_f32 v210, v210
    v_add_f32 v253, v253, v198
    v_add_f32 v253, v253, v199
    v_exp_f32 v211, v211
    v_exp_f32 v200, v200
    v_cvt_pk_bf16_f32 v90, v208, v209
    v_cvt_pk_bf16_f32 v91, v210, v211
    v_exp_f32 v201, v201
    v_add_f32 v253, v253, v208
    v_add_f32 v253, v253, v209
    v_exp_f32 v202, v202
    v_add_f32 v253, v253, v210
    v_add_f32 v253, v253, v211
    v_exp_f32 v203, v203
    v_exp_f32 v212, v212
    v_cvt_pk_bf16_f32 v92, v200, v201
    v_cvt_pk_bf16_f32 v93, v202, v203
    v_exp_f32 v213, v213
    v_add_f32 v254, v254, v200
    v_add_f32 v254, v254, v201
    v_exp_f32 v214, v214
    v_add_f32 v254, v254, v202
    v_add_f32 v254, v254, v203
    v_exp_f32 v215, v215
    v_cvt_pk_bf16_f32 v94, v212, v213
    v_cvt_pk_bf16_f32 v95, v214, v215
    v_add_f32 v254, v254, v212
    v_add_f32 v254, v254, v213
    v_add_f32 v254, v254, v214
    v_add_f32 v254, v254, v215
    s_mov_b32 s84, 131072
    s_mov_b32 s85, 139264
    buffer_load_dwordx4 a[144:147], v216, s[40:43], s84 offen
    buffer_load_dwordx4 a[148:151], v216, s[40:43], s85 offen
    buffer_load_dwordx4 a[152:155], v216, s[40:43], s84 offen offset:64
    buffer_load_dwordx4 a[156:159], v216, s[40:43], s85 offen offset:64
    s_waitcnt vmcnt(3)
    v_mfma_f32_16x16x32_bf16 v[192:195], a[144:147], a[0:3], v[228:231]
    v_mfma_f32_16x16x32_bf16 v[196:199], a[144:147], a[4:7], v[232:235]
    v_mfma_f32_16x16x32_bf16 v[200:203], a[144:147], a[8:11], v[236:239]
    s_waitcnt vmcnt(2)
    v_mfma_f32_16x16x32_bf16 v[204:207], a[148:151], a[0:3], v[228:231]
    v_mfma_f32_16x16x32_bf16 v[208:211], a[148:151], a[4:7], v[232:235]
    v_mfma_f32_16x16x32_bf16 v[212:215], a[148:151], a[8:11], v[236:239]
    s_waitcnt vmcnt(1)
    v_mfma_f32_16x16x32_bf16 v[192:195], a[152:155], a[12:15], v[192:195]
    v_mfma_f32_16x16x32_bf16 v[196:199], a[152:155], a[16:19], v[196:199]
    v_mfma_f32_16x16x32_bf16 v[200:203], a[152:155], a[20:23], v[200:203]
    s_waitcnt vmcnt(0)
    v_mfma_f32_16x16x32_bf16 v[204:207], a[156:159], a[12:15], v[204:207]
    v_mfma_f32_16x16x32_bf16 v[208:211], a[156:159], a[16:19], v[208:211]
    v_mfma_f32_16x16x32_bf16 v[212:215], a[156:159], a[20:23], v[212:215]
    s_nop 7
    buffer_load_dwordx4 a[144:147], v216, s[40:43], s84 offen offset:128
    buffer_load_dwordx4 a[148:151], v216, s[40:43], s85 offen offset:128
    buffer_load_dwordx4 a[152:155], v216, s[40:43], s84 offen offset:192
    buffer_load_dwordx4 a[156:159], v216, s[40:43], s85 offen offset:192
    s_waitcnt vmcnt(3)
    v_mfma_f32_16x16x32_bf16 v[192:195], a[144:147], a[24:27], v[192:195]
    v_mfma_f32_16x16x32_bf16 v[196:199], a[144:147], a[28:31], v[196:199]
    v_mfma_f32_16x16x32_bf16 v[200:203], a[144:147], a[32:35], v[200:203]
    s_waitcnt vmcnt(2)
    v_mfma_f32_16x16x32_bf16 v[204:207], a[148:151], a[24:27], v[204:207]
    v_mfma_f32_16x16x32_bf16 v[208:211], a[148:151], a[28:31], v[208:211]
    v_mfma_f32_16x16x32_bf16 v[212:215], a[148:151], a[32:35], v[212:215]
    s_waitcnt vmcnt(1)
    v_mfma_f32_16x16x32_bf16 v[192:195], a[152:155], a[36:39], v[192:195]
    v_mfma_f32_16x16x32_bf16 v[196:199], a[152:155], a[40:43], v[196:199]
    v_mfma_f32_16x16x32_bf16 v[200:203], a[152:155], a[44:47], v[200:203]
    s_waitcnt vmcnt(0)
    v_mfma_f32_16x16x32_bf16 v[204:207], a[156:159], a[36:39], v[204:207]
    v_mfma_f32_16x16x32_bf16 v[208:211], a[156:159], a[40:43], v[208:211]
    v_mfma_f32_16x16x32_bf16 v[212:215], a[156:159], a[44:47], v[212:215]
    s_nop 7
    buffer_load_dwordx4 a[144:147], v216, s[40:43], s84 offen offset:256
    buffer_load_dwordx4 a[148:151], v216, s[40:43], s85 offen offset:256
    buffer_load_dwordx4 a[152:155], v216, s[40:43], s84 offen offset:320
    buffer_load_dwordx4 a[156:159], v216, s[40:43], s85 offen offset:320
    s_waitcnt vmcnt(3)
    v_mfma_f32_16x16x32_bf16 v[192:195], a[144:147], a[48:51], v[192:195]
    v_mfma_f32_16x16x32_bf16 v[196:199], a[144:147], a[52:55], v[196:199]
    v_mfma_f32_16x16x32_bf16 v[200:203], a[144:147], a[56:59], v[200:203]
    s_waitcnt vmcnt(2)
    v_mfma_f32_16x16x32_bf16 v[204:207], a[148:151], a[48:51], v[204:207]
    v_mfma_f32_16x16x32_bf16 v[208:211], a[148:151], a[52:55], v[208:211]
    v_mfma_f32_16x16x32_bf16 v[212:215], a[148:151], a[56:59], v[212:215]
    s_waitcnt vmcnt(1)
    v_mfma_f32_16x16x32_bf16 v[192:195], a[152:155], a[60:63], v[192:195]
    v_mfma_f32_16x16x32_bf16 v[196:199], a[152:155], a[64:67], v[196:199]
    v_mfma_f32_16x16x32_bf16 v[200:203], a[152:155], a[68:71], v[200:203]
    s_waitcnt vmcnt(0)
    v_mfma_f32_16x16x32_bf16 v[204:207], a[156:159], a[60:63], v[204:207]
    v_mfma_f32_16x16x32_bf16 v[208:211], a[156:159], a[64:67], v[208:211]
    v_mfma_f32_16x16x32_bf16 v[212:215], a[156:159], a[68:71], v[212:215]
    s_nop 7
    buffer_load_dwordx4 a[144:147], v216, s[40:43], s84 offen offset:384
    buffer_load_dwordx4 a[148:151], v216, s[40:43], s85 offen offset:384
    buffer_load_dwordx4 a[152:155], v216, s[40:43], s84 offen offset:448
    buffer_load_dwordx4 a[156:159], v216, s[40:43], s85 offen offset:448
    s_waitcnt vmcnt(3)
    v_mfma_f32_16x16x32_bf16 v[192:195], a[144:147], a[72:75], v[192:195]
    v_mfma_f32_16x16x32_bf16 v[196:199], a[144:147], a[76:79], v[196:199]
    v_mfma_f32_16x16x32_bf16 v[200:203], a[144:147], a[80:83], v[200:203]
    s_waitcnt vmcnt(2)
    v_mfma_f32_16x16x32_bf16 v[204:207], a[148:151], a[72:75], v[204:207]
    v_mfma_f32_16x16x32_bf16 v[208:211], a[148:151], a[76:79], v[208:211]
    v_mfma_f32_16x16x32_bf16 v[212:215], a[148:151], a[80:83], v[212:215]
    s_waitcnt vmcnt(1)
    v_mfma_f32_16x16x32_bf16 v[192:195], a[152:155], a[84:87], v[192:195]
    v_mfma_f32_16x16x32_bf16 v[196:199], a[152:155], a[88:91], v[196:199]
    v_mfma_f32_16x16x32_bf16 v[200:203], a[152:155], a[92:95], v[200:203]
    s_waitcnt vmcnt(0)
    v_mfma_f32_16x16x32_bf16 v[204:207], a[156:159], a[84:87], v[204:207]
    v_mfma_f32_16x16x32_bf16 v[208:211], a[156:159], a[88:91], v[208:211]
    v_mfma_f32_16x16x32_bf16 v[212:215], a[156:159], a[92:95], v[212:215]
    s_nop 7
    v_exp_f32 v192, v192
    v_exp_f32 v193, v193
    v_exp_f32 v194, v194
    v_exp_f32 v195, v195
    v_exp_f32 v204, v204
    v_cvt_pk_bf16_f32 v96, v192, v193
    v_cvt_pk_bf16_f32 v97, v194, v195
    v_exp_f32 v205, v205
    v_add_f32 v252, v252, v192
    v_add_f32 v252, v252, v193
    v_exp_f32 v206, v206
    v_add_f32 v252, v252, v194
    v_add_f32 v252, v252, v195
    v_exp_f32 v207, v207
    v_exp_f32 v196, v196
    v_cvt_pk_bf16_f32 v98, v204, v205
    v_cvt_pk_bf16_f32 v99, v206, v207
    v_exp_f32 v197, v197
    v_add_f32 v252, v252, v204
    v_add_f32 v252, v252, v205
    v_exp_f32 v198, v198
    v_add_f32 v252, v252, v206
    v_add_f32 v252, v252, v207
    v_exp_f32 v199, v199
    v_exp_f32 v208, v208
    v_cvt_pk_bf16_f32 v100, v196, v197
    v_cvt_pk_bf16_f32 v101, v198, v199
    v_exp_f32 v209, v209
    v_add_f32 v253, v253, v196
    v_add_f32 v253, v253, v197
    v_exp_f32 v210, v210
    v_add_f32 v253, v253, v198
    v_add_f32 v253, v253, v199
    v_exp_f32 v211, v211
    v_exp_f32 v200, v200
    v_cvt_pk_bf16_f32 v102, v208, v209
    v_cvt_pk_bf16_f32 v103, v210, v211
    v_exp_f32 v201, v201
    v_add_f32 v253, v253, v208
    v_add_f32 v253, v253, v209
    v_exp_f32 v202, v202
    v_add_f32 v253, v253, v210
    v_add_f32 v253, v253, v211
    v_exp_f32 v203, v203
    v_exp_f32 v212, v212
    v_cvt_pk_bf16_f32 v104, v200, v201
    v_cvt_pk_bf16_f32 v105, v202, v203
    v_exp_f32 v213, v213
    v_add_f32 v254, v254, v200
    v_add_f32 v254, v254, v201
    v_exp_f32 v214, v214
    v_add_f32 v254, v254, v202
    v_add_f32 v254, v254, v203
    v_exp_f32 v215, v215
    v_cvt_pk_bf16_f32 v106, v212, v213
    v_cvt_pk_bf16_f32 v107, v214, v215
    v_add_f32 v254, v254, v212
    v_add_f32 v254, v254, v213
    v_add_f32 v254, v254, v214
    v_add_f32 v254, v254, v215
    s_mov_b32 s84, 147456
    s_mov_b32 s85, 155648
    buffer_load_dwordx4 a[144:147], v216, s[40:43], s84 offen
    buffer_load_dwordx4 a[148:151], v216, s[40:43], s85 offen
    buffer_load_dwordx4 a[152:155], v216, s[40:43], s84 offen offset:64
    buffer_load_dwordx4 a[156:159], v216, s[40:43], s85 offen offset:64
    s_waitcnt vmcnt(3)
    v_mfma_f32_16x16x32_bf16 v[192:195], a[144:147], a[0:3], v[228:231]
    v_mfma_f32_16x16x32_bf16 v[196:199], a[144:147], a[4:7], v[232:235]
    v_mfma_f32_16x16x32_bf16 v[200:203], a[144:147], a[8:11], v[236:239]
    s_waitcnt vmcnt(2)
    v_mfma_f32_16x16x32_bf16 v[204:207], a[148:151], a[0:3], v[228:231]
    v_mfma_f32_16x16x32_bf16 v[208:211], a[148:151], a[4:7], v[232:235]
    v_mfma_f32_16x16x32_bf16 v[212:215], a[148:151], a[8:11], v[236:239]
    s_waitcnt vmcnt(1)
    v_mfma_f32_16x16x32_bf16 v[192:195], a[152:155], a[12:15], v[192:195]
    v_mfma_f32_16x16x32_bf16 v[196:199], a[152:155], a[16:19], v[196:199]
    v_mfma_f32_16x16x32_bf16 v[200:203], a[152:155], a[20:23], v[200:203]
    s_waitcnt vmcnt(0)
    v_mfma_f32_16x16x32_bf16 v[204:207], a[156:159], a[12:15], v[204:207]
    v_mfma_f32_16x16x32_bf16 v[208:211], a[156:159], a[16:19], v[208:211]
    v_mfma_f32_16x16x32_bf16 v[212:215], a[156:159], a[20:23], v[212:215]
    s_nop 7
    buffer_load_dwordx4 a[144:147], v216, s[40:43], s84 offen offset:128
    buffer_load_dwordx4 a[148:151], v216, s[40:43], s85 offen offset:128
    buffer_load_dwordx4 a[152:155], v216, s[40:43], s84 offen offset:192
    buffer_load_dwordx4 a[156:159], v216, s[40:43], s85 offen offset:192
    s_waitcnt vmcnt(3)
    v_mfma_f32_16x16x32_bf16 v[192:195], a[144:147], a[24:27], v[192:195]
    v_mfma_f32_16x16x32_bf16 v[196:199], a[144:147], a[28:31], v[196:199]
    v_mfma_f32_16x16x32_bf16 v[200:203], a[144:147], a[32:35], v[200:203]
    s_waitcnt vmcnt(2)
    v_mfma_f32_16x16x32_bf16 v[204:207], a[148:151], a[24:27], v[204:207]
    v_mfma_f32_16x16x32_bf16 v[208:211], a[148:151], a[28:31], v[208:211]
    v_mfma_f32_16x16x32_bf16 v[212:215], a[148:151], a[32:35], v[212:215]
    s_waitcnt vmcnt(1)
    v_mfma_f32_16x16x32_bf16 v[192:195], a[152:155], a[36:39], v[192:195]
    v_mfma_f32_16x16x32_bf16 v[196:199], a[152:155], a[40:43], v[196:199]
    v_mfma_f32_16x16x32_bf16 v[200:203], a[152:155], a[44:47], v[200:203]
    s_waitcnt vmcnt(0)
    v_mfma_f32_16x16x32_bf16 v[204:207], a[156:159], a[36:39], v[204:207]
    v_mfma_f32_16x16x32_bf16 v[208:211], a[156:159], a[40:43], v[208:211]
    v_mfma_f32_16x16x32_bf16 v[212:215], a[156:159], a[44:47], v[212:215]
    s_nop 7
    buffer_load_dwordx4 a[144:147], v216, s[40:43], s84 offen offset:256
    buffer_load_dwordx4 a[148:151], v216, s[40:43], s85 offen offset:256
    buffer_load_dwordx4 a[152:155], v216, s[40:43], s84 offen offset:320
    buffer_load_dwordx4 a[156:159], v216, s[40:43], s85 offen offset:320
    s_waitcnt vmcnt(3)
    v_mfma_f32_16x16x32_bf16 v[192:195], a[144:147], a[48:51], v[192:195]
    v_mfma_f32_16x16x32_bf16 v[196:199], a[144:147], a[52:55], v[196:199]
    v_mfma_f32_16x16x32_bf16 v[200:203], a[144:147], a[56:59], v[200:203]
    s_waitcnt vmcnt(2)
    v_mfma_f32_16x16x32_bf16 v[204:207], a[148:151], a[48:51], v[204:207]
    v_mfma_f32_16x16x32_bf16 v[208:211], a[148:151], a[52:55], v[208:211]
    v_mfma_f32_16x16x32_bf16 v[212:215], a[148:151], a[56:59], v[212:215]
    s_waitcnt vmcnt(1)
    v_mfma_f32_16x16x32_bf16 v[192:195], a[152:155], a[60:63], v[192:195]
    v_mfma_f32_16x16x32_bf16 v[196:199], a[152:155], a[64:67], v[196:199]
    v_mfma_f32_16x16x32_bf16 v[200:203], a[152:155], a[68:71], v[200:203]
    s_waitcnt vmcnt(0)
    v_mfma_f32_16x16x32_bf16 v[204:207], a[156:159], a[60:63], v[204:207]
    v_mfma_f32_16x16x32_bf16 v[208:211], a[156:159], a[64:67], v[208:211]
    v_mfma_f32_16x16x32_bf16 v[212:215], a[156:159], a[68:71], v[212:215]
    s_nop 7
    buffer_load_dwordx4 a[144:147], v216, s[40:43], s84 offen offset:384
    buffer_load_dwordx4 a[148:151], v216, s[40:43], s85 offen offset:384
    buffer_load_dwordx4 a[152:155], v216, s[40:43], s84 offen offset:448
    buffer_load_dwordx4 a[156:159], v216, s[40:43], s85 offen offset:448
    s_waitcnt vmcnt(3)
    v_mfma_f32_16x16x32_bf16 v[192:195], a[144:147], a[72:75], v[192:195]
    v_mfma_f32_16x16x32_bf16 v[196:199], a[144:147], a[76:79], v[196:199]
    v_mfma_f32_16x16x32_bf16 v[200:203], a[144:147], a[80:83], v[200:203]
    s_waitcnt vmcnt(2)
    v_mfma_f32_16x16x32_bf16 v[204:207], a[148:151], a[72:75], v[204:207]
    v_mfma_f32_16x16x32_bf16 v[208:211], a[148:151], a[76:79], v[208:211]
    v_mfma_f32_16x16x32_bf16 v[212:215], a[148:151], a[80:83], v[212:215]
    s_waitcnt vmcnt(1)
    v_mfma_f32_16x16x32_bf16 v[192:195], a[152:155], a[84:87], v[192:195]
    v_mfma_f32_16x16x32_bf16 v[196:199], a[152:155], a[88:91], v[196:199]
    v_mfma_f32_16x16x32_bf16 v[200:203], a[152:155], a[92:95], v[200:203]
    s_waitcnt vmcnt(0)
    v_mfma_f32_16x16x32_bf16 v[204:207], a[156:159], a[84:87], v[204:207]
    v_mfma_f32_16x16x32_bf16 v[208:211], a[156:159], a[88:91], v[208:211]
    v_mfma_f32_16x16x32_bf16 v[212:215], a[156:159], a[92:95], v[212:215]
    s_nop 7
    v_exp_f32 v192, v192
    v_exp_f32 v193, v193
    v_exp_f32 v194, v194
    v_exp_f32 v195, v195
    v_exp_f32 v204, v204
    v_cvt_pk_bf16_f32 v108, v192, v193
    v_cvt_pk_bf16_f32 v109, v194, v195
    v_exp_f32 v205, v205
    v_add_f32 v252, v252, v192
    v_add_f32 v252, v252, v193
    v_exp_f32 v206, v206
    v_add_f32 v252, v252, v194
    v_add_f32 v252, v252, v195
    v_exp_f32 v207, v207
    v_exp_f32 v196, v196
    v_cvt_pk_bf16_f32 v110, v204, v205
    v_cvt_pk_bf16_f32 v111, v206, v207
    v_exp_f32 v197, v197
    v_add_f32 v252, v252, v204
    v_add_f32 v252, v252, v205
    v_exp_f32 v198, v198
    v_add_f32 v252, v252, v206
    v_add_f32 v252, v252, v207
    v_exp_f32 v199, v199
    v_exp_f32 v208, v208
    v_cvt_pk_bf16_f32 v112, v196, v197
    v_cvt_pk_bf16_f32 v113, v198, v199
    v_exp_f32 v209, v209
    v_add_f32 v253, v253, v196
    v_add_f32 v253, v253, v197
    v_exp_f32 v210, v210
    v_add_f32 v253, v253, v198
    v_add_f32 v253, v253, v199
    v_exp_f32 v211, v211
    v_exp_f32 v200, v200
    v_cvt_pk_bf16_f32 v114, v208, v209
    v_cvt_pk_bf16_f32 v115, v210, v211
    v_exp_f32 v201, v201
    v_add_f32 v253, v253, v208
    v_add_f32 v253, v253, v209
    v_exp_f32 v202, v202
    v_add_f32 v253, v253, v210
    v_add_f32 v253, v253, v211
    v_exp_f32 v203, v203
    v_exp_f32 v212, v212
    v_cvt_pk_bf16_f32 v116, v200, v201
    v_cvt_pk_bf16_f32 v117, v202, v203
    v_exp_f32 v213, v213
    v_add_f32 v254, v254, v200
    v_add_f32 v254, v254, v201
    v_exp_f32 v214, v214
    v_add_f32 v254, v254, v202
    v_add_f32 v254, v254, v203
    v_exp_f32 v215, v215
    v_cvt_pk_bf16_f32 v118, v212, v213
    v_cvt_pk_bf16_f32 v119, v214, v215
    v_add_f32 v254, v254, v212
    v_add_f32 v254, v254, v213
    v_add_f32 v254, v254, v214
    v_add_f32 v254, v254, v215
    s_mov_b32 s84, 163840
    s_mov_b32 s85, 172032
    buffer_load_dwordx4 a[144:147], v216, s[40:43], s84 offen
    buffer_load_dwordx4 a[148:151], v216, s[40:43], s85 offen
    buffer_load_dwordx4 a[152:155], v216, s[40:43], s84 offen offset:64
    buffer_load_dwordx4 a[156:159], v216, s[40:43], s85 offen offset:64
    s_waitcnt vmcnt(3)
    v_mfma_f32_16x16x32_bf16 v[192:195], a[144:147], a[0:3], v[228:231]
    v_mfma_f32_16x16x32_bf16 v[196:199], a[144:147], a[4:7], v[232:235]
    v_mfma_f32_16x16x32_bf16 v[200:203], a[144:147], a[8:11], v[236:239]
    s_waitcnt vmcnt(2)
    v_mfma_f32_16x16x32_bf16 v[204:207], a[148:151], a[0:3], v[228:231]
    v_mfma_f32_16x16x32_bf16 v[208:211], a[148:151], a[4:7], v[232:235]
    v_mfma_f32_16x16x32_bf16 v[212:215], a[148:151], a[8:11], v[236:239]
    s_waitcnt vmcnt(1)
    v_mfma_f32_16x16x32_bf16 v[192:195], a[152:155], a[12:15], v[192:195]
    v_mfma_f32_16x16x32_bf16 v[196:199], a[152:155], a[16:19], v[196:199]
    v_mfma_f32_16x16x32_bf16 v[200:203], a[152:155], a[20:23], v[200:203]
    s_waitcnt vmcnt(0)
    v_mfma_f32_16x16x32_bf16 v[204:207], a[156:159], a[12:15], v[204:207]
    v_mfma_f32_16x16x32_bf16 v[208:211], a[156:159], a[16:19], v[208:211]
    v_mfma_f32_16x16x32_bf16 v[212:215], a[156:159], a[20:23], v[212:215]
    s_nop 7
    buffer_load_dwordx4 a[144:147], v216, s[40:43], s84 offen offset:128
    buffer_load_dwordx4 a[148:151], v216, s[40:43], s85 offen offset:128
    buffer_load_dwordx4 a[152:155], v216, s[40:43], s84 offen offset:192
    buffer_load_dwordx4 a[156:159], v216, s[40:43], s85 offen offset:192
    s_waitcnt vmcnt(3)
    v_mfma_f32_16x16x32_bf16 v[192:195], a[144:147], a[24:27], v[192:195]
    v_mfma_f32_16x16x32_bf16 v[196:199], a[144:147], a[28:31], v[196:199]
    v_mfma_f32_16x16x32_bf16 v[200:203], a[144:147], a[32:35], v[200:203]
    s_waitcnt vmcnt(2)
    v_mfma_f32_16x16x32_bf16 v[204:207], a[148:151], a[24:27], v[204:207]
    v_mfma_f32_16x16x32_bf16 v[208:211], a[148:151], a[28:31], v[208:211]
    v_mfma_f32_16x16x32_bf16 v[212:215], a[148:151], a[32:35], v[212:215]
    s_waitcnt vmcnt(1)
    v_mfma_f32_16x16x32_bf16 v[192:195], a[152:155], a[36:39], v[192:195]
    v_mfma_f32_16x16x32_bf16 v[196:199], a[152:155], a[40:43], v[196:199]
    v_mfma_f32_16x16x32_bf16 v[200:203], a[152:155], a[44:47], v[200:203]
    s_waitcnt vmcnt(0)
    v_mfma_f32_16x16x32_bf16 v[204:207], a[156:159], a[36:39], v[204:207]
    v_mfma_f32_16x16x32_bf16 v[208:211], a[156:159], a[40:43], v[208:211]
    v_mfma_f32_16x16x32_bf16 v[212:215], a[156:159], a[44:47], v[212:215]
    s_nop 7
    buffer_load_dwordx4 a[144:147], v216, s[40:43], s84 offen offset:256
    buffer_load_dwordx4 a[148:151], v216, s[40:43], s85 offen offset:256
    buffer_load_dwordx4 a[152:155], v216, s[40:43], s84 offen offset:320
    buffer_load_dwordx4 a[156:159], v216, s[40:43], s85 offen offset:320
    s_waitcnt vmcnt(3)
    v_mfma_f32_16x16x32_bf16 v[192:195], a[144:147], a[48:51], v[192:195]
    v_mfma_f32_16x16x32_bf16 v[196:199], a[144:147], a[52:55], v[196:199]
    v_mfma_f32_16x16x32_bf16 v[200:203], a[144:147], a[56:59], v[200:203]
    s_waitcnt vmcnt(2)
    v_mfma_f32_16x16x32_bf16 v[204:207], a[148:151], a[48:51], v[204:207]
    v_mfma_f32_16x16x32_bf16 v[208:211], a[148:151], a[52:55], v[208:211]
    v_mfma_f32_16x16x32_bf16 v[212:215], a[148:151], a[56:59], v[212:215]
    s_waitcnt vmcnt(1)
    v_mfma_f32_16x16x32_bf16 v[192:195], a[152:155], a[60:63], v[192:195]
    v_mfma_f32_16x16x32_bf16 v[196:199], a[152:155], a[64:67], v[196:199]
    v_mfma_f32_16x16x32_bf16 v[200:203], a[152:155], a[68:71], v[200:203]
    s_waitcnt vmcnt(0)
    v_mfma_f32_16x16x32_bf16 v[204:207], a[156:159], a[60:63], v[204:207]
    v_mfma_f32_16x16x32_bf16 v[208:211], a[156:159], a[64:67], v[208:211]
    v_mfma_f32_16x16x32_bf16 v[212:215], a[156:159], a[68:71], v[212:215]
    s_nop 7
    buffer_load_dwordx4 a[144:147], v216, s[40:43], s84 offen offset:384
    buffer_load_dwordx4 a[148:151], v216, s[40:43], s85 offen offset:384
    buffer_load_dwordx4 a[152:155], v216, s[40:43], s84 offen offset:448
    buffer_load_dwordx4 a[156:159], v216, s[40:43], s85 offen offset:448
    s_waitcnt vmcnt(3)
    v_mfma_f32_16x16x32_bf16 v[192:195], a[144:147], a[72:75], v[192:195]
    v_mfma_f32_16x16x32_bf16 v[196:199], a[144:147], a[76:79], v[196:199]
    v_mfma_f32_16x16x32_bf16 v[200:203], a[144:147], a[80:83], v[200:203]
    s_waitcnt vmcnt(2)
    v_mfma_f32_16x16x32_bf16 v[204:207], a[148:151], a[72:75], v[204:207]
    v_mfma_f32_16x16x32_bf16 v[208:211], a[148:151], a[76:79], v[208:211]
    v_mfma_f32_16x16x32_bf16 v[212:215], a[148:151], a[80:83], v[212:215]
    s_waitcnt vmcnt(1)
    v_mfma_f32_16x16x32_bf16 v[192:195], a[152:155], a[84:87], v[192:195]
    v_mfma_f32_16x16x32_bf16 v[196:199], a[152:155], a[88:91], v[196:199]
    v_mfma_f32_16x16x32_bf16 v[200:203], a[152:155], a[92:95], v[200:203]
    s_waitcnt vmcnt(0)
    v_mfma_f32_16x16x32_bf16 v[204:207], a[156:159], a[84:87], v[204:207]
    v_mfma_f32_16x16x32_bf16 v[208:211], a[156:159], a[88:91], v[208:211]
    v_mfma_f32_16x16x32_bf16 v[212:215], a[156:159], a[92:95], v[212:215]
    s_nop 7
    v_exp_f32 v192, v192
    v_exp_f32 v193, v193
    v_exp_f32 v194, v194
    v_exp_f32 v195, v195
    v_exp_f32 v204, v204
    v_cvt_pk_bf16_f32 v120, v192, v193
    v_cvt_pk_bf16_f32 v121, v194, v195
    v_exp_f32 v205, v205
    v_add_f32 v252, v252, v192
    v_add_f32 v252, v252, v193
    v_exp_f32 v206, v206
    v_add_f32 v252, v252, v194
    v_add_f32 v252, v252, v195
    v_exp_f32 v207, v207
    v_exp_f32 v196, v196
    v_cvt_pk_bf16_f32 v122, v204, v205
    v_cvt_pk_bf16_f32 v123, v206, v207
    v_exp_f32 v197, v197
    v_add_f32 v252, v252, v204
    v_add_f32 v252, v252, v205
    v_exp_f32 v198, v198
    v_add_f32 v252, v252, v206
    v_add_f32 v252, v252, v207
    v_exp_f32 v199, v199
    v_exp_f32 v208, v208
    v_cvt_pk_bf16_f32 v124, v196, v197
    v_cvt_pk_bf16_f32 v125, v198, v199
    v_exp_f32 v209, v209
    v_add_f32 v253, v253, v196
    v_add_f32 v253, v253, v197
    v_exp_f32 v210, v210
    v_add_f32 v253, v253, v198
    v_add_f32 v253, v253, v199
    v_exp_f32 v211, v211
    v_exp_f32 v200, v200
    v_cvt_pk_bf16_f32 v126, v208, v209
    v_cvt_pk_bf16_f32 v127, v210, v211
    v_exp_f32 v201, v201
    v_add_f32 v253, v253, v208
    v_add_f32 v253, v253, v209
    v_exp_f32 v202, v202
    v_add_f32 v253, v253, v210
    v_add_f32 v253, v253, v211
    v_exp_f32 v203, v203
    v_exp_f32 v212, v212
    v_cvt_pk_bf16_f32 v128, v200, v201
    v_cvt_pk_bf16_f32 v129, v202, v203
    v_exp_f32 v213, v213
    v_add_f32 v254, v254, v200
    v_add_f32 v254, v254, v201
    v_exp_f32 v214, v214
    v_add_f32 v254, v254, v202
    v_add_f32 v254, v254, v203
    v_exp_f32 v215, v215
    v_cvt_pk_bf16_f32 v130, v212, v213
    v_cvt_pk_bf16_f32 v131, v214, v215
    v_add_f32 v254, v254, v212
    v_add_f32 v254, v254, v213
    v_add_f32 v254, v254, v214
    v_add_f32 v254, v254, v215
    s_mov_b32 s84, 180224
    s_mov_b32 s85, 188416
    buffer_load_dwordx4 a[144:147], v216, s[40:43], s84 offen
    buffer_load_dwordx4 a[148:151], v216, s[40:43], s85 offen
    buffer_load_dwordx4 a[152:155], v216, s[40:43], s84 offen offset:64
    buffer_load_dwordx4 a[156:159], v216, s[40:43], s85 offen offset:64
    s_waitcnt vmcnt(3)
    v_mfma_f32_16x16x32_bf16 v[192:195], a[144:147], a[0:3], v[228:231]
    v_mfma_f32_16x16x32_bf16 v[196:199], a[144:147], a[4:7], v[232:235]
    v_mfma_f32_16x16x32_bf16 v[200:203], a[144:147], a[8:11], v[236:239]
    s_waitcnt vmcnt(2)
    v_mfma_f32_16x16x32_bf16 v[204:207], a[148:151], a[0:3], v[228:231]
    v_mfma_f32_16x16x32_bf16 v[208:211], a[148:151], a[4:7], v[232:235]
    v_mfma_f32_16x16x32_bf16 v[212:215], a[148:151], a[8:11], v[236:239]
    s_waitcnt vmcnt(1)
    v_mfma_f32_16x16x32_bf16 v[192:195], a[152:155], a[12:15], v[192:195]
    v_mfma_f32_16x16x32_bf16 v[196:199], a[152:155], a[16:19], v[196:199]
    v_mfma_f32_16x16x32_bf16 v[200:203], a[152:155], a[20:23], v[200:203]
    s_waitcnt vmcnt(0)
    v_mfma_f32_16x16x32_bf16 v[204:207], a[156:159], a[12:15], v[204:207]
    v_mfma_f32_16x16x32_bf16 v[208:211], a[156:159], a[16:19], v[208:211]
    v_mfma_f32_16x16x32_bf16 v[212:215], a[156:159], a[20:23], v[212:215]
    s_nop 7
    buffer_load_dwordx4 a[144:147], v216, s[40:43], s84 offen offset:128
    buffer_load_dwordx4 a[148:151], v216, s[40:43], s85 offen offset:128
    buffer_load_dwordx4 a[152:155], v216, s[40:43], s84 offen offset:192
    buffer_load_dwordx4 a[156:159], v216, s[40:43], s85 offen offset:192
    s_waitcnt vmcnt(3)
    v_mfma_f32_16x16x32_bf16 v[192:195], a[144:147], a[24:27], v[192:195]
    v_mfma_f32_16x16x32_bf16 v[196:199], a[144:147], a[28:31], v[196:199]
    v_mfma_f32_16x16x32_bf16 v[200:203], a[144:147], a[32:35], v[200:203]
    s_waitcnt vmcnt(2)
    v_mfma_f32_16x16x32_bf16 v[204:207], a[148:151], a[24:27], v[204:207]
    v_mfma_f32_16x16x32_bf16 v[208:211], a[148:151], a[28:31], v[208:211]
    v_mfma_f32_16x16x32_bf16 v[212:215], a[148:151], a[32:35], v[212:215]
    s_waitcnt vmcnt(1)
    v_mfma_f32_16x16x32_bf16 v[192:195], a[152:155], a[36:39], v[192:195]
    v_mfma_f32_16x16x32_bf16 v[196:199], a[152:155], a[40:43], v[196:199]
    v_mfma_f32_16x16x32_bf16 v[200:203], a[152:155], a[44:47], v[200:203]
    s_waitcnt vmcnt(0)
    v_mfma_f32_16x16x32_bf16 v[204:207], a[156:159], a[36:39], v[204:207]
    v_mfma_f32_16x16x32_bf16 v[208:211], a[156:159], a[40:43], v[208:211]
    v_mfma_f32_16x16x32_bf16 v[212:215], a[156:159], a[44:47], v[212:215]
    s_nop 7
    buffer_load_dwordx4 a[144:147], v216, s[40:43], s84 offen offset:256
    buffer_load_dwordx4 a[148:151], v216, s[40:43], s85 offen offset:256
    buffer_load_dwordx4 a[152:155], v216, s[40:43], s84 offen offset:320
    buffer_load_dwordx4 a[156:159], v216, s[40:43], s85 offen offset:320
    s_waitcnt vmcnt(3)
    v_mfma_f32_16x16x32_bf16 v[192:195], a[144:147], a[48:51], v[192:195]
    v_mfma_f32_16x16x32_bf16 v[196:199], a[144:147], a[52:55], v[196:199]
    v_mfma_f32_16x16x32_bf16 v[200:203], a[144:147], a[56:59], v[200:203]
    s_waitcnt vmcnt(2)
    v_mfma_f32_16x16x32_bf16 v[204:207], a[148:151], a[48:51], v[204:207]
    v_mfma_f32_16x16x32_bf16 v[208:211], a[148:151], a[52:55], v[208:211]
    v_mfma_f32_16x16x32_bf16 v[212:215], a[148:151], a[56:59], v[212:215]
    s_waitcnt vmcnt(1)
    v_mfma_f32_16x16x32_bf16 v[192:195], a[152:155], a[60:63], v[192:195]
    v_mfma_f32_16x16x32_bf16 v[196:199], a[152:155], a[64:67], v[196:199]
    v_mfma_f32_16x16x32_bf16 v[200:203], a[152:155], a[68:71], v[200:203]
    s_waitcnt vmcnt(0)
    v_mfma_f32_16x16x32_bf16 v[204:207], a[156:159], a[60:63], v[204:207]
    v_mfma_f32_16x16x32_bf16 v[208:211], a[156:159], a[64:67], v[208:211]
    v_mfma_f32_16x16x32_bf16 v[212:215], a[156:159], a[68:71], v[212:215]
    s_nop 7
    buffer_load_dwordx4 a[144:147], v216, s[40:43], s84 offen offset:384
    buffer_load_dwordx4 a[148:151], v216, s[40:43], s85 offen offset:384
    buffer_load_dwordx4 a[152:155], v216, s[40:43], s84 offen offset:448
    buffer_load_dwordx4 a[156:159], v216, s[40:43], s85 offen offset:448
    s_waitcnt vmcnt(3)
    v_mfma_f32_16x16x32_bf16 v[192:195], a[144:147], a[72:75], v[192:195]
    v_mfma_f32_16x16x32_bf16 v[196:199], a[144:147], a[76:79], v[196:199]
    v_mfma_f32_16x16x32_bf16 v[200:203], a[144:147], a[80:83], v[200:203]
    s_waitcnt vmcnt(2)
    v_mfma_f32_16x16x32_bf16 v[204:207], a[148:151], a[72:75], v[204:207]
    v_mfma_f32_16x16x32_bf16 v[208:211], a[148:151], a[76:79], v[208:211]
    v_mfma_f32_16x16x32_bf16 v[212:215], a[148:151], a[80:83], v[212:215]
    s_waitcnt vmcnt(1)
    v_mfma_f32_16x16x32_bf16 v[192:195], a[152:155], a[84:87], v[192:195]
    v_mfma_f32_16x16x32_bf16 v[196:199], a[152:155], a[88:91], v[196:199]
    v_mfma_f32_16x16x32_bf16 v[200:203], a[152:155], a[92:95], v[200:203]
    s_waitcnt vmcnt(0)
    v_mfma_f32_16x16x32_bf16 v[204:207], a[156:159], a[84:87], v[204:207]
    v_mfma_f32_16x16x32_bf16 v[208:211], a[156:159], a[88:91], v[208:211]
    v_mfma_f32_16x16x32_bf16 v[212:215], a[156:159], a[92:95], v[212:215]
    s_nop 7
    v_exp_f32 v192, v192
    v_exp_f32 v193, v193
    v_exp_f32 v194, v194
    v_exp_f32 v195, v195
    v_exp_f32 v204, v204
    v_cvt_pk_bf16_f32 v132, v192, v193
    v_cvt_pk_bf16_f32 v133, v194, v195
    v_exp_f32 v205, v205
    v_add_f32 v252, v252, v192
    v_add_f32 v252, v252, v193
    v_exp_f32 v206, v206
    v_add_f32 v252, v252, v194
    v_add_f32 v252, v252, v195
    v_exp_f32 v207, v207
    v_exp_f32 v196, v196
    v_cvt_pk_bf16_f32 v134, v204, v205
    v_cvt_pk_bf16_f32 v135, v206, v207
    v_exp_f32 v197, v197
    v_add_f32 v252, v252, v204
    v_add_f32 v252, v252, v205
    v_exp_f32 v198, v198
    v_add_f32 v252, v252, v206
    v_add_f32 v252, v252, v207
    v_exp_f32 v199, v199
    v_exp_f32 v208, v208
    v_cvt_pk_bf16_f32 v136, v196, v197
    v_cvt_pk_bf16_f32 v137, v198, v199
    v_exp_f32 v209, v209
    v_add_f32 v253, v253, v196
    v_add_f32 v253, v253, v197
    v_exp_f32 v210, v210
    v_add_f32 v253, v253, v198
    v_add_f32 v253, v253, v199
    v_exp_f32 v211, v211
    v_exp_f32 v200, v200
    v_cvt_pk_bf16_f32 v138, v208, v209
    v_cvt_pk_bf16_f32 v139, v210, v211
    v_exp_f32 v201, v201
    v_add_f32 v253, v253, v208
    v_add_f32 v253, v253, v209
    v_exp_f32 v202, v202
    v_add_f32 v253, v253, v210
    v_add_f32 v253, v253, v211
    v_exp_f32 v203, v203
    v_exp_f32 v212, v212
    v_cvt_pk_bf16_f32 v140, v200, v201
    v_cvt_pk_bf16_f32 v141, v202, v203
    v_exp_f32 v213, v213
    v_add_f32 v254, v254, v200
    v_add_f32 v254, v254, v201
    v_exp_f32 v214, v214
    v_add_f32 v254, v254, v202
    v_add_f32 v254, v254, v203
    v_exp_f32 v215, v215
    v_cvt_pk_bf16_f32 v142, v212, v213
    v_cvt_pk_bf16_f32 v143, v214, v215
    v_add_f32 v254, v254, v212
    v_add_f32 v254, v254, v213
    v_add_f32 v254, v254, v214
    v_add_f32 v254, v254, v215
    s_mov_b32 s84, 196608
    s_mov_b32 s85, 204800
    buffer_load_dwordx4 a[144:147], v216, s[40:43], s84 offen
    buffer_load_dwordx4 a[148:151], v216, s[40:43], s85 offen
    buffer_load_dwordx4 a[152:155], v216, s[40:43], s84 offen offset:64
    buffer_load_dwordx4 a[156:159], v216, s[40:43], s85 offen offset:64
    s_waitcnt vmcnt(3)
    v_mfma_f32_16x16x32_bf16 v[192:195], a[144:147], a[0:3], v[228:231]
    v_mfma_f32_16x16x32_bf16 v[196:199], a[144:147], a[4:7], v[232:235]
    v_mfma_f32_16x16x32_bf16 v[200:203], a[144:147], a[8:11], v[236:239]
    s_waitcnt vmcnt(2)
    v_mfma_f32_16x16x32_bf16 v[204:207], a[148:151], a[0:3], v[228:231]
    v_mfma_f32_16x16x32_bf16 v[208:211], a[148:151], a[4:7], v[232:235]
    v_mfma_f32_16x16x32_bf16 v[212:215], a[148:151], a[8:11], v[236:239]
    s_waitcnt vmcnt(1)
    v_mfma_f32_16x16x32_bf16 v[192:195], a[152:155], a[12:15], v[192:195]
    v_mfma_f32_16x16x32_bf16 v[196:199], a[152:155], a[16:19], v[196:199]
    v_mfma_f32_16x16x32_bf16 v[200:203], a[152:155], a[20:23], v[200:203]
    s_waitcnt vmcnt(0)
    v_mfma_f32_16x16x32_bf16 v[204:207], a[156:159], a[12:15], v[204:207]
    v_mfma_f32_16x16x32_bf16 v[208:211], a[156:159], a[16:19], v[208:211]
    v_mfma_f32_16x16x32_bf16 v[212:215], a[156:159], a[20:23], v[212:215]
    s_nop 7
    buffer_load_dwordx4 a[144:147], v216, s[40:43], s84 offen offset:128
    buffer_load_dwordx4 a[148:151], v216, s[40:43], s85 offen offset:128
    buffer_load_dwordx4 a[152:155], v216, s[40:43], s84 offen offset:192
    buffer_load_dwordx4 a[156:159], v216, s[40:43], s85 offen offset:192
    s_waitcnt vmcnt(3)
    v_mfma_f32_16x16x32_bf16 v[192:195], a[144:147], a[24:27], v[192:195]
    v_mfma_f32_16x16x32_bf16 v[196:199], a[144:147], a[28:31], v[196:199]
    v_mfma_f32_16x16x32_bf16 v[200:203], a[144:147], a[32:35], v[200:203]
    s_waitcnt vmcnt(2)
    v_mfma_f32_16x16x32_bf16 v[204:207], a[148:151], a[24:27], v[204:207]
    v_mfma_f32_16x16x32_bf16 v[208:211], a[148:151], a[28:31], v[208:211]
    v_mfma_f32_16x16x32_bf16 v[212:215], a[148:151], a[32:35], v[212:215]
    s_waitcnt vmcnt(1)
    v_mfma_f32_16x16x32_bf16 v[192:195], a[152:155], a[36:39], v[192:195]
    v_mfma_f32_16x16x32_bf16 v[196:199], a[152:155], a[40:43], v[196:199]
    v_mfma_f32_16x16x32_bf16 v[200:203], a[152:155], a[44:47], v[200:203]
    s_waitcnt vmcnt(0)
    v_mfma_f32_16x16x32_bf16 v[204:207], a[156:159], a[36:39], v[204:207]
    v_mfma_f32_16x16x32_bf16 v[208:211], a[156:159], a[40:43], v[208:211]
    v_mfma_f32_16x16x32_bf16 v[212:215], a[156:159], a[44:47], v[212:215]
    s_nop 7
    buffer_load_dwordx4 a[144:147], v216, s[40:43], s84 offen offset:256
    buffer_load_dwordx4 a[148:151], v216, s[40:43], s85 offen offset:256
    buffer_load_dwordx4 a[152:155], v216, s[40:43], s84 offen offset:320
    buffer_load_dwordx4 a[156:159], v216, s[40:43], s85 offen offset:320
    s_waitcnt vmcnt(3)
    v_mfma_f32_16x16x32_bf16 v[192:195], a[144:147], a[48:51], v[192:195]
    v_mfma_f32_16x16x32_bf16 v[196:199], a[144:147], a[52:55], v[196:199]
    v_mfma_f32_16x16x32_bf16 v[200:203], a[144:147], a[56:59], v[200:203]
    s_waitcnt vmcnt(2)
    v_mfma_f32_16x16x32_bf16 v[204:207], a[148:151], a[48:51], v[204:207]
    v_mfma_f32_16x16x32_bf16 v[208:211], a[148:151], a[52:55], v[208:211]
    v_mfma_f32_16x16x32_bf16 v[212:215], a[148:151], a[56:59], v[212:215]
    s_waitcnt vmcnt(1)
    v_mfma_f32_16x16x32_bf16 v[192:195], a[152:155], a[60:63], v[192:195]
    v_mfma_f32_16x16x32_bf16 v[196:199], a[152:155], a[64:67], v[196:199]
    v_mfma_f32_16x16x32_bf16 v[200:203], a[152:155], a[68:71], v[200:203]
    s_waitcnt vmcnt(0)
    v_mfma_f32_16x16x32_bf16 v[204:207], a[156:159], a[60:63], v[204:207]
    v_mfma_f32_16x16x32_bf16 v[208:211], a[156:159], a[64:67], v[208:211]
    v_mfma_f32_16x16x32_bf16 v[212:215], a[156:159], a[68:71], v[212:215]
    s_nop 7
    buffer_load_dwordx4 a[144:147], v216, s[40:43], s84 offen offset:384
    buffer_load_dwordx4 a[148:151], v216, s[40:43], s85 offen offset:384
    buffer_load_dwordx4 a[152:155], v216, s[40:43], s84 offen offset:448
    buffer_load_dwordx4 a[156:159], v216, s[40:43], s85 offen offset:448
    s_waitcnt vmcnt(3)
    v_mfma_f32_16x16x32_bf16 v[192:195], a[144:147], a[72:75], v[192:195]
    v_mfma_f32_16x16x32_bf16 v[196:199], a[144:147], a[76:79], v[196:199]
    v_mfma_f32_16x16x32_bf16 v[200:203], a[144:147], a[80:83], v[200:203]
    s_waitcnt vmcnt(2)
    v_mfma_f32_16x16x32_bf16 v[204:207], a[148:151], a[72:75], v[204:207]
    v_mfma_f32_16x16x32_bf16 v[208:211], a[148:151], a[76:79], v[208:211]
    v_mfma_f32_16x16x32_bf16 v[212:215], a[148:151], a[80:83], v[212:215]
    s_waitcnt vmcnt(1)
    v_mfma_f32_16x16x32_bf16 v[192:195], a[152:155], a[84:87], v[192:195]
    v_mfma_f32_16x16x32_bf16 v[196:199], a[152:155], a[88:91], v[196:199]
    v_mfma_f32_16x16x32_bf16 v[200:203], a[152:155], a[92:95], v[200:203]
    s_waitcnt vmcnt(0)
    v_mfma_f32_16x16x32_bf16 v[204:207], a[156:159], a[84:87], v[204:207]
    v_mfma_f32_16x16x32_bf16 v[208:211], a[156:159], a[88:91], v[208:211]
    v_mfma_f32_16x16x32_bf16 v[212:215], a[156:159], a[92:95], v[212:215]
    s_nop 7
    v_exp_f32 v192, v192
    v_exp_f32 v193, v193
    v_exp_f32 v194, v194
    v_exp_f32 v195, v195
    v_exp_f32 v204, v204
    v_cvt_pk_bf16_f32 v144, v192, v193
    v_cvt_pk_bf16_f32 v145, v194, v195
    v_exp_f32 v205, v205
    v_add_f32 v252, v252, v192
    v_add_f32 v252, v252, v193
    v_exp_f32 v206, v206
    v_add_f32 v252, v252, v194
    v_add_f32 v252, v252, v195
    v_exp_f32 v207, v207
    v_exp_f32 v196, v196
    v_cvt_pk_bf16_f32 v146, v204, v205
    v_cvt_pk_bf16_f32 v147, v206, v207
    v_exp_f32 v197, v197
    v_add_f32 v252, v252, v204
    v_add_f32 v252, v252, v205
    v_exp_f32 v198, v198
    v_add_f32 v252, v252, v206
    v_add_f32 v252, v252, v207
    v_exp_f32 v199, v199
    v_exp_f32 v208, v208
    v_cvt_pk_bf16_f32 v148, v196, v197
    v_cvt_pk_bf16_f32 v149, v198, v199
    v_exp_f32 v209, v209
    v_add_f32 v253, v253, v196
    v_add_f32 v253, v253, v197
    v_exp_f32 v210, v210
    v_add_f32 v253, v253, v198
    v_add_f32 v253, v253, v199
    v_exp_f32 v211, v211
    v_exp_f32 v200, v200
    v_cvt_pk_bf16_f32 v150, v208, v209
    v_cvt_pk_bf16_f32 v151, v210, v211
    v_exp_f32 v201, v201
    v_add_f32 v253, v253, v208
    v_add_f32 v253, v253, v209
    v_exp_f32 v202, v202
    v_add_f32 v253, v253, v210
    v_add_f32 v253, v253, v211
    v_exp_f32 v203, v203
    v_exp_f32 v212, v212
    v_cvt_pk_bf16_f32 v152, v200, v201
    v_cvt_pk_bf16_f32 v153, v202, v203
    v_exp_f32 v213, v213
    v_add_f32 v254, v254, v200
    v_add_f32 v254, v254, v201
    v_exp_f32 v214, v214
    v_add_f32 v254, v254, v202
    v_add_f32 v254, v254, v203
    v_exp_f32 v215, v215
    v_cvt_pk_bf16_f32 v154, v212, v213
    v_cvt_pk_bf16_f32 v155, v214, v215
    v_add_f32 v254, v254, v212
    v_add_f32 v254, v254, v213
    v_add_f32 v254, v254, v214
    v_add_f32 v254, v254, v215
    s_mov_b32 s84, 212992
    s_mov_b32 s85, 221184
    buffer_load_dwordx4 a[144:147], v216, s[40:43], s84 offen
    buffer_load_dwordx4 a[148:151], v216, s[40:43], s85 offen
    buffer_load_dwordx4 a[152:155], v216, s[40:43], s84 offen offset:64
    buffer_load_dwordx4 a[156:159], v216, s[40:43], s85 offen offset:64
    s_waitcnt vmcnt(3)
    v_mfma_f32_16x16x32_bf16 v[192:195], a[144:147], a[0:3], v[228:231]
    v_mfma_f32_16x16x32_bf16 v[196:199], a[144:147], a[4:7], v[232:235]
    v_mfma_f32_16x16x32_bf16 v[200:203], a[144:147], a[8:11], v[236:239]
    s_waitcnt vmcnt(2)
    v_mfma_f32_16x16x32_bf16 v[204:207], a[148:151], a[0:3], v[228:231]
    v_mfma_f32_16x16x32_bf16 v[208:211], a[148:151], a[4:7], v[232:235]
    v_mfma_f32_16x16x32_bf16 v[212:215], a[148:151], a[8:11], v[236:239]
    s_waitcnt vmcnt(1)
    v_mfma_f32_16x16x32_bf16 v[192:195], a[152:155], a[12:15], v[192:195]
    v_mfma_f32_16x16x32_bf16 v[196:199], a[152:155], a[16:19], v[196:199]
    v_mfma_f32_16x16x32_bf16 v[200:203], a[152:155], a[20:23], v[200:203]
    s_waitcnt vmcnt(0)
    v_mfma_f32_16x16x32_bf16 v[204:207], a[156:159], a[12:15], v[204:207]
    v_mfma_f32_16x16x32_bf16 v[208:211], a[156:159], a[16:19], v[208:211]
    v_mfma_f32_16x16x32_bf16 v[212:215], a[156:159], a[20:23], v[212:215]
    s_nop 7
    buffer_load_dwordx4 a[144:147], v216, s[40:43], s84 offen offset:128
    buffer_load_dwordx4 a[148:151], v216, s[40:43], s85 offen offset:128
    buffer_load_dwordx4 a[152:155], v216, s[40:43], s84 offen offset:192
    buffer_load_dwordx4 a[156:159], v216, s[40:43], s85 offen offset:192
    s_waitcnt vmcnt(3)
    v_mfma_f32_16x16x32_bf16 v[192:195], a[144:147], a[24:27], v[192:195]
    v_mfma_f32_16x16x32_bf16 v[196:199], a[144:147], a[28:31], v[196:199]
    v_mfma_f32_16x16x32_bf16 v[200:203], a[144:147], a[32:35], v[200:203]
    s_waitcnt vmcnt(2)
    v_mfma_f32_16x16x32_bf16 v[204:207], a[148:151], a[24:27], v[204:207]
    v_mfma_f32_16x16x32_bf16 v[208:211], a[148:151], a[28:31], v[208:211]
    v_mfma_f32_16x16x32_bf16 v[212:215], a[148:151], a[32:35], v[212:215]
    s_waitcnt vmcnt(1)
    v_mfma_f32_16x16x32_bf16 v[192:195], a[152:155], a[36:39], v[192:195]
    v_mfma_f32_16x16x32_bf16 v[196:199], a[152:155], a[40:43], v[196:199]
    v_mfma_f32_16x16x32_bf16 v[200:203], a[152:155], a[44:47], v[200:203]
    s_waitcnt vmcnt(0)
    v_mfma_f32_16x16x32_bf16 v[204:207], a[156:159], a[36:39], v[204:207]
    v_mfma_f32_16x16x32_bf16 v[208:211], a[156:159], a[40:43], v[208:211]
    v_mfma_f32_16x16x32_bf16 v[212:215], a[156:159], a[44:47], v[212:215]
    s_nop 7
    buffer_load_dwordx4 a[144:147], v216, s[40:43], s84 offen offset:256
    buffer_load_dwordx4 a[148:151], v216, s[40:43], s85 offen offset:256
    buffer_load_dwordx4 a[152:155], v216, s[40:43], s84 offen offset:320
    buffer_load_dwordx4 a[156:159], v216, s[40:43], s85 offen offset:320
    s_waitcnt vmcnt(3)
    v_mfma_f32_16x16x32_bf16 v[192:195], a[144:147], a[48:51], v[192:195]
    v_mfma_f32_16x16x32_bf16 v[196:199], a[144:147], a[52:55], v[196:199]
    v_mfma_f32_16x16x32_bf16 v[200:203], a[144:147], a[56:59], v[200:203]
    s_waitcnt vmcnt(2)
    v_mfma_f32_16x16x32_bf16 v[204:207], a[148:151], a[48:51], v[204:207]
    v_mfma_f32_16x16x32_bf16 v[208:211], a[148:151], a[52:55], v[208:211]
    v_mfma_f32_16x16x32_bf16 v[212:215], a[148:151], a[56:59], v[212:215]
    s_waitcnt vmcnt(1)
    v_mfma_f32_16x16x32_bf16 v[192:195], a[152:155], a[60:63], v[192:195]
    v_mfma_f32_16x16x32_bf16 v[196:199], a[152:155], a[64:67], v[196:199]
    v_mfma_f32_16x16x32_bf16 v[200:203], a[152:155], a[68:71], v[200:203]
    s_waitcnt vmcnt(0)
    v_mfma_f32_16x16x32_bf16 v[204:207], a[156:159], a[60:63], v[204:207]
    v_mfma_f32_16x16x32_bf16 v[208:211], a[156:159], a[64:67], v[208:211]
    v_mfma_f32_16x16x32_bf16 v[212:215], a[156:159], a[68:71], v[212:215]
    s_nop 7
    buffer_load_dwordx4 a[144:147], v216, s[40:43], s84 offen offset:384
    buffer_load_dwordx4 a[148:151], v216, s[40:43], s85 offen offset:384
    buffer_load_dwordx4 a[152:155], v216, s[40:43], s84 offen offset:448
    buffer_load_dwordx4 a[156:159], v216, s[40:43], s85 offen offset:448
    s_waitcnt vmcnt(3)
    v_mfma_f32_16x16x32_bf16 v[192:195], a[144:147], a[72:75], v[192:195]
    v_mfma_f32_16x16x32_bf16 v[196:199], a[144:147], a[76:79], v[196:199]
    v_mfma_f32_16x16x32_bf16 v[200:203], a[144:147], a[80:83], v[200:203]
    s_waitcnt vmcnt(2)
    v_mfma_f32_16x16x32_bf16 v[204:207], a[148:151], a[72:75], v[204:207]
    v_mfma_f32_16x16x32_bf16 v[208:211], a[148:151], a[76:79], v[208:211]
    v_mfma_f32_16x16x32_bf16 v[212:215], a[148:151], a[80:83], v[212:215]
    s_waitcnt vmcnt(1)
    v_mfma_f32_16x16x32_bf16 v[192:195], a[152:155], a[84:87], v[192:195]
    v_mfma_f32_16x16x32_bf16 v[196:199], a[152:155], a[88:91], v[196:199]
    v_mfma_f32_16x16x32_bf16 v[200:203], a[152:155], a[92:95], v[200:203]
    s_waitcnt vmcnt(0)
    v_mfma_f32_16x16x32_bf16 v[204:207], a[156:159], a[84:87], v[204:207]
    v_mfma_f32_16x16x32_bf16 v[208:211], a[156:159], a[88:91], v[208:211]
    v_mfma_f32_16x16x32_bf16 v[212:215], a[156:159], a[92:95], v[212:215]
    s_nop 7
    v_exp_f32 v192, v192
    v_exp_f32 v193, v193
    v_exp_f32 v194, v194
    v_exp_f32 v195, v195
    v_exp_f32 v204, v204
    v_cvt_pk_bf16_f32 v156, v192, v193
    v_cvt_pk_bf16_f32 v157, v194, v195
    v_exp_f32 v205, v205
    v_add_f32 v252, v252, v192
    v_add_f32 v252, v252, v193
    v_exp_f32 v206, v206
    v_add_f32 v252, v252, v194
    v_add_f32 v252, v252, v195
    v_exp_f32 v207, v207
    v_exp_f32 v196, v196
    v_cvt_pk_bf16_f32 v158, v204, v205
    v_cvt_pk_bf16_f32 v159, v206, v207
    v_exp_f32 v197, v197
    v_add_f32 v252, v252, v204
    v_add_f32 v252, v252, v205
    v_exp_f32 v198, v198
    v_add_f32 v252, v252, v206
    v_add_f32 v252, v252, v207
    v_exp_f32 v199, v199
    v_exp_f32 v208, v208
    v_cvt_pk_bf16_f32 v160, v196, v197
    v_cvt_pk_bf16_f32 v161, v198, v199
    v_exp_f32 v209, v209
    v_add_f32 v253, v253, v196
    v_add_f32 v253, v253, v197
    v_exp_f32 v210, v210
    v_add_f32 v253, v253, v198
    v_add_f32 v253, v253, v199
    v_exp_f32 v211, v211
    v_exp_f32 v200, v200
    v_cvt_pk_bf16_f32 v162, v208, v209
    v_cvt_pk_bf16_f32 v163, v210, v211
    v_exp_f32 v201, v201
    v_add_f32 v253, v253, v208
    v_add_f32 v253, v253, v209
    v_exp_f32 v202, v202
    v_add_f32 v253, v253, v210
    v_add_f32 v253, v253, v211
    v_exp_f32 v203, v203
    v_exp_f32 v212, v212
    v_cvt_pk_bf16_f32 v164, v200, v201
    v_cvt_pk_bf16_f32 v165, v202, v203
    v_exp_f32 v213, v213
    v_add_f32 v254, v254, v200
    v_add_f32 v254, v254, v201
    v_exp_f32 v214, v214
    v_add_f32 v254, v254, v202
    v_add_f32 v254, v254, v203
    v_exp_f32 v215, v215
    v_cvt_pk_bf16_f32 v166, v212, v213
    v_cvt_pk_bf16_f32 v167, v214, v215
    v_add_f32 v254, v254, v212
    v_add_f32 v254, v254, v213
    v_add_f32 v254, v254, v214
    v_add_f32 v254, v254, v215
    s_mov_b32 s84, 229376
    s_mov_b32 s85, 237568
    buffer_load_dwordx4 a[144:147], v216, s[40:43], s84 offen
    buffer_load_dwordx4 a[148:151], v216, s[40:43], s85 offen
    buffer_load_dwordx4 a[152:155], v216, s[40:43], s84 offen offset:64
    buffer_load_dwordx4 a[156:159], v216, s[40:43], s85 offen offset:64
    s_waitcnt vmcnt(3)
    v_mfma_f32_16x16x32_bf16 v[192:195], a[144:147], a[0:3], v[228:231]
    v_mfma_f32_16x16x32_bf16 v[196:199], a[144:147], a[4:7], v[232:235]
    v_mfma_f32_16x16x32_bf16 v[200:203], a[144:147], a[8:11], v[236:239]
    s_waitcnt vmcnt(2)
    v_mfma_f32_16x16x32_bf16 v[204:207], a[148:151], a[0:3], v[228:231]
    v_mfma_f32_16x16x32_bf16 v[208:211], a[148:151], a[4:7], v[232:235]
    v_mfma_f32_16x16x32_bf16 v[212:215], a[148:151], a[8:11], v[236:239]
    s_waitcnt vmcnt(1)
    v_mfma_f32_16x16x32_bf16 v[192:195], a[152:155], a[12:15], v[192:195]
    v_mfma_f32_16x16x32_bf16 v[196:199], a[152:155], a[16:19], v[196:199]
    v_mfma_f32_16x16x32_bf16 v[200:203], a[152:155], a[20:23], v[200:203]
    s_waitcnt vmcnt(0)
    v_mfma_f32_16x16x32_bf16 v[204:207], a[156:159], a[12:15], v[204:207]
    v_mfma_f32_16x16x32_bf16 v[208:211], a[156:159], a[16:19], v[208:211]
    v_mfma_f32_16x16x32_bf16 v[212:215], a[156:159], a[20:23], v[212:215]
    s_nop 7
    buffer_load_dwordx4 a[144:147], v216, s[40:43], s84 offen offset:128
    buffer_load_dwordx4 a[148:151], v216, s[40:43], s85 offen offset:128
    buffer_load_dwordx4 a[152:155], v216, s[40:43], s84 offen offset:192
    buffer_load_dwordx4 a[156:159], v216, s[40:43], s85 offen offset:192
    s_waitcnt vmcnt(3)
    v_mfma_f32_16x16x32_bf16 v[192:195], a[144:147], a[24:27], v[192:195]
    v_mfma_f32_16x16x32_bf16 v[196:199], a[144:147], a[28:31], v[196:199]
    v_mfma_f32_16x16x32_bf16 v[200:203], a[144:147], a[32:35], v[200:203]
    s_waitcnt vmcnt(2)
    v_mfma_f32_16x16x32_bf16 v[204:207], a[148:151], a[24:27], v[204:207]
    v_mfma_f32_16x16x32_bf16 v[208:211], a[148:151], a[28:31], v[208:211]
    v_mfma_f32_16x16x32_bf16 v[212:215], a[148:151], a[32:35], v[212:215]
    s_waitcnt vmcnt(1)
    v_mfma_f32_16x16x32_bf16 v[192:195], a[152:155], a[36:39], v[192:195]
    v_mfma_f32_16x16x32_bf16 v[196:199], a[152:155], a[40:43], v[196:199]
    v_mfma_f32_16x16x32_bf16 v[200:203], a[152:155], a[44:47], v[200:203]
    s_waitcnt vmcnt(0)
    v_mfma_f32_16x16x32_bf16 v[204:207], a[156:159], a[36:39], v[204:207]
    v_mfma_f32_16x16x32_bf16 v[208:211], a[156:159], a[40:43], v[208:211]
    v_mfma_f32_16x16x32_bf16 v[212:215], a[156:159], a[44:47], v[212:215]
    s_nop 7
    buffer_load_dwordx4 a[144:147], v216, s[40:43], s84 offen offset:256
    buffer_load_dwordx4 a[148:151], v216, s[40:43], s85 offen offset:256
    buffer_load_dwordx4 a[152:155], v216, s[40:43], s84 offen offset:320
    buffer_load_dwordx4 a[156:159], v216, s[40:43], s85 offen offset:320
    s_waitcnt vmcnt(3)
    v_mfma_f32_16x16x32_bf16 v[192:195], a[144:147], a[48:51], v[192:195]
    v_mfma_f32_16x16x32_bf16 v[196:199], a[144:147], a[52:55], v[196:199]
    v_mfma_f32_16x16x32_bf16 v[200:203], a[144:147], a[56:59], v[200:203]
    s_waitcnt vmcnt(2)
    v_mfma_f32_16x16x32_bf16 v[204:207], a[148:151], a[48:51], v[204:207]
    v_mfma_f32_16x16x32_bf16 v[208:211], a[148:151], a[52:55], v[208:211]
    v_mfma_f32_16x16x32_bf16 v[212:215], a[148:151], a[56:59], v[212:215]
    s_waitcnt vmcnt(1)
    v_mfma_f32_16x16x32_bf16 v[192:195], a[152:155], a[60:63], v[192:195]
    v_mfma_f32_16x16x32_bf16 v[196:199], a[152:155], a[64:67], v[196:199]
    v_mfma_f32_16x16x32_bf16 v[200:203], a[152:155], a[68:71], v[200:203]
    s_waitcnt vmcnt(0)
    v_mfma_f32_16x16x32_bf16 v[204:207], a[156:159], a[60:63], v[204:207]
    v_mfma_f32_16x16x32_bf16 v[208:211], a[156:159], a[64:67], v[208:211]
    v_mfma_f32_16x16x32_bf16 v[212:215], a[156:159], a[68:71], v[212:215]
    s_nop 7
    buffer_load_dwordx4 a[144:147], v216, s[40:43], s84 offen offset:384
    buffer_load_dwordx4 a[148:151], v216, s[40:43], s85 offen offset:384
    buffer_load_dwordx4 a[152:155], v216, s[40:43], s84 offen offset:448
    buffer_load_dwordx4 a[156:159], v216, s[40:43], s85 offen offset:448
    s_waitcnt vmcnt(3)
    v_mfma_f32_16x16x32_bf16 v[192:195], a[144:147], a[72:75], v[192:195]
    v_mfma_f32_16x16x32_bf16 v[196:199], a[144:147], a[76:79], v[196:199]
    v_mfma_f32_16x16x32_bf16 v[200:203], a[144:147], a[80:83], v[200:203]
    s_waitcnt vmcnt(2)
    v_mfma_f32_16x16x32_bf16 v[204:207], a[148:151], a[72:75], v[204:207]
    v_mfma_f32_16x16x32_bf16 v[208:211], a[148:151], a[76:79], v[208:211]
    v_mfma_f32_16x16x32_bf16 v[212:215], a[148:151], a[80:83], v[212:215]
    s_waitcnt vmcnt(1)
    v_mfma_f32_16x16x32_bf16 v[192:195], a[152:155], a[84:87], v[192:195]
    v_mfma_f32_16x16x32_bf16 v[196:199], a[152:155], a[88:91], v[196:199]
    v_mfma_f32_16x16x32_bf16 v[200:203], a[152:155], a[92:95], v[200:203]
    s_waitcnt vmcnt(0)
    v_mfma_f32_16x16x32_bf16 v[204:207], a[156:159], a[84:87], v[204:207]
    v_mfma_f32_16x16x32_bf16 v[208:211], a[156:159], a[88:91], v[208:211]
    v_mfma_f32_16x16x32_bf16 v[212:215], a[156:159], a[92:95], v[212:215]
    s_nop 7
    v_exp_f32 v192, v192
    v_exp_f32 v193, v193
    v_exp_f32 v194, v194
    v_exp_f32 v195, v195
    v_exp_f32 v204, v204
    v_cvt_pk_bf16_f32 v168, v192, v193
    v_cvt_pk_bf16_f32 v169, v194, v195
    v_exp_f32 v205, v205
    v_add_f32 v252, v252, v192
    v_add_f32 v252, v252, v193
    v_exp_f32 v206, v206
    v_add_f32 v252, v252, v194
    v_add_f32 v252, v252, v195
    v_exp_f32 v207, v207
    v_exp_f32 v196, v196
    v_cvt_pk_bf16_f32 v170, v204, v205
    v_cvt_pk_bf16_f32 v171, v206, v207
    v_exp_f32 v197, v197
    v_add_f32 v252, v252, v204
    v_add_f32 v252, v252, v205
    v_exp_f32 v198, v198
    v_add_f32 v252, v252, v206
    v_add_f32 v252, v252, v207
    v_exp_f32 v199, v199
    v_exp_f32 v208, v208
    v_cvt_pk_bf16_f32 v172, v196, v197
    v_cvt_pk_bf16_f32 v173, v198, v199
    v_exp_f32 v209, v209
    v_add_f32 v253, v253, v196
    v_add_f32 v253, v253, v197
    v_exp_f32 v210, v210
    v_add_f32 v253, v253, v198
    v_add_f32 v253, v253, v199
    v_exp_f32 v211, v211
    v_exp_f32 v200, v200
    v_cvt_pk_bf16_f32 v174, v208, v209
    v_cvt_pk_bf16_f32 v175, v210, v211
    v_exp_f32 v201, v201
    v_add_f32 v253, v253, v208
    v_add_f32 v253, v253, v209
    v_exp_f32 v202, v202
    v_add_f32 v253, v253, v210
    v_add_f32 v253, v253, v211
    v_exp_f32 v203, v203
    v_exp_f32 v212, v212
    v_cvt_pk_bf16_f32 v176, v200, v201
    v_cvt_pk_bf16_f32 v177, v202, v203
    v_exp_f32 v213, v213
    v_add_f32 v254, v254, v200
    v_add_f32 v254, v254, v201
    v_exp_f32 v214, v214
    v_add_f32 v254, v254, v202
    v_add_f32 v254, v254, v203
    v_exp_f32 v215, v215
    v_cvt_pk_bf16_f32 v178, v212, v213
    v_cvt_pk_bf16_f32 v179, v214, v215
    v_add_f32 v254, v254, v212
    v_add_f32 v254, v254, v213
    v_add_f32 v254, v254, v214
    v_add_f32 v254, v254, v215
    s_mov_b32 s84, 245760
    s_mov_b32 s85, 253952
    buffer_load_dwordx4 a[144:147], v216, s[40:43], s84 offen
    buffer_load_dwordx4 a[148:151], v216, s[40:43], s85 offen
    buffer_load_dwordx4 a[152:155], v216, s[40:43], s84 offen offset:64
    buffer_load_dwordx4 a[156:159], v216, s[40:43], s85 offen offset:64
    s_waitcnt vmcnt(3)
    v_mfma_f32_16x16x32_bf16 v[192:195], a[144:147], a[0:3], v[228:231]
    v_mfma_f32_16x16x32_bf16 v[196:199], a[144:147], a[4:7], v[232:235]
    v_mfma_f32_16x16x32_bf16 v[200:203], a[144:147], a[8:11], v[236:239]
    s_waitcnt vmcnt(2)
    v_mfma_f32_16x16x32_bf16 v[204:207], a[148:151], a[0:3], v[228:231]
    v_mfma_f32_16x16x32_bf16 v[208:211], a[148:151], a[4:7], v[232:235]
    v_mfma_f32_16x16x32_bf16 v[212:215], a[148:151], a[8:11], v[236:239]
    s_waitcnt vmcnt(1)
    v_mfma_f32_16x16x32_bf16 v[192:195], a[152:155], a[12:15], v[192:195]
    v_mfma_f32_16x16x32_bf16 v[196:199], a[152:155], a[16:19], v[196:199]
    v_mfma_f32_16x16x32_bf16 v[200:203], a[152:155], a[20:23], v[200:203]
    s_waitcnt vmcnt(0)
    v_mfma_f32_16x16x32_bf16 v[204:207], a[156:159], a[12:15], v[204:207]
    v_mfma_f32_16x16x32_bf16 v[208:211], a[156:159], a[16:19], v[208:211]
    v_mfma_f32_16x16x32_bf16 v[212:215], a[156:159], a[20:23], v[212:215]
    s_nop 7
    buffer_load_dwordx4 a[144:147], v216, s[40:43], s84 offen offset:128
    buffer_load_dwordx4 a[148:151], v216, s[40:43], s85 offen offset:128
    buffer_load_dwordx4 a[152:155], v216, s[40:43], s84 offen offset:192
    buffer_load_dwordx4 a[156:159], v216, s[40:43], s85 offen offset:192
    s_waitcnt vmcnt(3)
    v_mfma_f32_16x16x32_bf16 v[192:195], a[144:147], a[24:27], v[192:195]
    v_mfma_f32_16x16x32_bf16 v[196:199], a[144:147], a[28:31], v[196:199]
    v_mfma_f32_16x16x32_bf16 v[200:203], a[144:147], a[32:35], v[200:203]
    s_waitcnt vmcnt(2)
    v_mfma_f32_16x16x32_bf16 v[204:207], a[148:151], a[24:27], v[204:207]
    v_mfma_f32_16x16x32_bf16 v[208:211], a[148:151], a[28:31], v[208:211]
    v_mfma_f32_16x16x32_bf16 v[212:215], a[148:151], a[32:35], v[212:215]
    s_waitcnt vmcnt(1)
    v_mfma_f32_16x16x32_bf16 v[192:195], a[152:155], a[36:39], v[192:195]
    v_mfma_f32_16x16x32_bf16 v[196:199], a[152:155], a[40:43], v[196:199]
    v_mfma_f32_16x16x32_bf16 v[200:203], a[152:155], a[44:47], v[200:203]
    s_waitcnt vmcnt(0)
    v_mfma_f32_16x16x32_bf16 v[204:207], a[156:159], a[36:39], v[204:207]
    v_mfma_f32_16x16x32_bf16 v[208:211], a[156:159], a[40:43], v[208:211]
    v_mfma_f32_16x16x32_bf16 v[212:215], a[156:159], a[44:47], v[212:215]
    s_nop 7
    buffer_load_dwordx4 a[144:147], v216, s[40:43], s84 offen offset:256
    buffer_load_dwordx4 a[148:151], v216, s[40:43], s85 offen offset:256
    buffer_load_dwordx4 a[152:155], v216, s[40:43], s84 offen offset:320
    buffer_load_dwordx4 a[156:159], v216, s[40:43], s85 offen offset:320
    s_waitcnt vmcnt(3)
    v_mfma_f32_16x16x32_bf16 v[192:195], a[144:147], a[48:51], v[192:195]
    v_mfma_f32_16x16x32_bf16 v[196:199], a[144:147], a[52:55], v[196:199]
    v_mfma_f32_16x16x32_bf16 v[200:203], a[144:147], a[56:59], v[200:203]
    s_waitcnt vmcnt(2)
    v_mfma_f32_16x16x32_bf16 v[204:207], a[148:151], a[48:51], v[204:207]
    v_mfma_f32_16x16x32_bf16 v[208:211], a[148:151], a[52:55], v[208:211]
    v_mfma_f32_16x16x32_bf16 v[212:215], a[148:151], a[56:59], v[212:215]
    s_waitcnt vmcnt(1)
    v_mfma_f32_16x16x32_bf16 v[192:195], a[152:155], a[60:63], v[192:195]
    v_mfma_f32_16x16x32_bf16 v[196:199], a[152:155], a[64:67], v[196:199]
    v_mfma_f32_16x16x32_bf16 v[200:203], a[152:155], a[68:71], v[200:203]
    s_waitcnt vmcnt(0)
    v_mfma_f32_16x16x32_bf16 v[204:207], a[156:159], a[60:63], v[204:207]
    v_mfma_f32_16x16x32_bf16 v[208:211], a[156:159], a[64:67], v[208:211]
    v_mfma_f32_16x16x32_bf16 v[212:215], a[156:159], a[68:71], v[212:215]
    s_nop 7
    buffer_load_dwordx4 a[144:147], v216, s[40:43], s84 offen offset:384
    buffer_load_dwordx4 a[148:151], v216, s[40:43], s85 offen offset:384
    buffer_load_dwordx4 a[152:155], v216, s[40:43], s84 offen offset:448
    buffer_load_dwordx4 a[156:159], v216, s[40:43], s85 offen offset:448
    s_waitcnt vmcnt(3)
    v_mfma_f32_16x16x32_bf16 v[192:195], a[144:147], a[72:75], v[192:195]
    v_mfma_f32_16x16x32_bf16 v[196:199], a[144:147], a[76:79], v[196:199]
    v_mfma_f32_16x16x32_bf16 v[200:203], a[144:147], a[80:83], v[200:203]
    s_waitcnt vmcnt(2)
    v_mfma_f32_16x16x32_bf16 v[204:207], a[148:151], a[72:75], v[204:207]
    v_mfma_f32_16x16x32_bf16 v[208:211], a[148:151], a[76:79], v[208:211]
    v_mfma_f32_16x16x32_bf16 v[212:215], a[148:151], a[80:83], v[212:215]
    s_waitcnt vmcnt(1)
    v_mfma_f32_16x16x32_bf16 v[192:195], a[152:155], a[84:87], v[192:195]
    v_mfma_f32_16x16x32_bf16 v[196:199], a[152:155], a[88:91], v[196:199]
    v_mfma_f32_16x16x32_bf16 v[200:203], a[152:155], a[92:95], v[200:203]
    s_waitcnt vmcnt(0)
    v_mfma_f32_16x16x32_bf16 v[204:207], a[156:159], a[84:87], v[204:207]
    v_mfma_f32_16x16x32_bf16 v[208:211], a[156:159], a[88:91], v[208:211]
    v_mfma_f32_16x16x32_bf16 v[212:215], a[156:159], a[92:95], v[212:215]
    s_nop 7
    v_exp_f32 v192, v192
    v_exp_f32 v193, v193
    v_exp_f32 v194, v194
    v_exp_f32 v195, v195
    v_exp_f32 v204, v204
    v_cvt_pk_bf16_f32 v180, v192, v193
    v_cvt_pk_bf16_f32 v181, v194, v195
    v_exp_f32 v205, v205
    v_add_f32 v252, v252, v192
    v_add_f32 v252, v252, v193
    v_exp_f32 v206, v206
    v_add_f32 v252, v252, v194
    v_add_f32 v252, v252, v195
    v_exp_f32 v207, v207
    v_exp_f32 v196, v196
    v_cvt_pk_bf16_f32 v182, v204, v205
    v_cvt_pk_bf16_f32 v183, v206, v207
    v_exp_f32 v197, v197
    v_add_f32 v252, v252, v204
    v_add_f32 v252, v252, v205
    v_exp_f32 v198, v198
    v_add_f32 v252, v252, v206
    v_add_f32 v252, v252, v207
    v_exp_f32 v199, v199
    v_exp_f32 v208, v208
    v_cvt_pk_bf16_f32 v184, v196, v197
    v_cvt_pk_bf16_f32 v185, v198, v199
    v_exp_f32 v209, v209
    v_add_f32 v253, v253, v196
    v_add_f32 v253, v253, v197
    v_exp_f32 v210, v210
    v_add_f32 v253, v253, v198
    v_add_f32 v253, v253, v199
    v_exp_f32 v211, v211
    v_exp_f32 v200, v200
    v_cvt_pk_bf16_f32 v186, v208, v209
    v_cvt_pk_bf16_f32 v187, v210, v211
    v_exp_f32 v201, v201
    v_add_f32 v253, v253, v208
    v_add_f32 v253, v253, v209
    v_exp_f32 v202, v202
    v_add_f32 v253, v253, v210
    v_add_f32 v253, v253, v211
    v_exp_f32 v203, v203
    v_exp_f32 v212, v212
    v_cvt_pk_bf16_f32 v188, v200, v201
    v_cvt_pk_bf16_f32 v189, v202, v203
    v_exp_f32 v213, v213
    v_add_f32 v254, v254, v200
    v_add_f32 v254, v254, v201
    v_exp_f32 v214, v214
    v_add_f32 v254, v254, v202
    v_add_f32 v254, v254, v203
    v_exp_f32 v215, v215
    v_cvt_pk_bf16_f32 v190, v212, v213
    v_cvt_pk_bf16_f32 v191, v214, v215
    v_add_f32 v254, v254, v212
    v_add_f32 v254, v254, v213
    v_add_f32 v254, v254, v214
    v_add_f32 v254, v254, v215
    s_waitcnt vmcnt(0) lgkmcnt(0)
    s_nop 3
    s_branch L_fb_ret
.section .rodata,"a"
.p2align 6
.amdhsa_kernel standalone__mha_block_cached__near_ridge_kernel
  .amdhsa_next_free_vgpr 512
  .amdhsa_next_free_sgpr 102
  .amdhsa_accum_offset 256
  .amdhsa_group_segment_fixed_size 0
  .amdhsa_kernarg_size 64
  .amdhsa_user_sgpr_count 2
  .amdhsa_user_sgpr_kernarg_segment_ptr 1
  .amdhsa_system_sgpr_workgroup_id_x 1
.end_amdhsa_kernel
```
